```python
import torch

def _softmax(x, axis=-1):
    return torch.softmax(x, dim=axis)
def _gelu(x):
    return torch.nn.functional.gelu(x, approximate="tanh")
def _silu(x):
    return torch.nn.functional.silu(x)
def _sigmoid(x):
    return torch.sigmoid(x)
def _layernorm(x, axis=-1, eps=1e-5):
    m = x.mean(dim=axis, keepdim=True)
    v = x.var(dim=axis, keepdim=True, unbiased=False)
    return (x - m) / torch.sqrt(v + eps)
def _scatter_add(tgt, idx, src, axis=0):
    return tgt.clone().index_add_(axis, idx, src)
def _segment_sum(src, seg, n):
    out = torch.zeros((n,) + src.shape[1:], dtype=src.dtype)
    return out.index_add_(0, seg, src)
def _pad(x, pw):
    flat = tuple(v for pair in reversed(pw) for v in pair)
    return torch.nn.functional.pad(x, flat)

kernel_name = 'recurrent_scan__sliding_block__glu_gated_glu__prompt'

def setup_inputs():

    _w = (lambda a: (lambda t: t.to(torch.bfloat16) if t.is_floating_point() else t)(torch.as_tensor(a)))
    def _A_setup():
        B, S, D = 1, 2048, 576
        return {
            "x": _w((lambda *s: torch.randn(*s, dtype=torch.bfloat16) * 0.05)(B, S, D)),
            "wqkv": _w((lambda *s: torch.randn(*s, dtype=torch.bfloat16) * 0.05)(D, 3 * D)),
            "wo": _w((lambda *s: torch.randn(*s, dtype=torch.bfloat16) * 0.05)(D, D)),
        }
    _A_in = _A_setup()

    def _B_setup():
        B, S, D, F = 1, 2048, 576, 4608
        return {
            "x": _w((lambda *s: torch.randn(*s, dtype=torch.bfloat16) * 0.05)(B, S, D)),
            "w_gate": _w((lambda *s: torch.randn(*s, dtype=torch.bfloat16) * 0.05)(D, F)),
            "w_up": _w((lambda *s: torch.randn(*s, dtype=torch.bfloat16) * 0.05)(D, F)),
            "w_down": _w((lambda *s: torch.randn(*s, dtype=torch.bfloat16) * 0.05)(F, D)),
        }
    _B_in = _B_setup()

    return {
        "A_x": _A_in["x"],
        "A_wqkv": _A_in["wqkv"],
        "A_wo": _A_in["wo"],
        "B_x": _B_in["x"],
        "B_w_gate": _B_in["w_gate"],
        "B_w_up": _B_in["w_up"],
        "B_w_down": _B_in["w_down"],
    }

def reference(A_x, A_wqkv, A_wo, B_x, B_w_gate, B_w_up, B_w_down):
    def _A_ref(x, wqkv, wo):
        B, S, D = x.shape
        H = 32; Dh = D // H; W = 256
        qkv = (lambda x, *d: x.permute(*d))((x @ wqkv).reshape(B, S, 3, H, Dh), 2, 0, 3, 1, 4)
        q, k, v = qkv[0], qkv[1], qkv[2]
        scores = torch.einsum("bhqd,bhkd->bhqk", q, k) * (Dh ** -0.5)
        idx = torch.arange(S)
        mask = (idx[:, None] - idx[None, :] >= 0) & (idx[:, None] - idx[None, :] < W)
        scores = torch.where(mask[None, None], scores, -1e9)
        p = _softmax(scores, axis=-1)
        o = torch.einsum("bhqk,bhkd->bhqd", p, v)
        return (lambda x, *d: x.permute(*d))(o, 0, 2, 1, 3).reshape(B, S, D) @ wo

    def _B_ref(x, w_gate, w_up, w_down):
        g = torch.einsum("bsd,df->bsf", x, w_gate)
        u = torch.einsum("bsd,df->bsf", x, w_up)
        h = _sigmoid(g) * u
        return torch.einsum("bsf,fd->bsd", h, w_down)

    x = A_x
    xn = _layernorm(x, axis=-1)
    s = _A_ref(xn, A_wqkv, A_wo)
    g = _silu(_B_ref(xn, B_w_gate, B_w_up, B_w_down))
    return x + s * g
```

```asm
; @launch grid=(256,1,1) block=(512,1,1) lds=163840
.amdgcn_target "amdgcn-amd-amdhsa--gfx950"
.text
.globl recurrent_scan__sliding_block__glu_gated_glu__prompt_kernel
.p2align 8
.type recurrent_scan__sliding_block__glu_gated_glu__prompt_kernel,@function
recurrent_scan__sliding_block__glu_gated_glu__prompt_kernel:
    s_cmp_ge_u32 s2, 256
    s_cbranch_scc1 L_k1_end
    s_load_dwordx16 s[4:19], s[0:1], 0
    s_load_dwordx4 s[20:23], s[0:1], 64
    v_and_b32 v1, 63, v0
    v_lshlrev_b32 v2, 4, v1
    v_lshrrev_b32 v11, 6, v0
    s_nop 0
    v_readfirstlane_b32 s52, v11
    s_nop 0
    s_and_b32 s53, s52, 3
    s_lshr_b32 s54, s52, 2
    s_and_b32 s57, s2, 7
    s_lshr_b32 s58, s2, 3
    s_and_b32 s59, s57, 1
    s_lshl_b32 s59, s59, 3
    s_and_b32 s60, s58, 7
    s_add_u32 s55, s59, s60
    s_lshr_b32 s57, s57, 1
    s_lshr_b32 s58, s58, 3
    s_waitcnt lgkmcnt(0)
    s_mov_b32 s24, s4
    s_mov_b32 s25, s5
    s_mov_b32 s26, 2359296
    s_mov_b32 s27, 0x20000
    s_mov_b32 s36, s22
    s_mov_b32 s37, s23
    s_mov_b32 s38, 67108864
    s_mov_b32 s39, 0x20000
    s_mov_b32 s40, s20
    s_mov_b32 s41, s21
    s_mov_b32 s42, 256
    s_mov_b32 s43, 0x20000
    s_cmp_ge_u32 s58, 3
    s_cbranch_scc1 L_att
    s_mul_i32 s56, s57, 3
    s_add_u32 s56, s56, s58
    s_cmp_lt_u32 s52, 4
    s_cselect_b32 s28, s12, s14
    s_cselect_b32 s29, s13, s15
    s_mov_b32 s30, 5308416
    s_mov_b32 s31, 0x20000
    s_mov_b32 s32, s16
    s_mov_b32 s33, s17
    s_mov_b32 s34, 5308416
    s_mov_b32 s35, 0x20000
    v_lshrrev_b32 v11, 3, v1
    v_and_b32 v12, 7, v1
    v_lshrrev_b32 v13, 1, v11
    v_xor_b32 v12, v12, v13
    v_mul_u32_u24 v11, 1152, v11
    v_lshl_add_u32 v13, v12, 4, v11
    v_xor_b32 v12, 4, v12
    v_lshl_add_u32 v12, v12, 4, v11
    v_add_u32 v12, 8192, v12
    s_lshl_b32 s57, s55, 7
    s_lshl_b32 s58, s53, 5
    s_add_u32 s57, s57, s58
    s_lshl_b32 s58, s54, 4
    s_add_u32 s57, s57, s58
    s_mul_i32 s57, s57, 1152
    s_lshl_b32 s58, s53, 1
    s_add_u32 s59, s58, s54
    s_mul_i32 s69, s59, 18432
    s_add_u32 s69, s69, 16384
    s_xor_b32 s59, s59, 1
    s_mul_i32 s70, s59, 18432
    s_add_u32 s70, s70, 16384
    s_lshr_b32 s59, s2, 6
    s_lshl_b32 s59, s59, 8
    s_lshl_b32 s60, s59, 4
    s_add_u32 m0, s69, s60
    s_add_u32 s58, s57, s59
    buffer_load_dwordx4 v13, s[24:27], s58 offen lds
    buffer_load_dwordx4 v12, s[24:27], s58 offen offset:1024 lds
    s_add_u32 s59, s59, 128
    s_cmp_eq_u32 s59, 1152
    s_cselect_b32 s59, 0, s59
    s_lshl_b32 s60, s59, 4
    s_add_u32 m0, s69, s60
    s_add_u32 s58, s57, s59
    buffer_load_dwordx4 v13, s[24:27], s58 offen lds
    buffer_load_dwordx4 v12, s[24:27], s58 offen offset:1024 lds
    s_add_u32 s59, s59, 128
    s_cmp_eq_u32 s59, 1152
    s_cselect_b32 s59, 0, s59
    s_lshl_b32 s60, s59, 4
    s_add_u32 m0, s69, s60
    s_add_u32 s58, s57, s59
    buffer_load_dwordx4 v13, s[24:27], s58 offen lds
    buffer_load_dwordx4 v12, s[24:27], s58 offen offset:1024 lds
    s_add_u32 s59, s59, 128
    s_cmp_eq_u32 s59, 1152
    s_cselect_b32 s59, 0, s59
    s_lshl_b32 s60, s59, 4
    s_add_u32 m0, s69, s60
    s_add_u32 s58, s57, s59
    buffer_load_dwordx4 v13, s[24:27], s58 offen lds
    buffer_load_dwordx4 v12, s[24:27], s58 offen offset:1024 lds
    s_add_u32 s59, s59, 128
    s_cmp_eq_u32 s59, 1152
    s_cselect_b32 s59, 0, s59
    s_lshl_b32 s60, s59, 4
    s_add_u32 m0, s69, s60
    s_add_u32 s58, s57, s59
    buffer_load_dwordx4 v13, s[24:27], s58 offen lds
    buffer_load_dwordx4 v12, s[24:27], s58 offen offset:1024 lds
    s_add_u32 s59, s59, 128
    s_cmp_eq_u32 s59, 1152
    s_cselect_b32 s59, 0, s59
    s_lshl_b32 s60, s59, 4
    s_add_u32 m0, s69, s60
    s_add_u32 s58, s57, s59
    buffer_load_dwordx4 v13, s[24:27], s58 offen lds
    buffer_load_dwordx4 v12, s[24:27], s58 offen offset:1024 lds
    s_add_u32 s59, s59, 128
    s_cmp_eq_u32 s59, 1152
    s_cselect_b32 s59, 0, s59
    s_lshl_b32 s60, s59, 4
    s_add_u32 m0, s69, s60
    s_add_u32 s58, s57, s59
    buffer_load_dwordx4 v13, s[24:27], s58 offen lds
    buffer_load_dwordx4 v12, s[24:27], s58 offen offset:1024 lds
    s_add_u32 s59, s59, 128
    s_cmp_eq_u32 s59, 1152
    s_cselect_b32 s59, 0, s59
    s_lshl_b32 s60, s59, 4
    s_add_u32 m0, s69, s60
    s_add_u32 s58, s57, s59
    buffer_load_dwordx4 v13, s[24:27], s58 offen lds
    buffer_load_dwordx4 v12, s[24:27], s58 offen offset:1024 lds
    s_add_u32 s59, s59, 128
    s_cmp_eq_u32 s59, 1152
    s_cselect_b32 s59, 0, s59
    s_lshl_b32 s60, s59, 4
    s_add_u32 m0, s69, s60
    s_add_u32 s58, s57, s59
    buffer_load_dwordx4 v13, s[24:27], s58 offen lds
    buffer_load_dwordx4 v12, s[24:27], s58 offen offset:1024 lds
    v_bfe_u32 v14, v1, 2, 3
    v_and_b32 v15, 3, v1
    v_lshrrev_b32 v40, 5, v1
    v_lshlrev_b32 v40, 6, v40
    v_lshl_add_u32 v15, v15, 4, v40
    v_mul_u32_u24 v3, 9216, v14
    v_add_u32 v3, v3, v15
    v_mul_u32_u24 v4, 1152, v14
    v_add_u32 v4, v4, v15
    s_lshl_b32 s61, s52, 10
    s_mul_i32 s57, s56, 384
    s_mul_i32 s62, s53, 73728
    s_lshl_b32 s58, s57, 1
    s_add_u32 s62, s62, s58
    s_lshl_b32 s58, s52, 3
    s_add_u32 s58, s58, s57
    s_mul_i32 s63, s58, 1152
    s_and_b32 s57, s55, 7
    s_lshl_b32 s58, s57, 2
    s_add_u32 s58, s58, s53
    s_mul_i32 s58, s58, 18
    v_add_u32 v16, s58, v1
    v_mul_u32_u24 v16, 9216, v16
    v_cmp_gt_u32 vcc, 18, v1
    s_nop 1
    v_cndmask_b32 v8, -1, v16, vcc
    v_mul_u32_u24 v16, 86, v1
    v_lshrrev_b32 v16, 8, v16
    v_mul_u32_u24 v17, 3, v16
    v_sub_u32 v17, v1, v17
    s_lshl_b32 s58, s57, 3
    s_add_u32 s58, s58, s52
    s_mul_i32 s58, s58, 6
    v_add_u32 v16, s58, v16
    v_mul_u32_u24 v16, 1152, v16
    v_lshl_add_u32 v16, v17, 7, v16
    v_cndmask_b32 v9, -1, v16, vcc
    s_mov_b32 s48, s28
    s_mov_b32 s49, s29
    s_mov_b32 s50, s30
    s_mov_b32 s51, s31
    s_mul_i32 s65, s56, 768
    s_mov_b32 s98, 128
    s_add_u32 m0, s61, 0
    s_add_u32 s60, s62, 0
    buffer_load_dwordx4 v3, s[28:31], s60 offen lds
    s_add_u32 m0, s61, 8192
    s_add_u32 s60, s62, 294912
    buffer_load_dwordx4 v3, s[28:31], s60 offen lds
    buffer_load_dword v0, v8, s[48:51], s65 offen
    s_add_u32 s65, s65, s98
    v_lshrrev_b32 v12, 5, v1
    v_lshlrev_b32 v12, 8, v12
    v_bfe_u32 v13, v1, 2, 2
    v_lshl_add_u32 v12, v13, 6, v12
    v_bfe_u32 v13, v1, 4, 1
    v_lshl_add_u32 v12, v13, 5, v12
    v_and_b32 v13, 3, v1
    v_lshl_add_u32 v12, v13, 3, v12
    s_lshl_b32 s57, s54, 9
    v_add_u32 v5, s57, v12
    v_add_u32 v6, 49152, v5
    v_add_u32 v7, 98304, v5
    s_lshl_b32 s57, s56, 4
    s_add_u32 s57, s57, s55
    s_mul_i32 s57, s57, 98304
    s_lshl_b32 s59, s53, 10
    s_add_u32 s64, s57, s59
    s_mul_i32 s57, s56, 2359296
    s_mul_i32 s60, s55, 147456
    s_add_u32 s57, s57, s60
    s_lshl_b32 s60, s54, 13
    s_add_u32 s57, s57, s60
    s_add_u32 s57, s57, 18874368
    s_lshl_b32 s59, s53, 11
    s_add_u32 s66, s57, s59
    s_mov_b32 s68, 0xbfb8aa3b
    v_and_b32 v40, 15, v1
    v_lshrrev_b32 v41, 4, v1
    v_and_b32 v42, 1, v41
    v_lshlrev_b32 v42, 3, v42
    v_lshl_add_u32 v42, v40, 7, v42
    v_add_u32 v42, s69, v42
    v_lshrrev_b32 v43, 1, v40
    v_and_b32 v44, 2, v41
    v_xor_b32 v43, v43, v44
    v_xor_b32 v44, 0, v43
    v_lshl_add_u32 v48, v44, 4, v42
    v_xor_b32 v44, 1, v43
    v_lshl_add_u32 v49, v44, 4, v42
    v_xor_b32 v44, 4, v43
    v_lshl_add_u32 v50, v44, 4, v42
    v_xor_b32 v44, 5, v43
    v_lshl_add_u32 v51, v44, 4, v42
    v_mov_b32 v52, 0x3f803f80
    v_mov_b32 v53, 0x3f803f80
    v_mov_b32 v54, 0x3f803f80
    v_mov_b32 v55, 0x3f803f80
    s_waitcnt vmcnt(3)
    ds_read_b64 v[104:105], v48 offset:0
    ds_read_b64 v[106:107], v49 offset:0
    ds_read_b64 v[108:109], v50 offset:0
    ds_read_b64 v[110:111], v51 offset:0
    ds_read_b64 v[112:113], v48 offset:2048
    ds_read_b64 v[114:115], v49 offset:2048
    ds_read_b64 v[116:117], v50 offset:2048
    ds_read_b64 v[118:119], v51 offset:2048
    ds_read_b64 v[120:121], v48 offset:4096
    ds_read_b64 v[122:123], v49 offset:4096
    s_waitcnt lgkmcnt(8)
    v_mfma_f32_16x16x32_bf16 v[56:59], v[52:55], v[104:107], 0
    v_mfma_f32_16x16x32_bf16 v[60:63], v[104:107], v[104:107], 0
    ds_read_b64 v[124:125], v50 offset:4096
    ds_read_b64 v[126:127], v51 offset:4096
    s_waitcnt lgkmcnt(8)
    v_mfma_f32_16x16x32_bf16 v[56:59], v[52:55], v[108:111], v[56:59]
    v_mfma_f32_16x16x32_bf16 v[60:63], v[108:111], v[108:111], v[60:63]
    ds_read_b64 v[128:129], v48 offset:6144
    ds_read_b64 v[130:131], v49 offset:6144
    s_waitcnt lgkmcnt(8)
    v_mfma_f32_16x16x32_bf16 v[56:59], v[52:55], v[112:115], v[56:59]
    v_mfma_f32_16x16x32_bf16 v[60:63], v[112:115], v[112:115], v[60:63]
    ds_read_b64 v[132:133], v50 offset:6144
    ds_read_b64 v[134:135], v51 offset:6144
    s_waitcnt lgkmcnt(8)
    v_mfma_f32_16x16x32_bf16 v[56:59], v[52:55], v[116:119], v[56:59]
    v_mfma_f32_16x16x32_bf16 v[60:63], v[116:119], v[116:119], v[60:63]
    ds_read_b64 v[136:137], v48 offset:8192
    ds_read_b64 v[138:139], v49 offset:8192
    s_waitcnt lgkmcnt(8)
    v_mfma_f32_16x16x32_bf16 v[56:59], v[52:55], v[120:123], v[56:59]
    v_mfma_f32_16x16x32_bf16 v[60:63], v[120:123], v[120:123], v[60:63]
    ds_read_b64 v[140:141], v50 offset:8192
    ds_read_b64 v[142:143], v51 offset:8192
    s_waitcnt lgkmcnt(8)
    v_mfma_f32_16x16x32_bf16 v[56:59], v[52:55], v[124:127], v[56:59]
    v_mfma_f32_16x16x32_bf16 v[60:63], v[124:127], v[124:127], v[60:63]
    ds_read_b64 v[144:145], v48 offset:10240
    ds_read_b64 v[146:147], v49 offset:10240
    s_waitcnt lgkmcnt(8)
    v_mfma_f32_16x16x32_bf16 v[56:59], v[52:55], v[128:131], v[56:59]
    v_mfma_f32_16x16x32_bf16 v[60:63], v[128:131], v[128:131], v[60:63]
    ds_read_b64 v[148:149], v50 offset:10240
    ds_read_b64 v[150:151], v51 offset:10240
    s_waitcnt lgkmcnt(8)
    v_mfma_f32_16x16x32_bf16 v[56:59], v[52:55], v[132:135], v[56:59]
    v_mfma_f32_16x16x32_bf16 v[60:63], v[132:135], v[132:135], v[60:63]
    ds_read_b64 v[152:153], v48 offset:12288
    ds_read_b64 v[154:155], v49 offset:12288
    s_waitcnt lgkmcnt(8)
    v_mfma_f32_16x16x32_bf16 v[56:59], v[52:55], v[136:139], v[56:59]
    v_mfma_f32_16x16x32_bf16 v[60:63], v[136:139], v[136:139], v[60:63]
    ds_read_b64 v[156:157], v50 offset:12288
    ds_read_b64 v[158:159], v51 offset:12288
    s_waitcnt lgkmcnt(8)
    v_mfma_f32_16x16x32_bf16 v[56:59], v[52:55], v[140:143], v[56:59]
    v_mfma_f32_16x16x32_bf16 v[60:63], v[140:143], v[140:143], v[60:63]
    ds_read_b64 v[160:161], v48 offset:14336
    ds_read_b64 v[162:163], v49 offset:14336
    s_waitcnt lgkmcnt(8)
    v_mfma_f32_16x16x32_bf16 v[56:59], v[52:55], v[144:147], v[56:59]
    v_mfma_f32_16x16x32_bf16 v[60:63], v[144:147], v[144:147], v[60:63]
    ds_read_b64 v[164:165], v50 offset:14336
    ds_read_b64 v[166:167], v51 offset:14336
    s_waitcnt lgkmcnt(8)
    v_mfma_f32_16x16x32_bf16 v[56:59], v[52:55], v[148:151], v[56:59]
    v_mfma_f32_16x16x32_bf16 v[60:63], v[148:151], v[148:151], v[60:63]
    ds_read_b64 v[168:169], v48 offset:16384
    ds_read_b64 v[170:171], v49 offset:16384
    s_waitcnt lgkmcnt(8)
    v_mfma_f32_16x16x32_bf16 v[56:59], v[52:55], v[152:155], v[56:59]
    v_mfma_f32_16x16x32_bf16 v[60:63], v[152:155], v[152:155], v[60:63]
    ds_read_b64 v[172:173], v50 offset:16384
    ds_read_b64 v[174:175], v51 offset:16384
    s_waitcnt lgkmcnt(8)
    v_mfma_f32_16x16x32_bf16 v[56:59], v[52:55], v[156:159], v[56:59]
    v_mfma_f32_16x16x32_bf16 v[60:63], v[156:159], v[156:159], v[60:63]
    s_waitcnt lgkmcnt(6)
    v_mfma_f32_16x16x32_bf16 v[56:59], v[52:55], v[160:163], v[56:59]
    v_mfma_f32_16x16x32_bf16 v[60:63], v[160:163], v[160:163], v[60:63]
    s_waitcnt lgkmcnt(4)
    v_mfma_f32_16x16x32_bf16 v[56:59], v[52:55], v[164:167], v[56:59]
    v_mfma_f32_16x16x32_bf16 v[60:63], v[164:167], v[164:167], v[60:63]
    s_waitcnt lgkmcnt(2)
    v_mfma_f32_16x16x32_bf16 v[56:59], v[52:55], v[168:171], v[56:59]
    v_mfma_f32_16x16x32_bf16 v[60:63], v[168:171], v[168:171], v[60:63]
    s_waitcnt lgkmcnt(0)
    v_mfma_f32_16x16x32_bf16 v[56:59], v[52:55], v[172:175], v[56:59]
    v_mfma_f32_16x16x32_bf16 v[60:63], v[172:175], v[172:175], v[60:63]
    v_and_b32 v44, 3, v40
    v_cmp_eq_u32 vcc, 1, v44
    s_nop 5
    v_cndmask_b32 v60, v60, v61, vcc
    v_cmp_eq_u32 vcc, 2, v44
    s_nop 1
    v_cndmask_b32 v60, v60, v62, vcc
    v_cmp_eq_u32 vcc, 3, v44
    s_nop 1
    v_cndmask_b32 v60, v60, v63, vcc
    v_lshrrev_b32 v44, 2, v40
    v_lshl_add_u32 v44, v44, 4, v40
    v_lshlrev_b32 v44, 2, v44
    ds_bpermute_b32 v60, v44, v60
    v_mul_f32 v56, 0x3ae38e39, v56
    s_waitcnt lgkmcnt(0)
    v_mul_f32 v60, 0x3ae38e39, v60
    v_fma_f32 v60, -v56, v56, v60
    v_max_f32 v60, 0, v60
    v_cvt_pk_bf16_f32 v60, v60, v60
    v_lshlrev_b32 v60, 16, v60
    v_add_f32 v60, 0x3727c5ac, v60
    v_cvt_pk_bf16_f32 v60, v60, v60
    v_lshlrev_b32 v60, 16, v60
    v_sqrt_f32 v60, v60
    s_nop 0
    v_cvt_pk_bf16_f32 v60, v60, v60
    v_lshlrev_b32 v60, 16, v60
    v_rcp_f32 v60, v60
    v_cvt_pk_bf16_f32 v56, v56, v56
    v_lshlrev_b32 v56, 16, v56
    v_mul_f32 v56, v56, v60
    v_sub_f32 v56, 0, v56
    v_add_u32 v45, s69, v2
    v_lshlrev_b32 v64, 16, v104
    v_and_b32 v65, 0xffff0000, v104
    v_lshlrev_b32 v66, 16, v105
    v_and_b32 v67, 0xffff0000, v105
    v_lshlrev_b32 v68, 16, v106
    v_and_b32 v69, 0xffff0000, v106
    v_lshlrev_b32 v70, 16, v107
    v_and_b32 v71, 0xffff0000, v107
    v_fma_f32 v64, v64, v60, v56
    v_fma_f32 v65, v65, v60, v56
    v_fma_f32 v66, v66, v60, v56
    v_fma_f32 v67, v67, v60, v56
    v_fma_f32 v68, v68, v60, v56
    v_fma_f32 v69, v69, v60, v56
    v_fma_f32 v70, v70, v60, v56
    v_fma_f32 v71, v71, v60, v56
    v_cvt_pk_bf16_f32 v104, v64, v65
    v_cvt_pk_bf16_f32 v105, v66, v67
    v_cvt_pk_bf16_f32 v106, v68, v69
    v_cvt_pk_bf16_f32 v107, v70, v71
    ds_write_b128 v45, v[104:107] offset:0
    v_lshlrev_b32 v64, 16, v108
    v_and_b32 v65, 0xffff0000, v108
    v_lshlrev_b32 v66, 16, v109
    v_and_b32 v67, 0xffff0000, v109
    v_lshlrev_b32 v68, 16, v110
    v_and_b32 v69, 0xffff0000, v110
    v_lshlrev_b32 v70, 16, v111
    v_and_b32 v71, 0xffff0000, v111
    v_fma_f32 v64, v64, v60, v56
    v_fma_f32 v65, v65, v60, v56
    v_fma_f32 v66, v66, v60, v56
    v_fma_f32 v67, v67, v60, v56
    v_fma_f32 v68, v68, v60, v56
    v_fma_f32 v69, v69, v60, v56
    v_fma_f32 v70, v70, v60, v56
    v_fma_f32 v71, v71, v60, v56
    v_cvt_pk_bf16_f32 v108, v64, v65
    v_cvt_pk_bf16_f32 v109, v66, v67
    v_cvt_pk_bf16_f32 v110, v68, v69
    v_cvt_pk_bf16_f32 v111, v70, v71
    ds_write_b128 v45, v[108:111] offset:1024
    v_lshlrev_b32 v64, 16, v112
    v_and_b32 v65, 0xffff0000, v112
    v_lshlrev_b32 v66, 16, v113
    v_and_b32 v67, 0xffff0000, v113
    v_lshlrev_b32 v68, 16, v114
    v_and_b32 v69, 0xffff0000, v114
    v_lshlrev_b32 v70, 16, v115
    v_and_b32 v71, 0xffff0000, v115
    v_fma_f32 v64, v64, v60, v56
    v_fma_f32 v65, v65, v60, v56
    v_fma_f32 v66, v66, v60, v56
    v_fma_f32 v67, v67, v60, v56
    v_fma_f32 v68, v68, v60, v56
    v_fma_f32 v69, v69, v60, v56
    v_fma_f32 v70, v70, v60, v56
    v_fma_f32 v71, v71, v60, v56
    v_cvt_pk_bf16_f32 v112, v64, v65
    v_cvt_pk_bf16_f32 v113, v66, v67
    v_cvt_pk_bf16_f32 v114, v68, v69
    v_cvt_pk_bf16_f32 v115, v70, v71
    ds_write_b128 v45, v[112:115] offset:2048
    v_lshlrev_b32 v64, 16, v116
    v_and_b32 v65, 0xffff0000, v116
    v_lshlrev_b32 v66, 16, v117
    v_and_b32 v67, 0xffff0000, v117
    v_lshlrev_b32 v68, 16, v118
    v_and_b32 v69, 0xffff0000, v118
    v_lshlrev_b32 v70, 16, v119
    v_and_b32 v71, 0xffff0000, v119
    v_fma_f32 v64, v64, v60, v56
    v_fma_f32 v65, v65, v60, v56
    v_fma_f32 v66, v66, v60, v56
    v_fma_f32 v67, v67, v60, v56
    v_fma_f32 v68, v68, v60, v56
    v_fma_f32 v69, v69, v60, v56
    v_fma_f32 v70, v70, v60, v56
    v_fma_f32 v71, v71, v60, v56
    v_cvt_pk_bf16_f32 v116, v64, v65
    v_cvt_pk_bf16_f32 v117, v66, v67
    v_cvt_pk_bf16_f32 v118, v68, v69
    v_cvt_pk_bf16_f32 v119, v70, v71
    ds_write_b128 v45, v[116:119] offset:3072
    v_lshlrev_b32 v64, 16, v120
    v_and_b32 v65, 0xffff0000, v120
    v_lshlrev_b32 v66, 16, v121
    v_and_b32 v67, 0xffff0000, v121
    v_lshlrev_b32 v68, 16, v122
    v_and_b32 v69, 0xffff0000, v122
    v_lshlrev_b32 v70, 16, v123
    v_and_b32 v71, 0xffff0000, v123
    v_fma_f32 v64, v64, v60, v56
    v_fma_f32 v65, v65, v60, v56
    v_fma_f32 v66, v66, v60, v56
    v_fma_f32 v67, v67, v60, v56
    v_fma_f32 v68, v68, v60, v56
    v_fma_f32 v69, v69, v60, v56
    v_fma_f32 v70, v70, v60, v56
    v_fma_f32 v71, v71, v60, v56
    v_cvt_pk_bf16_f32 v120, v64, v65
    v_cvt_pk_bf16_f32 v121, v66, v67
    v_cvt_pk_bf16_f32 v122, v68, v69
    v_cvt_pk_bf16_f32 v123, v70, v71
    ds_write_b128 v45, v[120:123] offset:4096
    v_lshlrev_b32 v64, 16, v124
    v_and_b32 v65, 0xffff0000, v124
    v_lshlrev_b32 v66, 16, v125
    v_and_b32 v67, 0xffff0000, v125
    v_lshlrev_b32 v68, 16, v126
    v_and_b32 v69, 0xffff0000, v126
    v_lshlrev_b32 v70, 16, v127
    v_and_b32 v71, 0xffff0000, v127
    v_fma_f32 v64, v64, v60, v56
    v_fma_f32 v65, v65, v60, v56
    v_fma_f32 v66, v66, v60, v56
    v_fma_f32 v67, v67, v60, v56
    v_fma_f32 v68, v68, v60, v56
    v_fma_f32 v69, v69, v60, v56
    v_fma_f32 v70, v70, v60, v56
    v_fma_f32 v71, v71, v60, v56
    v_cvt_pk_bf16_f32 v124, v64, v65
    v_cvt_pk_bf16_f32 v125, v66, v67
    v_cvt_pk_bf16_f32 v126, v68, v69
    v_cvt_pk_bf16_f32 v127, v70, v71
    ds_write_b128 v45, v[124:127] offset:5120
    v_lshlrev_b32 v64, 16, v128
    v_and_b32 v65, 0xffff0000, v128
    v_lshlrev_b32 v66, 16, v129
    v_and_b32 v67, 0xffff0000, v129
    v_lshlrev_b32 v68, 16, v130
    v_and_b32 v69, 0xffff0000, v130
    v_lshlrev_b32 v70, 16, v131
    v_and_b32 v71, 0xffff0000, v131
    v_fma_f32 v64, v64, v60, v56
    v_fma_f32 v65, v65, v60, v56
    v_fma_f32 v66, v66, v60, v56
    v_fma_f32 v67, v67, v60, v56
    v_fma_f32 v68, v68, v60, v56
    v_fma_f32 v69, v69, v60, v56
    v_fma_f32 v70, v70, v60, v56
    v_fma_f32 v71, v71, v60, v56
    v_cvt_pk_bf16_f32 v128, v64, v65
    v_cvt_pk_bf16_f32 v129, v66, v67
    v_cvt_pk_bf16_f32 v130, v68, v69
    v_cvt_pk_bf16_f32 v131, v70, v71
    ds_write_b128 v45, v[128:131] offset:6144
    v_lshlrev_b32 v64, 16, v132
    v_and_b32 v65, 0xffff0000, v132
    v_lshlrev_b32 v66, 16, v133
    v_and_b32 v67, 0xffff0000, v133
    v_lshlrev_b32 v68, 16, v134
    v_and_b32 v69, 0xffff0000, v134
    v_lshlrev_b32 v70, 16, v135
    v_and_b32 v71, 0xffff0000, v135
    v_fma_f32 v64, v64, v60, v56
    v_fma_f32 v65, v65, v60, v56
    v_fma_f32 v66, v66, v60, v56
    v_fma_f32 v67, v67, v60, v56
    v_fma_f32 v68, v68, v60, v56
    v_fma_f32 v69, v69, v60, v56
    v_fma_f32 v70, v70, v60, v56
    v_fma_f32 v71, v71, v60, v56
    v_cvt_pk_bf16_f32 v132, v64, v65
    v_cvt_pk_bf16_f32 v133, v66, v67
    v_cvt_pk_bf16_f32 v134, v68, v69
    v_cvt_pk_bf16_f32 v135, v70, v71
    ds_write_b128 v45, v[132:135] offset:7168
    v_lshlrev_b32 v64, 16, v136
    v_and_b32 v65, 0xffff0000, v136
    v_lshlrev_b32 v66, 16, v137
    v_and_b32 v67, 0xffff0000, v137
    v_lshlrev_b32 v68, 16, v138
    v_and_b32 v69, 0xffff0000, v138
    v_lshlrev_b32 v70, 16, v139
    v_and_b32 v71, 0xffff0000, v139
    v_fma_f32 v64, v64, v60, v56
    v_fma_f32 v65, v65, v60, v56
    v_fma_f32 v66, v66, v60, v56
    v_fma_f32 v67, v67, v60, v56
    v_fma_f32 v68, v68, v60, v56
    v_fma_f32 v69, v69, v60, v56
    v_fma_f32 v70, v70, v60, v56
    v_fma_f32 v71, v71, v60, v56
    v_cvt_pk_bf16_f32 v136, v64, v65
    v_cvt_pk_bf16_f32 v137, v66, v67
    v_cvt_pk_bf16_f32 v138, v68, v69
    v_cvt_pk_bf16_f32 v139, v70, v71
    ds_write_b128 v45, v[136:139] offset:8192
    v_lshlrev_b32 v64, 16, v140
    v_and_b32 v65, 0xffff0000, v140
    v_lshlrev_b32 v66, 16, v141
    v_and_b32 v67, 0xffff0000, v141
    v_lshlrev_b32 v68, 16, v142
    v_and_b32 v69, 0xffff0000, v142
    v_lshlrev_b32 v70, 16, v143
    v_and_b32 v71, 0xffff0000, v143
    v_fma_f32 v64, v64, v60, v56
    v_fma_f32 v65, v65, v60, v56
    v_fma_f32 v66, v66, v60, v56
    v_fma_f32 v67, v67, v60, v56
    v_fma_f32 v68, v68, v60, v56
    v_fma_f32 v69, v69, v60, v56
    v_fma_f32 v70, v70, v60, v56
    v_fma_f32 v71, v71, v60, v56
    v_cvt_pk_bf16_f32 v140, v64, v65
    v_cvt_pk_bf16_f32 v141, v66, v67
    v_cvt_pk_bf16_f32 v142, v68, v69
    v_cvt_pk_bf16_f32 v143, v70, v71
    ds_write_b128 v45, v[140:143] offset:9216
    v_lshlrev_b32 v64, 16, v144
    v_and_b32 v65, 0xffff0000, v144
    v_lshlrev_b32 v66, 16, v145
    v_and_b32 v67, 0xffff0000, v145
    v_lshlrev_b32 v68, 16, v146
    v_and_b32 v69, 0xffff0000, v146
    v_lshlrev_b32 v70, 16, v147
    v_and_b32 v71, 0xffff0000, v147
    v_fma_f32 v64, v64, v60, v56
    v_fma_f32 v65, v65, v60, v56
    v_fma_f32 v66, v66, v60, v56
    v_fma_f32 v67, v67, v60, v56
    v_fma_f32 v68, v68, v60, v56
    v_fma_f32 v69, v69, v60, v56
    v_fma_f32 v70, v70, v60, v56
    v_fma_f32 v71, v71, v60, v56
    v_cvt_pk_bf16_f32 v144, v64, v65
    v_cvt_pk_bf16_f32 v145, v66, v67
    v_cvt_pk_bf16_f32 v146, v68, v69
    v_cvt_pk_bf16_f32 v147, v70, v71
    ds_write_b128 v45, v[144:147] offset:10240
    v_lshlrev_b32 v64, 16, v148
    v_and_b32 v65, 0xffff0000, v148
    v_lshlrev_b32 v66, 16, v149
    v_and_b32 v67, 0xffff0000, v149
    v_lshlrev_b32 v68, 16, v150
    v_and_b32 v69, 0xffff0000, v150
    v_lshlrev_b32 v70, 16, v151
    v_and_b32 v71, 0xffff0000, v151
    v_fma_f32 v64, v64, v60, v56
    v_fma_f32 v65, v65, v60, v56
    v_fma_f32 v66, v66, v60, v56
    v_fma_f32 v67, v67, v60, v56
    v_fma_f32 v68, v68, v60, v56
    v_fma_f32 v69, v69, v60, v56
    v_fma_f32 v70, v70, v60, v56
    v_fma_f32 v71, v71, v60, v56
    v_cvt_pk_bf16_f32 v148, v64, v65
    v_cvt_pk_bf16_f32 v149, v66, v67
    v_cvt_pk_bf16_f32 v150, v68, v69
    v_cvt_pk_bf16_f32 v151, v70, v71
    ds_write_b128 v45, v[148:151] offset:11264
    v_lshlrev_b32 v64, 16, v152
    v_and_b32 v65, 0xffff0000, v152
    v_lshlrev_b32 v66, 16, v153
    v_and_b32 v67, 0xffff0000, v153
    v_lshlrev_b32 v68, 16, v154
    v_and_b32 v69, 0xffff0000, v154
    v_lshlrev_b32 v70, 16, v155
    v_and_b32 v71, 0xffff0000, v155
    v_fma_f32 v64, v64, v60, v56
    v_fma_f32 v65, v65, v60, v56
    v_fma_f32 v66, v66, v60, v56
    v_fma_f32 v67, v67, v60, v56
    v_fma_f32 v68, v68, v60, v56
    v_fma_f32 v69, v69, v60, v56
    v_fma_f32 v70, v70, v60, v56
    v_fma_f32 v71, v71, v60, v56
    v_cvt_pk_bf16_f32 v152, v64, v65
    v_cvt_pk_bf16_f32 v153, v66, v67
    v_cvt_pk_bf16_f32 v154, v68, v69
    v_cvt_pk_bf16_f32 v155, v70, v71
    ds_write_b128 v45, v[152:155] offset:12288
    v_lshlrev_b32 v64, 16, v156
    v_and_b32 v65, 0xffff0000, v156
    v_lshlrev_b32 v66, 16, v157
    v_and_b32 v67, 0xffff0000, v157
    v_lshlrev_b32 v68, 16, v158
    v_and_b32 v69, 0xffff0000, v158
    v_lshlrev_b32 v70, 16, v159
    v_and_b32 v71, 0xffff0000, v159
    v_fma_f32 v64, v64, v60, v56
    v_fma_f32 v65, v65, v60, v56
    v_fma_f32 v66, v66, v60, v56
    v_fma_f32 v67, v67, v60, v56
    v_fma_f32 v68, v68, v60, v56
    v_fma_f32 v69, v69, v60, v56
    v_fma_f32 v70, v70, v60, v56
    v_fma_f32 v71, v71, v60, v56
    v_cvt_pk_bf16_f32 v156, v64, v65
    v_cvt_pk_bf16_f32 v157, v66, v67
    v_cvt_pk_bf16_f32 v158, v68, v69
    v_cvt_pk_bf16_f32 v159, v70, v71
    ds_write_b128 v45, v[156:159] offset:13312
    v_lshlrev_b32 v64, 16, v160
    v_and_b32 v65, 0xffff0000, v160
    v_lshlrev_b32 v66, 16, v161
    v_and_b32 v67, 0xffff0000, v161
    v_lshlrev_b32 v68, 16, v162
    v_and_b32 v69, 0xffff0000, v162
    v_lshlrev_b32 v70, 16, v163
    v_and_b32 v71, 0xffff0000, v163
    v_fma_f32 v64, v64, v60, v56
    v_fma_f32 v65, v65, v60, v56
    v_fma_f32 v66, v66, v60, v56
    v_fma_f32 v67, v67, v60, v56
    v_fma_f32 v68, v68, v60, v56
    v_fma_f32 v69, v69, v60, v56
    v_fma_f32 v70, v70, v60, v56
    v_fma_f32 v71, v71, v60, v56
    v_cvt_pk_bf16_f32 v160, v64, v65
    v_cvt_pk_bf16_f32 v161, v66, v67
    v_cvt_pk_bf16_f32 v162, v68, v69
    v_cvt_pk_bf16_f32 v163, v70, v71
    ds_write_b128 v45, v[160:163] offset:14336
    v_lshlrev_b32 v64, 16, v164
    v_and_b32 v65, 0xffff0000, v164
    v_lshlrev_b32 v66, 16, v165
    v_and_b32 v67, 0xffff0000, v165
    v_lshlrev_b32 v68, 16, v166
    v_and_b32 v69, 0xffff0000, v166
    v_lshlrev_b32 v70, 16, v167
    v_and_b32 v71, 0xffff0000, v167
    v_fma_f32 v64, v64, v60, v56
    v_fma_f32 v65, v65, v60, v56
    v_fma_f32 v66, v66, v60, v56
    v_fma_f32 v67, v67, v60, v56
    v_fma_f32 v68, v68, v60, v56
    v_fma_f32 v69, v69, v60, v56
    v_fma_f32 v70, v70, v60, v56
    v_fma_f32 v71, v71, v60, v56
    v_cvt_pk_bf16_f32 v164, v64, v65
    v_cvt_pk_bf16_f32 v165, v66, v67
    v_cvt_pk_bf16_f32 v166, v68, v69
    v_cvt_pk_bf16_f32 v167, v70, v71
    ds_write_b128 v45, v[164:167] offset:15360
    v_lshlrev_b32 v64, 16, v168
    v_and_b32 v65, 0xffff0000, v168
    v_lshlrev_b32 v66, 16, v169
    v_and_b32 v67, 0xffff0000, v169
    v_lshlrev_b32 v68, 16, v170
    v_and_b32 v69, 0xffff0000, v170
    v_lshlrev_b32 v70, 16, v171
    v_and_b32 v71, 0xffff0000, v171
    v_fma_f32 v64, v64, v60, v56
    v_fma_f32 v65, v65, v60, v56
    v_fma_f32 v66, v66, v60, v56
    v_fma_f32 v67, v67, v60, v56
    v_fma_f32 v68, v68, v60, v56
    v_fma_f32 v69, v69, v60, v56
    v_fma_f32 v70, v70, v60, v56
    v_fma_f32 v71, v71, v60, v56
    v_cvt_pk_bf16_f32 v168, v64, v65
    v_cvt_pk_bf16_f32 v169, v66, v67
    v_cvt_pk_bf16_f32 v170, v68, v69
    v_cvt_pk_bf16_f32 v171, v70, v71
    ds_write_b128 v45, v[168:171] offset:16384
    v_lshlrev_b32 v64, 16, v172
    v_and_b32 v65, 0xffff0000, v172
    v_lshlrev_b32 v66, 16, v173
    v_and_b32 v67, 0xffff0000, v173
    v_lshlrev_b32 v68, 16, v174
    v_and_b32 v69, 0xffff0000, v174
    v_lshlrev_b32 v70, 16, v175
    v_and_b32 v71, 0xffff0000, v175
    v_fma_f32 v64, v64, v60, v56
    v_fma_f32 v65, v65, v60, v56
    v_fma_f32 v66, v66, v60, v56
    v_fma_f32 v67, v67, v60, v56
    v_fma_f32 v68, v68, v60, v56
    v_fma_f32 v69, v69, v60, v56
    v_fma_f32 v70, v70, v60, v56
    v_fma_f32 v71, v71, v60, v56
    v_cvt_pk_bf16_f32 v172, v64, v65
    v_cvt_pk_bf16_f32 v173, v66, v67
    v_cvt_pk_bf16_f32 v174, v68, v69
    v_cvt_pk_bf16_f32 v175, v70, v71
    ds_write_b128 v45, v[172:175] offset:17408
    s_min_u32 s57, s69, s70
    v_bfe_u32 v44, v1, 4, 1
    v_mul_u32_u24 v45, 18432, v44
    v_lshrrev_b32 v44, 5, v1
    v_lshl_add_u32 v45, v44, 8, v45
    v_lshl_add_u32 v45, v40, 4, v45
    v_add_u32 v45, s57, v45
    s_waitcnt lgkmcnt(0)
    s_barrier
    s_lshl_b32 s57, s55, 2
    v_mov_b32 v13, s57
    buffer_load_dword v14, v13, s[40:43], 0 offen offset:64 sc1
    buffer_load_dword v0, v8, s[48:51], s65 offen
    s_add_u32 s65, s65, s98
    ds_read_b128 v[104:107], v45 offset:0
    ds_read_b128 v[108:111], v45 offset:512
    ds_read_b128 v[112:115], v45 offset:1024
    ds_read_b128 v[116:119], v45 offset:1536
    ds_read_b128 v[120:123], v45 offset:2048
    ds_read_b128 v[124:127], v45 offset:2560
    ds_read_b128 v[128:131], v45 offset:3072
    ds_read_b128 v[132:135], v45 offset:3584
    ds_read_b128 v[136:139], v45 offset:4096
    ds_read_b128 v[140:143], v45 offset:4608
    ds_read_b128 v[144:147], v45 offset:5120
    ds_read_b128 v[148:151], v45 offset:5632
    ds_read_b128 v[152:155], v45 offset:6144
    ds_read_b128 v[156:159], v45 offset:6656
    ds_read_b128 v[160:163], v45 offset:7168
    ds_read_b128 v[164:167], v45 offset:7680
    ds_read_b128 v[168:171], v45 offset:8192
    ds_read_b128 v[172:175], v45 offset:8704
    ds_read_b128 v[176:179], v45 offset:9216
    ds_read_b128 v[180:183], v45 offset:9728
    ds_read_b128 v[184:187], v45 offset:10240
    ds_read_b128 v[188:191], v45 offset:10752
    ds_read_b128 v[192:195], v45 offset:11264
    ds_read_b128 v[196:199], v45 offset:11776
    ds_read_b128 v[200:203], v45 offset:12288
    ds_read_b128 v[204:207], v45 offset:12800
    ds_read_b128 v[208:211], v45 offset:13312
    ds_read_b128 v[212:215], v45 offset:13824
    ds_read_b128 v[216:219], v45 offset:14336
    ds_read_b128 v[220:223], v45 offset:14848
    ds_read_b128 v[224:227], v45 offset:15360
    ds_read_b128 v[228:231], v45 offset:15872
    ds_read_b128 v[232:235], v45 offset:16384
    ds_read_b128 v[236:239], v45 offset:16896
    ds_read_b128 v[240:243], v45 offset:17408
    ds_read_b128 v[244:247], v45 offset:17920
    s_waitcnt lgkmcnt(0)
    s_barrier
    s_add_u32 m0, s61, 16384
    s_add_u32 s60, s62, 589824
    buffer_load_dwordx4 v3, s[28:31], s60 offen lds
    s_add_u32 m0, s61, 24576
    s_add_u32 s60, s62, 884736
    buffer_load_dwordx4 v3, s[28:31], s60 offen lds
    s_add_u32 m0, s61, 32768
    s_add_u32 s60, s62, 1179648
    buffer_load_dwordx4 v3, s[28:31], s60 offen lds
    s_add_u32 m0, s61, 40960
    s_add_u32 s60, s62, 1474560
    buffer_load_dwordx4 v3, s[28:31], s60 offen lds
    s_add_u32 m0, s61, 49152
    s_add_u32 s60, s62, 1769472
    buffer_load_dwordx4 v3, s[28:31], s60 offen lds
    s_add_u32 m0, s61, 57344
    s_add_u32 s60, s62, 2064384
    buffer_load_dwordx4 v3, s[28:31], s60 offen lds
    s_add_u32 m0, s61, 65536
    s_add_u32 s60, s62, 2359296
    buffer_load_dwordx4 v3, s[28:31], s60 offen lds
    s_add_u32 m0, s61, 73728
    s_add_u32 s60, s62, 2654208
    buffer_load_dwordx4 v3, s[28:31], s60 offen lds
    s_add_u32 m0, s61, 81920
    s_add_u32 s60, s62, 2949120
    buffer_load_dwordx4 v3, s[28:31], s60 offen lds
    s_add_u32 m0, s61, 90112
    s_add_u32 s60, s62, 3244032
    buffer_load_dwordx4 v3, s[28:31], s60 offen lds
    s_waitcnt vmcnt(11)
    v_cmp_eq_u32 vcc, 0, v14
    s_cbranch_vccz L_ic_m_x
    s_mov_b32 s59, 0
L_ic_m:
    buffer_load_dword v14, v13, s[40:43], 0 offen offset:64 sc1
    s_add_u32 s59, s59, 1
    s_cmp_gt_u32 s59, 0x40000
    s_cbranch_scc1 L_ic_m_x
    s_waitcnt vmcnt(0)
    v_cmp_eq_u32 vcc, 0, v14
    s_cbranch_vccnz L_ic_m
L_ic_m_x:
    s_mov_b32 s71, 0
    s_mov_b32 s72, s62
    s_mov_b32 s69, 0x70000000
    s_waitcnt vmcnt(9)
    s_waitcnt lgkmcnt(0)
    s_barrier
    ds_read_b64_tr_b16 v[16:17], v5 offset:0
    ds_read_b64_tr_b16 v[18:19], v5 offset:1024
    ds_read_b64_tr_b16 v[20:21], v5 offset:4096
    ds_read_b64_tr_b16 v[22:23], v5 offset:5120
    ds_read_b64_tr_b16 v[24:25], v5 offset:2048
    ds_read_b64_tr_b16 v[26:27], v5 offset:3072
    ds_read_b64_tr_b16 v[28:29], v5 offset:6144
    ds_read_b64_tr_b16 v[30:31], v5 offset:7168
L_p1:
    s_waitcnt lgkmcnt(6)
    v_mfma_f32_32x32x16_bf16 v[40:55], v[16:19], v[104:107], 0
    ds_read_b64_tr_b16 v[32:33], v5 offset:8192
    ds_read_b64_tr_b16 v[34:35], v5 offset:9216
    s_add_u32 m0, s61, 98304
    s_add_u32 s60, s72, 3538944
    buffer_load_dwordx4 v3, s[28:31], s60 offen lds
    s_waitcnt lgkmcnt(6)
    v_mfma_f32_32x32x16_bf16 v[56:71], v[20:23], v[104:107], 0
    ds_read_b64_tr_b16 v[36:37], v5 offset:12288
    ds_read_b64_tr_b16 v[38:39], v5 offset:13312
    s_waitcnt lgkmcnt(6)
    v_mfma_f32_32x32x16_bf16 v[40:55], v[24:27], v[108:111], v[40:55]
    ds_read_b64_tr_b16 v[16:17], v5 offset:10240
    ds_read_b64_tr_b16 v[18:19], v5 offset:11264
    s_waitcnt lgkmcnt(6)
    v_mfma_f32_32x32x16_bf16 v[56:71], v[28:31], v[108:111], v[56:71]
    ds_read_b64_tr_b16 v[20:21], v5 offset:14336
    ds_read_b64_tr_b16 v[22:23], v5 offset:15360
    v_mul_f32 v72, s68, v72
    v_mul_f32 v73, s68, v73
    v_mul_f32 v74, s68, v74
    v_mul_f32 v75, s68, v75
    s_add_u32 m0, s61, 106496
    s_add_u32 s60, s72, 3833856
    buffer_load_dwordx4 v3, s[28:31], s60 offen lds
    s_waitcnt lgkmcnt(6)
    v_mfma_f32_32x32x16_bf16 v[40:55], v[32:35], v[112:115], v[40:55]
    ds_read_b64_tr_b16 v[24:25], v5 offset:16384
    ds_read_b64_tr_b16 v[26:27], v5 offset:17408
    v_exp_f32 v72, v72
    v_exp_f32 v73, v73
    v_exp_f32 v74, v74
    s_waitcnt lgkmcnt(6)
    v_mfma_f32_32x32x16_bf16 v[56:71], v[36:39], v[112:115], v[56:71]
    ds_read_b64_tr_b16 v[28:29], v5 offset:20480
    ds_read_b64_tr_b16 v[30:31], v5 offset:21504
    v_exp_f32 v75, v75
    v_add_f32 v72, 1.0, v72
    v_add_f32 v73, 1.0, v73
    buffer_load_dword v0, v8, s[48:51], s65 offen
    s_add_u32 s65, s65, s98
    s_waitcnt lgkmcnt(6)
    v_mfma_f32_32x32x16_bf16 v[40:55], v[16:19], v[116:119], v[40:55]
    ds_read_b64_tr_b16 v[32:33], v5 offset:18432
    ds_read_b64_tr_b16 v[34:35], v5 offset:19456
    v_add_f32 v74, 1.0, v74
    v_add_f32 v75, 1.0, v75
    v_rcp_f32 v72, v72
    s_add_u32 m0, s61, 114688
    s_add_u32 s60, s72, 4128768
    buffer_load_dwordx4 v3, s[28:31], s60 offen lds
    s_waitcnt lgkmcnt(6)
    v_mfma_f32_32x32x16_bf16 v[56:71], v[20:23], v[116:119], v[56:71]
    ds_read_b64_tr_b16 v[36:37], v5 offset:22528
    ds_read_b64_tr_b16 v[38:39], v5 offset:23552
    v_rcp_f32 v73, v73
    v_rcp_f32 v74, v74
    v_rcp_f32 v75, v75
    s_waitcnt lgkmcnt(6)
    v_mfma_f32_32x32x16_bf16 v[40:55], v[24:27], v[120:123], v[40:55]
    s_waitcnt vmcnt(10)
    s_barrier
    ds_read_b64_tr_b16 v[16:17], v5 offset:24576
    ds_read_b64_tr_b16 v[18:19], v5 offset:25600
    v_mul_f32 v88, v88, v72
    v_mul_f32 v89, v89, v73
    v_mul_f32 v90, v90, v74
    s_waitcnt lgkmcnt(6)
    v_mfma_f32_32x32x16_bf16 v[56:71], v[28:31], v[120:123], v[56:71]
    ds_read_b64_tr_b16 v[20:21], v5 offset:28672
    ds_read_b64_tr_b16 v[22:23], v5 offset:29696
    v_mul_f32 v91, v91, v75
    v_mul_f32 v76, s68, v76
    v_mul_f32 v77, s68, v77
    s_waitcnt lgkmcnt(6)
    v_mfma_f32_32x32x16_bf16 v[40:55], v[32:35], v[124:127], v[40:55]
    ds_read_b64_tr_b16 v[24:25], v5 offset:26624
    ds_read_b64_tr_b16 v[26:27], v5 offset:27648
    v_mul_f32 v78, s68, v78
    v_mul_f32 v79, s68, v79
    v_exp_f32 v76, v76
    s_add_u32 m0, s61, 122880
    s_add_u32 s60, s72, 4423680
    buffer_load_dwordx4 v3, s[28:31], s60 offen lds
    s_waitcnt lgkmcnt(6)
    v_mfma_f32_32x32x16_bf16 v[56:71], v[36:39], v[124:127], v[56:71]
    ds_read_b64_tr_b16 v[28:29], v5 offset:30720
    ds_read_b64_tr_b16 v[30:31], v5 offset:31744
    v_exp_f32 v77, v77
    v_exp_f32 v78, v78
    v_exp_f32 v79, v79
    s_waitcnt lgkmcnt(6)
    v_mfma_f32_32x32x16_bf16 v[40:55], v[16:19], v[128:131], v[40:55]
    ds_read_b64_tr_b16 v[32:33], v5 offset:32768
    ds_read_b64_tr_b16 v[34:35], v5 offset:33792
    v_add_f32 v76, 1.0, v76
    v_add_f32 v77, 1.0, v77
    v_add_f32 v78, 1.0, v78
    v_add_f32 v79, 1.0, v79
    s_waitcnt lgkmcnt(6)
    v_mfma_f32_32x32x16_bf16 v[56:71], v[20:23], v[128:131], v[56:71]
    ds_read_b64_tr_b16 v[36:37], v5 offset:36864
    ds_read_b64_tr_b16 v[38:39], v5 offset:37888
    v_rcp_f32 v76, v76
    v_rcp_f32 v77, v77
    v_rcp_f32 v78, v78
    s_add_u32 m0, s61, 131072
    s_add_u32 s60, s72, 4718592
    buffer_load_dwordx4 v3, s[28:31], s60 offen lds
    s_waitcnt lgkmcnt(6)
    v_mfma_f32_32x32x16_bf16 v[40:55], v[24:27], v[132:135], v[40:55]
    ds_read_b64_tr_b16 v[16:17], v5 offset:34816
    ds_read_b64_tr_b16 v[18:19], v5 offset:35840
    v_rcp_f32 v79, v79
    v_mul_f32 v92, v92, v76
    v_mul_f32 v93, v93, v77
    s_waitcnt lgkmcnt(6)
    v_mfma_f32_32x32x16_bf16 v[56:71], v[28:31], v[132:135], v[56:71]
    ds_read_b64_tr_b16 v[20:21], v5 offset:38912
    ds_read_b64_tr_b16 v[22:23], v5 offset:39936
    v_mul_f32 v94, v94, v78
    v_mul_f32 v95, v95, v79
    v_cvt_pk_bf16_f32 v72, v88, v89
    s_waitcnt lgkmcnt(6)
    v_mfma_f32_32x32x16_bf16 v[40:55], v[32:35], v[136:139], v[40:55]
    ds_read_b64_tr_b16 v[24:25], v5 offset:40960
    ds_read_b64_tr_b16 v[26:27], v5 offset:41984
    v_cvt_pk_bf16_f32 v73, v90, v91
    v_cvt_pk_bf16_f32 v74, v92, v93
    v_cvt_pk_bf16_f32 v75, v94, v95
    s_add_u32 m0, s61, 139264
    s_add_u32 s60, s72, 5013504
    buffer_load_dwordx4 v3, s[28:31], s60 offen lds
    s_waitcnt lgkmcnt(6)
    v_mfma_f32_32x32x16_bf16 v[56:71], v[36:39], v[136:139], v[56:71]
    ds_read_b64_tr_b16 v[28:29], v5 offset:45056
    ds_read_b64_tr_b16 v[30:31], v5 offset:46080
    s_add_u32 s57, s69, 0
    buffer_store_dwordx4 v[72:75], v2, s[36:39], s57 offen
    v_mul_f32 v80, s68, v80
    v_mul_f32 v81, s68, v81
    s_waitcnt lgkmcnt(6)
    v_mfma_f32_32x32x16_bf16 v[40:55], v[16:19], v[140:143], v[40:55]
    ds_read_b64_tr_b16 v[32:33], v5 offset:43008
    ds_read_b64_tr_b16 v[34:35], v5 offset:44032
    v_mul_f32 v82, s68, v82
    v_mul_f32 v83, s68, v83
    v_exp_f32 v80, v80
    s_waitcnt lgkmcnt(6)
    v_mfma_f32_32x32x16_bf16 v[56:71], v[20:23], v[140:143], v[56:71]
    ds_read_b64_tr_b16 v[36:37], v5 offset:47104
    ds_read_b64_tr_b16 v[38:39], v5 offset:48128
    v_exp_f32 v81, v81
    v_exp_f32 v82, v82
    v_exp_f32 v83, v83
    s_waitcnt lgkmcnt(6)
    v_mfma_f32_32x32x16_bf16 v[40:55], v[24:27], v[144:147], v[40:55]
    s_waitcnt vmcnt(11)
    s_barrier
    ds_read_b64_tr_b16 v[16:17], v6 offset:0
    ds_read_b64_tr_b16 v[18:19], v6 offset:1024
    v_add_f32 v80, 1.0, v80
    v_add_f32 v81, 1.0, v81
    v_add_f32 v82, 1.0, v82
    s_waitcnt lgkmcnt(6)
    v_mfma_f32_32x32x16_bf16 v[56:71], v[28:31], v[144:147], v[56:71]
    ds_read_b64_tr_b16 v[20:21], v6 offset:4096
    ds_read_b64_tr_b16 v[22:23], v6 offset:5120
    v_add_f32 v83, 1.0, v83
    v_rcp_f32 v80, v80
    v_rcp_f32 v81, v81
    s_waitcnt lgkmcnt(6)
    v_mfma_f32_32x32x16_bf16 v[40:55], v[32:35], v[148:151], v[40:55]
    ds_read_b64_tr_b16 v[24:25], v6 offset:2048
    ds_read_b64_tr_b16 v[26:27], v6 offset:3072
    v_rcp_f32 v82, v82
    v_rcp_f32 v83, v83
    v_mul_f32 v96, v96, v80
    v_mul_f32 v97, v97, v81
    s_add_u32 m0, s61, 0
    s_add_u32 s60, s72, 128
    buffer_load_dwordx4 v3, s[28:31], s60 offen lds
    s_waitcnt lgkmcnt(6)
    v_mfma_f32_32x32x16_bf16 v[56:71], v[36:39], v[148:151], v[56:71]
    ds_read_b64_tr_b16 v[28:29], v6 offset:6144
    ds_read_b64_tr_b16 v[30:31], v6 offset:7168
    v_mul_f32 v98, v98, v82
    v_mul_f32 v99, v99, v83
    v_mul_f32 v84, s68, v84
    s_waitcnt lgkmcnt(6)
    v_mfma_f32_32x32x16_bf16 v[40:55], v[16:19], v[152:155], v[40:55]
    ds_read_b64_tr_b16 v[32:33], v6 offset:8192
    ds_read_b64_tr_b16 v[34:35], v6 offset:9216
    v_mul_f32 v85, s68, v85
    v_mul_f32 v86, s68, v86
    v_mul_f32 v87, s68, v87
    s_waitcnt lgkmcnt(6)
    v_mfma_f32_32x32x16_bf16 v[56:71], v[20:23], v[152:155], v[56:71]
    ds_read_b64_tr_b16 v[36:37], v6 offset:12288
    ds_read_b64_tr_b16 v[38:39], v6 offset:13312
    v_exp_f32 v84, v84
    v_exp_f32 v85, v85
    v_exp_f32 v86, v86
    s_add_u32 m0, s61, 8192
    s_add_u32 s60, s72, 295040
    buffer_load_dwordx4 v3, s[28:31], s60 offen lds
    s_waitcnt lgkmcnt(6)
    v_mfma_f32_32x32x16_bf16 v[40:55], v[24:27], v[156:159], v[40:55]
    ds_read_b64_tr_b16 v[16:17], v6 offset:10240
    ds_read_b64_tr_b16 v[18:19], v6 offset:11264
    v_exp_f32 v87, v87
    v_add_f32 v84, 1.0, v84
    v_add_f32 v85, 1.0, v85
    s_waitcnt lgkmcnt(6)
    v_mfma_f32_32x32x16_bf16 v[56:71], v[28:31], v[156:159], v[56:71]
    ds_read_b64_tr_b16 v[20:21], v6 offset:14336
    ds_read_b64_tr_b16 v[22:23], v6 offset:15360
    v_add_f32 v86, 1.0, v86
    v_add_f32 v87, 1.0, v87
    v_rcp_f32 v84, v84
    s_waitcnt lgkmcnt(6)
    v_mfma_f32_32x32x16_bf16 v[40:55], v[32:35], v[160:163], v[40:55]
    ds_read_b64_tr_b16 v[24:25], v6 offset:16384
    ds_read_b64_tr_b16 v[26:27], v6 offset:17408
    v_rcp_f32 v85, v85
    v_rcp_f32 v86, v86
    v_rcp_f32 v87, v87
    s_add_u32 m0, s61, 16384
    s_add_u32 s60, s72, 589952
    buffer_load_dwordx4 v3, s[28:31], s60 offen lds
    s_waitcnt lgkmcnt(6)
    v_mfma_f32_32x32x16_bf16 v[56:71], v[36:39], v[160:163], v[56:71]
    ds_read_b64_tr_b16 v[28:29], v6 offset:20480
    ds_read_b64_tr_b16 v[30:31], v6 offset:21504
    v_mul_f32 v100, v100, v84
    v_mul_f32 v101, v101, v85
    v_mul_f32 v102, v102, v86
    s_waitcnt lgkmcnt(6)
    v_mfma_f32_32x32x16_bf16 v[40:55], v[16:19], v[164:167], v[40:55]
    ds_read_b64_tr_b16 v[32:33], v6 offset:18432
    ds_read_b64_tr_b16 v[34:35], v6 offset:19456
    v_mul_f32 v103, v103, v87
    v_cvt_pk_bf16_f32 v80, v96, v97
    v_cvt_pk_bf16_f32 v81, v98, v99
    s_waitcnt lgkmcnt(6)
    v_mfma_f32_32x32x16_bf16 v[56:71], v[20:23], v[164:167], v[56:71]
    ds_read_b64_tr_b16 v[36:37], v6 offset:22528
    ds_read_b64_tr_b16 v[38:39], v6 offset:23552
    v_cvt_pk_bf16_f32 v82, v100, v101
    v_cvt_pk_bf16_f32 v83, v102, v103
    s_add_u32 s57, s69, 4096
    buffer_store_dwordx4 v[80:83], v2, s[36:39], s57 offen
    s_waitcnt lgkmcnt(6)
    v_mfma_f32_32x32x16_bf16 v[40:55], v[24:27], v[168:171], v[40:55]
    s_waitcnt vmcnt(12)
    s_barrier
    ds_read_b64_tr_b16 v[16:17], v6 offset:24576
    ds_read_b64_tr_b16 v[18:19], v6 offset:25600
    s_waitcnt lgkmcnt(6)
    v_mfma_f32_32x32x16_bf16 v[56:71], v[28:31], v[168:171], v[56:71]
    ds_read_b64_tr_b16 v[20:21], v6 offset:28672
    ds_read_b64_tr_b16 v[22:23], v6 offset:29696
    s_waitcnt lgkmcnt(6)
    v_mfma_f32_32x32x16_bf16 v[40:55], v[32:35], v[172:175], v[40:55]
    ds_read_b64_tr_b16 v[24:25], v6 offset:26624
    ds_read_b64_tr_b16 v[26:27], v6 offset:27648
    s_add_u32 m0, s61, 24576
    s_add_u32 s60, s72, 884864
    buffer_load_dwordx4 v3, s[28:31], s60 offen lds
    s_waitcnt lgkmcnt(6)
    v_mfma_f32_32x32x16_bf16 v[56:71], v[36:39], v[172:175], v[56:71]
    ds_read_b64_tr_b16 v[28:29], v6 offset:30720
    ds_read_b64_tr_b16 v[30:31], v6 offset:31744
    s_waitcnt lgkmcnt(6)
    v_mfma_f32_32x32x16_bf16 v[40:55], v[16:19], v[176:179], v[40:55]
    ds_read_b64_tr_b16 v[32:33], v6 offset:32768
    ds_read_b64_tr_b16 v[34:35], v6 offset:33792
    s_waitcnt lgkmcnt(6)
    v_mfma_f32_32x32x16_bf16 v[56:71], v[20:23], v[176:179], v[56:71]
    ds_read_b64_tr_b16 v[36:37], v6 offset:36864
    ds_read_b64_tr_b16 v[38:39], v6 offset:37888
    s_add_u32 m0, s61, 32768
    s_add_u32 s60, s72, 1179776
    buffer_load_dwordx4 v3, s[28:31], s60 offen lds
    s_waitcnt lgkmcnt(6)
    v_mfma_f32_32x32x16_bf16 v[40:55], v[24:27], v[180:183], v[40:55]
    ds_read_b64_tr_b16 v[16:17], v6 offset:34816
    ds_read_b64_tr_b16 v[18:19], v6 offset:35840
    s_waitcnt lgkmcnt(6)
    v_mfma_f32_32x32x16_bf16 v[56:71], v[28:31], v[180:183], v[56:71]
    ds_read_b64_tr_b16 v[20:21], v6 offset:38912
    ds_read_b64_tr_b16 v[22:23], v6 offset:39936
    s_waitcnt lgkmcnt(6)
    v_mfma_f32_32x32x16_bf16 v[40:55], v[32:35], v[184:187], v[40:55]
    ds_read_b64_tr_b16 v[24:25], v6 offset:40960
    ds_read_b64_tr_b16 v[26:27], v6 offset:41984
    s_add_u32 m0, s61, 40960
    s_add_u32 s60, s72, 1474688
    buffer_load_dwordx4 v3, s[28:31], s60 offen lds
    s_waitcnt lgkmcnt(6)
    v_mfma_f32_32x32x16_bf16 v[56:71], v[36:39], v[184:187], v[56:71]
    ds_read_b64_tr_b16 v[28:29], v6 offset:45056
    ds_read_b64_tr_b16 v[30:31], v6 offset:46080
    s_waitcnt lgkmcnt(6)
    v_mfma_f32_32x32x16_bf16 v[40:55], v[16:19], v[188:191], v[40:55]
    ds_read_b64_tr_b16 v[32:33], v6 offset:43008
    ds_read_b64_tr_b16 v[34:35], v6 offset:44032
    s_waitcnt lgkmcnt(6)
    v_mfma_f32_32x32x16_bf16 v[56:71], v[20:23], v[188:191], v[56:71]
    ds_read_b64_tr_b16 v[36:37], v6 offset:47104
    ds_read_b64_tr_b16 v[38:39], v6 offset:48128
    s_waitcnt lgkmcnt(6)
    v_mfma_f32_32x32x16_bf16 v[40:55], v[24:27], v[192:195], v[40:55]
    s_waitcnt vmcnt(11)
    s_barrier
    ds_read_b64_tr_b16 v[16:17], v7 offset:0
    ds_read_b64_tr_b16 v[18:19], v7 offset:1024
    s_waitcnt lgkmcnt(6)
    v_mfma_f32_32x32x16_bf16 v[56:71], v[28:31], v[192:195], v[56:71]
    ds_read_b64_tr_b16 v[20:21], v7 offset:4096
    ds_read_b64_tr_b16 v[22:23], v7 offset:5120
    s_waitcnt lgkmcnt(6)
    v_mfma_f32_32x32x16_bf16 v[40:55], v[32:35], v[196:199], v[40:55]
    ds_read_b64_tr_b16 v[24:25], v7 offset:2048
    ds_read_b64_tr_b16 v[26:27], v7 offset:3072
    s_add_u32 m0, s61, 49152
    s_add_u32 s60, s72, 1769600
    buffer_load_dwordx4 v3, s[28:31], s60 offen lds
    s_waitcnt lgkmcnt(6)
    v_mfma_f32_32x32x16_bf16 v[56:71], v[36:39], v[196:199], v[56:71]
    ds_read_b64_tr_b16 v[28:29], v7 offset:6144
    ds_read_b64_tr_b16 v[30:31], v7 offset:7168
    s_waitcnt lgkmcnt(6)
    v_mfma_f32_32x32x16_bf16 v[40:55], v[16:19], v[200:203], v[40:55]
    ds_read_b64_tr_b16 v[32:33], v7 offset:8192
    ds_read_b64_tr_b16 v[34:35], v7 offset:9216
    s_waitcnt lgkmcnt(6)
    v_mfma_f32_32x32x16_bf16 v[56:71], v[20:23], v[200:203], v[56:71]
    ds_read_b64_tr_b16 v[36:37], v7 offset:12288
    ds_read_b64_tr_b16 v[38:39], v7 offset:13312
    s_add_u32 m0, s61, 57344
    s_add_u32 s60, s72, 2064512
    buffer_load_dwordx4 v3, s[28:31], s60 offen lds
    s_waitcnt lgkmcnt(6)
    v_mfma_f32_32x32x16_bf16 v[40:55], v[24:27], v[204:207], v[40:55]
    ds_read_b64_tr_b16 v[16:17], v7 offset:10240
    ds_read_b64_tr_b16 v[18:19], v7 offset:11264
    s_waitcnt lgkmcnt(6)
    v_mfma_f32_32x32x16_bf16 v[56:71], v[28:31], v[204:207], v[56:71]
    ds_read_b64_tr_b16 v[20:21], v7 offset:14336
    ds_read_b64_tr_b16 v[22:23], v7 offset:15360
    s_waitcnt lgkmcnt(6)
    v_mfma_f32_32x32x16_bf16 v[40:55], v[32:35], v[208:211], v[40:55]
    ds_read_b64_tr_b16 v[24:25], v7 offset:16384
    ds_read_b64_tr_b16 v[26:27], v7 offset:17408
    s_add_u32 m0, s61, 65536
    s_add_u32 s60, s72, 2359424
    buffer_load_dwordx4 v3, s[28:31], s60 offen lds
    s_waitcnt lgkmcnt(6)
    v_mfma_f32_32x32x16_bf16 v[56:71], v[36:39], v[208:211], v[56:71]
    ds_read_b64_tr_b16 v[28:29], v7 offset:20480
    ds_read_b64_tr_b16 v[30:31], v7 offset:21504
    s_waitcnt lgkmcnt(6)
    v_mfma_f32_32x32x16_bf16 v[40:55], v[16:19], v[212:215], v[40:55]
    ds_read_b64_tr_b16 v[32:33], v7 offset:18432
    ds_read_b64_tr_b16 v[34:35], v7 offset:19456
    s_waitcnt lgkmcnt(6)
    v_mfma_f32_32x32x16_bf16 v[56:71], v[20:23], v[212:215], v[56:71]
    ds_read_b64_tr_b16 v[36:37], v7 offset:22528
    ds_read_b64_tr_b16 v[38:39], v7 offset:23552
    s_waitcnt lgkmcnt(6)
    v_mfma_f32_32x32x16_bf16 v[40:55], v[24:27], v[216:219], v[40:55]
    s_waitcnt vmcnt(6)
    s_barrier
    ds_read_b64_tr_b16 v[16:17], v7 offset:24576
    ds_read_b64_tr_b16 v[18:19], v7 offset:25600
    s_waitcnt lgkmcnt(6)
    v_mfma_f32_32x32x16_bf16 v[56:71], v[28:31], v[216:219], v[56:71]
    ds_read_b64_tr_b16 v[20:21], v7 offset:28672
    ds_read_b64_tr_b16 v[22:23], v7 offset:29696
    s_waitcnt lgkmcnt(6)
    v_mfma_f32_32x32x16_bf16 v[40:55], v[32:35], v[220:223], v[40:55]
    ds_read_b64_tr_b16 v[24:25], v7 offset:26624
    ds_read_b64_tr_b16 v[26:27], v7 offset:27648
    s_add_u32 m0, s61, 73728
    s_add_u32 s60, s72, 2654336
    buffer_load_dwordx4 v3, s[28:31], s60 offen lds
    s_waitcnt lgkmcnt(6)
    v_mfma_f32_32x32x16_bf16 v[56:71], v[36:39], v[220:223], v[56:71]
    ds_read_b64_tr_b16 v[28:29], v7 offset:30720
    ds_read_b64_tr_b16 v[30:31], v7 offset:31744
    s_waitcnt lgkmcnt(6)
    v_mfma_f32_32x32x16_bf16 v[40:55], v[16:19], v[224:227], v[40:55]
    ds_read_b64_tr_b16 v[32:33], v7 offset:32768
    ds_read_b64_tr_b16 v[34:35], v7 offset:33792
    s_waitcnt lgkmcnt(6)
    v_mfma_f32_32x32x16_bf16 v[56:71], v[20:23], v[224:227], v[56:71]
    ds_read_b64_tr_b16 v[36:37], v7 offset:36864
    ds_read_b64_tr_b16 v[38:39], v7 offset:37888
    s_add_u32 m0, s61, 81920
    s_add_u32 s60, s72, 2949248
    buffer_load_dwordx4 v3, s[28:31], s60 offen lds
    s_waitcnt lgkmcnt(6)
    v_mfma_f32_32x32x16_bf16 v[40:55], v[24:27], v[228:231], v[40:55]
    ds_read_b64_tr_b16 v[16:17], v7 offset:34816
    ds_read_b64_tr_b16 v[18:19], v7 offset:35840
    s_waitcnt lgkmcnt(6)
    v_mfma_f32_32x32x16_bf16 v[56:71], v[28:31], v[228:231], v[56:71]
    ds_read_b64_tr_b16 v[20:21], v7 offset:38912
    ds_read_b64_tr_b16 v[22:23], v7 offset:39936
    s_waitcnt lgkmcnt(6)
    v_mfma_f32_32x32x16_bf16 v[40:55], v[32:35], v[232:235], v[40:55]
    ds_read_b64_tr_b16 v[24:25], v7 offset:40960
    ds_read_b64_tr_b16 v[26:27], v7 offset:41984
    s_add_u32 m0, s61, 90112
    s_add_u32 s60, s72, 3244160
    buffer_load_dwordx4 v3, s[28:31], s60 offen lds
    s_waitcnt lgkmcnt(6)
    v_mfma_f32_32x32x16_bf16 v[56:71], v[36:39], v[232:235], v[56:71]
    ds_read_b64_tr_b16 v[28:29], v7 offset:45056
    ds_read_b64_tr_b16 v[30:31], v7 offset:46080
    s_waitcnt lgkmcnt(6)
    v_mfma_f32_32x32x16_bf16 v[40:55], v[16:19], v[236:239], v[40:55]
    ds_read_b64_tr_b16 v[32:33], v7 offset:43008
    ds_read_b64_tr_b16 v[34:35], v7 offset:44032
    s_waitcnt lgkmcnt(6)
    v_mfma_f32_32x32x16_bf16 v[56:71], v[20:23], v[236:239], v[56:71]
    ds_read_b64_tr_b16 v[36:37], v7 offset:47104
    ds_read_b64_tr_b16 v[38:39], v7 offset:48128
    s_waitcnt lgkmcnt(6)
    v_mfma_f32_32x32x16_bf16 v[40:55], v[24:27], v[240:243], v[40:55]
    s_waitcnt vmcnt(10)
    s_barrier
    ds_read_b64_tr_b16 v[16:17], v5 offset:0
    ds_read_b64_tr_b16 v[18:19], v5 offset:1024
    s_waitcnt lgkmcnt(6)
    v_mfma_f32_32x32x16_bf16 v[56:71], v[28:31], v[240:243], v[56:71]
    ds_read_b64_tr_b16 v[20:21], v5 offset:4096
    ds_read_b64_tr_b16 v[22:23], v5 offset:5120
    s_waitcnt lgkmcnt(6)
    v_mfma_f32_32x32x16_bf16 v[40:55], v[32:35], v[244:247], v[40:55]
    ds_read_b64_tr_b16 v[24:25], v5 offset:2048
    ds_read_b64_tr_b16 v[26:27], v5 offset:3072
    s_waitcnt lgkmcnt(6)
    v_mfma_f32_32x32x16_bf16 v[56:71], v[36:39], v[244:247], v[56:71]
    ds_read_b64_tr_b16 v[28:29], v5 offset:6144
    ds_read_b64_tr_b16 v[30:31], v5 offset:7168
    s_lshl_b32 s57, s54, 13
    s_lshl_b32 s69, s71, 14
    s_add_u32 s69, s69, s57
    s_add_u32 s69, s69, s64
    s_add_u32 s72, s72, 128
    s_add_u32 s71, s71, 1
    s_waitcnt lgkmcnt(6)
    v_mfma_f32_32x32x16_bf16 v[72:87], v[16:19], v[104:107], 0
    ds_read_b64_tr_b16 v[32:33], v5 offset:8192
    ds_read_b64_tr_b16 v[34:35], v5 offset:9216
    s_add_u32 m0, s61, 98304
    s_add_u32 s60, s72, 3538944
    buffer_load_dwordx4 v3, s[28:31], s60 offen lds
    s_waitcnt lgkmcnt(6)
    v_mfma_f32_32x32x16_bf16 v[88:103], v[20:23], v[104:107], 0
    ds_read_b64_tr_b16 v[36:37], v5 offset:12288
    ds_read_b64_tr_b16 v[38:39], v5 offset:13312
    s_waitcnt lgkmcnt(6)
    v_mfma_f32_32x32x16_bf16 v[72:87], v[24:27], v[108:111], v[72:87]
    ds_read_b64_tr_b16 v[16:17], v5 offset:10240
    ds_read_b64_tr_b16 v[18:19], v5 offset:11264
    s_waitcnt lgkmcnt(6)
    v_mfma_f32_32x32x16_bf16 v[88:103], v[28:31], v[108:111], v[88:103]
    ds_read_b64_tr_b16 v[20:21], v5 offset:14336
    ds_read_b64_tr_b16 v[22:23], v5 offset:15360
    v_mul_f32 v40, s68, v40
    v_mul_f32 v41, s68, v41
    v_mul_f32 v42, s68, v42
    v_mul_f32 v43, s68, v43
    s_add_u32 m0, s61, 106496
    s_add_u32 s60, s72, 3833856
    buffer_load_dwordx4 v3, s[28:31], s60 offen lds
    s_waitcnt lgkmcnt(6)
    v_mfma_f32_32x32x16_bf16 v[72:87], v[32:35], v[112:115], v[72:87]
    ds_read_b64_tr_b16 v[24:25], v5 offset:16384
    ds_read_b64_tr_b16 v[26:27], v5 offset:17408
    v_exp_f32 v40, v40
    v_exp_f32 v41, v41
    v_exp_f32 v42, v42
    s_waitcnt lgkmcnt(6)
    v_mfma_f32_32x32x16_bf16 v[88:103], v[36:39], v[112:115], v[88:103]
    ds_read_b64_tr_b16 v[28:29], v5 offset:20480
    ds_read_b64_tr_b16 v[30:31], v5 offset:21504
    v_exp_f32 v43, v43
    v_add_f32 v40, 1.0, v40
    v_add_f32 v41, 1.0, v41
    buffer_load_dword v0, v8, s[48:51], s65 offen
    s_add_u32 s65, s65, s98
    s_waitcnt lgkmcnt(6)
    v_mfma_f32_32x32x16_bf16 v[72:87], v[16:19], v[116:119], v[72:87]
    ds_read_b64_tr_b16 v[32:33], v5 offset:18432
    ds_read_b64_tr_b16 v[34:35], v5 offset:19456
    v_add_f32 v42, 1.0, v42
    v_add_f32 v43, 1.0, v43
    v_rcp_f32 v40, v40
    s_add_u32 m0, s61, 114688
    s_add_u32 s60, s72, 4128768
    buffer_load_dwordx4 v3, s[28:31], s60 offen lds
    s_waitcnt lgkmcnt(6)
    v_mfma_f32_32x32x16_bf16 v[88:103], v[20:23], v[116:119], v[88:103]
    ds_read_b64_tr_b16 v[36:37], v5 offset:22528
    ds_read_b64_tr_b16 v[38:39], v5 offset:23552
    v_rcp_f32 v41, v41
    v_rcp_f32 v42, v42
    v_rcp_f32 v43, v43
    s_waitcnt lgkmcnt(6)
    v_mfma_f32_32x32x16_bf16 v[72:87], v[24:27], v[120:123], v[72:87]
    s_waitcnt vmcnt(10)
    s_barrier
    ds_read_b64_tr_b16 v[16:17], v5 offset:24576
    ds_read_b64_tr_b16 v[18:19], v5 offset:25600
    v_mul_f32 v56, v56, v40
    v_mul_f32 v57, v57, v41
    v_mul_f32 v58, v58, v42
    s_waitcnt lgkmcnt(6)
    v_mfma_f32_32x32x16_bf16 v[88:103], v[28:31], v[120:123], v[88:103]
    ds_read_b64_tr_b16 v[20:21], v5 offset:28672
    ds_read_b64_tr_b16 v[22:23], v5 offset:29696
    v_mul_f32 v59, v59, v43
    v_mul_f32 v44, s68, v44
    v_mul_f32 v45, s68, v45
    s_waitcnt lgkmcnt(6)
    v_mfma_f32_32x32x16_bf16 v[72:87], v[32:35], v[124:127], v[72:87]
    ds_read_b64_tr_b16 v[24:25], v5 offset:26624
    ds_read_b64_tr_b16 v[26:27], v5 offset:27648
    v_mul_f32 v46, s68, v46
    v_mul_f32 v47, s68, v47
    v_exp_f32 v44, v44
    s_add_u32 m0, s61, 122880
    s_add_u32 s60, s72, 4423680
    buffer_load_dwordx4 v3, s[28:31], s60 offen lds
    s_waitcnt lgkmcnt(6)
    v_mfma_f32_32x32x16_bf16 v[88:103], v[36:39], v[124:127], v[88:103]
    ds_read_b64_tr_b16 v[28:29], v5 offset:30720
    ds_read_b64_tr_b16 v[30:31], v5 offset:31744
    v_exp_f32 v45, v45
    v_exp_f32 v46, v46
    v_exp_f32 v47, v47
    s_waitcnt lgkmcnt(6)
    v_mfma_f32_32x32x16_bf16 v[72:87], v[16:19], v[128:131], v[72:87]
    ds_read_b64_tr_b16 v[32:33], v5 offset:32768
    ds_read_b64_tr_b16 v[34:35], v5 offset:33792
    v_add_f32 v44, 1.0, v44
    v_add_f32 v45, 1.0, v45
    v_add_f32 v46, 1.0, v46
    v_add_f32 v47, 1.0, v47
    s_waitcnt lgkmcnt(6)
    v_mfma_f32_32x32x16_bf16 v[88:103], v[20:23], v[128:131], v[88:103]
    ds_read_b64_tr_b16 v[36:37], v5 offset:36864
    ds_read_b64_tr_b16 v[38:39], v5 offset:37888
    v_rcp_f32 v44, v44
    v_rcp_f32 v45, v45
    v_rcp_f32 v46, v46
    s_add_u32 m0, s61, 131072
    s_add_u32 s60, s72, 4718592
    buffer_load_dwordx4 v3, s[28:31], s60 offen lds
    s_waitcnt lgkmcnt(6)
    v_mfma_f32_32x32x16_bf16 v[72:87], v[24:27], v[132:135], v[72:87]
    ds_read_b64_tr_b16 v[16:17], v5 offset:34816
    ds_read_b64_tr_b16 v[18:19], v5 offset:35840
    v_rcp_f32 v47, v47
    v_mul_f32 v60, v60, v44
    v_mul_f32 v61, v61, v45
    s_waitcnt lgkmcnt(6)
    v_mfma_f32_32x32x16_bf16 v[88:103], v[28:31], v[132:135], v[88:103]
    ds_read_b64_tr_b16 v[20:21], v5 offset:38912
    ds_read_b64_tr_b16 v[22:23], v5 offset:39936
    v_mul_f32 v62, v62, v46
    v_mul_f32 v63, v63, v47
    v_cvt_pk_bf16_f32 v40, v56, v57
    s_waitcnt lgkmcnt(6)
    v_mfma_f32_32x32x16_bf16 v[72:87], v[32:35], v[136:139], v[72:87]
    ds_read_b64_tr_b16 v[24:25], v5 offset:40960
    ds_read_b64_tr_b16 v[26:27], v5 offset:41984
    v_cvt_pk_bf16_f32 v41, v58, v59
    v_cvt_pk_bf16_f32 v42, v60, v61
    v_cvt_pk_bf16_f32 v43, v62, v63
    s_add_u32 m0, s61, 139264
    s_add_u32 s60, s72, 5013504
    buffer_load_dwordx4 v3, s[28:31], s60 offen lds
    s_waitcnt lgkmcnt(6)
    v_mfma_f32_32x32x16_bf16 v[88:103], v[36:39], v[136:139], v[88:103]
    ds_read_b64_tr_b16 v[28:29], v5 offset:45056
    ds_read_b64_tr_b16 v[30:31], v5 offset:46080
    s_add_u32 s57, s69, 0
    buffer_store_dwordx4 v[40:43], v2, s[36:39], s57 offen
    v_mul_f32 v48, s68, v48
    v_mul_f32 v49, s68, v49
    s_waitcnt lgkmcnt(6)
    v_mfma_f32_32x32x16_bf16 v[72:87], v[16:19], v[140:143], v[72:87]
    ds_read_b64_tr_b16 v[32:33], v5 offset:43008
    ds_read_b64_tr_b16 v[34:35], v5 offset:44032
    v_mul_f32 v50, s68, v50
    v_mul_f32 v51, s68, v51
    v_exp_f32 v48, v48
    s_waitcnt lgkmcnt(6)
    v_mfma_f32_32x32x16_bf16 v[88:103], v[20:23], v[140:143], v[88:103]
    ds_read_b64_tr_b16 v[36:37], v5 offset:47104
    ds_read_b64_tr_b16 v[38:39], v5 offset:48128
    v_exp_f32 v49, v49
    v_exp_f32 v50, v50
    v_exp_f32 v51, v51
    s_waitcnt lgkmcnt(6)
    v_mfma_f32_32x32x16_bf16 v[72:87], v[24:27], v[144:147], v[72:87]
    s_waitcnt vmcnt(11)
    s_barrier
    ds_read_b64_tr_b16 v[16:17], v6 offset:0
    ds_read_b64_tr_b16 v[18:19], v6 offset:1024
    v_add_f32 v48, 1.0, v48
    v_add_f32 v49, 1.0, v49
    v_add_f32 v50, 1.0, v50
    s_waitcnt lgkmcnt(6)
    v_mfma_f32_32x32x16_bf16 v[88:103], v[28:31], v[144:147], v[88:103]
    ds_read_b64_tr_b16 v[20:21], v6 offset:4096
    ds_read_b64_tr_b16 v[22:23], v6 offset:5120
    v_add_f32 v51, 1.0, v51
    v_rcp_f32 v48, v48
    v_rcp_f32 v49, v49
    s_waitcnt lgkmcnt(6)
    v_mfma_f32_32x32x16_bf16 v[72:87], v[32:35], v[148:151], v[72:87]
    ds_read_b64_tr_b16 v[24:25], v6 offset:2048
    ds_read_b64_tr_b16 v[26:27], v6 offset:3072
    v_rcp_f32 v50, v50
    v_rcp_f32 v51, v51
    v_mul_f32 v64, v64, v48
    v_mul_f32 v65, v65, v49
    s_add_u32 m0, s61, 0
    s_add_u32 s60, s72, 128
    buffer_load_dwordx4 v3, s[28:31], s60 offen lds
    s_waitcnt lgkmcnt(6)
    v_mfma_f32_32x32x16_bf16 v[88:103], v[36:39], v[148:151], v[88:103]
    ds_read_b64_tr_b16 v[28:29], v6 offset:6144
    ds_read_b64_tr_b16 v[30:31], v6 offset:7168
    v_mul_f32 v66, v66, v50
    v_mul_f32 v67, v67, v51
    v_mul_f32 v52, s68, v52
    s_waitcnt lgkmcnt(6)
    v_mfma_f32_32x32x16_bf16 v[72:87], v[16:19], v[152:155], v[72:87]
    ds_read_b64_tr_b16 v[32:33], v6 offset:8192
    ds_read_b64_tr_b16 v[34:35], v6 offset:9216
    v_mul_f32 v53, s68, v53
    v_mul_f32 v54, s68, v54
    v_mul_f32 v55, s68, v55
    s_waitcnt lgkmcnt(6)
    v_mfma_f32_32x32x16_bf16 v[88:103], v[20:23], v[152:155], v[88:103]
    ds_read_b64_tr_b16 v[36:37], v6 offset:12288
    ds_read_b64_tr_b16 v[38:39], v6 offset:13312
    v_exp_f32 v52, v52
    v_exp_f32 v53, v53
    v_exp_f32 v54, v54
    s_add_u32 m0, s61, 8192
    s_add_u32 s60, s72, 295040
    buffer_load_dwordx4 v3, s[28:31], s60 offen lds
    s_waitcnt lgkmcnt(6)
    v_mfma_f32_32x32x16_bf16 v[72:87], v[24:27], v[156:159], v[72:87]
    ds_read_b64_tr_b16 v[16:17], v6 offset:10240
    ds_read_b64_tr_b16 v[18:19], v6 offset:11264
    v_exp_f32 v55, v55
    v_add_f32 v52, 1.0, v52
    v_add_f32 v53, 1.0, v53
    s_waitcnt lgkmcnt(6)
    v_mfma_f32_32x32x16_bf16 v[88:103], v[28:31], v[156:159], v[88:103]
    ds_read_b64_tr_b16 v[20:21], v6 offset:14336
    ds_read_b64_tr_b16 v[22:23], v6 offset:15360
    v_add_f32 v54, 1.0, v54
    v_add_f32 v55, 1.0, v55
    v_rcp_f32 v52, v52
    s_waitcnt lgkmcnt(6)
    v_mfma_f32_32x32x16_bf16 v[72:87], v[32:35], v[160:163], v[72:87]
    ds_read_b64_tr_b16 v[24:25], v6 offset:16384
    ds_read_b64_tr_b16 v[26:27], v6 offset:17408
    v_rcp_f32 v53, v53
    v_rcp_f32 v54, v54
    v_rcp_f32 v55, v55
    s_add_u32 m0, s61, 16384
    s_add_u32 s60, s72, 589952
    buffer_load_dwordx4 v3, s[28:31], s60 offen lds
    s_waitcnt lgkmcnt(6)
    v_mfma_f32_32x32x16_bf16 v[88:103], v[36:39], v[160:163], v[88:103]
    ds_read_b64_tr_b16 v[28:29], v6 offset:20480
    ds_read_b64_tr_b16 v[30:31], v6 offset:21504
    v_mul_f32 v68, v68, v52
    v_mul_f32 v69, v69, v53
    v_mul_f32 v70, v70, v54
    s_waitcnt lgkmcnt(6)
    v_mfma_f32_32x32x16_bf16 v[72:87], v[16:19], v[164:167], v[72:87]
    ds_read_b64_tr_b16 v[32:33], v6 offset:18432
    ds_read_b64_tr_b16 v[34:35], v6 offset:19456
    v_mul_f32 v71, v71, v55
    v_cvt_pk_bf16_f32 v48, v64, v65
    v_cvt_pk_bf16_f32 v49, v66, v67
    s_waitcnt lgkmcnt(6)
    v_mfma_f32_32x32x16_bf16 v[88:103], v[20:23], v[164:167], v[88:103]
    ds_read_b64_tr_b16 v[36:37], v6 offset:22528
    ds_read_b64_tr_b16 v[38:39], v6 offset:23552
    v_cvt_pk_bf16_f32 v50, v68, v69
    v_cvt_pk_bf16_f32 v51, v70, v71
    s_add_u32 s57, s69, 4096
    buffer_store_dwordx4 v[48:51], v2, s[36:39], s57 offen
    s_waitcnt lgkmcnt(6)
    v_mfma_f32_32x32x16_bf16 v[72:87], v[24:27], v[168:171], v[72:87]
    s_waitcnt vmcnt(12)
    s_barrier
    ds_read_b64_tr_b16 v[16:17], v6 offset:24576
    ds_read_b64_tr_b16 v[18:19], v6 offset:25600
    s_waitcnt lgkmcnt(6)
    v_mfma_f32_32x32x16_bf16 v[88:103], v[28:31], v[168:171], v[88:103]
    ds_read_b64_tr_b16 v[20:21], v6 offset:28672
    ds_read_b64_tr_b16 v[22:23], v6 offset:29696
    s_waitcnt lgkmcnt(6)
    v_mfma_f32_32x32x16_bf16 v[72:87], v[32:35], v[172:175], v[72:87]
    ds_read_b64_tr_b16 v[24:25], v6 offset:26624
    ds_read_b64_tr_b16 v[26:27], v6 offset:27648
    s_add_u32 m0, s61, 24576
    s_add_u32 s60, s72, 884864
    buffer_load_dwordx4 v3, s[28:31], s60 offen lds
    s_waitcnt lgkmcnt(6)
    v_mfma_f32_32x32x16_bf16 v[88:103], v[36:39], v[172:175], v[88:103]
    ds_read_b64_tr_b16 v[28:29], v6 offset:30720
    ds_read_b64_tr_b16 v[30:31], v6 offset:31744
    s_waitcnt lgkmcnt(6)
    v_mfma_f32_32x32x16_bf16 v[72:87], v[16:19], v[176:179], v[72:87]
    ds_read_b64_tr_b16 v[32:33], v6 offset:32768
    ds_read_b64_tr_b16 v[34:35], v6 offset:33792
    s_waitcnt lgkmcnt(6)
    v_mfma_f32_32x32x16_bf16 v[88:103], v[20:23], v[176:179], v[88:103]
    ds_read_b64_tr_b16 v[36:37], v6 offset:36864
    ds_read_b64_tr_b16 v[38:39], v6 offset:37888
    s_add_u32 m0, s61, 32768
    s_add_u32 s60, s72, 1179776
    buffer_load_dwordx4 v3, s[28:31], s60 offen lds
    s_waitcnt lgkmcnt(6)
    v_mfma_f32_32x32x16_bf16 v[72:87], v[24:27], v[180:183], v[72:87]
    ds_read_b64_tr_b16 v[16:17], v6 offset:34816
    ds_read_b64_tr_b16 v[18:19], v6 offset:35840
    s_waitcnt lgkmcnt(6)
    v_mfma_f32_32x32x16_bf16 v[88:103], v[28:31], v[180:183], v[88:103]
    ds_read_b64_tr_b16 v[20:21], v6 offset:38912
    ds_read_b64_tr_b16 v[22:23], v6 offset:39936
    s_waitcnt lgkmcnt(6)
    v_mfma_f32_32x32x16_bf16 v[72:87], v[32:35], v[184:187], v[72:87]
    ds_read_b64_tr_b16 v[24:25], v6 offset:40960
    ds_read_b64_tr_b16 v[26:27], v6 offset:41984
    s_add_u32 m0, s61, 40960
    s_add_u32 s60, s72, 1474688
    buffer_load_dwordx4 v3, s[28:31], s60 offen lds
    s_waitcnt lgkmcnt(6)
    v_mfma_f32_32x32x16_bf16 v[88:103], v[36:39], v[184:187], v[88:103]
    ds_read_b64_tr_b16 v[28:29], v6 offset:45056
    ds_read_b64_tr_b16 v[30:31], v6 offset:46080
    s_waitcnt lgkmcnt(6)
    v_mfma_f32_32x32x16_bf16 v[72:87], v[16:19], v[188:191], v[72:87]
    ds_read_b64_tr_b16 v[32:33], v6 offset:43008
    ds_read_b64_tr_b16 v[34:35], v6 offset:44032
    s_waitcnt lgkmcnt(6)
    v_mfma_f32_32x32x16_bf16 v[88:103], v[20:23], v[188:191], v[88:103]
    ds_read_b64_tr_b16 v[36:37], v6 offset:47104
    ds_read_b64_tr_b16 v[38:39], v6 offset:48128
    s_waitcnt lgkmcnt(6)
    v_mfma_f32_32x32x16_bf16 v[72:87], v[24:27], v[192:195], v[72:87]
    s_waitcnt vmcnt(11)
    s_barrier
    ds_read_b64_tr_b16 v[16:17], v7 offset:0
    ds_read_b64_tr_b16 v[18:19], v7 offset:1024
    s_waitcnt lgkmcnt(6)
    v_mfma_f32_32x32x16_bf16 v[88:103], v[28:31], v[192:195], v[88:103]
    ds_read_b64_tr_b16 v[20:21], v7 offset:4096
    ds_read_b64_tr_b16 v[22:23], v7 offset:5120
    s_waitcnt lgkmcnt(6)
    v_mfma_f32_32x32x16_bf16 v[72:87], v[32:35], v[196:199], v[72:87]
    ds_read_b64_tr_b16 v[24:25], v7 offset:2048
    ds_read_b64_tr_b16 v[26:27], v7 offset:3072
    s_add_u32 m0, s61, 49152
    s_add_u32 s60, s72, 1769600
    buffer_load_dwordx4 v3, s[28:31], s60 offen lds
    s_waitcnt lgkmcnt(6)
    v_mfma_f32_32x32x16_bf16 v[88:103], v[36:39], v[196:199], v[88:103]
    ds_read_b64_tr_b16 v[28:29], v7 offset:6144
    ds_read_b64_tr_b16 v[30:31], v7 offset:7168
    s_waitcnt lgkmcnt(6)
    v_mfma_f32_32x32x16_bf16 v[72:87], v[16:19], v[200:203], v[72:87]
    ds_read_b64_tr_b16 v[32:33], v7 offset:8192
    ds_read_b64_tr_b16 v[34:35], v7 offset:9216
    s_waitcnt lgkmcnt(6)
    v_mfma_f32_32x32x16_bf16 v[88:103], v[20:23], v[200:203], v[88:103]
    ds_read_b64_tr_b16 v[36:37], v7 offset:12288
    ds_read_b64_tr_b16 v[38:39], v7 offset:13312
    s_add_u32 m0, s61, 57344
    s_add_u32 s60, s72, 2064512
    buffer_load_dwordx4 v3, s[28:31], s60 offen lds
    s_waitcnt lgkmcnt(6)
    v_mfma_f32_32x32x16_bf16 v[72:87], v[24:27], v[204:207], v[72:87]
    ds_read_b64_tr_b16 v[16:17], v7 offset:10240
    ds_read_b64_tr_b16 v[18:19], v7 offset:11264
    s_waitcnt lgkmcnt(6)
    v_mfma_f32_32x32x16_bf16 v[88:103], v[28:31], v[204:207], v[88:103]
    ds_read_b64_tr_b16 v[20:21], v7 offset:14336
    ds_read_b64_tr_b16 v[22:23], v7 offset:15360
    s_waitcnt lgkmcnt(6)
    v_mfma_f32_32x32x16_bf16 v[72:87], v[32:35], v[208:211], v[72:87]
    ds_read_b64_tr_b16 v[24:25], v7 offset:16384
    ds_read_b64_tr_b16 v[26:27], v7 offset:17408
    s_add_u32 m0, s61, 65536
    s_add_u32 s60, s72, 2359424
    buffer_load_dwordx4 v3, s[28:31], s60 offen lds
    s_waitcnt lgkmcnt(6)
    v_mfma_f32_32x32x16_bf16 v[88:103], v[36:39], v[208:211], v[88:103]
    ds_read_b64_tr_b16 v[28:29], v7 offset:20480
    ds_read_b64_tr_b16 v[30:31], v7 offset:21504
    s_waitcnt lgkmcnt(6)
    v_mfma_f32_32x32x16_bf16 v[72:87], v[16:19], v[212:215], v[72:87]
    ds_read_b64_tr_b16 v[32:33], v7 offset:18432
    ds_read_b64_tr_b16 v[34:35], v7 offset:19456
    s_waitcnt lgkmcnt(6)
    v_mfma_f32_32x32x16_bf16 v[88:103], v[20:23], v[212:215], v[88:103]
    ds_read_b64_tr_b16 v[36:37], v7 offset:22528
    ds_read_b64_tr_b16 v[38:39], v7 offset:23552
    s_waitcnt lgkmcnt(6)
    v_mfma_f32_32x32x16_bf16 v[72:87], v[24:27], v[216:219], v[72:87]
    s_waitcnt vmcnt(6)
    s_barrier
    ds_read_b64_tr_b16 v[16:17], v7 offset:24576
    ds_read_b64_tr_b16 v[18:19], v7 offset:25600
    s_waitcnt lgkmcnt(6)
    v_mfma_f32_32x32x16_bf16 v[88:103], v[28:31], v[216:219], v[88:103]
    ds_read_b64_tr_b16 v[20:21], v7 offset:28672
    ds_read_b64_tr_b16 v[22:23], v7 offset:29696
    s_waitcnt lgkmcnt(6)
    v_mfma_f32_32x32x16_bf16 v[72:87], v[32:35], v[220:223], v[72:87]
    ds_read_b64_tr_b16 v[24:25], v7 offset:26624
    ds_read_b64_tr_b16 v[26:27], v7 offset:27648
    s_add_u32 m0, s61, 73728
    s_add_u32 s60, s72, 2654336
    buffer_load_dwordx4 v3, s[28:31], s60 offen lds
    s_waitcnt lgkmcnt(6)
    v_mfma_f32_32x32x16_bf16 v[88:103], v[36:39], v[220:223], v[88:103]
    ds_read_b64_tr_b16 v[28:29], v7 offset:30720
    ds_read_b64_tr_b16 v[30:31], v7 offset:31744
    s_waitcnt lgkmcnt(6)
    v_mfma_f32_32x32x16_bf16 v[72:87], v[16:19], v[224:227], v[72:87]
    ds_read_b64_tr_b16 v[32:33], v7 offset:32768
    ds_read_b64_tr_b16 v[34:35], v7 offset:33792
    s_waitcnt lgkmcnt(6)
    v_mfma_f32_32x32x16_bf16 v[88:103], v[20:23], v[224:227], v[88:103]
    ds_read_b64_tr_b16 v[36:37], v7 offset:36864
    ds_read_b64_tr_b16 v[38:39], v7 offset:37888
    s_add_u32 m0, s61, 81920
    s_add_u32 s60, s72, 2949248
    buffer_load_dwordx4 v3, s[28:31], s60 offen lds
    s_waitcnt lgkmcnt(6)
    v_mfma_f32_32x32x16_bf16 v[72:87], v[24:27], v[228:231], v[72:87]
    ds_read_b64_tr_b16 v[16:17], v7 offset:34816
    ds_read_b64_tr_b16 v[18:19], v7 offset:35840
    s_waitcnt lgkmcnt(6)
    v_mfma_f32_32x32x16_bf16 v[88:103], v[28:31], v[228:231], v[88:103]
    ds_read_b64_tr_b16 v[20:21], v7 offset:38912
    ds_read_b64_tr_b16 v[22:23], v7 offset:39936
    s_waitcnt lgkmcnt(6)
    v_mfma_f32_32x32x16_bf16 v[72:87], v[32:35], v[232:235], v[72:87]
    ds_read_b64_tr_b16 v[24:25], v7 offset:40960
    ds_read_b64_tr_b16 v[26:27], v7 offset:41984
    s_add_u32 m0, s61, 90112
    s_add_u32 s60, s72, 3244160
    buffer_load_dwordx4 v3, s[28:31], s60 offen lds
    s_waitcnt lgkmcnt(6)
    v_mfma_f32_32x32x16_bf16 v[88:103], v[36:39], v[232:235], v[88:103]
    ds_read_b64_tr_b16 v[28:29], v7 offset:45056
    ds_read_b64_tr_b16 v[30:31], v7 offset:46080
    s_waitcnt lgkmcnt(6)
    v_mfma_f32_32x32x16_bf16 v[72:87], v[16:19], v[236:239], v[72:87]
    ds_read_b64_tr_b16 v[32:33], v7 offset:43008
    ds_read_b64_tr_b16 v[34:35], v7 offset:44032
    s_waitcnt lgkmcnt(6)
    v_mfma_f32_32x32x16_bf16 v[88:103], v[20:23], v[236:239], v[88:103]
    ds_read_b64_tr_b16 v[36:37], v7 offset:47104
    ds_read_b64_tr_b16 v[38:39], v7 offset:48128
    s_waitcnt lgkmcnt(6)
    v_mfma_f32_32x32x16_bf16 v[72:87], v[24:27], v[240:243], v[72:87]
    s_waitcnt vmcnt(10)
    s_barrier
    ds_read_b64_tr_b16 v[16:17], v5 offset:0
    ds_read_b64_tr_b16 v[18:19], v5 offset:1024
    s_waitcnt lgkmcnt(6)
    v_mfma_f32_32x32x16_bf16 v[88:103], v[28:31], v[240:243], v[88:103]
    ds_read_b64_tr_b16 v[20:21], v5 offset:4096
    ds_read_b64_tr_b16 v[22:23], v5 offset:5120
    s_waitcnt lgkmcnt(6)
    v_mfma_f32_32x32x16_bf16 v[72:87], v[32:35], v[244:247], v[72:87]
    ds_read_b64_tr_b16 v[24:25], v5 offset:2048
    ds_read_b64_tr_b16 v[26:27], v5 offset:3072
    s_waitcnt lgkmcnt(6)
    v_mfma_f32_32x32x16_bf16 v[88:103], v[36:39], v[244:247], v[88:103]
    ds_read_b64_tr_b16 v[28:29], v5 offset:6144
    ds_read_b64_tr_b16 v[30:31], v5 offset:7168
    s_lshl_b32 s57, s54, 13
    s_lshl_b32 s69, s71, 14
    s_add_u32 s69, s69, s57
    s_add_u32 s69, s69, s64
    s_add_u32 s72, s72, 128
    s_add_u32 s71, s71, 1
    s_cmp_lt_u32 s71, 4
    s_cbranch_scc1 L_p1
    s_waitcnt lgkmcnt(6)
    v_mfma_f32_32x32x16_bf16 v[40:55], v[16:19], v[104:107], 0
    ds_read_b64_tr_b16 v[32:33], v5 offset:8192
    ds_read_b64_tr_b16 v[34:35], v5 offset:9216
    s_add_u32 m0, s61, 98304
    s_add_u32 s60, s72, 3538944
    buffer_load_dwordx4 v3, s[28:31], s60 offen lds
    s_waitcnt lgkmcnt(6)
    v_mfma_f32_32x32x16_bf16 v[56:71], v[20:23], v[104:107], 0
    ds_read_b64_tr_b16 v[36:37], v5 offset:12288
    ds_read_b64_tr_b16 v[38:39], v5 offset:13312
    s_waitcnt lgkmcnt(6)
    v_mfma_f32_32x32x16_bf16 v[40:55], v[24:27], v[108:111], v[40:55]
    ds_read_b64_tr_b16 v[16:17], v5 offset:10240
    ds_read_b64_tr_b16 v[18:19], v5 offset:11264
    s_waitcnt lgkmcnt(6)
    v_mfma_f32_32x32x16_bf16 v[56:71], v[28:31], v[108:111], v[56:71]
    ds_read_b64_tr_b16 v[20:21], v5 offset:14336
    ds_read_b64_tr_b16 v[22:23], v5 offset:15360
    v_mul_f32 v72, s68, v72
    v_mul_f32 v73, s68, v73
    v_mul_f32 v74, s68, v74
    v_mul_f32 v75, s68, v75
    s_add_u32 m0, s61, 106496
    s_add_u32 s60, s72, 3833856
    buffer_load_dwordx4 v3, s[28:31], s60 offen lds
    s_waitcnt lgkmcnt(6)
    v_mfma_f32_32x32x16_bf16 v[40:55], v[32:35], v[112:115], v[40:55]
    ds_read_b64_tr_b16 v[24:25], v5 offset:16384
    ds_read_b64_tr_b16 v[26:27], v5 offset:17408
    v_exp_f32 v72, v72
    v_exp_f32 v73, v73
    v_exp_f32 v74, v74
    s_waitcnt lgkmcnt(6)
    v_mfma_f32_32x32x16_bf16 v[56:71], v[36:39], v[112:115], v[56:71]
    ds_read_b64_tr_b16 v[28:29], v5 offset:20480
    ds_read_b64_tr_b16 v[30:31], v5 offset:21504
    v_exp_f32 v75, v75
    v_add_f32 v72, 1.0, v72
    v_add_f32 v73, 1.0, v73
    s_mul_i32 s65, s56, 442368
    s_mov_b32 s98, 384
    s_mov_b32 s48, s32
    s_mov_b32 s49, s33
    v_mov_b32 v8, v9
    buffer_load_dword v0, v8, s[48:51], s65 offen
    s_add_u32 s65, s65, s98
    s_waitcnt lgkmcnt(6)
    v_mfma_f32_32x32x16_bf16 v[40:55], v[16:19], v[116:119], v[40:55]
    ds_read_b64_tr_b16 v[32:33], v5 offset:18432
    ds_read_b64_tr_b16 v[34:35], v5 offset:19456
    v_add_f32 v74, 1.0, v74
    v_add_f32 v75, 1.0, v75
    v_rcp_f32 v72, v72
    s_add_u32 m0, s61, 114688
    s_add_u32 s60, s72, 4128768
    buffer_load_dwordx4 v3, s[28:31], s60 offen lds
    s_waitcnt lgkmcnt(6)
    v_mfma_f32_32x32x16_bf16 v[56:71], v[20:23], v[116:119], v[56:71]
    ds_read_b64_tr_b16 v[36:37], v5 offset:22528
    ds_read_b64_tr_b16 v[38:39], v5 offset:23552
    v_rcp_f32 v73, v73
    v_rcp_f32 v74, v74
    v_rcp_f32 v75, v75
    s_waitcnt lgkmcnt(6)
    v_mfma_f32_32x32x16_bf16 v[40:55], v[24:27], v[120:123], v[40:55]
    s_waitcnt vmcnt(10)
    s_barrier
    ds_read_b64_tr_b16 v[16:17], v5 offset:24576
    ds_read_b64_tr_b16 v[18:19], v5 offset:25600
    v_mul_f32 v88, v88, v72
    v_mul_f32 v89, v89, v73
    v_mul_f32 v90, v90, v74
    s_waitcnt lgkmcnt(6)
    v_mfma_f32_32x32x16_bf16 v[56:71], v[28:31], v[120:123], v[56:71]
    ds_read_b64_tr_b16 v[20:21], v5 offset:28672
    ds_read_b64_tr_b16 v[22:23], v5 offset:29696
    v_mul_f32 v91, v91, v75
    v_mul_f32 v76, s68, v76
    v_mul_f32 v77, s68, v77
    s_waitcnt lgkmcnt(6)
    v_mfma_f32_32x32x16_bf16 v[40:55], v[32:35], v[124:127], v[40:55]
    ds_read_b64_tr_b16 v[24:25], v5 offset:26624
    ds_read_b64_tr_b16 v[26:27], v5 offset:27648
    v_mul_f32 v78, s68, v78
    v_mul_f32 v79, s68, v79
    v_exp_f32 v76, v76
    s_add_u32 m0, s61, 122880
    s_add_u32 s60, s72, 4423680
    buffer_load_dwordx4 v3, s[28:31], s60 offen lds
    s_waitcnt lgkmcnt(6)
    v_mfma_f32_32x32x16_bf16 v[56:71], v[36:39], v[124:127], v[56:71]
    ds_read_b64_tr_b16 v[28:29], v5 offset:30720
    ds_read_b64_tr_b16 v[30:31], v5 offset:31744
    v_exp_f32 v77, v77
    v_exp_f32 v78, v78
    v_exp_f32 v79, v79
    s_waitcnt lgkmcnt(6)
    v_mfma_f32_32x32x16_bf16 v[40:55], v[16:19], v[128:131], v[40:55]
    ds_read_b64_tr_b16 v[32:33], v5 offset:32768
    ds_read_b64_tr_b16 v[34:35], v5 offset:33792
    v_add_f32 v76, 1.0, v76
    v_add_f32 v77, 1.0, v77
    v_add_f32 v78, 1.0, v78
    v_add_f32 v79, 1.0, v79
    s_waitcnt lgkmcnt(6)
    v_mfma_f32_32x32x16_bf16 v[56:71], v[20:23], v[128:131], v[56:71]
    ds_read_b64_tr_b16 v[36:37], v5 offset:36864
    ds_read_b64_tr_b16 v[38:39], v5 offset:37888
    v_rcp_f32 v76, v76
    v_rcp_f32 v77, v77
    v_rcp_f32 v78, v78
    s_add_u32 m0, s61, 131072
    s_add_u32 s60, s72, 4718592
    buffer_load_dwordx4 v3, s[28:31], s60 offen lds
    s_waitcnt lgkmcnt(6)
    v_mfma_f32_32x32x16_bf16 v[40:55], v[24:27], v[132:135], v[40:55]
    ds_read_b64_tr_b16 v[16:17], v5 offset:34816
    ds_read_b64_tr_b16 v[18:19], v5 offset:35840
    v_rcp_f32 v79, v79
    v_mul_f32 v92, v92, v76
    v_mul_f32 v93, v93, v77
    s_waitcnt lgkmcnt(6)
    v_mfma_f32_32x32x16_bf16 v[56:71], v[28:31], v[132:135], v[56:71]
    ds_read_b64_tr_b16 v[20:21], v5 offset:38912
    ds_read_b64_tr_b16 v[22:23], v5 offset:39936
    v_mul_f32 v94, v94, v78
    v_mul_f32 v95, v95, v79
    v_cvt_pk_bf16_f32 v72, v88, v89
    s_waitcnt lgkmcnt(6)
    v_mfma_f32_32x32x16_bf16 v[40:55], v[32:35], v[136:139], v[40:55]
    ds_read_b64_tr_b16 v[24:25], v5 offset:40960
    ds_read_b64_tr_b16 v[26:27], v5 offset:41984
    v_cvt_pk_bf16_f32 v73, v90, v91
    v_cvt_pk_bf16_f32 v74, v92, v93
    v_cvt_pk_bf16_f32 v75, v94, v95
    s_add_u32 m0, s61, 139264
    s_add_u32 s60, s72, 5013504
    buffer_load_dwordx4 v3, s[28:31], s60 offen lds
    s_waitcnt lgkmcnt(6)
    v_mfma_f32_32x32x16_bf16 v[56:71], v[36:39], v[136:139], v[56:71]
    ds_read_b64_tr_b16 v[28:29], v5 offset:45056
    ds_read_b64_tr_b16 v[30:31], v5 offset:46080
    s_add_u32 s57, s69, 0
    buffer_store_dwordx4 v[72:75], v2, s[36:39], s57 offen
    v_mul_f32 v80, s68, v80
    v_mul_f32 v81, s68, v81
    s_waitcnt lgkmcnt(6)
    v_mfma_f32_32x32x16_bf16 v[40:55], v[16:19], v[140:143], v[40:55]
    ds_read_b64_tr_b16 v[32:33], v5 offset:43008
    ds_read_b64_tr_b16 v[34:35], v5 offset:44032
    v_mul_f32 v82, s68, v82
    v_mul_f32 v83, s68, v83
    v_exp_f32 v80, v80
    s_waitcnt lgkmcnt(6)
    v_mfma_f32_32x32x16_bf16 v[56:71], v[20:23], v[140:143], v[56:71]
    ds_read_b64_tr_b16 v[36:37], v5 offset:47104
    ds_read_b64_tr_b16 v[38:39], v5 offset:48128
    v_exp_f32 v81, v81
    v_exp_f32 v82, v82
    v_exp_f32 v83, v83
    s_waitcnt lgkmcnt(6)
    v_mfma_f32_32x32x16_bf16 v[40:55], v[24:27], v[144:147], v[40:55]
    s_waitcnt vmcnt(11)
    s_barrier
    ds_read_b64_tr_b16 v[16:17], v6 offset:0
    ds_read_b64_tr_b16 v[18:19], v6 offset:1024
    v_add_f32 v80, 1.0, v80
    v_add_f32 v81, 1.0, v81
    v_add_f32 v82, 1.0, v82
    s_waitcnt lgkmcnt(6)
    v_mfma_f32_32x32x16_bf16 v[56:71], v[28:31], v[144:147], v[56:71]
    ds_read_b64_tr_b16 v[20:21], v6 offset:4096
    ds_read_b64_tr_b16 v[22:23], v6 offset:5120
    v_add_f32 v83, 1.0, v83
    v_rcp_f32 v80, v80
    v_rcp_f32 v81, v81
    s_waitcnt lgkmcnt(6)
    v_mfma_f32_32x32x16_bf16 v[40:55], v[32:35], v[148:151], v[40:55]
    ds_read_b64_tr_b16 v[24:25], v6 offset:2048
    ds_read_b64_tr_b16 v[26:27], v6 offset:3072
    v_rcp_f32 v82, v82
    v_rcp_f32 v83, v83
    v_mul_f32 v96, v96, v80
    v_mul_f32 v97, v97, v81
    s_add_u32 m0, s61, 0
    s_add_u32 s60, s72, 128
    buffer_load_dwordx4 v3, s[28:31], s60 offen lds
    s_waitcnt lgkmcnt(6)
    v_mfma_f32_32x32x16_bf16 v[56:71], v[36:39], v[148:151], v[56:71]
    ds_read_b64_tr_b16 v[28:29], v6 offset:6144
    ds_read_b64_tr_b16 v[30:31], v6 offset:7168
    v_mul_f32 v98, v98, v82
    v_mul_f32 v99, v99, v83
    v_mul_f32 v84, s68, v84
    s_waitcnt lgkmcnt(6)
    v_mfma_f32_32x32x16_bf16 v[40:55], v[16:19], v[152:155], v[40:55]
    ds_read_b64_tr_b16 v[32:33], v6 offset:8192
    ds_read_b64_tr_b16 v[34:35], v6 offset:9216
    v_mul_f32 v85, s68, v85
    v_mul_f32 v86, s68, v86
    v_mul_f32 v87, s68, v87
    s_waitcnt lgkmcnt(6)
    v_mfma_f32_32x32x16_bf16 v[56:71], v[20:23], v[152:155], v[56:71]
    ds_read_b64_tr_b16 v[36:37], v6 offset:12288
    ds_read_b64_tr_b16 v[38:39], v6 offset:13312
    v_exp_f32 v84, v84
    v_exp_f32 v85, v85
    v_exp_f32 v86, v86
    s_add_u32 m0, s61, 8192
    s_add_u32 s60, s72, 295040
    buffer_load_dwordx4 v3, s[28:31], s60 offen lds
    s_waitcnt lgkmcnt(6)
    v_mfma_f32_32x32x16_bf16 v[40:55], v[24:27], v[156:159], v[40:55]
    ds_read_b64_tr_b16 v[16:17], v6 offset:10240
    ds_read_b64_tr_b16 v[18:19], v6 offset:11264
    v_exp_f32 v87, v87
    v_add_f32 v84, 1.0, v84
    v_add_f32 v85, 1.0, v85
    s_waitcnt lgkmcnt(6)
    v_mfma_f32_32x32x16_bf16 v[56:71], v[28:31], v[156:159], v[56:71]
    ds_read_b64_tr_b16 v[20:21], v6 offset:14336
    ds_read_b64_tr_b16 v[22:23], v6 offset:15360
    v_add_f32 v86, 1.0, v86
    v_add_f32 v87, 1.0, v87
    v_rcp_f32 v84, v84
    s_waitcnt lgkmcnt(6)
    v_mfma_f32_32x32x16_bf16 v[40:55], v[32:35], v[160:163], v[40:55]
    ds_read_b64_tr_b16 v[24:25], v6 offset:16384
    ds_read_b64_tr_b16 v[26:27], v6 offset:17408
    v_rcp_f32 v85, v85
    v_rcp_f32 v86, v86
    v_rcp_f32 v87, v87
    s_add_u32 m0, s61, 16384
    s_add_u32 s60, s72, 589952
    buffer_load_dwordx4 v3, s[28:31], s60 offen lds
    s_waitcnt lgkmcnt(6)
    v_mfma_f32_32x32x16_bf16 v[56:71], v[36:39], v[160:163], v[56:71]
    ds_read_b64_tr_b16 v[28:29], v6 offset:20480
    ds_read_b64_tr_b16 v[30:31], v6 offset:21504
    v_mul_f32 v100, v100, v84
    v_mul_f32 v101, v101, v85
    v_mul_f32 v102, v102, v86
    s_waitcnt lgkmcnt(6)
    v_mfma_f32_32x32x16_bf16 v[40:55], v[16:19], v[164:167], v[40:55]
    ds_read_b64_tr_b16 v[32:33], v6 offset:18432
    ds_read_b64_tr_b16 v[34:35], v6 offset:19456
    v_mul_f32 v103, v103, v87
    v_cvt_pk_bf16_f32 v80, v96, v97
    v_cvt_pk_bf16_f32 v81, v98, v99
    s_waitcnt lgkmcnt(6)
    v_mfma_f32_32x32x16_bf16 v[56:71], v[20:23], v[164:167], v[56:71]
    ds_read_b64_tr_b16 v[36:37], v6 offset:22528
    ds_read_b64_tr_b16 v[38:39], v6 offset:23552
    v_cvt_pk_bf16_f32 v82, v100, v101
    v_cvt_pk_bf16_f32 v83, v102, v103
    s_add_u32 s57, s69, 4096
    buffer_store_dwordx4 v[80:83], v2, s[36:39], s57 offen
    s_waitcnt lgkmcnt(6)
    v_mfma_f32_32x32x16_bf16 v[40:55], v[24:27], v[168:171], v[40:55]
    s_waitcnt vmcnt(12)
    s_barrier
    ds_read_b64_tr_b16 v[16:17], v6 offset:24576
    ds_read_b64_tr_b16 v[18:19], v6 offset:25600
    s_waitcnt lgkmcnt(6)
    v_mfma_f32_32x32x16_bf16 v[56:71], v[28:31], v[168:171], v[56:71]
    ds_read_b64_tr_b16 v[20:21], v6 offset:28672
    ds_read_b64_tr_b16 v[22:23], v6 offset:29696
    s_waitcnt lgkmcnt(6)
    v_mfma_f32_32x32x16_bf16 v[40:55], v[32:35], v[172:175], v[40:55]
    ds_read_b64_tr_b16 v[24:25], v6 offset:26624
    ds_read_b64_tr_b16 v[26:27], v6 offset:27648
    s_add_u32 m0, s61, 24576
    s_add_u32 s60, s72, 884864
    buffer_load_dwordx4 v3, s[28:31], s60 offen lds
    s_waitcnt lgkmcnt(6)
    v_mfma_f32_32x32x16_bf16 v[56:71], v[36:39], v[172:175], v[56:71]
    ds_read_b64_tr_b16 v[28:29], v6 offset:30720
    ds_read_b64_tr_b16 v[30:31], v6 offset:31744
    s_waitcnt lgkmcnt(6)
    v_mfma_f32_32x32x16_bf16 v[40:55], v[16:19], v[176:179], v[40:55]
    ds_read_b64_tr_b16 v[32:33], v6 offset:32768
    ds_read_b64_tr_b16 v[34:35], v6 offset:33792
    s_waitcnt lgkmcnt(6)
    v_mfma_f32_32x32x16_bf16 v[56:71], v[20:23], v[176:179], v[56:71]
    ds_read_b64_tr_b16 v[36:37], v6 offset:36864
    ds_read_b64_tr_b16 v[38:39], v6 offset:37888
    s_add_u32 m0, s61, 32768
    s_add_u32 s60, s72, 1179776
    buffer_load_dwordx4 v3, s[28:31], s60 offen lds
    s_waitcnt lgkmcnt(6)
    v_mfma_f32_32x32x16_bf16 v[40:55], v[24:27], v[180:183], v[40:55]
    ds_read_b64_tr_b16 v[16:17], v6 offset:34816
    ds_read_b64_tr_b16 v[18:19], v6 offset:35840
    s_waitcnt lgkmcnt(6)
    v_mfma_f32_32x32x16_bf16 v[56:71], v[28:31], v[180:183], v[56:71]
    ds_read_b64_tr_b16 v[20:21], v6 offset:38912
    ds_read_b64_tr_b16 v[22:23], v6 offset:39936
    s_waitcnt lgkmcnt(6)
    v_mfma_f32_32x32x16_bf16 v[40:55], v[32:35], v[184:187], v[40:55]
    ds_read_b64_tr_b16 v[24:25], v6 offset:40960
    ds_read_b64_tr_b16 v[26:27], v6 offset:41984
    s_add_u32 m0, s61, 40960
    s_add_u32 s60, s72, 1474688
    buffer_load_dwordx4 v3, s[28:31], s60 offen lds
    s_waitcnt lgkmcnt(6)
    v_mfma_f32_32x32x16_bf16 v[56:71], v[36:39], v[184:187], v[56:71]
    ds_read_b64_tr_b16 v[28:29], v6 offset:45056
    ds_read_b64_tr_b16 v[30:31], v6 offset:46080
    s_waitcnt lgkmcnt(6)
    v_mfma_f32_32x32x16_bf16 v[40:55], v[16:19], v[188:191], v[40:55]
    ds_read_b64_tr_b16 v[32:33], v6 offset:43008
    ds_read_b64_tr_b16 v[34:35], v6 offset:44032
    s_waitcnt lgkmcnt(6)
    v_mfma_f32_32x32x16_bf16 v[56:71], v[20:23], v[188:191], v[56:71]
    ds_read_b64_tr_b16 v[36:37], v6 offset:47104
    ds_read_b64_tr_b16 v[38:39], v6 offset:48128
    s_waitcnt lgkmcnt(6)
    v_mfma_f32_32x32x16_bf16 v[40:55], v[24:27], v[192:195], v[40:55]
    s_waitcnt vmcnt(11)
    s_barrier
    ds_read_b64_tr_b16 v[16:17], v7 offset:0
    ds_read_b64_tr_b16 v[18:19], v7 offset:1024
    s_waitcnt lgkmcnt(6)
    v_mfma_f32_32x32x16_bf16 v[56:71], v[28:31], v[192:195], v[56:71]
    ds_read_b64_tr_b16 v[20:21], v7 offset:4096
    ds_read_b64_tr_b16 v[22:23], v7 offset:5120
    s_waitcnt lgkmcnt(6)
    v_mfma_f32_32x32x16_bf16 v[40:55], v[32:35], v[196:199], v[40:55]
    ds_read_b64_tr_b16 v[24:25], v7 offset:2048
    ds_read_b64_tr_b16 v[26:27], v7 offset:3072
    s_add_u32 m0, s61, 49152
    s_add_u32 s60, s72, 1769600
    buffer_load_dwordx4 v3, s[28:31], s60 offen lds
    s_waitcnt lgkmcnt(6)
    v_mfma_f32_32x32x16_bf16 v[56:71], v[36:39], v[196:199], v[56:71]
    ds_read_b64_tr_b16 v[28:29], v7 offset:6144
    ds_read_b64_tr_b16 v[30:31], v7 offset:7168
    s_waitcnt lgkmcnt(6)
    v_mfma_f32_32x32x16_bf16 v[40:55], v[16:19], v[200:203], v[40:55]
    ds_read_b64_tr_b16 v[32:33], v7 offset:8192
    ds_read_b64_tr_b16 v[34:35], v7 offset:9216
    s_waitcnt lgkmcnt(6)
    v_mfma_f32_32x32x16_bf16 v[56:71], v[20:23], v[200:203], v[56:71]
    ds_read_b64_tr_b16 v[36:37], v7 offset:12288
    ds_read_b64_tr_b16 v[38:39], v7 offset:13312
    s_add_u32 m0, s61, 57344
    s_add_u32 s60, s72, 2064512
    buffer_load_dwordx4 v3, s[28:31], s60 offen lds
    s_waitcnt lgkmcnt(6)
    v_mfma_f32_32x32x16_bf16 v[40:55], v[24:27], v[204:207], v[40:55]
    ds_read_b64_tr_b16 v[16:17], v7 offset:10240
    ds_read_b64_tr_b16 v[18:19], v7 offset:11264
    s_waitcnt lgkmcnt(6)
    v_mfma_f32_32x32x16_bf16 v[56:71], v[28:31], v[204:207], v[56:71]
    ds_read_b64_tr_b16 v[20:21], v7 offset:14336
    ds_read_b64_tr_b16 v[22:23], v7 offset:15360
    s_waitcnt lgkmcnt(6)
    v_mfma_f32_32x32x16_bf16 v[40:55], v[32:35], v[208:211], v[40:55]
    ds_read_b64_tr_b16 v[24:25], v7 offset:16384
    ds_read_b64_tr_b16 v[26:27], v7 offset:17408
    s_add_u32 m0, s61, 65536
    s_add_u32 s60, s72, 2359424
    buffer_load_dwordx4 v3, s[28:31], s60 offen lds
    s_waitcnt lgkmcnt(6)
    v_mfma_f32_32x32x16_bf16 v[56:71], v[36:39], v[208:211], v[56:71]
    ds_read_b64_tr_b16 v[28:29], v7 offset:20480
    ds_read_b64_tr_b16 v[30:31], v7 offset:21504
    s_waitcnt lgkmcnt(6)
    v_mfma_f32_32x32x16_bf16 v[40:55], v[16:19], v[212:215], v[40:55]
    ds_read_b64_tr_b16 v[32:33], v7 offset:18432
    ds_read_b64_tr_b16 v[34:35], v7 offset:19456
    s_waitcnt lgkmcnt(6)
    v_mfma_f32_32x32x16_bf16 v[56:71], v[20:23], v[212:215], v[56:71]
    ds_read_b64_tr_b16 v[36:37], v7 offset:22528
    ds_read_b64_tr_b16 v[38:39], v7 offset:23552
    s_waitcnt lgkmcnt(6)
    v_mfma_f32_32x32x16_bf16 v[40:55], v[24:27], v[216:219], v[40:55]
    s_waitcnt vmcnt(6)
    s_barrier
    ds_read_b64_tr_b16 v[16:17], v7 offset:24576
    ds_read_b64_tr_b16 v[18:19], v7 offset:25600
    s_waitcnt lgkmcnt(6)
    v_mfma_f32_32x32x16_bf16 v[56:71], v[28:31], v[216:219], v[56:71]
    ds_read_b64_tr_b16 v[20:21], v7 offset:28672
    ds_read_b64_tr_b16 v[22:23], v7 offset:29696
    s_waitcnt lgkmcnt(6)
    v_mfma_f32_32x32x16_bf16 v[40:55], v[32:35], v[220:223], v[40:55]
    ds_read_b64_tr_b16 v[24:25], v7 offset:26624
    ds_read_b64_tr_b16 v[26:27], v7 offset:27648
    s_add_u32 m0, s61, 73728
    s_add_u32 s60, s72, 2654336
    buffer_load_dwordx4 v3, s[28:31], s60 offen lds
    s_waitcnt lgkmcnt(6)
    v_mfma_f32_32x32x16_bf16 v[56:71], v[36:39], v[220:223], v[56:71]
    ds_read_b64_tr_b16 v[28:29], v7 offset:30720
    ds_read_b64_tr_b16 v[30:31], v7 offset:31744
    s_waitcnt lgkmcnt(6)
    v_mfma_f32_32x32x16_bf16 v[40:55], v[16:19], v[224:227], v[40:55]
    ds_read_b64_tr_b16 v[32:33], v7 offset:32768
    ds_read_b64_tr_b16 v[34:35], v7 offset:33792
    s_waitcnt lgkmcnt(6)
    v_mfma_f32_32x32x16_bf16 v[56:71], v[20:23], v[224:227], v[56:71]
    ds_read_b64_tr_b16 v[36:37], v7 offset:36864
    ds_read_b64_tr_b16 v[38:39], v7 offset:37888
    s_add_u32 m0, s61, 81920
    s_add_u32 s60, s72, 2949248
    buffer_load_dwordx4 v3, s[28:31], s60 offen lds
    s_waitcnt lgkmcnt(6)
    v_mfma_f32_32x32x16_bf16 v[40:55], v[24:27], v[228:231], v[40:55]
    ds_read_b64_tr_b16 v[16:17], v7 offset:34816
    ds_read_b64_tr_b16 v[18:19], v7 offset:35840
    s_waitcnt lgkmcnt(6)
    v_mfma_f32_32x32x16_bf16 v[56:71], v[28:31], v[228:231], v[56:71]
    ds_read_b64_tr_b16 v[20:21], v7 offset:38912
    ds_read_b64_tr_b16 v[22:23], v7 offset:39936
    s_waitcnt lgkmcnt(6)
    v_mfma_f32_32x32x16_bf16 v[40:55], v[32:35], v[232:235], v[40:55]
    ds_read_b64_tr_b16 v[24:25], v7 offset:40960
    ds_read_b64_tr_b16 v[26:27], v7 offset:41984
    s_add_u32 m0, s61, 90112
    s_add_u32 s60, s72, 3244160
    buffer_load_dwordx4 v3, s[28:31], s60 offen lds
    s_waitcnt lgkmcnt(6)
    v_mfma_f32_32x32x16_bf16 v[56:71], v[36:39], v[232:235], v[56:71]
    ds_read_b64_tr_b16 v[28:29], v7 offset:45056
    ds_read_b64_tr_b16 v[30:31], v7 offset:46080
    s_waitcnt lgkmcnt(6)
    v_mfma_f32_32x32x16_bf16 v[40:55], v[16:19], v[236:239], v[40:55]
    ds_read_b64_tr_b16 v[32:33], v7 offset:43008
    ds_read_b64_tr_b16 v[34:35], v7 offset:44032
    s_waitcnt lgkmcnt(6)
    v_mfma_f32_32x32x16_bf16 v[56:71], v[20:23], v[236:239], v[56:71]
    ds_read_b64_tr_b16 v[36:37], v7 offset:47104
    ds_read_b64_tr_b16 v[38:39], v7 offset:48128
    s_waitcnt lgkmcnt(6)
    v_mfma_f32_32x32x16_bf16 v[40:55], v[24:27], v[240:243], v[40:55]
    s_waitcnt vmcnt(10)
    s_barrier
    ds_read_b64_tr_b16 v[16:17], v5 offset:0
    ds_read_b64_tr_b16 v[18:19], v5 offset:1024
    s_waitcnt lgkmcnt(6)
    v_mfma_f32_32x32x16_bf16 v[56:71], v[28:31], v[240:243], v[56:71]
    ds_read_b64_tr_b16 v[20:21], v5 offset:4096
    ds_read_b64_tr_b16 v[22:23], v5 offset:5120
    s_waitcnt lgkmcnt(6)
    v_mfma_f32_32x32x16_bf16 v[40:55], v[32:35], v[244:247], v[40:55]
    ds_read_b64_tr_b16 v[24:25], v5 offset:2048
    ds_read_b64_tr_b16 v[26:27], v5 offset:3072
    s_waitcnt lgkmcnt(6)
    v_mfma_f32_32x32x16_bf16 v[56:71], v[36:39], v[244:247], v[56:71]
    ds_read_b64_tr_b16 v[28:29], v5 offset:6144
    ds_read_b64_tr_b16 v[30:31], v5 offset:7168
    s_lshl_b32 s57, s54, 13
    s_lshl_b32 s69, s71, 14
    s_add_u32 s69, s69, s57
    s_add_u32 s69, s69, s64
    s_add_u32 s72, s72, 128
    s_add_u32 s71, s71, 1
    s_waitcnt lgkmcnt(6)
    v_mfma_f32_32x32x16_bf16 v[72:87], v[16:19], v[104:107], 0
    ds_read_b64_tr_b16 v[32:33], v5 offset:8192
    ds_read_b64_tr_b16 v[34:35], v5 offset:9216
    s_add_u32 m0, s61, 98304
    s_add_u32 s60, s72, 3538944
    buffer_load_dwordx4 v3, s[28:31], s60 offen lds
    s_waitcnt lgkmcnt(6)
    v_mfma_f32_32x32x16_bf16 v[88:103], v[20:23], v[104:107], 0
    ds_read_b64_tr_b16 v[36:37], v5 offset:12288
    ds_read_b64_tr_b16 v[38:39], v5 offset:13312
    s_waitcnt lgkmcnt(6)
    v_mfma_f32_32x32x16_bf16 v[72:87], v[24:27], v[108:111], v[72:87]
    ds_read_b64_tr_b16 v[16:17], v5 offset:10240
    ds_read_b64_tr_b16 v[18:19], v5 offset:11264
    s_waitcnt lgkmcnt(6)
    v_mfma_f32_32x32x16_bf16 v[88:103], v[28:31], v[108:111], v[88:103]
    ds_read_b64_tr_b16 v[20:21], v5 offset:14336
    ds_read_b64_tr_b16 v[22:23], v5 offset:15360
    v_mul_f32 v40, s68, v40
    v_mul_f32 v41, s68, v41
    v_mul_f32 v42, s68, v42
    v_mul_f32 v43, s68, v43
    s_add_u32 m0, s61, 106496
    s_add_u32 s60, s72, 3833856
    buffer_load_dwordx4 v3, s[28:31], s60 offen lds
    s_waitcnt lgkmcnt(6)
    v_mfma_f32_32x32x16_bf16 v[72:87], v[32:35], v[112:115], v[72:87]
    ds_read_b64_tr_b16 v[24:25], v5 offset:16384
    ds_read_b64_tr_b16 v[26:27], v5 offset:17408
    v_exp_f32 v40, v40
    v_exp_f32 v41, v41
    v_exp_f32 v42, v42
    s_add_u32 s57, s64, 0
    buffer_load_dwordx4 v[104:107], v2, s[36:39], s57 offen
    s_waitcnt lgkmcnt(6)
    v_mfma_f32_32x32x16_bf16 v[88:103], v[36:39], v[112:115], v[88:103]
    ds_read_b64_tr_b16 v[28:29], v5 offset:20480
    ds_read_b64_tr_b16 v[30:31], v5 offset:21504
    v_exp_f32 v43, v43
    v_add_f32 v40, 1.0, v40
    v_add_f32 v41, 1.0, v41
    buffer_load_dword v0, v8, s[48:51], s65 offen
    s_add_u32 s65, s65, s98
    s_waitcnt lgkmcnt(6)
    v_mfma_f32_32x32x16_bf16 v[72:87], v[16:19], v[116:119], v[72:87]
    ds_read_b64_tr_b16 v[32:33], v5 offset:18432
    ds_read_b64_tr_b16 v[34:35], v5 offset:19456
    v_add_f32 v42, 1.0, v42
    v_add_f32 v43, 1.0, v43
    v_rcp_f32 v40, v40
    s_add_u32 m0, s61, 114688
    s_add_u32 s60, s72, 4128768
    buffer_load_dwordx4 v3, s[28:31], s60 offen lds
    s_waitcnt lgkmcnt(6)
    v_mfma_f32_32x32x16_bf16 v[88:103], v[20:23], v[116:119], v[88:103]
    ds_read_b64_tr_b16 v[36:37], v5 offset:22528
    ds_read_b64_tr_b16 v[38:39], v5 offset:23552
    v_rcp_f32 v41, v41
    v_rcp_f32 v42, v42
    v_rcp_f32 v43, v43
    s_waitcnt lgkmcnt(6)
    v_mfma_f32_32x32x16_bf16 v[72:87], v[24:27], v[120:123], v[72:87]
    s_waitcnt vmcnt(11)
    s_barrier
    ds_read_b64_tr_b16 v[16:17], v5 offset:24576
    ds_read_b64_tr_b16 v[18:19], v5 offset:25600
    v_mul_f32 v56, v56, v40
    v_mul_f32 v57, v57, v41
    v_mul_f32 v58, v58, v42
    s_waitcnt lgkmcnt(6)
    v_mfma_f32_32x32x16_bf16 v[88:103], v[28:31], v[120:123], v[88:103]
    ds_read_b64_tr_b16 v[20:21], v5 offset:28672
    ds_read_b64_tr_b16 v[22:23], v5 offset:29696
    v_mul_f32 v59, v59, v43
    v_mul_f32 v44, s68, v44
    v_mul_f32 v45, s68, v45
    s_waitcnt lgkmcnt(6)
    v_mfma_f32_32x32x16_bf16 v[72:87], v[32:35], v[124:127], v[72:87]
    ds_read_b64_tr_b16 v[24:25], v5 offset:26624
    ds_read_b64_tr_b16 v[26:27], v5 offset:27648
    v_mul_f32 v46, s68, v46
    v_mul_f32 v47, s68, v47
    v_exp_f32 v44, v44
    s_add_u32 m0, s61, 122880
    s_add_u32 s60, s72, 4423680
    buffer_load_dwordx4 v3, s[28:31], s60 offen lds
    s_waitcnt lgkmcnt(6)
    v_mfma_f32_32x32x16_bf16 v[88:103], v[36:39], v[124:127], v[88:103]
    ds_read_b64_tr_b16 v[28:29], v5 offset:30720
    ds_read_b64_tr_b16 v[30:31], v5 offset:31744
    v_exp_f32 v45, v45
    v_exp_f32 v46, v46
    v_exp_f32 v47, v47
    s_waitcnt lgkmcnt(6)
    v_mfma_f32_32x32x16_bf16 v[72:87], v[16:19], v[128:131], v[72:87]
    ds_read_b64_tr_b16 v[32:33], v5 offset:32768
    ds_read_b64_tr_b16 v[34:35], v5 offset:33792
    v_add_f32 v44, 1.0, v44
    v_add_f32 v45, 1.0, v45
    v_add_f32 v46, 1.0, v46
    v_add_f32 v47, 1.0, v47
    s_add_u32 s57, s64, 4096
    buffer_load_dwordx4 v[108:111], v2, s[36:39], s57 offen
    s_waitcnt lgkmcnt(6)
    v_mfma_f32_32x32x16_bf16 v[88:103], v[20:23], v[128:131], v[88:103]
    ds_read_b64_tr_b16 v[36:37], v5 offset:36864
    ds_read_b64_tr_b16 v[38:39], v5 offset:37888
    v_rcp_f32 v44, v44
    v_rcp_f32 v45, v45
    v_rcp_f32 v46, v46
    s_add_u32 m0, s61, 131072
    s_add_u32 s60, s72, 4718592
    buffer_load_dwordx4 v3, s[28:31], s60 offen lds
    s_waitcnt lgkmcnt(6)
    v_mfma_f32_32x32x16_bf16 v[72:87], v[24:27], v[132:135], v[72:87]
    ds_read_b64_tr_b16 v[16:17], v5 offset:34816
    ds_read_b64_tr_b16 v[18:19], v5 offset:35840
    v_rcp_f32 v47, v47
    v_mul_f32 v60, v60, v44
    v_mul_f32 v61, v61, v45
    s_waitcnt lgkmcnt(6)
    v_mfma_f32_32x32x16_bf16 v[88:103], v[28:31], v[132:135], v[88:103]
    ds_read_b64_tr_b16 v[20:21], v5 offset:38912
    ds_read_b64_tr_b16 v[22:23], v5 offset:39936
    v_mul_f32 v62, v62, v46
    v_mul_f32 v63, v63, v47
    v_cvt_pk_bf16_f32 v40, v56, v57
    s_waitcnt lgkmcnt(6)
    v_mfma_f32_32x32x16_bf16 v[72:87], v[32:35], v[136:139], v[72:87]
    ds_read_b64_tr_b16 v[24:25], v5 offset:40960
    ds_read_b64_tr_b16 v[26:27], v5 offset:41984
    v_cvt_pk_bf16_f32 v41, v58, v59
    v_cvt_pk_bf16_f32 v42, v60, v61
    v_cvt_pk_bf16_f32 v43, v62, v63
    s_add_u32 m0, s61, 139264
    s_add_u32 s60, s72, 5013504
    buffer_load_dwordx4 v3, s[28:31], s60 offen lds
    s_waitcnt lgkmcnt(6)
    v_mfma_f32_32x32x16_bf16 v[88:103], v[36:39], v[136:139], v[88:103]
    ds_read_b64_tr_b16 v[28:29], v5 offset:45056
    ds_read_b64_tr_b16 v[30:31], v5 offset:46080
    s_add_u32 s57, s69, 0
    buffer_store_dwordx4 v[40:43], v2, s[36:39], s57 offen
    v_mul_f32 v48, s68, v48
    v_mul_f32 v49, s68, v49
    s_waitcnt lgkmcnt(6)
    v_mfma_f32_32x32x16_bf16 v[72:87], v[16:19], v[140:143], v[72:87]
    ds_read_b64_tr_b16 v[32:33], v5 offset:43008
    ds_read_b64_tr_b16 v[34:35], v5 offset:44032
    v_mul_f32 v50, s68, v50
    v_mul_f32 v51, s68, v51
    v_exp_f32 v48, v48
    s_waitcnt lgkmcnt(6)
    v_mfma_f32_32x32x16_bf16 v[88:103], v[20:23], v[140:143], v[88:103]
    ds_read_b64_tr_b16 v[36:37], v5 offset:47104
    ds_read_b64_tr_b16 v[38:39], v5 offset:48128
    v_exp_f32 v49, v49
    v_exp_f32 v50, v50
    v_exp_f32 v51, v51
    s_waitcnt lgkmcnt(6)
    v_mfma_f32_32x32x16_bf16 v[72:87], v[24:27], v[144:147], v[72:87]
    s_waitcnt vmcnt(13)
    s_barrier
    ds_read_b64_tr_b16 v[16:17], v6 offset:0
    ds_read_b64_tr_b16 v[18:19], v6 offset:1024
    v_add_f32 v48, 1.0, v48
    v_add_f32 v49, 1.0, v49
    v_add_f32 v50, 1.0, v50
    s_add_u32 s57, s64, 8192
    buffer_load_dwordx4 v[112:115], v2, s[36:39], s57 offen
    s_waitcnt lgkmcnt(6)
    v_mfma_f32_32x32x16_bf16 v[88:103], v[28:31], v[144:147], v[88:103]
    ds_read_b64_tr_b16 v[20:21], v6 offset:4096
    ds_read_b64_tr_b16 v[22:23], v6 offset:5120
    v_add_f32 v51, 1.0, v51
    v_rcp_f32 v48, v48
    v_rcp_f32 v49, v49
    s_waitcnt lgkmcnt(6)
    v_mfma_f32_32x32x16_bf16 v[72:87], v[32:35], v[148:151], v[72:87]
    ds_read_b64_tr_b16 v[24:25], v6 offset:2048
    ds_read_b64_tr_b16 v[26:27], v6 offset:3072
    v_rcp_f32 v50, v50
    v_rcp_f32 v51, v51
    v_mul_f32 v64, v64, v48
    v_mul_f32 v65, v65, v49
    s_add_u32 m0, s61, 0
    s_add_u32 s60, s63, 0
    buffer_load_dwordx4 v4, s[32:35], s60 offen lds
    s_waitcnt lgkmcnt(6)
    v_mfma_f32_32x32x16_bf16 v[88:103], v[36:39], v[148:151], v[88:103]
    ds_read_b64_tr_b16 v[28:29], v6 offset:6144
    ds_read_b64_tr_b16 v[30:31], v6 offset:7168
    v_mul_f32 v66, v66, v50
    v_mul_f32 v67, v67, v51
    v_mul_f32 v52, s68, v52
    s_waitcnt lgkmcnt(6)
    v_mfma_f32_32x32x16_bf16 v[72:87], v[16:19], v[152:155], v[72:87]
    ds_read_b64_tr_b16 v[32:33], v6 offset:8192
    ds_read_b64_tr_b16 v[34:35], v6 offset:9216
    v_mul_f32 v53, s68, v53
    v_mul_f32 v54, s68, v54
    v_mul_f32 v55, s68, v55
    s_waitcnt lgkmcnt(6)
    v_mfma_f32_32x32x16_bf16 v[88:103], v[20:23], v[152:155], v[88:103]
    ds_read_b64_tr_b16 v[36:37], v6 offset:12288
    ds_read_b64_tr_b16 v[38:39], v6 offset:13312
    v_exp_f32 v52, v52
    v_exp_f32 v53, v53
    v_exp_f32 v54, v54
    s_add_u32 m0, s61, 8192
    s_add_u32 s60, s63, 73728
    buffer_load_dwordx4 v4, s[32:35], s60 offen lds
    s_waitcnt lgkmcnt(6)
    v_mfma_f32_32x32x16_bf16 v[72:87], v[24:27], v[156:159], v[72:87]
    ds_read_b64_tr_b16 v[16:17], v6 offset:10240
    ds_read_b64_tr_b16 v[18:19], v6 offset:11264
    v_exp_f32 v55, v55
    v_add_f32 v52, 1.0, v52
    v_add_f32 v53, 1.0, v53
    s_waitcnt lgkmcnt(6)
    v_mfma_f32_32x32x16_bf16 v[88:103], v[28:31], v[156:159], v[88:103]
    ds_read_b64_tr_b16 v[20:21], v6 offset:14336
    ds_read_b64_tr_b16 v[22:23], v6 offset:15360
    v_add_f32 v54, 1.0, v54
    v_add_f32 v55, 1.0, v55
    v_rcp_f32 v52, v52
    s_waitcnt lgkmcnt(6)
    v_mfma_f32_32x32x16_bf16 v[72:87], v[32:35], v[160:163], v[72:87]
    ds_read_b64_tr_b16 v[24:25], v6 offset:16384
    ds_read_b64_tr_b16 v[26:27], v6 offset:17408
    v_rcp_f32 v53, v53
    v_rcp_f32 v54, v54
    v_rcp_f32 v55, v55
    s_add_u32 m0, s61, 16384
    s_add_u32 s60, s63, 147456
    buffer_load_dwordx4 v4, s[32:35], s60 offen lds
    s_add_u32 s57, s64, 12288
    buffer_load_dwordx4 v[116:119], v2, s[36:39], s57 offen
    s_waitcnt lgkmcnt(6)
    v_mfma_f32_32x32x16_bf16 v[88:103], v[36:39], v[160:163], v[88:103]
    ds_read_b64_tr_b16 v[28:29], v6 offset:20480
    ds_read_b64_tr_b16 v[30:31], v6 offset:21504
    v_mul_f32 v68, v68, v52
    v_mul_f32 v69, v69, v53
    v_mul_f32 v70, v70, v54
    s_waitcnt lgkmcnt(6)
    v_mfma_f32_32x32x16_bf16 v[72:87], v[16:19], v[164:167], v[72:87]
    ds_read_b64_tr_b16 v[32:33], v6 offset:18432
    ds_read_b64_tr_b16 v[34:35], v6 offset:19456
    v_mul_f32 v71, v71, v55
    v_cvt_pk_bf16_f32 v48, v64, v65
    v_cvt_pk_bf16_f32 v49, v66, v67
    s_waitcnt lgkmcnt(6)
    v_mfma_f32_32x32x16_bf16 v[88:103], v[20:23], v[164:167], v[88:103]
    ds_read_b64_tr_b16 v[36:37], v6 offset:22528
    ds_read_b64_tr_b16 v[38:39], v6 offset:23552
    v_cvt_pk_bf16_f32 v50, v68, v69
    v_cvt_pk_bf16_f32 v51, v70, v71
    s_add_u32 s57, s69, 4096
    buffer_store_dwordx4 v[48:51], v2, s[36:39], s57 offen
    s_waitcnt lgkmcnt(6)
    v_mfma_f32_32x32x16_bf16 v[72:87], v[24:27], v[168:171], v[72:87]
    s_waitcnt vmcnt(16)
    s_barrier
    ds_read_b64_tr_b16 v[16:17], v6 offset:24576
    ds_read_b64_tr_b16 v[18:19], v6 offset:25600
    s_waitcnt lgkmcnt(6)
    v_mfma_f32_32x32x16_bf16 v[88:103], v[28:31], v[168:171], v[88:103]
    ds_read_b64_tr_b16 v[20:21], v6 offset:28672
    ds_read_b64_tr_b16 v[22:23], v6 offset:29696
    s_waitcnt lgkmcnt(6)
    v_mfma_f32_32x32x16_bf16 v[72:87], v[32:35], v[172:175], v[72:87]
    ds_read_b64_tr_b16 v[24:25], v6 offset:26624
    ds_read_b64_tr_b16 v[26:27], v6 offset:27648
    s_add_u32 m0, s61, 24576
    s_add_u32 s60, s63, 221184
    buffer_load_dwordx4 v4, s[32:35], s60 offen lds
    s_waitcnt lgkmcnt(6)
    v_mfma_f32_32x32x16_bf16 v[88:103], v[36:39], v[172:175], v[88:103]
    ds_read_b64_tr_b16 v[28:29], v6 offset:30720
    ds_read_b64_tr_b16 v[30:31], v6 offset:31744
    s_waitcnt lgkmcnt(6)
    v_mfma_f32_32x32x16_bf16 v[72:87], v[16:19], v[176:179], v[72:87]
    ds_read_b64_tr_b16 v[32:33], v6 offset:32768
    ds_read_b64_tr_b16 v[34:35], v6 offset:33792
    s_waitcnt lgkmcnt(6)
    v_mfma_f32_32x32x16_bf16 v[88:103], v[20:23], v[176:179], v[88:103]
    ds_read_b64_tr_b16 v[36:37], v6 offset:36864
    ds_read_b64_tr_b16 v[38:39], v6 offset:37888
    s_add_u32 m0, s61, 32768
    s_add_u32 s60, s63, 294912
    buffer_load_dwordx4 v4, s[32:35], s60 offen lds
    s_add_u32 s57, s64, 16384
    buffer_load_dwordx4 v[120:123], v2, s[36:39], s57 offen
    s_waitcnt lgkmcnt(6)
    v_mfma_f32_32x32x16_bf16 v[72:87], v[24:27], v[180:183], v[72:87]
    ds_read_b64_tr_b16 v[16:17], v6 offset:34816
    ds_read_b64_tr_b16 v[18:19], v6 offset:35840
    s_waitcnt lgkmcnt(6)
    v_mfma_f32_32x32x16_bf16 v[88:103], v[28:31], v[180:183], v[88:103]
    ds_read_b64_tr_b16 v[20:21], v6 offset:38912
    ds_read_b64_tr_b16 v[22:23], v6 offset:39936
    s_waitcnt lgkmcnt(6)
    v_mfma_f32_32x32x16_bf16 v[72:87], v[32:35], v[184:187], v[72:87]
    ds_read_b64_tr_b16 v[24:25], v6 offset:40960
    ds_read_b64_tr_b16 v[26:27], v6 offset:41984
    s_add_u32 m0, s61, 40960
    s_add_u32 s60, s63, 368640
    buffer_load_dwordx4 v4, s[32:35], s60 offen lds
    s_waitcnt lgkmcnt(6)
    v_mfma_f32_32x32x16_bf16 v[88:103], v[36:39], v[184:187], v[88:103]
    ds_read_b64_tr_b16 v[28:29], v6 offset:45056
    ds_read_b64_tr_b16 v[30:31], v6 offset:46080
    s_waitcnt lgkmcnt(6)
    v_mfma_f32_32x32x16_bf16 v[72:87], v[16:19], v[188:191], v[72:87]
    ds_read_b64_tr_b16 v[32:33], v6 offset:43008
    ds_read_b64_tr_b16 v[34:35], v6 offset:44032
    s_waitcnt lgkmcnt(6)
    v_mfma_f32_32x32x16_bf16 v[88:103], v[20:23], v[188:191], v[88:103]
    ds_read_b64_tr_b16 v[36:37], v6 offset:47104
    ds_read_b64_tr_b16 v[38:39], v6 offset:48128
    s_waitcnt lgkmcnt(6)
    v_mfma_f32_32x32x16_bf16 v[72:87], v[24:27], v[192:195], v[72:87]
    s_waitcnt vmcnt(15)
    s_barrier
    ds_read_b64_tr_b16 v[16:17], v7 offset:0
    ds_read_b64_tr_b16 v[18:19], v7 offset:1024
    s_waitcnt lgkmcnt(6)
    v_mfma_f32_32x32x16_bf16 v[88:103], v[28:31], v[192:195], v[88:103]
    ds_read_b64_tr_b16 v[20:21], v7 offset:4096
    ds_read_b64_tr_b16 v[22:23], v7 offset:5120
    s_add_u32 s57, s64, 20480
    buffer_load_dwordx4 v[124:127], v2, s[36:39], s57 offen
    s_waitcnt lgkmcnt(6)
    v_mfma_f32_32x32x16_bf16 v[72:87], v[32:35], v[196:199], v[72:87]
    ds_read_b64_tr_b16 v[24:25], v7 offset:2048
    ds_read_b64_tr_b16 v[26:27], v7 offset:3072
    s_add_u32 m0, s61, 49152
    s_add_u32 s60, s63, 128
    buffer_load_dwordx4 v4, s[32:35], s60 offen lds
    s_waitcnt lgkmcnt(6)
    v_mfma_f32_32x32x16_bf16 v[88:103], v[36:39], v[196:199], v[88:103]
    ds_read_b64_tr_b16 v[28:29], v7 offset:6144
    ds_read_b64_tr_b16 v[30:31], v7 offset:7168
    s_waitcnt lgkmcnt(6)
    v_mfma_f32_32x32x16_bf16 v[72:87], v[16:19], v[200:203], v[72:87]
    ds_read_b64_tr_b16 v[32:33], v7 offset:8192
    ds_read_b64_tr_b16 v[34:35], v7 offset:9216
    s_waitcnt lgkmcnt(6)
    v_mfma_f32_32x32x16_bf16 v[88:103], v[20:23], v[200:203], v[88:103]
    ds_read_b64_tr_b16 v[36:37], v7 offset:12288
    ds_read_b64_tr_b16 v[38:39], v7 offset:13312
    s_add_u32 m0, s61, 57344
    s_add_u32 s60, s63, 73856
    buffer_load_dwordx4 v4, s[32:35], s60 offen lds
    s_waitcnt lgkmcnt(6)
    v_mfma_f32_32x32x16_bf16 v[72:87], v[24:27], v[204:207], v[72:87]
    ds_read_b64_tr_b16 v[16:17], v7 offset:10240
    ds_read_b64_tr_b16 v[18:19], v7 offset:11264
    s_waitcnt lgkmcnt(6)
    v_mfma_f32_32x32x16_bf16 v[88:103], v[28:31], v[204:207], v[88:103]
    ds_read_b64_tr_b16 v[20:21], v7 offset:14336
    ds_read_b64_tr_b16 v[22:23], v7 offset:15360
    s_waitcnt lgkmcnt(6)
    v_mfma_f32_32x32x16_bf16 v[72:87], v[32:35], v[208:211], v[72:87]
    ds_read_b64_tr_b16 v[24:25], v7 offset:16384
    ds_read_b64_tr_b16 v[26:27], v7 offset:17408
    s_add_u32 m0, s61, 65536
    s_add_u32 s60, s63, 147584
    buffer_load_dwordx4 v4, s[32:35], s60 offen lds
    s_waitcnt lgkmcnt(6)
    v_mfma_f32_32x32x16_bf16 v[88:103], v[36:39], v[208:211], v[88:103]
    ds_read_b64_tr_b16 v[28:29], v7 offset:20480
    ds_read_b64_tr_b16 v[30:31], v7 offset:21504
    s_add_u32 s57, s64, 24576
    buffer_load_dwordx4 v[128:131], v2, s[36:39], s57 offen
    s_waitcnt lgkmcnt(6)
    v_mfma_f32_32x32x16_bf16 v[72:87], v[16:19], v[212:215], v[72:87]
    ds_read_b64_tr_b16 v[32:33], v7 offset:18432
    ds_read_b64_tr_b16 v[34:35], v7 offset:19456
    s_waitcnt lgkmcnt(6)
    v_mfma_f32_32x32x16_bf16 v[88:103], v[20:23], v[212:215], v[88:103]
    ds_read_b64_tr_b16 v[36:37], v7 offset:22528
    ds_read_b64_tr_b16 v[38:39], v7 offset:23552
    s_waitcnt lgkmcnt(6)
    v_mfma_f32_32x32x16_bf16 v[72:87], v[24:27], v[216:219], v[72:87]
    s_waitcnt vmcnt(9)
    s_barrier
    ds_read_b64_tr_b16 v[16:17], v7 offset:24576
    ds_read_b64_tr_b16 v[18:19], v7 offset:25600
    s_waitcnt lgkmcnt(6)
    v_mfma_f32_32x32x16_bf16 v[88:103], v[28:31], v[216:219], v[88:103]
    ds_read_b64_tr_b16 v[20:21], v7 offset:28672
    ds_read_b64_tr_b16 v[22:23], v7 offset:29696
    s_waitcnt lgkmcnt(6)
    v_mfma_f32_32x32x16_bf16 v[72:87], v[32:35], v[220:223], v[72:87]
    ds_read_b64_tr_b16 v[24:25], v7 offset:26624
    ds_read_b64_tr_b16 v[26:27], v7 offset:27648
    s_add_u32 m0, s61, 73728
    s_add_u32 s60, s63, 221312
    buffer_load_dwordx4 v4, s[32:35], s60 offen lds
    s_waitcnt lgkmcnt(6)
    v_mfma_f32_32x32x16_bf16 v[88:103], v[36:39], v[220:223], v[88:103]
    ds_read_b64_tr_b16 v[28:29], v7 offset:30720
    ds_read_b64_tr_b16 v[30:31], v7 offset:31744
    s_waitcnt lgkmcnt(6)
    v_mfma_f32_32x32x16_bf16 v[72:87], v[16:19], v[224:227], v[72:87]
    ds_read_b64_tr_b16 v[32:33], v7 offset:32768
    ds_read_b64_tr_b16 v[34:35], v7 offset:33792
    s_waitcnt lgkmcnt(6)
    v_mfma_f32_32x32x16_bf16 v[88:103], v[20:23], v[224:227], v[88:103]
    ds_read_b64_tr_b16 v[36:37], v7 offset:36864
    ds_read_b64_tr_b16 v[38:39], v7 offset:37888
    s_add_u32 m0, s61, 81920
    s_add_u32 s60, s63, 295040
    buffer_load_dwordx4 v4, s[32:35], s60 offen lds
    s_add_u32 s57, s64, 28672
    buffer_load_dwordx4 v[132:135], v2, s[36:39], s57 offen
    s_waitcnt lgkmcnt(6)
    v_mfma_f32_32x32x16_bf16 v[72:87], v[24:27], v[228:231], v[72:87]
    ds_read_b64_tr_b16 v[16:17], v7 offset:34816
    ds_read_b64_tr_b16 v[18:19], v7 offset:35840
    s_waitcnt lgkmcnt(6)
    v_mfma_f32_32x32x16_bf16 v[88:103], v[28:31], v[228:231], v[88:103]
    ds_read_b64_tr_b16 v[20:21], v7 offset:38912
    ds_read_b64_tr_b16 v[22:23], v7 offset:39936
    s_waitcnt lgkmcnt(6)
    v_mfma_f32_32x32x16_bf16 v[72:87], v[32:35], v[232:235], v[72:87]
    ds_read_b64_tr_b16 v[24:25], v7 offset:40960
    ds_read_b64_tr_b16 v[26:27], v7 offset:41984
    s_add_u32 m0, s61, 90112
    s_add_u32 s60, s63, 368768
    buffer_load_dwordx4 v4, s[32:35], s60 offen lds
    s_waitcnt lgkmcnt(6)
    v_mfma_f32_32x32x16_bf16 v[88:103], v[36:39], v[232:235], v[88:103]
    ds_read_b64_tr_b16 v[28:29], v7 offset:45056
    ds_read_b64_tr_b16 v[30:31], v7 offset:46080
    s_waitcnt lgkmcnt(6)
    v_mfma_f32_32x32x16_bf16 v[72:87], v[16:19], v[236:239], v[72:87]
    ds_read_b64_tr_b16 v[32:33], v7 offset:43008
    ds_read_b64_tr_b16 v[34:35], v7 offset:44032
    s_waitcnt lgkmcnt(6)
    v_mfma_f32_32x32x16_bf16 v[88:103], v[20:23], v[236:239], v[88:103]
    ds_read_b64_tr_b16 v[36:37], v7 offset:47104
    ds_read_b64_tr_b16 v[38:39], v7 offset:48128
    s_waitcnt lgkmcnt(6)
    v_mfma_f32_32x32x16_bf16 v[72:87], v[24:27], v[240:243], v[72:87]
    s_waitcnt lgkmcnt(4)
    v_mfma_f32_32x32x16_bf16 v[88:103], v[28:31], v[240:243], v[88:103]
    s_waitcnt lgkmcnt(2)
    v_mfma_f32_32x32x16_bf16 v[72:87], v[32:35], v[244:247], v[72:87]
    s_waitcnt lgkmcnt(0)
    v_mfma_f32_32x32x16_bf16 v[88:103], v[36:39], v[244:247], v[88:103]
    s_add_u32 s57, s64, 32768
    buffer_load_dwordx4 v[136:139], v2, s[36:39], s57 offen
    s_add_u32 s57, s64, 36864
    buffer_load_dwordx4 v[140:143], v2, s[36:39], s57 offen
    s_add_u32 s57, s64, 40960
    buffer_load_dwordx4 v[144:147], v2, s[36:39], s57 offen
    s_add_u32 s57, s64, 45056
    buffer_load_dwordx4 v[148:151], v2, s[36:39], s57 offen
    s_add_u32 s57, s64, 49152
    buffer_load_dwordx4 v[152:155], v2, s[36:39], s57 offen
    s_add_u32 s57, s64, 53248
    buffer_load_dwordx4 v[156:159], v2, s[36:39], s57 offen
    s_add_u32 s57, s64, 57344
    buffer_load_dwordx4 v[160:163], v2, s[36:39], s57 offen
    s_add_u32 s57, s64, 61440
    buffer_load_dwordx4 v[164:167], v2, s[36:39], s57 offen
    s_add_u32 s57, s64, 65536
    buffer_load_dwordx4 v[168:171], v2, s[36:39], s57 offen
    s_add_u32 s57, s64, 69632
    buffer_load_dwordx4 v[172:175], v2, s[36:39], s57 offen
    s_add_u32 s57, s64, 73728
    buffer_load_dwordx4 v[176:179], v2, s[36:39], s57 offen
    s_add_u32 s57, s64, 77824
    buffer_load_dwordx4 v[180:183], v2, s[36:39], s57 offen
    s_add_u32 s73, s63, 256
    s_lshl_b32 s57, s53, 10
    s_add_u32 s57, s57, 122880
    v_add_u32 v11, s57, v2
    s_lshl_b32 s57, s54, 13
    v_add_u32 v12, s57, v11
    s_waitcnt lgkmcnt(0)
    v_mul_f32 v72, s68, v72
    v_mul_f32 v73, s68, v73
    v_mul_f32 v74, s68, v74
    v_mul_f32 v75, s68, v75
    v_exp_f32 v72, v72
    v_exp_f32 v73, v73
    v_exp_f32 v74, v74
    v_exp_f32 v75, v75
    v_add_f32 v72, 1.0, v72
    v_add_f32 v73, 1.0, v73
    v_add_f32 v74, 1.0, v74
    v_add_f32 v75, 1.0, v75
    v_rcp_f32 v72, v72
    v_rcp_f32 v73, v73
    v_rcp_f32 v74, v74
    v_rcp_f32 v75, v75
    v_mul_f32 v88, v88, v72
    v_mul_f32 v89, v89, v73
    v_mul_f32 v90, v90, v74
    v_mul_f32 v91, v91, v75
    s_barrier
    v_mul_f32 v76, s68, v76
    v_mul_f32 v77, s68, v77
    v_mul_f32 v78, s68, v78
    v_mul_f32 v79, s68, v79
    v_exp_f32 v76, v76
    v_exp_f32 v77, v77
    v_exp_f32 v78, v78
    v_exp_f32 v79, v79
    v_add_f32 v76, 1.0, v76
    v_add_f32 v77, 1.0, v77
    v_add_f32 v78, 1.0, v78
    v_add_f32 v79, 1.0, v79
    v_rcp_f32 v76, v76
    v_rcp_f32 v77, v77
    v_rcp_f32 v78, v78
    v_rcp_f32 v79, v79
    v_mul_f32 v92, v92, v76
    v_mul_f32 v93, v93, v77
    v_mul_f32 v94, v94, v78
    v_mul_f32 v95, v95, v79
    v_cvt_pk_bf16_f32 v72, v88, v89
    v_cvt_pk_bf16_f32 v73, v90, v91
    v_cvt_pk_bf16_f32 v74, v92, v93
    v_cvt_pk_bf16_f32 v75, v94, v95
    ds_write_b128 v12, v[72:75] offset:0
    v_mul_f32 v80, s68, v80
    v_mul_f32 v81, s68, v81
    v_mul_f32 v82, s68, v82
    v_mul_f32 v83, s68, v83
    v_exp_f32 v80, v80
    v_exp_f32 v81, v81
    v_exp_f32 v82, v82
    v_exp_f32 v83, v83
    v_add_f32 v80, 1.0, v80
    v_add_f32 v81, 1.0, v81
    v_add_f32 v82, 1.0, v82
    v_add_f32 v83, 1.0, v83
    v_rcp_f32 v80, v80
    v_rcp_f32 v81, v81
    v_rcp_f32 v82, v82
    v_rcp_f32 v83, v83
    v_mul_f32 v96, v96, v80
    v_mul_f32 v97, v97, v81
    v_mul_f32 v98, v98, v82
    v_mul_f32 v99, v99, v83
    v_mul_f32 v84, s68, v84
    v_mul_f32 v85, s68, v85
    v_mul_f32 v86, s68, v86
    v_mul_f32 v87, s68, v87
    v_exp_f32 v84, v84
    v_exp_f32 v85, v85
    v_exp_f32 v86, v86
    v_exp_f32 v87, v87
    v_add_f32 v84, 1.0, v84
    v_add_f32 v85, 1.0, v85
    v_add_f32 v86, 1.0, v86
    v_add_f32 v87, 1.0, v87
    v_rcp_f32 v84, v84
    v_rcp_f32 v85, v85
    v_rcp_f32 v86, v86
    v_rcp_f32 v87, v87
    v_mul_f32 v100, v100, v84
    v_mul_f32 v101, v101, v85
    v_mul_f32 v102, v102, v86
    v_mul_f32 v103, v103, v87
    v_cvt_pk_bf16_f32 v80, v96, v97
    v_cvt_pk_bf16_f32 v81, v98, v99
    v_cvt_pk_bf16_f32 v82, v100, v101
    v_cvt_pk_bf16_f32 v83, v102, v103
    ds_write_b128 v12, v[80:83] offset:4096
    s_waitcnt lgkmcnt(0)
    s_barrier
    buffer_load_dword v0, v8, s[48:51], s65 offen
    s_add_u32 s65, s65, s98
    ds_read_b128 v[184:187], v11 offset:0
    ds_read_b128 v[188:191], v11 offset:4096
    ds_read_b128 v[192:195], v11 offset:8192
    ds_read_b128 v[196:199], v11 offset:12288
    s_mov_b32 s71, 0
    s_mov_b32 s69, 0x70000000
    s_lshr_b32 s75, s56, 1
    s_add_u32 s72, s75, 3
    s_and_b32 s62, s56, 1
    s_lshl_b32 s62, s62, 3
    s_add_u32 s62, s62, s52
    s_mov_b32 s98, 0
    s_mov_b32 s63, 100
    v_and_b32 v13, 31, v1
    v_mul_u32_u24 v13, 1152, v13
    v_lshrrev_b32 v14, 5, v1
    v_lshl_add_u32 v13, v14, 3, v13
    ds_read_b64_tr_b16 v[16:17], v5 offset:0
    ds_read_b64_tr_b16 v[18:19], v5 offset:1024
    ds_read_b64_tr_b16 v[20:21], v5 offset:2048
    ds_read_b64_tr_b16 v[22:23], v5 offset:3072
    ds_read_b64_tr_b16 v[24:25], v5 offset:4096
    ds_read_b64_tr_b16 v[26:27], v5 offset:5120
    ds_read_b64_tr_b16 v[28:29], v5 offset:6144
    ds_read_b64_tr_b16 v[30:31], v5 offset:7168
    s_waitcnt lgkmcnt(6)
    v_mfma_f32_32x32x16_bf16 v[40:55], v[16:19], v[104:107], 0
    ds_read_b64_tr_b16 v[32:33], v5 offset:8192
    ds_read_b64_tr_b16 v[34:35], v5 offset:9216
    s_add_u32 m0, s61, 98304
    s_mov_b32 s60, s73
    buffer_load_dwordx4 v4, s[32:35], s60 offen lds
    s_add_u32 s73, s73, 73728
    s_waitcnt lgkmcnt(6)
    v_mfma_f32_32x32x16_bf16 v[40:55], v[20:23], v[108:111], v[40:55]
    ds_read_b64_tr_b16 v[36:37], v5 offset:10240
    ds_read_b64_tr_b16 v[38:39], v5 offset:11264
    s_waitcnt lgkmcnt(6)
    v_mfma_f32_32x32x16_bf16 v[40:55], v[24:27], v[112:115], v[40:55]
    ds_read_b64_tr_b16 v[16:17], v5 offset:12288
    ds_read_b64_tr_b16 v[18:19], v5 offset:13312
    v_cvt_pk_bf16_f32 v72, v72, v73
    v_cvt_pk_bf16_f32 v73, v74, v75
    s_waitcnt lgkmcnt(6)
    v_mfma_f32_32x32x16_bf16 v[40:55], v[28:31], v[116:119], v[40:55]
    ds_read_b64_tr_b16 v[20:21], v5 offset:14336
    ds_read_b64_tr_b16 v[22:23], v5 offset:15360
    v_cvt_pk_bf16_f32 v74, v76, v77
    v_cvt_pk_bf16_f32 v75, v78, v79
    s_add_u32 m0, s61, 106496
    s_mov_b32 s60, s73
    buffer_load_dwordx4 v4, s[32:35], s60 offen lds
    s_add_u32 s73, s73, 73728
    s_waitcnt vmcnt(25)
    s_waitcnt lgkmcnt(6)
    v_mfma_f32_32x32x16_bf16 v[40:55], v[32:35], v[120:123], v[40:55]
    ds_read_b64_tr_b16 v[24:25], v5 offset:16384
    ds_read_b64_tr_b16 v[26:27], v5 offset:17408
    s_add_u32 s67, s66, s69
    buffer_store_dwordx4 v[72:75], v2, s[36:39], s67 offen offset:0 sc1
    s_waitcnt vmcnt(24)
    s_waitcnt lgkmcnt(6)
    v_mfma_f32_32x32x16_bf16 v[40:55], v[36:39], v[124:127], v[40:55]
    ds_read_b64_tr_b16 v[28:29], v5 offset:18432
    ds_read_b64_tr_b16 v[30:31], v5 offset:19456
    v_cvt_pk_bf16_f32 v80, v80, v81
    v_cvt_pk_bf16_f32 v81, v82, v83
    s_waitcnt vmcnt(20)
    s_waitcnt lgkmcnt(6)
    v_mfma_f32_32x32x16_bf16 v[40:55], v[16:19], v[128:131], v[40:55]
    ds_read_b64_tr_b16 v[32:33], v5 offset:20480
    ds_read_b64_tr_b16 v[34:35], v5 offset:21504
    v_cvt_pk_bf16_f32 v82, v84, v85
    v_cvt_pk_bf16_f32 v83, v86, v87
    s_add_u32 m0, s61, 114688
    s_mov_b32 s60, s73
    buffer_load_dwordx4 v4, s[32:35], s60 offen lds
    s_add_u32 s73, s73, 73728
    s_waitcnt vmcnt(18)
    s_waitcnt lgkmcnt(6)
    v_mfma_f32_32x32x16_bf16 v[40:55], v[20:23], v[132:135], v[40:55]
    ds_read_b64_tr_b16 v[36:37], v5 offset:22528
    ds_read_b64_tr_b16 v[38:39], v5 offset:23552
    buffer_store_dwordx4 v[80:83], v2, s[36:39], s67 offen offset:1024 sc1
    s_waitcnt vmcnt(17)
    s_waitcnt lgkmcnt(6)
    v_mfma_f32_32x32x16_bf16 v[40:55], v[24:27], v[136:139], v[40:55]
    s_barrier
    ds_read_b64_tr_b16 v[16:17], v5 offset:24576
    ds_read_b64_tr_b16 v[18:19], v5 offset:25600
    s_waitcnt vmcnt(16)
    s_waitcnt lgkmcnt(6)
    v_mfma_f32_32x32x16_bf16 v[40:55], v[28:31], v[140:143], v[40:55]
    ds_read_b64_tr_b16 v[20:21], v5 offset:26624
    ds_read_b64_tr_b16 v[22:23], v5 offset:27648
    s_waitcnt vmcnt(15)
    s_waitcnt lgkmcnt(6)
    v_mfma_f32_32x32x16_bf16 v[40:55], v[32:35], v[144:147], v[40:55]
    ds_read_b64_tr_b16 v[24:25], v5 offset:28672
    ds_read_b64_tr_b16 v[26:27], v5 offset:29696
    s_add_u32 m0, s61, 122880
    s_mov_b32 s60, s73
    buffer_load_dwordx4 v4, s[32:35], s60 offen lds
    s_add_u32 s73, s73, 73728
    s_waitcnt vmcnt(15)
    s_waitcnt lgkmcnt(6)
    v_mfma_f32_32x32x16_bf16 v[40:55], v[36:39], v[148:151], v[40:55]
    ds_read_b64_tr_b16 v[28:29], v5 offset:30720
    ds_read_b64_tr_b16 v[30:31], v5 offset:31744
    s_waitcnt vmcnt(14)
    s_waitcnt lgkmcnt(6)
    v_mfma_f32_32x32x16_bf16 v[40:55], v[16:19], v[152:155], v[40:55]
    ds_read_b64_tr_b16 v[32:33], v5 offset:32768
    ds_read_b64_tr_b16 v[34:35], v5 offset:33792
    s_waitcnt vmcnt(13)
    s_waitcnt lgkmcnt(6)
    v_mfma_f32_32x32x16_bf16 v[40:55], v[20:23], v[156:159], v[40:55]
    ds_read_b64_tr_b16 v[36:37], v5 offset:34816
    ds_read_b64_tr_b16 v[38:39], v5 offset:35840
    s_add_u32 m0, s61, 131072
    s_mov_b32 s60, s73
    buffer_load_dwordx4 v4, s[32:35], s60 offen lds
    s_add_u32 s73, s73, 73728
    s_waitcnt vmcnt(13)
    s_waitcnt lgkmcnt(6)
    v_mfma_f32_32x32x16_bf16 v[40:55], v[24:27], v[160:163], v[40:55]
    ds_read_b64_tr_b16 v[16:17], v5 offset:36864
    ds_read_b64_tr_b16 v[18:19], v5 offset:37888
    s_waitcnt vmcnt(12)
    s_waitcnt lgkmcnt(6)
    v_mfma_f32_32x32x16_bf16 v[40:55], v[28:31], v[164:167], v[40:55]
    ds_read_b64_tr_b16 v[20:21], v5 offset:38912
    ds_read_b64_tr_b16 v[22:23], v5 offset:39936
    s_waitcnt vmcnt(11)
    s_waitcnt lgkmcnt(6)
    v_mfma_f32_32x32x16_bf16 v[40:55], v[32:35], v[168:171], v[40:55]
    ds_read_b64_tr_b16 v[24:25], v5 offset:40960
    ds_read_b64_tr_b16 v[26:27], v5 offset:41984
    s_add_u32 m0, s61, 139264
    s_mov_b32 s60, s73
    buffer_load_dwordx4 v4, s[32:35], s60 offen lds
    s_add_u32 s73, s73, 4294598784
    s_waitcnt vmcnt(11)
    s_waitcnt lgkmcnt(6)
    v_mfma_f32_32x32x16_bf16 v[40:55], v[36:39], v[172:175], v[40:55]
    ds_read_b64_tr_b16 v[28:29], v5 offset:43008
    ds_read_b64_tr_b16 v[30:31], v5 offset:44032
    s_waitcnt vmcnt(10)
    s_waitcnt lgkmcnt(6)
    v_mfma_f32_32x32x16_bf16 v[40:55], v[16:19], v[176:179], v[40:55]
    ds_read_b64_tr_b16 v[32:33], v5 offset:45056
    ds_read_b64_tr_b16 v[34:35], v5 offset:46080
    s_waitcnt vmcnt(9)
    s_waitcnt lgkmcnt(6)
    v_mfma_f32_32x32x16_bf16 v[40:55], v[20:23], v[180:183], v[40:55]
    ds_read_b64_tr_b16 v[36:37], v5 offset:47104
    ds_read_b64_tr_b16 v[38:39], v5 offset:48128
    s_waitcnt lgkmcnt(6)
    v_mfma_f32_32x32x16_bf16 v[40:55], v[24:27], v[184:187], v[40:55]
    s_barrier
    ds_read_b64_tr_b16 v[16:17], v6 offset:0
    ds_read_b64_tr_b16 v[18:19], v6 offset:1024
    s_waitcnt lgkmcnt(6)
    v_mfma_f32_32x32x16_bf16 v[40:55], v[28:31], v[188:191], v[40:55]
    ds_read_b64_tr_b16 v[20:21], v6 offset:2048
    ds_read_b64_tr_b16 v[22:23], v6 offset:3072
    s_cmp_eq_u32 s71, 2
    s_cselect_b32 s73, 0x70000000, s73
    s_waitcnt lgkmcnt(6)
    v_mfma_f32_32x32x16_bf16 v[40:55], v[32:35], v[192:195], v[40:55]
    ds_read_b64_tr_b16 v[24:25], v6 offset:4096
    ds_read_b64_tr_b16 v[26:27], v6 offset:5120
    s_add_u32 m0, s61, 0
    s_mov_b32 s60, s73
    buffer_load_dwordx4 v4, s[32:35], s60 offen lds
    s_add_u32 s73, s73, 73728
    s_waitcnt lgkmcnt(6)
    v_mfma_f32_32x32x16_bf16 v[40:55], v[36:39], v[196:199], v[40:55]
    ds_read_b64_tr_b16 v[28:29], v6 offset:6144
    ds_read_b64_tr_b16 v[30:31], v6 offset:7168
    s_waitcnt lgkmcnt(6)
    v_mfma_f32_32x32x16_bf16 v[56:71], v[16:19], v[104:107], 0
    ds_read_b64_tr_b16 v[32:33], v6 offset:8192
    ds_read_b64_tr_b16 v[34:35], v6 offset:9216
    s_waitcnt lgkmcnt(6)
    v_mfma_f32_32x32x16_bf16 v[56:71], v[20:23], v[108:111], v[56:71]
    ds_read_b64_tr_b16 v[36:37], v6 offset:10240
    ds_read_b64_tr_b16 v[38:39], v6 offset:11264
    s_add_u32 m0, s61, 8192
    s_mov_b32 s60, s73
    buffer_load_dwordx4 v4, s[32:35], s60 offen lds
    s_add_u32 s73, s73, 73728
    s_waitcnt lgkmcnt(6)
    v_mfma_f32_32x32x16_bf16 v[56:71], v[24:27], v[112:115], v[56:71]
    ds_read_b64_tr_b16 v[16:17], v6 offset:12288
    ds_read_b64_tr_b16 v[18:19], v6 offset:13312
    v_cvt_pk_bf16_f32 v40, v40, v41
    v_cvt_pk_bf16_f32 v41, v42, v43
    s_waitcnt lgkmcnt(6)
    v_mfma_f32_32x32x16_bf16 v[56:71], v[28:31], v[116:119], v[56:71]
    ds_read_b64_tr_b16 v[20:21], v6 offset:14336
    ds_read_b64_tr_b16 v[22:23], v6 offset:15360
    v_cvt_pk_bf16_f32 v42, v44, v45
    v_cvt_pk_bf16_f32 v43, v46, v47
    s_waitcnt lgkmcnt(6)
    v_mfma_f32_32x32x16_bf16 v[56:71], v[32:35], v[120:123], v[56:71]
    ds_read_b64_tr_b16 v[24:25], v6 offset:16384
    ds_read_b64_tr_b16 v[26:27], v6 offset:17408
    s_add_u32 s67, s66, 0
    buffer_store_dwordx4 v[40:43], v2, s[36:39], s67 offen offset:0 sc1
    s_add_u32 m0, s61, 16384
    s_mov_b32 s60, s73
    buffer_load_dwordx4 v4, s[32:35], s60 offen lds
    s_add_u32 s73, s73, 73728
    s_waitcnt lgkmcnt(6)
    v_mfma_f32_32x32x16_bf16 v[56:71], v[36:39], v[124:127], v[56:71]
    ds_read_b64_tr_b16 v[28:29], v6 offset:18432
    ds_read_b64_tr_b16 v[30:31], v6 offset:19456
    v_cvt_pk_bf16_f32 v48, v48, v49
    v_cvt_pk_bf16_f32 v49, v50, v51
    s_waitcnt lgkmcnt(6)
    v_mfma_f32_32x32x16_bf16 v[56:71], v[16:19], v[128:131], v[56:71]
    ds_read_b64_tr_b16 v[32:33], v6 offset:20480
    ds_read_b64_tr_b16 v[34:35], v6 offset:21504
    v_cvt_pk_bf16_f32 v50, v52, v53
    v_cvt_pk_bf16_f32 v51, v54, v55
    s_waitcnt lgkmcnt(6)
    v_mfma_f32_32x32x16_bf16 v[56:71], v[20:23], v[132:135], v[56:71]
    ds_read_b64_tr_b16 v[36:37], v6 offset:22528
    ds_read_b64_tr_b16 v[38:39], v6 offset:23552
    buffer_store_dwordx4 v[48:51], v2, s[36:39], s67 offen offset:1024 sc1
    s_waitcnt lgkmcnt(6)
    v_mfma_f32_32x32x16_bf16 v[56:71], v[24:27], v[136:139], v[56:71]
    s_waitcnt vmcnt(8)
    s_barrier
    ds_read_b64_tr_b16 v[16:17], v6 offset:24576
    ds_read_b64_tr_b16 v[18:19], v6 offset:25600
    s_waitcnt lgkmcnt(6)
    v_mfma_f32_32x32x16_bf16 v[56:71], v[28:31], v[140:143], v[56:71]
    ds_read_b64_tr_b16 v[20:21], v6 offset:26624
    ds_read_b64_tr_b16 v[22:23], v6 offset:27648
    s_waitcnt lgkmcnt(6)
    v_mfma_f32_32x32x16_bf16 v[56:71], v[32:35], v[144:147], v[56:71]
    ds_read_b64_tr_b16 v[24:25], v6 offset:28672
    ds_read_b64_tr_b16 v[26:27], v6 offset:29696
    s_add_u32 m0, s61, 24576
    s_mov_b32 s60, s73
    buffer_load_dwordx4 v4, s[32:35], s60 offen lds
    s_add_u32 s73, s73, 73728
    s_waitcnt lgkmcnt(6)
    v_mfma_f32_32x32x16_bf16 v[56:71], v[36:39], v[148:151], v[56:71]
    ds_read_b64_tr_b16 v[28:29], v6 offset:30720
    ds_read_b64_tr_b16 v[30:31], v6 offset:31744
    s_waitcnt lgkmcnt(6)
    v_mfma_f32_32x32x16_bf16 v[56:71], v[16:19], v[152:155], v[56:71]
    ds_read_b64_tr_b16 v[32:33], v6 offset:32768
    ds_read_b64_tr_b16 v[34:35], v6 offset:33792
    s_waitcnt lgkmcnt(6)
    v_mfma_f32_32x32x16_bf16 v[56:71], v[20:23], v[156:159], v[56:71]
    ds_read_b64_tr_b16 v[36:37], v6 offset:34816
    ds_read_b64_tr_b16 v[38:39], v6 offset:35840
    s_add_u32 m0, s61, 32768
    s_mov_b32 s60, s73
    buffer_load_dwordx4 v4, s[32:35], s60 offen lds
    s_add_u32 s73, s73, 73728
    s_waitcnt lgkmcnt(6)
    v_mfma_f32_32x32x16_bf16 v[56:71], v[24:27], v[160:163], v[56:71]
    ds_read_b64_tr_b16 v[16:17], v6 offset:36864
    ds_read_b64_tr_b16 v[18:19], v6 offset:37888
    s_waitcnt lgkmcnt(6)
    v_mfma_f32_32x32x16_bf16 v[56:71], v[28:31], v[164:167], v[56:71]
    ds_read_b64_tr_b16 v[20:21], v6 offset:38912
    ds_read_b64_tr_b16 v[22:23], v6 offset:39936
    s_waitcnt lgkmcnt(6)
    v_mfma_f32_32x32x16_bf16 v[56:71], v[32:35], v[168:171], v[56:71]
    ds_read_b64_tr_b16 v[24:25], v6 offset:40960
    ds_read_b64_tr_b16 v[26:27], v6 offset:41984
    s_add_u32 m0, s61, 40960
    s_mov_b32 s60, s73
    buffer_load_dwordx4 v4, s[32:35], s60 offen lds
    s_add_u32 s73, s73, 4294598784
    s_waitcnt lgkmcnt(6)
    v_mfma_f32_32x32x16_bf16 v[56:71], v[36:39], v[172:175], v[56:71]
    ds_read_b64_tr_b16 v[28:29], v6 offset:43008
    ds_read_b64_tr_b16 v[30:31], v6 offset:44032
    s_waitcnt lgkmcnt(6)
    v_mfma_f32_32x32x16_bf16 v[56:71], v[16:19], v[176:179], v[56:71]
    ds_read_b64_tr_b16 v[32:33], v6 offset:45056
    ds_read_b64_tr_b16 v[34:35], v6 offset:46080
    s_waitcnt lgkmcnt(6)
    v_mfma_f32_32x32x16_bf16 v[56:71], v[20:23], v[180:183], v[56:71]
    ds_read_b64_tr_b16 v[36:37], v6 offset:47104
    ds_read_b64_tr_b16 v[38:39], v6 offset:48128
    s_waitcnt lgkmcnt(6)
    v_mfma_f32_32x32x16_bf16 v[56:71], v[24:27], v[184:187], v[56:71]
    s_barrier
    ds_read_b64_tr_b16 v[16:17], v7 offset:0
    ds_read_b64_tr_b16 v[18:19], v7 offset:1024
    s_waitcnt lgkmcnt(6)
    v_mfma_f32_32x32x16_bf16 v[56:71], v[28:31], v[188:191], v[56:71]
    ds_read_b64_tr_b16 v[20:21], v7 offset:2048
    ds_read_b64_tr_b16 v[22:23], v7 offset:3072
    s_waitcnt lgkmcnt(6)
    v_mfma_f32_32x32x16_bf16 v[56:71], v[32:35], v[192:195], v[56:71]
    ds_read_b64_tr_b16 v[24:25], v7 offset:4096
    ds_read_b64_tr_b16 v[26:27], v7 offset:5120
    s_add_u32 m0, s61, 49152
    s_mov_b32 s60, s73
    buffer_load_dwordx4 v4, s[32:35], s60 offen lds
    s_add_u32 s73, s73, 73728
    s_waitcnt lgkmcnt(6)
    v_mfma_f32_32x32x16_bf16 v[56:71], v[36:39], v[196:199], v[56:71]
    ds_read_b64_tr_b16 v[28:29], v7 offset:6144
    ds_read_b64_tr_b16 v[30:31], v7 offset:7168
    s_waitcnt lgkmcnt(6)
    v_mfma_f32_32x32x16_bf16 v[72:87], v[16:19], v[104:107], 0
    ds_read_b64_tr_b16 v[32:33], v7 offset:8192
    ds_read_b64_tr_b16 v[34:35], v7 offset:9216
    s_waitcnt lgkmcnt(6)
    v_mfma_f32_32x32x16_bf16 v[72:87], v[20:23], v[108:111], v[72:87]
    ds_read_b64_tr_b16 v[36:37], v7 offset:10240
    ds_read_b64_tr_b16 v[38:39], v7 offset:11264
    s_add_u32 m0, s61, 57344
    s_mov_b32 s60, s73
    buffer_load_dwordx4 v4, s[32:35], s60 offen lds
    s_add_u32 s73, s73, 73728
    s_waitcnt lgkmcnt(6)
    v_mfma_f32_32x32x16_bf16 v[72:87], v[24:27], v[112:115], v[72:87]
    ds_read_b64_tr_b16 v[16:17], v7 offset:12288
    ds_read_b64_tr_b16 v[18:19], v7 offset:13312
    v_cvt_pk_bf16_f32 v56, v56, v57
    v_cvt_pk_bf16_f32 v57, v58, v59
    s_waitcnt lgkmcnt(6)
    v_mfma_f32_32x32x16_bf16 v[72:87], v[28:31], v[116:119], v[72:87]
    ds_read_b64_tr_b16 v[20:21], v7 offset:14336
    ds_read_b64_tr_b16 v[22:23], v7 offset:15360
    v_cvt_pk_bf16_f32 v58, v60, v61
    v_cvt_pk_bf16_f32 v59, v62, v63
    s_waitcnt lgkmcnt(6)
    v_mfma_f32_32x32x16_bf16 v[72:87], v[32:35], v[120:123], v[72:87]
    ds_read_b64_tr_b16 v[24:25], v7 offset:16384
    ds_read_b64_tr_b16 v[26:27], v7 offset:17408
    s_add_u32 s67, s66, 16384
    buffer_store_dwordx4 v[56:59], v2, s[36:39], s67 offen offset:0 sc1
    s_add_u32 m0, s61, 65536
    s_mov_b32 s60, s73
    buffer_load_dwordx4 v4, s[32:35], s60 offen lds
    s_add_u32 s73, s73, 73728
    s_waitcnt lgkmcnt(6)
    v_mfma_f32_32x32x16_bf16 v[72:87], v[36:39], v[124:127], v[72:87]
    ds_read_b64_tr_b16 v[28:29], v7 offset:18432
    ds_read_b64_tr_b16 v[30:31], v7 offset:19456
    v_cvt_pk_bf16_f32 v64, v64, v65
    v_cvt_pk_bf16_f32 v65, v66, v67
    s_waitcnt lgkmcnt(6)
    v_mfma_f32_32x32x16_bf16 v[72:87], v[16:19], v[128:131], v[72:87]
    ds_read_b64_tr_b16 v[32:33], v7 offset:20480
    ds_read_b64_tr_b16 v[34:35], v7 offset:21504
    v_cvt_pk_bf16_f32 v66, v68, v69
    v_cvt_pk_bf16_f32 v67, v70, v71
    s_waitcnt lgkmcnt(6)
    v_mfma_f32_32x32x16_bf16 v[72:87], v[20:23], v[132:135], v[72:87]
    ds_read_b64_tr_b16 v[36:37], v7 offset:22528
    ds_read_b64_tr_b16 v[38:39], v7 offset:23552
    buffer_store_dwordx4 v[64:67], v2, s[36:39], s67 offen offset:1024 sc1
    s_waitcnt lgkmcnt(6)
    v_mfma_f32_32x32x16_bf16 v[72:87], v[24:27], v[136:139], v[72:87]
    s_waitcnt vmcnt(8)
    s_barrier
    s_cmp_eq_u32 s52, 0
    s_cbranch_scc1 L_sgpq
L_sgpq_b:
    ds_read_b64_tr_b16 v[16:17], v7 offset:24576
    ds_read_b64_tr_b16 v[18:19], v7 offset:25600
    s_waitcnt lgkmcnt(6)
    v_mfma_f32_32x32x16_bf16 v[72:87], v[28:31], v[140:143], v[72:87]
    ds_read_b64_tr_b16 v[20:21], v7 offset:26624
    ds_read_b64_tr_b16 v[22:23], v7 offset:27648
    s_waitcnt lgkmcnt(6)
    v_mfma_f32_32x32x16_bf16 v[72:87], v[32:35], v[144:147], v[72:87]
    ds_read_b64_tr_b16 v[24:25], v7 offset:28672
    ds_read_b64_tr_b16 v[26:27], v7 offset:29696
    s_add_u32 m0, s61, 73728
    s_mov_b32 s60, s73
    buffer_load_dwordx4 v4, s[32:35], s60 offen lds
    s_add_u32 s73, s73, 73728
    s_waitcnt lgkmcnt(6)
    v_mfma_f32_32x32x16_bf16 v[72:87], v[36:39], v[148:151], v[72:87]
    ds_read_b64_tr_b16 v[28:29], v7 offset:30720
    ds_read_b64_tr_b16 v[30:31], v7 offset:31744
    s_waitcnt lgkmcnt(6)
    v_mfma_f32_32x32x16_bf16 v[72:87], v[16:19], v[152:155], v[72:87]
    ds_read_b64_tr_b16 v[32:33], v7 offset:32768
    ds_read_b64_tr_b16 v[34:35], v7 offset:33792
    s_waitcnt lgkmcnt(6)
    v_mfma_f32_32x32x16_bf16 v[72:87], v[20:23], v[156:159], v[72:87]
    ds_read_b64_tr_b16 v[36:37], v7 offset:34816
    ds_read_b64_tr_b16 v[38:39], v7 offset:35840
    s_add_u32 m0, s61, 81920
    s_mov_b32 s60, s73
    buffer_load_dwordx4 v4, s[32:35], s60 offen lds
    s_add_u32 s73, s73, 73728
    s_waitcnt lgkmcnt(6)
    v_mfma_f32_32x32x16_bf16 v[72:87], v[24:27], v[160:163], v[72:87]
    ds_read_b64_tr_b16 v[16:17], v7 offset:36864
    ds_read_b64_tr_b16 v[18:19], v7 offset:37888
    s_waitcnt lgkmcnt(6)
    v_mfma_f32_32x32x16_bf16 v[72:87], v[28:31], v[164:167], v[72:87]
    ds_read_b64_tr_b16 v[20:21], v7 offset:38912
    ds_read_b64_tr_b16 v[22:23], v7 offset:39936
    s_waitcnt lgkmcnt(6)
    v_mfma_f32_32x32x16_bf16 v[72:87], v[32:35], v[168:171], v[72:87]
    ds_read_b64_tr_b16 v[24:25], v7 offset:40960
    ds_read_b64_tr_b16 v[26:27], v7 offset:41984
    s_add_u32 m0, s61, 90112
    s_mov_b32 s60, s73
    buffer_load_dwordx4 v4, s[32:35], s60 offen lds
    s_add_u32 s73, s73, 4294598784
    s_waitcnt lgkmcnt(6)
    v_mfma_f32_32x32x16_bf16 v[72:87], v[36:39], v[172:175], v[72:87]
    ds_read_b64_tr_b16 v[28:29], v7 offset:43008
    ds_read_b64_tr_b16 v[30:31], v7 offset:44032
    s_waitcnt lgkmcnt(6)
    v_mfma_f32_32x32x16_bf16 v[72:87], v[16:19], v[176:179], v[72:87]
    ds_read_b64_tr_b16 v[32:33], v7 offset:45056
    ds_read_b64_tr_b16 v[34:35], v7 offset:46080
    s_waitcnt lgkmcnt(6)
    v_mfma_f32_32x32x16_bf16 v[72:87], v[20:23], v[180:183], v[72:87]
    ds_read_b64_tr_b16 v[36:37], v7 offset:47104
    ds_read_b64_tr_b16 v[38:39], v7 offset:48128
    s_waitcnt lgkmcnt(6)
    v_mfma_f32_32x32x16_bf16 v[72:87], v[24:27], v[184:187], v[72:87]
    s_barrier
    ds_read_b64_tr_b16 v[16:17], v5 offset:0
    ds_read_b64_tr_b16 v[18:19], v5 offset:1024
    s_waitcnt lgkmcnt(6)
    v_mfma_f32_32x32x16_bf16 v[72:87], v[28:31], v[188:191], v[72:87]
    ds_read_b64_tr_b16 v[20:21], v5 offset:2048
    ds_read_b64_tr_b16 v[22:23], v5 offset:3072
    s_waitcnt lgkmcnt(6)
    v_mfma_f32_32x32x16_bf16 v[72:87], v[32:35], v[192:195], v[72:87]
    ds_read_b64_tr_b16 v[24:25], v5 offset:4096
    ds_read_b64_tr_b16 v[26:27], v5 offset:5120
    s_waitcnt lgkmcnt(6)
    v_mfma_f32_32x32x16_bf16 v[72:87], v[36:39], v[196:199], v[72:87]
    ds_read_b64_tr_b16 v[28:29], v5 offset:6144
    ds_read_b64_tr_b16 v[30:31], v5 offset:7168
    s_add_u32 s66, s66, 49152
    s_mov_b32 s69, 4294950912
    s_add_u32 s98, s98, 3
    s_add_u32 s71, s71, 1
L_p2:
    s_waitcnt lgkmcnt(6)
    v_mfma_f32_32x32x16_bf16 v[40:55], v[16:19], v[104:107], 0
    ds_read_b64_tr_b16 v[32:33], v5 offset:8192
    ds_read_b64_tr_b16 v[34:35], v5 offset:9216
    s_add_u32 m0, s61, 98304
    s_mov_b32 s60, s73
    buffer_load_dwordx4 v4, s[32:35], s60 offen lds
    s_add_u32 s73, s73, 73728
    s_waitcnt lgkmcnt(6)
    v_mfma_f32_32x32x16_bf16 v[40:55], v[20:23], v[108:111], v[40:55]
    ds_read_b64_tr_b16 v[36:37], v5 offset:10240
    ds_read_b64_tr_b16 v[38:39], v5 offset:11264
    s_waitcnt lgkmcnt(6)
    v_mfma_f32_32x32x16_bf16 v[40:55], v[24:27], v[112:115], v[40:55]
    ds_read_b64_tr_b16 v[16:17], v5 offset:12288
    ds_read_b64_tr_b16 v[18:19], v5 offset:13312
    v_cvt_pk_bf16_f32 v72, v72, v73
    v_cvt_pk_bf16_f32 v73, v74, v75
    s_waitcnt lgkmcnt(6)
    v_mfma_f32_32x32x16_bf16 v[40:55], v[28:31], v[116:119], v[40:55]
    ds_read_b64_tr_b16 v[20:21], v5 offset:14336
    ds_read_b64_tr_b16 v[22:23], v5 offset:15360
    v_cvt_pk_bf16_f32 v74, v76, v77
    v_cvt_pk_bf16_f32 v75, v78, v79
    s_add_u32 m0, s61, 106496
    s_mov_b32 s60, s73
    buffer_load_dwordx4 v4, s[32:35], s60 offen lds
    s_add_u32 s73, s73, 73728
    s_waitcnt lgkmcnt(6)
    v_mfma_f32_32x32x16_bf16 v[40:55], v[32:35], v[120:123], v[40:55]
    ds_read_b64_tr_b16 v[24:25], v5 offset:16384
    ds_read_b64_tr_b16 v[26:27], v5 offset:17408
    s_add_u32 s67, s66, s69
    buffer_store_dwordx4 v[72:75], v2, s[36:39], s67 offen offset:0 sc1
    s_waitcnt lgkmcnt(6)
    v_mfma_f32_32x32x16_bf16 v[40:55], v[36:39], v[124:127], v[40:55]
    ds_read_b64_tr_b16 v[28:29], v5 offset:18432
    ds_read_b64_tr_b16 v[30:31], v5 offset:19456
    v_cvt_pk_bf16_f32 v80, v80, v81
    v_cvt_pk_bf16_f32 v81, v82, v83
    s_waitcnt lgkmcnt(6)
    v_mfma_f32_32x32x16_bf16 v[40:55], v[16:19], v[128:131], v[40:55]
    ds_read_b64_tr_b16 v[32:33], v5 offset:20480
    ds_read_b64_tr_b16 v[34:35], v5 offset:21504
    v_cvt_pk_bf16_f32 v82, v84, v85
    v_cvt_pk_bf16_f32 v83, v86, v87
    s_add_u32 m0, s61, 114688
    s_mov_b32 s60, s73
    buffer_load_dwordx4 v4, s[32:35], s60 offen lds
    s_add_u32 s73, s73, 73728
    s_waitcnt lgkmcnt(6)
    v_mfma_f32_32x32x16_bf16 v[40:55], v[20:23], v[132:135], v[40:55]
    ds_read_b64_tr_b16 v[36:37], v5 offset:22528
    ds_read_b64_tr_b16 v[38:39], v5 offset:23552
    buffer_store_dwordx4 v[80:83], v2, s[36:39], s67 offen offset:1024 sc1
    s_waitcnt lgkmcnt(6)
    v_mfma_f32_32x32x16_bf16 v[40:55], v[24:27], v[136:139], v[40:55]
    s_waitcnt vmcnt(8)
    s_barrier
    s_cmp_eq_u32 s52, 0
    s_cbranch_scc1 L_sgp0
L_sgp0_b:
    ds_read_b64_tr_b16 v[16:17], v5 offset:24576
    ds_read_b64_tr_b16 v[18:19], v5 offset:25600
    s_waitcnt lgkmcnt(6)
    v_mfma_f32_32x32x16_bf16 v[40:55], v[28:31], v[140:143], v[40:55]
    ds_read_b64_tr_b16 v[20:21], v5 offset:26624
    ds_read_b64_tr_b16 v[22:23], v5 offset:27648
    s_waitcnt lgkmcnt(6)
    v_mfma_f32_32x32x16_bf16 v[40:55], v[32:35], v[144:147], v[40:55]
    ds_read_b64_tr_b16 v[24:25], v5 offset:28672
    ds_read_b64_tr_b16 v[26:27], v5 offset:29696
    s_add_u32 m0, s61, 122880
    s_mov_b32 s60, s73
    buffer_load_dwordx4 v4, s[32:35], s60 offen lds
    s_add_u32 s73, s73, 73728
    s_waitcnt lgkmcnt(6)
    v_mfma_f32_32x32x16_bf16 v[40:55], v[36:39], v[148:151], v[40:55]
    ds_read_b64_tr_b16 v[28:29], v5 offset:30720
    ds_read_b64_tr_b16 v[30:31], v5 offset:31744
    s_waitcnt lgkmcnt(6)
    v_mfma_f32_32x32x16_bf16 v[40:55], v[16:19], v[152:155], v[40:55]
    ds_read_b64_tr_b16 v[32:33], v5 offset:32768
    ds_read_b64_tr_b16 v[34:35], v5 offset:33792
    s_waitcnt lgkmcnt(6)
    v_mfma_f32_32x32x16_bf16 v[40:55], v[20:23], v[156:159], v[40:55]
    ds_read_b64_tr_b16 v[36:37], v5 offset:34816
    ds_read_b64_tr_b16 v[38:39], v5 offset:35840
    s_add_u32 m0, s61, 131072
    s_mov_b32 s60, s73
    buffer_load_dwordx4 v4, s[32:35], s60 offen lds
    s_add_u32 s73, s73, 73728
    s_waitcnt lgkmcnt(6)
    v_mfma_f32_32x32x16_bf16 v[40:55], v[24:27], v[160:163], v[40:55]
    ds_read_b64_tr_b16 v[16:17], v5 offset:36864
    ds_read_b64_tr_b16 v[18:19], v5 offset:37888
    s_waitcnt lgkmcnt(6)
    v_mfma_f32_32x32x16_bf16 v[40:55], v[28:31], v[164:167], v[40:55]
    ds_read_b64_tr_b16 v[20:21], v5 offset:38912
    ds_read_b64_tr_b16 v[22:23], v5 offset:39936
    s_waitcnt lgkmcnt(6)
    v_mfma_f32_32x32x16_bf16 v[40:55], v[32:35], v[168:171], v[40:55]
    ds_read_b64_tr_b16 v[24:25], v5 offset:40960
    ds_read_b64_tr_b16 v[26:27], v5 offset:41984
    s_add_u32 m0, s61, 139264
    s_mov_b32 s60, s73
    buffer_load_dwordx4 v4, s[32:35], s60 offen lds
    s_add_u32 s73, s73, 4294598784
    s_waitcnt lgkmcnt(6)
    v_mfma_f32_32x32x16_bf16 v[40:55], v[36:39], v[172:175], v[40:55]
    ds_read_b64_tr_b16 v[28:29], v5 offset:43008
    ds_read_b64_tr_b16 v[30:31], v5 offset:44032
    s_waitcnt lgkmcnt(6)
    v_mfma_f32_32x32x16_bf16 v[40:55], v[16:19], v[176:179], v[40:55]
    ds_read_b64_tr_b16 v[32:33], v5 offset:45056
    ds_read_b64_tr_b16 v[34:35], v5 offset:46080
    s_waitcnt lgkmcnt(6)
    v_mfma_f32_32x32x16_bf16 v[40:55], v[20:23], v[180:183], v[40:55]
    ds_read_b64_tr_b16 v[36:37], v5 offset:47104
    ds_read_b64_tr_b16 v[38:39], v5 offset:48128
    s_waitcnt lgkmcnt(6)
    v_mfma_f32_32x32x16_bf16 v[40:55], v[24:27], v[184:187], v[40:55]
    s_waitcnt vmcnt(12)
    s_barrier
    ds_read_b64_tr_b16 v[16:17], v6 offset:0
    ds_read_b64_tr_b16 v[18:19], v6 offset:1024
    s_waitcnt lgkmcnt(6)
    v_mfma_f32_32x32x16_bf16 v[40:55], v[28:31], v[188:191], v[40:55]
    ds_read_b64_tr_b16 v[20:21], v6 offset:2048
    ds_read_b64_tr_b16 v[22:23], v6 offset:3072
    s_cmp_eq_u32 s71, 2
    s_cselect_b32 s73, 0x70000000, s73
    s_waitcnt lgkmcnt(6)
    v_mfma_f32_32x32x16_bf16 v[40:55], v[32:35], v[192:195], v[40:55]
    ds_read_b64_tr_b16 v[24:25], v6 offset:4096
    ds_read_b64_tr_b16 v[26:27], v6 offset:5120
    s_add_u32 m0, s61, 0
    s_mov_b32 s60, s73
    buffer_load_dwordx4 v4, s[32:35], s60 offen lds
    s_add_u32 s73, s73, 73728
    s_waitcnt lgkmcnt(6)
    v_mfma_f32_32x32x16_bf16 v[40:55], v[36:39], v[196:199], v[40:55]
    ds_read_b64_tr_b16 v[28:29], v6 offset:6144
    ds_read_b64_tr_b16 v[30:31], v6 offset:7168
    s_waitcnt lgkmcnt(6)
    v_mfma_f32_32x32x16_bf16 v[56:71], v[16:19], v[104:107], 0
    ds_read_b64_tr_b16 v[32:33], v6 offset:8192
    ds_read_b64_tr_b16 v[34:35], v6 offset:9216
    s_waitcnt lgkmcnt(6)
    v_mfma_f32_32x32x16_bf16 v[56:71], v[20:23], v[108:111], v[56:71]
    ds_read_b64_tr_b16 v[36:37], v6 offset:10240
    ds_read_b64_tr_b16 v[38:39], v6 offset:11264
    s_add_u32 m0, s61, 8192
    s_mov_b32 s60, s73
    buffer_load_dwordx4 v4, s[32:35], s60 offen lds
    s_add_u32 s73, s73, 73728
    s_waitcnt lgkmcnt(6)
    v_mfma_f32_32x32x16_bf16 v[56:71], v[24:27], v[112:115], v[56:71]
    ds_read_b64_tr_b16 v[16:17], v6 offset:12288
    ds_read_b64_tr_b16 v[18:19], v6 offset:13312
    v_cvt_pk_bf16_f32 v40, v40, v41
    v_cvt_pk_bf16_f32 v41, v42, v43
    s_waitcnt lgkmcnt(6)
    v_mfma_f32_32x32x16_bf16 v[56:71], v[28:31], v[116:119], v[56:71]
    ds_read_b64_tr_b16 v[20:21], v6 offset:14336
    ds_read_b64_tr_b16 v[22:23], v6 offset:15360
    v_cvt_pk_bf16_f32 v42, v44, v45
    v_cvt_pk_bf16_f32 v43, v46, v47
    s_waitcnt lgkmcnt(6)
    v_mfma_f32_32x32x16_bf16 v[56:71], v[32:35], v[120:123], v[56:71]
    ds_read_b64_tr_b16 v[24:25], v6 offset:16384
    ds_read_b64_tr_b16 v[26:27], v6 offset:17408
    s_add_u32 s67, s66, 0
    buffer_store_dwordx4 v[40:43], v2, s[36:39], s67 offen offset:0 sc1
    s_add_u32 m0, s61, 16384
    s_mov_b32 s60, s73
    buffer_load_dwordx4 v4, s[32:35], s60 offen lds
    s_add_u32 s73, s73, 73728
    s_waitcnt lgkmcnt(6)
    v_mfma_f32_32x32x16_bf16 v[56:71], v[36:39], v[124:127], v[56:71]
    ds_read_b64_tr_b16 v[28:29], v6 offset:18432
    ds_read_b64_tr_b16 v[30:31], v6 offset:19456
    v_cvt_pk_bf16_f32 v48, v48, v49
    v_cvt_pk_bf16_f32 v49, v50, v51
    s_waitcnt lgkmcnt(6)
    v_mfma_f32_32x32x16_bf16 v[56:71], v[16:19], v[128:131], v[56:71]
    ds_read_b64_tr_b16 v[32:33], v6 offset:20480
    ds_read_b64_tr_b16 v[34:35], v6 offset:21504
    v_cvt_pk_bf16_f32 v50, v52, v53
    v_cvt_pk_bf16_f32 v51, v54, v55
    s_waitcnt lgkmcnt(6)
    v_mfma_f32_32x32x16_bf16 v[56:71], v[20:23], v[132:135], v[56:71]
    ds_read_b64_tr_b16 v[36:37], v6 offset:22528
    ds_read_b64_tr_b16 v[38:39], v6 offset:23552
    buffer_store_dwordx4 v[48:51], v2, s[36:39], s67 offen offset:1024 sc1
    s_waitcnt lgkmcnt(6)
    v_mfma_f32_32x32x16_bf16 v[56:71], v[24:27], v[136:139], v[56:71]
    s_waitcnt vmcnt(8)
    s_barrier
    s_cmp_eq_u32 s52, 0
    s_cbranch_scc1 L_sgp1
L_sgp1_b:
    ds_read_b64_tr_b16 v[16:17], v6 offset:24576
    ds_read_b64_tr_b16 v[18:19], v6 offset:25600
    s_waitcnt lgkmcnt(6)
    v_mfma_f32_32x32x16_bf16 v[56:71], v[28:31], v[140:143], v[56:71]
    ds_read_b64_tr_b16 v[20:21], v6 offset:26624
    ds_read_b64_tr_b16 v[22:23], v6 offset:27648
    s_waitcnt lgkmcnt(6)
    v_mfma_f32_32x32x16_bf16 v[56:71], v[32:35], v[144:147], v[56:71]
    ds_read_b64_tr_b16 v[24:25], v6 offset:28672
    ds_read_b64_tr_b16 v[26:27], v6 offset:29696
    s_add_u32 m0, s61, 24576
    s_mov_b32 s60, s73
    buffer_load_dwordx4 v4, s[32:35], s60 offen lds
    s_add_u32 s73, s73, 73728
    s_waitcnt lgkmcnt(6)
    v_mfma_f32_32x32x16_bf16 v[56:71], v[36:39], v[148:151], v[56:71]
    ds_read_b64_tr_b16 v[28:29], v6 offset:30720
    ds_read_b64_tr_b16 v[30:31], v6 offset:31744
    s_waitcnt lgkmcnt(6)
    v_mfma_f32_32x32x16_bf16 v[56:71], v[16:19], v[152:155], v[56:71]
    ds_read_b64_tr_b16 v[32:33], v6 offset:32768
    ds_read_b64_tr_b16 v[34:35], v6 offset:33792
    s_waitcnt lgkmcnt(6)
    v_mfma_f32_32x32x16_bf16 v[56:71], v[20:23], v[156:159], v[56:71]
    ds_read_b64_tr_b16 v[36:37], v6 offset:34816
    ds_read_b64_tr_b16 v[38:39], v6 offset:35840
    s_add_u32 m0, s61, 32768
    s_mov_b32 s60, s73
    buffer_load_dwordx4 v4, s[32:35], s60 offen lds
    s_add_u32 s73, s73, 73728
    s_waitcnt lgkmcnt(6)
    v_mfma_f32_32x32x16_bf16 v[56:71], v[24:27], v[160:163], v[56:71]
    ds_read_b64_tr_b16 v[16:17], v6 offset:36864
    ds_read_b64_tr_b16 v[18:19], v6 offset:37888
    s_waitcnt lgkmcnt(6)
    v_mfma_f32_32x32x16_bf16 v[56:71], v[28:31], v[164:167], v[56:71]
    ds_read_b64_tr_b16 v[20:21], v6 offset:38912
    ds_read_b64_tr_b16 v[22:23], v6 offset:39936
    s_waitcnt lgkmcnt(6)
    v_mfma_f32_32x32x16_bf16 v[56:71], v[32:35], v[168:171], v[56:71]
    ds_read_b64_tr_b16 v[24:25], v6 offset:40960
    ds_read_b64_tr_b16 v[26:27], v6 offset:41984
    s_add_u32 m0, s61, 40960
    s_mov_b32 s60, s73
    buffer_load_dwordx4 v4, s[32:35], s60 offen lds
    s_add_u32 s73, s73, 4294598784
    s_waitcnt lgkmcnt(6)
    v_mfma_f32_32x32x16_bf16 v[56:71], v[36:39], v[172:175], v[56:71]
    ds_read_b64_tr_b16 v[28:29], v6 offset:43008
    ds_read_b64_tr_b16 v[30:31], v6 offset:44032
    s_waitcnt lgkmcnt(6)
    v_mfma_f32_32x32x16_bf16 v[56:71], v[16:19], v[176:179], v[56:71]
    ds_read_b64_tr_b16 v[32:33], v6 offset:45056
    ds_read_b64_tr_b16 v[34:35], v6 offset:46080
    s_waitcnt lgkmcnt(6)
    v_mfma_f32_32x32x16_bf16 v[56:71], v[20:23], v[180:183], v[56:71]
    ds_read_b64_tr_b16 v[36:37], v6 offset:47104
    ds_read_b64_tr_b16 v[38:39], v6 offset:48128
    s_waitcnt lgkmcnt(6)
    v_mfma_f32_32x32x16_bf16 v[56:71], v[24:27], v[184:187], v[56:71]
    s_waitcnt vmcnt(12)
    s_barrier
    ds_read_b64_tr_b16 v[16:17], v7 offset:0
    ds_read_b64_tr_b16 v[18:19], v7 offset:1024
    s_waitcnt lgkmcnt(6)
    v_mfma_f32_32x32x16_bf16 v[56:71], v[28:31], v[188:191], v[56:71]
    ds_read_b64_tr_b16 v[20:21], v7 offset:2048
    ds_read_b64_tr_b16 v[22:23], v7 offset:3072
    s_waitcnt lgkmcnt(6)
    v_mfma_f32_32x32x16_bf16 v[56:71], v[32:35], v[192:195], v[56:71]
    ds_read_b64_tr_b16 v[24:25], v7 offset:4096
    ds_read_b64_tr_b16 v[26:27], v7 offset:5120
    s_add_u32 m0, s61, 49152
    s_mov_b32 s60, s73
    buffer_load_dwordx4 v4, s[32:35], s60 offen lds
    s_add_u32 s73, s73, 73728
    s_waitcnt lgkmcnt(6)
    v_mfma_f32_32x32x16_bf16 v[56:71], v[36:39], v[196:199], v[56:71]
    ds_read_b64_tr_b16 v[28:29], v7 offset:6144
    ds_read_b64_tr_b16 v[30:31], v7 offset:7168
    s_waitcnt lgkmcnt(6)
    v_mfma_f32_32x32x16_bf16 v[72:87], v[16:19], v[104:107], 0
    ds_read_b64_tr_b16 v[32:33], v7 offset:8192
    ds_read_b64_tr_b16 v[34:35], v7 offset:9216
    s_waitcnt lgkmcnt(6)
    v_mfma_f32_32x32x16_bf16 v[72:87], v[20:23], v[108:111], v[72:87]
    ds_read_b64_tr_b16 v[36:37], v7 offset:10240
    ds_read_b64_tr_b16 v[38:39], v7 offset:11264
    s_add_u32 m0, s61, 57344
    s_mov_b32 s60, s73
    buffer_load_dwordx4 v4, s[32:35], s60 offen lds
    s_add_u32 s73, s73, 73728
    s_waitcnt lgkmcnt(6)
    v_mfma_f32_32x32x16_bf16 v[72:87], v[24:27], v[112:115], v[72:87]
    ds_read_b64_tr_b16 v[16:17], v7 offset:12288
    ds_read_b64_tr_b16 v[18:19], v7 offset:13312
    v_cvt_pk_bf16_f32 v56, v56, v57
    v_cvt_pk_bf16_f32 v57, v58, v59
    s_waitcnt lgkmcnt(6)
    v_mfma_f32_32x32x16_bf16 v[72:87], v[28:31], v[116:119], v[72:87]
    ds_read_b64_tr_b16 v[20:21], v7 offset:14336
    ds_read_b64_tr_b16 v[22:23], v7 offset:15360
    v_cvt_pk_bf16_f32 v58, v60, v61
    v_cvt_pk_bf16_f32 v59, v62, v63
    s_waitcnt lgkmcnt(6)
    v_mfma_f32_32x32x16_bf16 v[72:87], v[32:35], v[120:123], v[72:87]
    ds_read_b64_tr_b16 v[24:25], v7 offset:16384
    ds_read_b64_tr_b16 v[26:27], v7 offset:17408
    s_add_u32 s67, s66, 16384
    buffer_store_dwordx4 v[56:59], v2, s[36:39], s67 offen offset:0 sc1
    s_add_u32 m0, s61, 65536
    s_mov_b32 s60, s73
    buffer_load_dwordx4 v4, s[32:35], s60 offen lds
    s_add_u32 s73, s73, 73728
    s_waitcnt lgkmcnt(6)
    v_mfma_f32_32x32x16_bf16 v[72:87], v[36:39], v[124:127], v[72:87]
    ds_read_b64_tr_b16 v[28:29], v7 offset:18432
    ds_read_b64_tr_b16 v[30:31], v7 offset:19456
    v_cvt_pk_bf16_f32 v64, v64, v65
    v_cvt_pk_bf16_f32 v65, v66, v67
    s_waitcnt lgkmcnt(6)
    v_mfma_f32_32x32x16_bf16 v[72:87], v[16:19], v[128:131], v[72:87]
    ds_read_b64_tr_b16 v[32:33], v7 offset:20480
    ds_read_b64_tr_b16 v[34:35], v7 offset:21504
    v_cvt_pk_bf16_f32 v66, v68, v69
    v_cvt_pk_bf16_f32 v67, v70, v71
    s_waitcnt lgkmcnt(6)
    v_mfma_f32_32x32x16_bf16 v[72:87], v[20:23], v[132:135], v[72:87]
    ds_read_b64_tr_b16 v[36:37], v7 offset:22528
    ds_read_b64_tr_b16 v[38:39], v7 offset:23552
    buffer_store_dwordx4 v[64:67], v2, s[36:39], s67 offen offset:1024 sc1
    s_waitcnt lgkmcnt(6)
    v_mfma_f32_32x32x16_bf16 v[72:87], v[24:27], v[136:139], v[72:87]
    s_waitcnt vmcnt(8)
    s_barrier
    s_cmp_eq_u32 s52, 0
    s_cbranch_scc1 L_sgp2
L_sgp2_b:
    ds_read_b64_tr_b16 v[16:17], v7 offset:24576
    ds_read_b64_tr_b16 v[18:19], v7 offset:25600
    s_waitcnt lgkmcnt(6)
    v_mfma_f32_32x32x16_bf16 v[72:87], v[28:31], v[140:143], v[72:87]
    ds_read_b64_tr_b16 v[20:21], v7 offset:26624
    ds_read_b64_tr_b16 v[22:23], v7 offset:27648
    s_waitcnt lgkmcnt(6)
    v_mfma_f32_32x32x16_bf16 v[72:87], v[32:35], v[144:147], v[72:87]
    ds_read_b64_tr_b16 v[24:25], v7 offset:28672
    ds_read_b64_tr_b16 v[26:27], v7 offset:29696
    s_add_u32 m0, s61, 73728
    s_mov_b32 s60, s73
    buffer_load_dwordx4 v4, s[32:35], s60 offen lds
    s_add_u32 s73, s73, 73728
    s_waitcnt lgkmcnt(6)
    v_mfma_f32_32x32x16_bf16 v[72:87], v[36:39], v[148:151], v[72:87]
    ds_read_b64_tr_b16 v[28:29], v7 offset:30720
    ds_read_b64_tr_b16 v[30:31], v7 offset:31744
    s_waitcnt lgkmcnt(6)
    v_mfma_f32_32x32x16_bf16 v[72:87], v[16:19], v[152:155], v[72:87]
    ds_read_b64_tr_b16 v[32:33], v7 offset:32768
    ds_read_b64_tr_b16 v[34:35], v7 offset:33792
    s_waitcnt lgkmcnt(6)
    v_mfma_f32_32x32x16_bf16 v[72:87], v[20:23], v[156:159], v[72:87]
    ds_read_b64_tr_b16 v[36:37], v7 offset:34816
    ds_read_b64_tr_b16 v[38:39], v7 offset:35840
    s_add_u32 m0, s61, 81920
    s_mov_b32 s60, s73
    buffer_load_dwordx4 v4, s[32:35], s60 offen lds
    s_add_u32 s73, s73, 73728
    s_waitcnt lgkmcnt(6)
    v_mfma_f32_32x32x16_bf16 v[72:87], v[24:27], v[160:163], v[72:87]
    ds_read_b64_tr_b16 v[16:17], v7 offset:36864
    ds_read_b64_tr_b16 v[18:19], v7 offset:37888
    s_waitcnt lgkmcnt(6)
    v_mfma_f32_32x32x16_bf16 v[72:87], v[28:31], v[164:167], v[72:87]
    ds_read_b64_tr_b16 v[20:21], v7 offset:38912
    ds_read_b64_tr_b16 v[22:23], v7 offset:39936
    s_waitcnt lgkmcnt(6)
    v_mfma_f32_32x32x16_bf16 v[72:87], v[32:35], v[168:171], v[72:87]
    ds_read_b64_tr_b16 v[24:25], v7 offset:40960
    ds_read_b64_tr_b16 v[26:27], v7 offset:41984
    s_add_u32 m0, s61, 90112
    s_mov_b32 s60, s73
    buffer_load_dwordx4 v4, s[32:35], s60 offen lds
    s_add_u32 s73, s73, 4294598784
    s_waitcnt lgkmcnt(6)
    v_mfma_f32_32x32x16_bf16 v[72:87], v[36:39], v[172:175], v[72:87]
    ds_read_b64_tr_b16 v[28:29], v7 offset:43008
    ds_read_b64_tr_b16 v[30:31], v7 offset:44032
    s_waitcnt lgkmcnt(6)
    v_mfma_f32_32x32x16_bf16 v[72:87], v[16:19], v[176:179], v[72:87]
    ds_read_b64_tr_b16 v[32:33], v7 offset:45056
    ds_read_b64_tr_b16 v[34:35], v7 offset:46080
    s_waitcnt lgkmcnt(6)
    v_mfma_f32_32x32x16_bf16 v[72:87], v[20:23], v[180:183], v[72:87]
    ds_read_b64_tr_b16 v[36:37], v7 offset:47104
    ds_read_b64_tr_b16 v[38:39], v7 offset:48128
    s_waitcnt lgkmcnt(6)
    v_mfma_f32_32x32x16_bf16 v[72:87], v[24:27], v[184:187], v[72:87]
    s_waitcnt vmcnt(12)
    s_barrier
    ds_read_b64_tr_b16 v[16:17], v5 offset:0
    ds_read_b64_tr_b16 v[18:19], v5 offset:1024
    s_waitcnt lgkmcnt(6)
    v_mfma_f32_32x32x16_bf16 v[72:87], v[28:31], v[188:191], v[72:87]
    ds_read_b64_tr_b16 v[20:21], v5 offset:2048
    ds_read_b64_tr_b16 v[22:23], v5 offset:3072
    s_waitcnt lgkmcnt(6)
    v_mfma_f32_32x32x16_bf16 v[72:87], v[32:35], v[192:195], v[72:87]
    ds_read_b64_tr_b16 v[24:25], v5 offset:4096
    ds_read_b64_tr_b16 v[26:27], v5 offset:5120
    s_waitcnt lgkmcnt(6)
    v_mfma_f32_32x32x16_bf16 v[72:87], v[36:39], v[196:199], v[72:87]
    ds_read_b64_tr_b16 v[28:29], v5 offset:6144
    ds_read_b64_tr_b16 v[30:31], v5 offset:7168
    s_add_u32 s66, s66, 49152
    s_mov_b32 s69, 4294950912
    s_add_u32 s98, s98, 3
    s_add_u32 s71, s71, 1
    s_cmp_lt_u32 s71, 3
    s_cbranch_scc1 L_p2
    s_nop 3
    v_cvt_pk_bf16_f32 v72, v72, v73
    v_cvt_pk_bf16_f32 v73, v74, v75
    v_cvt_pk_bf16_f32 v74, v76, v77
    v_cvt_pk_bf16_f32 v75, v78, v79
    s_add_u32 s67, s66, s69
    buffer_store_dwordx4 v[72:75], v2, s[36:39], s67 offen offset:0 sc1
    v_cvt_pk_bf16_f32 v80, v80, v81
    v_cvt_pk_bf16_f32 v81, v82, v83
    v_cvt_pk_bf16_f32 v82, v84, v85
    v_cvt_pk_bf16_f32 v83, v86, v87
    buffer_store_dwordx4 v[80:83], v2, s[36:39], s67 offen offset:1024 sc1
    s_load_dwordx2 s[4:5], s[0:1], 56
    s_load_dwordx2 s[6:7], s[0:1], 16
    s_load_dwordx2 s[8:9], s[0:1], 0
    s_waitcnt lgkmcnt(0)
    v_min_u32 v248, 11, v1
    v_lshlrev_b32 v248, 2, v248
    v_and_b32 v249, 3, v1
    v_lshlrev_b32 v249, 2, v249
    s_lshr_b32 s57, s56, 1
    s_add_u32 s70, s57, 12
    s_lshl_b32 s70, s70, 6
    s_sub_u32 s66, s70, 384
    s_and_b32 s57, s56, 1
    s_lshl_b32 s57, s57, 1
    s_and_b32 s58, s52, 1
    s_add_u32 s72, s57, s58
    s_mov_b32 s73, 1
    s_bitcmp0_b32 s52, 1
    s_cselect_b32 s71, s66, s70
    s_lshr_b32 s69, s71, 7
    s_bfe_u32 s57, s71, 0x10006
    s_lshl_b32 s74, s57, 3
    s_lshl_b32 s57, s72, 1
    s_add_u32 s74, s74, s57
    s_add_u32 s75, s74, 1
    s_lshl_b32 s62, s55, 11
    s_add_u32 s62, s62, 65011712
    s_lshl_b32 s58, s69, 6
    s_add_u32 s63, s62, s58
    s_add_u32 s63, s63, 128
    s_lshl_b32 s57, s55, 2
    s_add_u32 s57, s57, s72
    s_mul_i32 s57, s57, 36864
    s_add_u32 s64, s57, s71
    s_add_u32 s65, s64, 32
    s_mov_b32 s44, s4
    s_mov_b32 s45, s5
    s_mov_b32 s46, 2359296
    s_mov_b32 s47, 0x20000
    s_mov_b32 s48, s6
    s_mov_b32 s49, s7
    s_mov_b32 s50, 663552
    s_mov_b32 s51, 0x20000
    s_mov_b32 s24, s8
    s_mov_b32 s25, s9
    s_mov_b32 s26, 2359296
    s_mov_b32 s27, 0x20000
    s_mov_b32 s68, 0xbfb8aa3b
    s_lshl_b32 s61, s52, 10
    v_lshrrev_b32 v12, 5, v1
    v_lshlrev_b32 v12, 8, v12
    v_bfe_u32 v13, v1, 2, 2
    v_lshl_add_u32 v12, v13, 6, v12
    v_bfe_u32 v13, v1, 4, 1
    v_lshl_add_u32 v12, v13, 5, v12
    v_and_b32 v13, 3, v1
    v_lshl_add_u32 v12, v13, 3, v12
    s_lshl_b32 s57, s54, 9
    v_add_u32 v5, s57, v12
    v_add_u32 v6, 49152, v5
    v_add_u32 v7, 98304, v5
    v_and_b32 v13, 31, v1
    v_mul_u32_u24 v13, 1152, v13
    v_lshrrev_b32 v250, 5, v1
    v_lshl_add_u32 v13, v250, 3, v13
    s_sub_u32 s57, s70, s66
    v_mul_lo_u32 v4, v250, s57
    v_bfe_u32 v250, v1, 2, 3
    v_mul_u32_u24 v250, 1152, v250
    v_add_u32 v4, v4, v250
    v_and_b32 v250, 3, v1
    v_lshl_add_u32 v4, v250, 4, v4
    v_bfe_u32 v250, v1, 4, 1
    v_mul_u32_u24 v250, 36864, v250
    v_add_u32 v3, v4, v250
    s_lshr_b32 s57, s52, 1
    s_mul_i32 s58, s57, 18
    s_and_b32 s59, s57, 1
    s_lshl_b32 s59, s59, 1
    s_add_u32 s58, s58, s59
    s_and_b32 s59, s52, 1
    s_lshl_b32 s60, s59, 3
    s_add_u32 s58, s58, s60
    s_mul_i32 s58, s58, 1152
    s_add_u32 s67, s58, s66
    s_mul_i32 s57, s57, 144
    s_mul_i32 s59, s59, 72
    s_add_u32 s57, s57, s59
    s_add_u32 s57, s57, 16
    s_mul_i32 s57, s57, 1152
    s_add_u32 s98, s57, s66
    buffer_load_dword v251, v249, s[36:39], s62 offen sc1
    buffer_load_dword v250, v248, s[36:39], s63 offen sc1
    s_barrier
    s_add_u32 m0, s61, 0
    s_add_u32 s60, s67, 0
    buffer_load_dwordx4 v4, s[48:51], s60 offen lds
    s_add_u32 m0, s61, 8192
    s_add_u32 s60, s67, 82944
    buffer_load_dwordx4 v4, s[48:51], s60 offen lds
    s_add_u32 m0, s61, 16384
    s_add_u32 s60, s67, 165888
    buffer_load_dwordx4 v4, s[48:51], s60 offen lds
    s_add_u32 m0, s61, 24576
    s_add_u32 s60, s67, 248832
    buffer_load_dwordx4 v4, s[48:51], s60 offen lds
    s_add_u32 m0, s61, 32768
    s_add_u32 s60, s67, 331776
    buffer_load_dwordx4 v4, s[48:51], s60 offen lds
    s_add_u32 m0, s61, 40960
    s_add_u32 s60, s67, 414720
    buffer_load_dwordx4 v4, s[48:51], s60 offen lds
    s_add_u32 m0, s61, 49152
    s_add_u32 s60, s67, 497664
    buffer_load_dwordx4 v4, s[48:51], s60 offen lds
    s_add_u32 m0, s61, 57344
    s_add_u32 s60, s67, 580608
    buffer_load_dwordx4 v4, s[48:51], s60 offen lds
    s_add_u32 m0, s61, 65536
    s_nop 0
    buffer_load_dwordx4 v3, s[48:51], s98 offen lds
    s_waitcnt vmcnt(9)
    s_barrier
    s_cmp_eq_u32 s52, 0
    s_cbranch_scc1 L_sgp3
L_sgp3_b:
    s_cmp_eq_u32 s52, 0
    s_cbranch_scc1 L_sgp4
L_sgp4_b:
    s_cmp_lg_u32 s73, 0
    s_cbranch_scc1 L_m_work
    s_waitcnt vmcnt(0)
    s_barrier
    s_branch L_m_fin
L_m_work:
    s_cmp_eq_u32 s54, 0
    s_cbranch_scc0 L_m_sum
    s_waitcnt vmcnt(0)
    s_barrier
    s_cmp_lt_u32 s52, 2
    s_cbranch_scc0 L_m_idle
    s_mov_b32 s59, 0
    s_branch L_sp_mog_c
L_sp_mog:
    buffer_load_dword v251, v249, s[36:39], s62 offen sc1
    s_add_u32 s59, s59, 1
    s_cmp_gt_u32 s59, 0x40000
    s_cbranch_scc1 L_sp_mog_x
    s_waitcnt vmcnt(0)
L_sp_mog_c:
    v_cmp_gt_u32 vcc, 2, v251
    s_cbranch_vccz L_sp_mog_x
    s_sleep 1
    s_branch L_sp_mog
L_sp_mog_x:
    s_lshl_b32 s57, s55, 2
    s_add_u32 s57, s57, s72
    s_mul_i32 s57, s57, 36864
    s_add_u32 s57, s57, 59768832
    buffer_load_dwordx4 v[104:107], v2, s[36:39], s57 offen offset:0 sc1
    buffer_load_dwordx4 v[108:111], v2, s[36:39], s57 offen offset:1024 sc1
    buffer_load_dwordx4 v[112:115], v2, s[36:39], s57 offen offset:2048 sc1
    buffer_load_dwordx4 v[116:119], v2, s[36:39], s57 offen offset:3072 sc1
    s_add_u32 s57, s57, 4096
    buffer_load_dwordx4 v[120:123], v2, s[36:39], s57 offen offset:0 sc1
    buffer_load_dwordx4 v[124:127], v2, s[36:39], s57 offen offset:1024 sc1
    buffer_load_dwordx4 v[128:131], v2, s[36:39], s57 offen offset:2048 sc1
    buffer_load_dwordx4 v[132:135], v2, s[36:39], s57 offen offset:3072 sc1
    s_add_u32 s57, s57, 4096
    buffer_load_dwordx4 v[136:139], v2, s[36:39], s57 offen offset:0 sc1
    buffer_load_dwordx4 v[140:143], v2, s[36:39], s57 offen offset:1024 sc1
    buffer_load_dwordx4 v[144:147], v2, s[36:39], s57 offen offset:2048 sc1
    buffer_load_dwordx4 v[148:151], v2, s[36:39], s57 offen offset:3072 sc1
    s_add_u32 s57, s57, 4096
    buffer_load_dwordx4 v[152:155], v2, s[36:39], s57 offen offset:0 sc1
    buffer_load_dwordx4 v[156:159], v2, s[36:39], s57 offen offset:1024 sc1
    buffer_load_dwordx4 v[160:163], v2, s[36:39], s57 offen offset:2048 sc1
    buffer_load_dwordx4 v[164:167], v2, s[36:39], s57 offen offset:3072 sc1
    s_add_u32 s57, s57, 4096
    buffer_load_dwordx4 v[168:171], v2, s[36:39], s57 offen offset:0 sc1
    buffer_load_dwordx4 v[172:175], v2, s[36:39], s57 offen offset:1024 sc1
    buffer_load_dwordx4 v[176:179], v2, s[36:39], s57 offen offset:2048 sc1
    buffer_load_dwordx4 v[180:183], v2, s[36:39], s57 offen offset:3072 sc1
    s_add_u32 s57, s57, 4096
    buffer_load_dwordx4 v[184:187], v2, s[36:39], s57 offen offset:0 sc1
    buffer_load_dwordx4 v[188:191], v2, s[36:39], s57 offen offset:1024 sc1
    buffer_load_dwordx4 v[192:195], v2, s[36:39], s57 offen offset:2048 sc1
    buffer_load_dwordx4 v[196:199], v2, s[36:39], s57 offen offset:3072 sc1
    s_add_u32 s57, s57, 4096
    buffer_load_dwordx4 v[200:203], v2, s[36:39], s57 offen offset:0 sc1
    buffer_load_dwordx4 v[204:207], v2, s[36:39], s57 offen offset:1024 sc1
    buffer_load_dwordx4 v[208:211], v2, s[36:39], s57 offen offset:2048 sc1
    buffer_load_dwordx4 v[212:215], v2, s[36:39], s57 offen offset:3072 sc1
    s_add_u32 s57, s57, 4096
    buffer_load_dwordx4 v[216:219], v2, s[36:39], s57 offen offset:0 sc1
    buffer_load_dwordx4 v[220:223], v2, s[36:39], s57 offen offset:1024 sc1
    buffer_load_dwordx4 v[224:227], v2, s[36:39], s57 offen offset:2048 sc1
    buffer_load_dwordx4 v[228:231], v2, s[36:39], s57 offen offset:3072 sc1
    s_add_u32 s57, s57, 4096
    buffer_load_dwordx4 v[232:235], v2, s[36:39], s57 offen offset:0 sc1
    buffer_load_dwordx4 v[236:239], v2, s[36:39], s57 offen offset:1024 sc1
    buffer_load_dwordx4 v[240:243], v2, s[36:39], s57 offen offset:2048 sc1
    buffer_load_dwordx4 v[244:247], v2, s[36:39], s57 offen offset:3072 sc1
    ds_read_b64_tr_b16 v[16:17], v5 offset:0
    ds_read_b64_tr_b16 v[18:19], v5 offset:1024
    ds_read_b64_tr_b16 v[20:21], v5 offset:512
    ds_read_b64_tr_b16 v[22:23], v5 offset:1536
    ds_read_b64_tr_b16 v[24:25], v5 offset:2048
    ds_read_b64_tr_b16 v[26:27], v5 offset:3072
    ds_read_b64_tr_b16 v[28:29], v5 offset:2560
    ds_read_b64_tr_b16 v[30:31], v5 offset:3584
    s_waitcnt vmcnt(35)
    s_waitcnt lgkmcnt(6)
    v_mfma_f32_32x32x16_bf16 v[40:55], v[16:19], v[104:107], 0
    ds_read_b64_tr_b16 v[32:33], v5 offset:4096
    ds_read_b64_tr_b16 v[34:35], v5 offset:5120
    s_waitcnt lgkmcnt(6)
    v_mfma_f32_32x32x16_bf16 v[56:71], v[20:23], v[104:107], 0
    ds_read_b64_tr_b16 v[36:37], v5 offset:4608
    ds_read_b64_tr_b16 v[38:39], v5 offset:5632
    s_waitcnt vmcnt(34)
    s_waitcnt lgkmcnt(6)
    v_mfma_f32_32x32x16_bf16 v[40:55], v[24:27], v[108:111], v[40:55]
    ds_read_b64_tr_b16 v[16:17], v5 offset:6144
    ds_read_b64_tr_b16 v[18:19], v5 offset:7168
    s_waitcnt lgkmcnt(6)
    v_mfma_f32_32x32x16_bf16 v[56:71], v[28:31], v[108:111], v[56:71]
    ds_read_b64_tr_b16 v[20:21], v5 offset:6656
    ds_read_b64_tr_b16 v[22:23], v5 offset:7680
    s_waitcnt vmcnt(33)
    s_waitcnt lgkmcnt(6)
    v_mfma_f32_32x32x16_bf16 v[40:55], v[32:35], v[112:115], v[40:55]
    ds_read_b64_tr_b16 v[24:25], v5 offset:8192
    ds_read_b64_tr_b16 v[26:27], v5 offset:9216
    s_waitcnt lgkmcnt(6)
    v_mfma_f32_32x32x16_bf16 v[56:71], v[36:39], v[112:115], v[56:71]
    ds_read_b64_tr_b16 v[28:29], v5 offset:8704
    ds_read_b64_tr_b16 v[30:31], v5 offset:9728
    s_waitcnt vmcnt(32)
    s_waitcnt lgkmcnt(6)
    v_mfma_f32_32x32x16_bf16 v[40:55], v[16:19], v[116:119], v[40:55]
    ds_read_b64_tr_b16 v[32:33], v5 offset:10240
    ds_read_b64_tr_b16 v[34:35], v5 offset:11264
    s_waitcnt lgkmcnt(6)
    v_mfma_f32_32x32x16_bf16 v[56:71], v[20:23], v[116:119], v[56:71]
    ds_read_b64_tr_b16 v[36:37], v5 offset:10752
    ds_read_b64_tr_b16 v[38:39], v5 offset:11776
    s_waitcnt vmcnt(31)
    s_waitcnt lgkmcnt(6)
    v_mfma_f32_32x32x16_bf16 v[40:55], v[24:27], v[120:123], v[40:55]
    ds_read_b64_tr_b16 v[16:17], v5 offset:12288
    ds_read_b64_tr_b16 v[18:19], v5 offset:13312
    s_waitcnt lgkmcnt(6)
    v_mfma_f32_32x32x16_bf16 v[56:71], v[28:31], v[120:123], v[56:71]
    ds_read_b64_tr_b16 v[20:21], v5 offset:12800
    ds_read_b64_tr_b16 v[22:23], v5 offset:13824
    s_waitcnt vmcnt(30)
    s_waitcnt lgkmcnt(6)
    v_mfma_f32_32x32x16_bf16 v[40:55], v[32:35], v[124:127], v[40:55]
    ds_read_b64_tr_b16 v[24:25], v5 offset:14336
    ds_read_b64_tr_b16 v[26:27], v5 offset:15360
    s_waitcnt lgkmcnt(6)
    v_mfma_f32_32x32x16_bf16 v[56:71], v[36:39], v[124:127], v[56:71]
    ds_read_b64_tr_b16 v[28:29], v5 offset:14848
    ds_read_b64_tr_b16 v[30:31], v5 offset:15872
    s_waitcnt vmcnt(29)
    s_waitcnt lgkmcnt(6)
    v_mfma_f32_32x32x16_bf16 v[40:55], v[16:19], v[128:131], v[40:55]
    ds_read_b64_tr_b16 v[32:33], v5 offset:16384
    ds_read_b64_tr_b16 v[34:35], v5 offset:17408
    s_waitcnt lgkmcnt(6)
    v_mfma_f32_32x32x16_bf16 v[56:71], v[20:23], v[128:131], v[56:71]
    ds_read_b64_tr_b16 v[36:37], v5 offset:16896
    ds_read_b64_tr_b16 v[38:39], v5 offset:17920
    s_waitcnt vmcnt(28)
    s_waitcnt lgkmcnt(6)
    v_mfma_f32_32x32x16_bf16 v[40:55], v[24:27], v[132:135], v[40:55]
    ds_read_b64_tr_b16 v[16:17], v5 offset:18432
    ds_read_b64_tr_b16 v[18:19], v5 offset:19456
    s_waitcnt lgkmcnt(6)
    v_mfma_f32_32x32x16_bf16 v[56:71], v[28:31], v[132:135], v[56:71]
    ds_read_b64_tr_b16 v[20:21], v5 offset:18944
    ds_read_b64_tr_b16 v[22:23], v5 offset:19968
    s_waitcnt vmcnt(27)
    s_waitcnt lgkmcnt(6)
    v_mfma_f32_32x32x16_bf16 v[40:55], v[32:35], v[136:139], v[40:55]
    ds_read_b64_tr_b16 v[24:25], v5 offset:20480
    ds_read_b64_tr_b16 v[26:27], v5 offset:21504
    s_waitcnt lgkmcnt(6)
    v_mfma_f32_32x32x16_bf16 v[56:71], v[36:39], v[136:139], v[56:71]
    ds_read_b64_tr_b16 v[28:29], v5 offset:20992
    ds_read_b64_tr_b16 v[30:31], v5 offset:22016
    s_waitcnt vmcnt(26)
    s_waitcnt lgkmcnt(6)
    v_mfma_f32_32x32x16_bf16 v[40:55], v[16:19], v[140:143], v[40:55]
    ds_read_b64_tr_b16 v[32:33], v5 offset:22528
    ds_read_b64_tr_b16 v[34:35], v5 offset:23552
    s_waitcnt lgkmcnt(6)
    v_mfma_f32_32x32x16_bf16 v[56:71], v[20:23], v[140:143], v[56:71]
    ds_read_b64_tr_b16 v[36:37], v5 offset:23040
    ds_read_b64_tr_b16 v[38:39], v5 offset:24064
    s_waitcnt vmcnt(25)
    s_waitcnt lgkmcnt(6)
    v_mfma_f32_32x32x16_bf16 v[40:55], v[24:27], v[144:147], v[40:55]
    ds_read_b64_tr_b16 v[16:17], v5 offset:24576
    ds_read_b64_tr_b16 v[18:19], v5 offset:25600
    s_waitcnt lgkmcnt(6)
    v_mfma_f32_32x32x16_bf16 v[56:71], v[28:31], v[144:147], v[56:71]
    ds_read_b64_tr_b16 v[20:21], v5 offset:25088
    ds_read_b64_tr_b16 v[22:23], v5 offset:26112
    s_waitcnt vmcnt(24)
    s_waitcnt lgkmcnt(6)
    v_mfma_f32_32x32x16_bf16 v[40:55], v[32:35], v[148:151], v[40:55]
    ds_read_b64_tr_b16 v[24:25], v5 offset:26624
    ds_read_b64_tr_b16 v[26:27], v5 offset:27648
    s_waitcnt lgkmcnt(6)
    v_mfma_f32_32x32x16_bf16 v[56:71], v[36:39], v[148:151], v[56:71]
    ds_read_b64_tr_b16 v[28:29], v5 offset:27136
    ds_read_b64_tr_b16 v[30:31], v5 offset:28160
    s_waitcnt vmcnt(23)
    s_waitcnt lgkmcnt(6)
    v_mfma_f32_32x32x16_bf16 v[40:55], v[16:19], v[152:155], v[40:55]
    ds_read_b64_tr_b16 v[32:33], v5 offset:28672
    ds_read_b64_tr_b16 v[34:35], v5 offset:29696
    s_waitcnt lgkmcnt(6)
    v_mfma_f32_32x32x16_bf16 v[56:71], v[20:23], v[152:155], v[56:71]
    ds_read_b64_tr_b16 v[36:37], v5 offset:29184
    ds_read_b64_tr_b16 v[38:39], v5 offset:30208
    s_waitcnt vmcnt(22)
    s_waitcnt lgkmcnt(6)
    v_mfma_f32_32x32x16_bf16 v[40:55], v[24:27], v[156:159], v[40:55]
    ds_read_b64_tr_b16 v[16:17], v5 offset:30720
    ds_read_b64_tr_b16 v[18:19], v5 offset:31744
    s_waitcnt lgkmcnt(6)
    v_mfma_f32_32x32x16_bf16 v[56:71], v[28:31], v[156:159], v[56:71]
    ds_read_b64_tr_b16 v[20:21], v5 offset:31232
    ds_read_b64_tr_b16 v[22:23], v5 offset:32256
    s_waitcnt vmcnt(21)
    s_waitcnt lgkmcnt(6)
    v_mfma_f32_32x32x16_bf16 v[40:55], v[32:35], v[160:163], v[40:55]
    ds_read_b64_tr_b16 v[24:25], v5 offset:32768
    ds_read_b64_tr_b16 v[26:27], v5 offset:33792
    s_waitcnt lgkmcnt(6)
    v_mfma_f32_32x32x16_bf16 v[56:71], v[36:39], v[160:163], v[56:71]
    ds_read_b64_tr_b16 v[28:29], v5 offset:33280
    ds_read_b64_tr_b16 v[30:31], v5 offset:34304
    s_waitcnt vmcnt(20)
    s_waitcnt lgkmcnt(6)
    v_mfma_f32_32x32x16_bf16 v[40:55], v[16:19], v[164:167], v[40:55]
    ds_read_b64_tr_b16 v[32:33], v5 offset:34816
    ds_read_b64_tr_b16 v[34:35], v5 offset:35840
    s_waitcnt lgkmcnt(6)
    v_mfma_f32_32x32x16_bf16 v[56:71], v[20:23], v[164:167], v[56:71]
    ds_read_b64_tr_b16 v[36:37], v5 offset:35328
    ds_read_b64_tr_b16 v[38:39], v5 offset:36352
    s_waitcnt vmcnt(19)
    s_waitcnt lgkmcnt(6)
    v_mfma_f32_32x32x16_bf16 v[40:55], v[24:27], v[168:171], v[40:55]
    ds_read_b64_tr_b16 v[16:17], v5 offset:36864
    ds_read_b64_tr_b16 v[18:19], v5 offset:37888
    s_waitcnt lgkmcnt(6)
    v_mfma_f32_32x32x16_bf16 v[56:71], v[28:31], v[168:171], v[56:71]
    ds_read_b64_tr_b16 v[20:21], v5 offset:37376
    ds_read_b64_tr_b16 v[22:23], v5 offset:38400
    s_waitcnt vmcnt(18)
    s_waitcnt lgkmcnt(6)
    v_mfma_f32_32x32x16_bf16 v[40:55], v[32:35], v[172:175], v[40:55]
    ds_read_b64_tr_b16 v[24:25], v5 offset:38912
    ds_read_b64_tr_b16 v[26:27], v5 offset:39936
    s_waitcnt lgkmcnt(6)
    v_mfma_f32_32x32x16_bf16 v[56:71], v[36:39], v[172:175], v[56:71]
    ds_read_b64_tr_b16 v[28:29], v5 offset:39424
    ds_read_b64_tr_b16 v[30:31], v5 offset:40448
    s_waitcnt vmcnt(17)
    s_waitcnt lgkmcnt(6)
    v_mfma_f32_32x32x16_bf16 v[40:55], v[16:19], v[176:179], v[40:55]
    ds_read_b64_tr_b16 v[32:33], v5 offset:40960
    ds_read_b64_tr_b16 v[34:35], v5 offset:41984
    s_waitcnt lgkmcnt(6)
    v_mfma_f32_32x32x16_bf16 v[56:71], v[20:23], v[176:179], v[56:71]
    ds_read_b64_tr_b16 v[36:37], v5 offset:41472
    ds_read_b64_tr_b16 v[38:39], v5 offset:42496
    s_waitcnt vmcnt(16)
    s_waitcnt lgkmcnt(6)
    v_mfma_f32_32x32x16_bf16 v[40:55], v[24:27], v[180:183], v[40:55]
    ds_read_b64_tr_b16 v[16:17], v5 offset:43008
    ds_read_b64_tr_b16 v[18:19], v5 offset:44032
    s_waitcnt lgkmcnt(6)
    v_mfma_f32_32x32x16_bf16 v[56:71], v[28:31], v[180:183], v[56:71]
    ds_read_b64_tr_b16 v[20:21], v5 offset:43520
    ds_read_b64_tr_b16 v[22:23], v5 offset:44544
    s_waitcnt vmcnt(15)
    s_waitcnt lgkmcnt(6)
    v_mfma_f32_32x32x16_bf16 v[40:55], v[32:35], v[184:187], v[40:55]
    ds_read_b64_tr_b16 v[24:25], v5 offset:45056
    ds_read_b64_tr_b16 v[26:27], v5 offset:46080
    s_waitcnt lgkmcnt(6)
    v_mfma_f32_32x32x16_bf16 v[56:71], v[36:39], v[184:187], v[56:71]
    ds_read_b64_tr_b16 v[28:29], v5 offset:45568
    ds_read_b64_tr_b16 v[30:31], v5 offset:46592
    s_waitcnt vmcnt(14)
    s_waitcnt lgkmcnt(6)
    v_mfma_f32_32x32x16_bf16 v[40:55], v[16:19], v[188:191], v[40:55]
    ds_read_b64_tr_b16 v[32:33], v5 offset:47104
    ds_read_b64_tr_b16 v[34:35], v5 offset:48128
    s_waitcnt lgkmcnt(6)
    v_mfma_f32_32x32x16_bf16 v[56:71], v[20:23], v[188:191], v[56:71]
    ds_read_b64_tr_b16 v[36:37], v5 offset:47616
    ds_read_b64_tr_b16 v[38:39], v5 offset:48640
    s_waitcnt vmcnt(13)
    s_waitcnt lgkmcnt(6)
    v_mfma_f32_32x32x16_bf16 v[40:55], v[24:27], v[192:195], v[40:55]
    ds_read_b64_tr_b16 v[16:17], v6 offset:0
    ds_read_b64_tr_b16 v[18:19], v6 offset:1024
    s_waitcnt lgkmcnt(6)
    v_mfma_f32_32x32x16_bf16 v[56:71], v[28:31], v[192:195], v[56:71]
    ds_read_b64_tr_b16 v[20:21], v6 offset:512
    ds_read_b64_tr_b16 v[22:23], v6 offset:1536
    s_waitcnt vmcnt(12)
    s_waitcnt lgkmcnt(6)
    v_mfma_f32_32x32x16_bf16 v[40:55], v[32:35], v[196:199], v[40:55]
    ds_read_b64_tr_b16 v[24:25], v6 offset:2048
    ds_read_b64_tr_b16 v[26:27], v6 offset:3072
    s_waitcnt lgkmcnt(6)
    v_mfma_f32_32x32x16_bf16 v[56:71], v[36:39], v[196:199], v[56:71]
    ds_read_b64_tr_b16 v[28:29], v6 offset:2560
    ds_read_b64_tr_b16 v[30:31], v6 offset:3584
    s_waitcnt vmcnt(11)
    s_waitcnt lgkmcnt(6)
    v_mfma_f32_32x32x16_bf16 v[40:55], v[16:19], v[200:203], v[40:55]
    ds_read_b64_tr_b16 v[32:33], v6 offset:4096
    ds_read_b64_tr_b16 v[34:35], v6 offset:5120
    s_waitcnt lgkmcnt(6)
    v_mfma_f32_32x32x16_bf16 v[56:71], v[20:23], v[200:203], v[56:71]
    ds_read_b64_tr_b16 v[36:37], v6 offset:4608
    ds_read_b64_tr_b16 v[38:39], v6 offset:5632
    s_waitcnt vmcnt(10)
    s_waitcnt lgkmcnt(6)
    v_mfma_f32_32x32x16_bf16 v[40:55], v[24:27], v[204:207], v[40:55]
    ds_read_b64_tr_b16 v[16:17], v6 offset:6144
    ds_read_b64_tr_b16 v[18:19], v6 offset:7168
    s_waitcnt lgkmcnt(6)
    v_mfma_f32_32x32x16_bf16 v[56:71], v[28:31], v[204:207], v[56:71]
    ds_read_b64_tr_b16 v[20:21], v6 offset:6656
    ds_read_b64_tr_b16 v[22:23], v6 offset:7680
    s_waitcnt vmcnt(9)
    s_waitcnt lgkmcnt(6)
    v_mfma_f32_32x32x16_bf16 v[40:55], v[32:35], v[208:211], v[40:55]
    ds_read_b64_tr_b16 v[24:25], v6 offset:8192
    ds_read_b64_tr_b16 v[26:27], v6 offset:9216
    s_waitcnt lgkmcnt(6)
    v_mfma_f32_32x32x16_bf16 v[56:71], v[36:39], v[208:211], v[56:71]
    ds_read_b64_tr_b16 v[28:29], v6 offset:8704
    ds_read_b64_tr_b16 v[30:31], v6 offset:9728
    s_waitcnt vmcnt(8)
    s_waitcnt lgkmcnt(6)
    v_mfma_f32_32x32x16_bf16 v[40:55], v[16:19], v[212:215], v[40:55]
    ds_read_b64_tr_b16 v[32:33], v6 offset:10240
    ds_read_b64_tr_b16 v[34:35], v6 offset:11264
    s_waitcnt lgkmcnt(6)
    v_mfma_f32_32x32x16_bf16 v[56:71], v[20:23], v[212:215], v[56:71]
    ds_read_b64_tr_b16 v[36:37], v6 offset:10752
    ds_read_b64_tr_b16 v[38:39], v6 offset:11776
    s_waitcnt vmcnt(7)
    s_waitcnt lgkmcnt(6)
    v_mfma_f32_32x32x16_bf16 v[40:55], v[24:27], v[216:219], v[40:55]
    ds_read_b64_tr_b16 v[16:17], v6 offset:12288
    ds_read_b64_tr_b16 v[18:19], v6 offset:13312
    s_waitcnt lgkmcnt(6)
    v_mfma_f32_32x32x16_bf16 v[56:71], v[28:31], v[216:219], v[56:71]
    ds_read_b64_tr_b16 v[20:21], v6 offset:12800
    ds_read_b64_tr_b16 v[22:23], v6 offset:13824
    s_waitcnt vmcnt(6)
    s_waitcnt lgkmcnt(6)
    v_mfma_f32_32x32x16_bf16 v[40:55], v[32:35], v[220:223], v[40:55]
    ds_read_b64_tr_b16 v[24:25], v6 offset:14336
    ds_read_b64_tr_b16 v[26:27], v6 offset:15360
    s_waitcnt lgkmcnt(6)
    v_mfma_f32_32x32x16_bf16 v[56:71], v[36:39], v[220:223], v[56:71]
    ds_read_b64_tr_b16 v[28:29], v6 offset:14848
    ds_read_b64_tr_b16 v[30:31], v6 offset:15872
    s_waitcnt vmcnt(5)
    s_waitcnt lgkmcnt(6)
    v_mfma_f32_32x32x16_bf16 v[40:55], v[16:19], v[224:227], v[40:55]
    ds_read_b64_tr_b16 v[32:33], v6 offset:16384
    ds_read_b64_tr_b16 v[34:35], v6 offset:17408
    s_waitcnt lgkmcnt(6)
    v_mfma_f32_32x32x16_bf16 v[56:71], v[20:23], v[224:227], v[56:71]
    ds_read_b64_tr_b16 v[36:37], v6 offset:16896
    ds_read_b64_tr_b16 v[38:39], v6 offset:17920
    s_waitcnt vmcnt(4)
    s_waitcnt lgkmcnt(6)
    v_mfma_f32_32x32x16_bf16 v[40:55], v[24:27], v[228:231], v[40:55]
    ds_read_b64_tr_b16 v[16:17], v6 offset:18432
    ds_read_b64_tr_b16 v[18:19], v6 offset:19456
    s_waitcnt lgkmcnt(6)
    v_mfma_f32_32x32x16_bf16 v[56:71], v[28:31], v[228:231], v[56:71]
    ds_read_b64_tr_b16 v[20:21], v6 offset:18944
    ds_read_b64_tr_b16 v[22:23], v6 offset:19968
    s_waitcnt vmcnt(3)
    s_waitcnt lgkmcnt(6)
    v_mfma_f32_32x32x16_bf16 v[40:55], v[32:35], v[232:235], v[40:55]
    ds_read_b64_tr_b16 v[24:25], v6 offset:20480
    ds_read_b64_tr_b16 v[26:27], v6 offset:21504
    s_waitcnt lgkmcnt(6)
    v_mfma_f32_32x32x16_bf16 v[56:71], v[36:39], v[232:235], v[56:71]
    ds_read_b64_tr_b16 v[28:29], v6 offset:20992
    ds_read_b64_tr_b16 v[30:31], v6 offset:22016
    s_waitcnt vmcnt(2)
    s_waitcnt lgkmcnt(6)
    v_mfma_f32_32x32x16_bf16 v[40:55], v[16:19], v[236:239], v[40:55]
    ds_read_b64_tr_b16 v[32:33], v6 offset:22528
    ds_read_b64_tr_b16 v[34:35], v6 offset:23552
    s_waitcnt lgkmcnt(6)
    v_mfma_f32_32x32x16_bf16 v[56:71], v[20:23], v[236:239], v[56:71]
    ds_read_b64_tr_b16 v[36:37], v6 offset:23040
    ds_read_b64_tr_b16 v[38:39], v6 offset:24064
    s_waitcnt vmcnt(1)
    s_waitcnt lgkmcnt(6)
    v_mfma_f32_32x32x16_bf16 v[40:55], v[24:27], v[240:243], v[40:55]
    s_waitcnt lgkmcnt(4)
    v_mfma_f32_32x32x16_bf16 v[56:71], v[28:31], v[240:243], v[56:71]
    s_waitcnt vmcnt(0)
    s_waitcnt lgkmcnt(2)
    v_mfma_f32_32x32x16_bf16 v[40:55], v[32:35], v[244:247], v[40:55]
    s_waitcnt lgkmcnt(0)
    v_mfma_f32_32x32x16_bf16 v[56:71], v[36:39], v[244:247], v[56:71]
    s_lshl_b32 s57, s52, 11
    s_add_u32 s57, s57, 73728
    v_add_u32 v250, s57, v2
    s_nop 6
    v_cvt_pk_bf16_f32 v40, v40, v41
    v_cvt_pk_bf16_f32 v41, v42, v43
    v_cvt_pk_bf16_f32 v42, v44, v45
    v_cvt_pk_bf16_f32 v43, v46, v47
    v_cvt_pk_bf16_f32 v44, v48, v49
    v_cvt_pk_bf16_f32 v45, v50, v51
    v_cvt_pk_bf16_f32 v46, v52, v53
    v_cvt_pk_bf16_f32 v47, v54, v55
    ds_write_b128 v250, v[40:43] offset:0
    ds_write_b128 v250, v[44:47] offset:1024
    v_cvt_pk_bf16_f32 v56, v56, v57
    v_cvt_pk_bf16_f32 v57, v58, v59
    v_cvt_pk_bf16_f32 v58, v60, v61
    v_cvt_pk_bf16_f32 v59, v62, v63
    v_cvt_pk_bf16_f32 v60, v64, v65
    v_cvt_pk_bf16_f32 v61, v66, v67
    v_cvt_pk_bf16_f32 v62, v68, v69
    v_cvt_pk_bf16_f32 v63, v70, v71
    ds_write_b128 v250, v[56:59] offset:4096
    ds_write_b128 v250, v[60:63] offset:5120
    s_waitcnt lgkmcnt(0)
L_m_idle:
    s_barrier
    s_branch L_m_fin
L_m_sum:
    s_waitcnt vmcnt(0)
    s_barrier
    s_mov_b32 s59, 0
    s_branch L_sp_mes_c
L_sp_mes:
    buffer_load_dword v250, v248, s[36:39], s63 offen sc1
    s_add_u32 s59, s59, 1
    s_cmp_gt_u32 s59, 0x40000
    s_cbranch_scc1 L_sp_mes_x
    s_waitcnt vmcnt(0)
L_sp_mes_c:
    v_cmp_gt_u32 vcc, 1, v250
    s_cbranch_vccz L_sp_mes_x
    s_sleep 1
    s_branch L_sp_mes
L_sp_mes_x:
    s_mul_i32 s57, s55, 9
    s_add_u32 s57, s57, s69
    s_lshl_b32 s57, s57, 4
    s_add_u32 s57, s57, s74
    s_lshl_b32 s57, s57, 10
    s_add_u32 s57, s57, 18874368
    buffer_load_dwordx4 v[104:107], v2, s[36:39], s57 offen sc1
    s_add_u32 s57, s57, 2359296
    buffer_load_dwordx4 v[108:111], v2, s[36:39], s57 offen sc1
    s_add_u32 s57, s57, 2359296
    buffer_load_dwordx4 v[112:115], v2, s[36:39], s57 offen sc1
    s_add_u32 s57, s57, 2359296
    buffer_load_dwordx4 v[116:119], v2, s[36:39], s57 offen sc1
    s_add_u32 s57, s57, 2359296
    buffer_load_dwordx4 v[120:123], v2, s[36:39], s57 offen sc1
    s_add_u32 s57, s57, 2359296
    buffer_load_dwordx4 v[124:127], v2, s[36:39], s57 offen sc1
    s_add_u32 s57, s57, 2359296
    buffer_load_dwordx4 v[128:131], v2, s[36:39], s57 offen sc1
    s_add_u32 s57, s57, 2359296
    buffer_load_dwordx4 v[132:135], v2, s[36:39], s57 offen sc1
    s_add_u32 s57, s57, 2359296
    buffer_load_dwordx4 v[136:139], v2, s[36:39], s57 offen sc1
    s_add_u32 s57, s57, 2359296
    buffer_load_dwordx4 v[140:143], v2, s[36:39], s57 offen sc1
    s_add_u32 s57, s57, 2359296
    buffer_load_dwordx4 v[144:147], v2, s[36:39], s57 offen sc1
    s_add_u32 s57, s57, 2359296
    buffer_load_dwordx4 v[148:151], v2, s[36:39], s57 offen sc1
    buffer_load_dwordx2 v[40:41], v13, s[24:27], s64 offen
    buffer_load_dwordx2 v[42:43], v13, s[24:27], s64 offen offset:16
    s_mul_i32 s57, s55, 9
    s_add_u32 s57, s57, s69
    s_lshl_b32 s57, s57, 4
    s_add_u32 s57, s57, s75
    s_lshl_b32 s57, s57, 10
    s_add_u32 s57, s57, 18874368
    buffer_load_dwordx4 v[152:155], v2, s[36:39], s57 offen sc1
    s_add_u32 s57, s57, 2359296
    buffer_load_dwordx4 v[156:159], v2, s[36:39], s57 offen sc1
    s_add_u32 s57, s57, 2359296
    buffer_load_dwordx4 v[160:163], v2, s[36:39], s57 offen sc1
    s_add_u32 s57, s57, 2359296
    buffer_load_dwordx4 v[164:167], v2, s[36:39], s57 offen sc1
    s_add_u32 s57, s57, 2359296
    buffer_load_dwordx4 v[168:171], v2, s[36:39], s57 offen sc1
    s_add_u32 s57, s57, 2359296
    buffer_load_dwordx4 v[172:175], v2, s[36:39], s57 offen sc1
    s_add_u32 s57, s57, 2359296
    buffer_load_dwordx4 v[176:179], v2, s[36:39], s57 offen sc1
    s_add_u32 s57, s57, 2359296
    buffer_load_dwordx4 v[180:183], v2, s[36:39], s57 offen sc1
    s_add_u32 s57, s57, 2359296
    buffer_load_dwordx4 v[184:187], v2, s[36:39], s57 offen sc1
    s_add_u32 s57, s57, 2359296
    buffer_load_dwordx4 v[188:191], v2, s[36:39], s57 offen sc1
    s_add_u32 s57, s57, 2359296
    buffer_load_dwordx4 v[192:195], v2, s[36:39], s57 offen sc1
    s_add_u32 s57, s57, 2359296
    buffer_load_dwordx4 v[196:199], v2, s[36:39], s57 offen sc1
    buffer_load_dwordx2 v[44:45], v13, s[24:27], s65 offen
    buffer_load_dwordx2 v[46:47], v13, s[24:27], s65 offen offset:16
    s_lshl_b32 s57, s53, 11
    s_add_u32 s57, s57, 73728
    v_add_u32 v250, s57, v2
    s_waitcnt vmcnt(14)
    v_lshlrev_b32 v48, 16, v104
    v_and_b32 v49, 0xffff0000, v104
    v_lshlrev_b32 v50, 16, v105
    v_and_b32 v51, 0xffff0000, v105
    v_lshlrev_b32 v52, 16, v106
    v_and_b32 v53, 0xffff0000, v106
    v_lshlrev_b32 v54, 16, v107
    v_and_b32 v55, 0xffff0000, v107
    v_lshlrev_b32 v64, 16, v108
    v_and_b32 v65, 0xffff0000, v108
    v_lshlrev_b32 v66, 16, v109
    v_and_b32 v67, 0xffff0000, v109
    v_lshlrev_b32 v68, 16, v110
    v_and_b32 v69, 0xffff0000, v110
    v_lshlrev_b32 v70, 16, v111
    v_and_b32 v71, 0xffff0000, v111
    v_add_f32 v48, v48, v64
    v_add_f32 v49, v49, v65
    v_add_f32 v50, v50, v66
    v_add_f32 v51, v51, v67
    v_add_f32 v52, v52, v68
    v_add_f32 v53, v53, v69
    v_add_f32 v54, v54, v70
    v_add_f32 v55, v55, v71
    v_lshlrev_b32 v64, 16, v112
    v_and_b32 v65, 0xffff0000, v112
    v_lshlrev_b32 v66, 16, v113
    v_and_b32 v67, 0xffff0000, v113
    v_lshlrev_b32 v68, 16, v114
    v_and_b32 v69, 0xffff0000, v114
    v_lshlrev_b32 v70, 16, v115
    v_and_b32 v71, 0xffff0000, v115
    v_add_f32 v48, v48, v64
    v_add_f32 v49, v49, v65
    v_add_f32 v50, v50, v66
    v_add_f32 v51, v51, v67
    v_add_f32 v52, v52, v68
    v_add_f32 v53, v53, v69
    v_add_f32 v54, v54, v70
    v_add_f32 v55, v55, v71
    v_lshlrev_b32 v64, 16, v116
    v_and_b32 v65, 0xffff0000, v116
    v_lshlrev_b32 v66, 16, v117
    v_and_b32 v67, 0xffff0000, v117
    v_lshlrev_b32 v68, 16, v118
    v_and_b32 v69, 0xffff0000, v118
    v_lshlrev_b32 v70, 16, v119
    v_and_b32 v71, 0xffff0000, v119
    v_add_f32 v48, v48, v64
    v_add_f32 v49, v49, v65
    v_add_f32 v50, v50, v66
    v_add_f32 v51, v51, v67
    v_add_f32 v52, v52, v68
    v_add_f32 v53, v53, v69
    v_add_f32 v54, v54, v70
    v_add_f32 v55, v55, v71
    v_lshlrev_b32 v64, 16, v120
    v_and_b32 v65, 0xffff0000, v120
    v_lshlrev_b32 v66, 16, v121
    v_and_b32 v67, 0xffff0000, v121
    v_lshlrev_b32 v68, 16, v122
    v_and_b32 v69, 0xffff0000, v122
    v_lshlrev_b32 v70, 16, v123
    v_and_b32 v71, 0xffff0000, v123
    v_add_f32 v48, v48, v64
    v_add_f32 v49, v49, v65
    v_add_f32 v50, v50, v66
    v_add_f32 v51, v51, v67
    v_add_f32 v52, v52, v68
    v_add_f32 v53, v53, v69
    v_add_f32 v54, v54, v70
    v_add_f32 v55, v55, v71
    v_lshlrev_b32 v64, 16, v124
    v_and_b32 v65, 0xffff0000, v124
    v_lshlrev_b32 v66, 16, v125
    v_and_b32 v67, 0xffff0000, v125
    v_lshlrev_b32 v68, 16, v126
    v_and_b32 v69, 0xffff0000, v126
    v_lshlrev_b32 v70, 16, v127
    v_and_b32 v71, 0xffff0000, v127
    v_add_f32 v48, v48, v64
    v_add_f32 v49, v49, v65
    v_add_f32 v50, v50, v66
    v_add_f32 v51, v51, v67
    v_add_f32 v52, v52, v68
    v_add_f32 v53, v53, v69
    v_add_f32 v54, v54, v70
    v_add_f32 v55, v55, v71
    v_lshlrev_b32 v64, 16, v128
    v_and_b32 v65, 0xffff0000, v128
    v_lshlrev_b32 v66, 16, v129
    v_and_b32 v67, 0xffff0000, v129
    v_lshlrev_b32 v68, 16, v130
    v_and_b32 v69, 0xffff0000, v130
    v_lshlrev_b32 v70, 16, v131
    v_and_b32 v71, 0xffff0000, v131
    v_add_f32 v48, v48, v64
    v_add_f32 v49, v49, v65
    v_add_f32 v50, v50, v66
    v_add_f32 v51, v51, v67
    v_add_f32 v52, v52, v68
    v_add_f32 v53, v53, v69
    v_add_f32 v54, v54, v70
    v_add_f32 v55, v55, v71
    v_lshlrev_b32 v64, 16, v132
    v_and_b32 v65, 0xffff0000, v132
    v_lshlrev_b32 v66, 16, v133
    v_and_b32 v67, 0xffff0000, v133
    v_lshlrev_b32 v68, 16, v134
    v_and_b32 v69, 0xffff0000, v134
    v_lshlrev_b32 v70, 16, v135
    v_and_b32 v71, 0xffff0000, v135
    v_add_f32 v48, v48, v64
    v_add_f32 v49, v49, v65
    v_add_f32 v50, v50, v66
    v_add_f32 v51, v51, v67
    v_add_f32 v52, v52, v68
    v_add_f32 v53, v53, v69
    v_add_f32 v54, v54, v70
    v_add_f32 v55, v55, v71
    v_lshlrev_b32 v64, 16, v136
    v_and_b32 v65, 0xffff0000, v136
    v_lshlrev_b32 v66, 16, v137
    v_and_b32 v67, 0xffff0000, v137
    v_lshlrev_b32 v68, 16, v138
    v_and_b32 v69, 0xffff0000, v138
    v_lshlrev_b32 v70, 16, v139
    v_and_b32 v71, 0xffff0000, v139
    v_add_f32 v48, v48, v64
    v_add_f32 v49, v49, v65
    v_add_f32 v50, v50, v66
    v_add_f32 v51, v51, v67
    v_add_f32 v52, v52, v68
    v_add_f32 v53, v53, v69
    v_add_f32 v54, v54, v70
    v_add_f32 v55, v55, v71
    v_lshlrev_b32 v64, 16, v140
    v_and_b32 v65, 0xffff0000, v140
    v_lshlrev_b32 v66, 16, v141
    v_and_b32 v67, 0xffff0000, v141
    v_lshlrev_b32 v68, 16, v142
    v_and_b32 v69, 0xffff0000, v142
    v_lshlrev_b32 v70, 16, v143
    v_and_b32 v71, 0xffff0000, v143
    v_add_f32 v48, v48, v64
    v_add_f32 v49, v49, v65
    v_add_f32 v50, v50, v66
    v_add_f32 v51, v51, v67
    v_add_f32 v52, v52, v68
    v_add_f32 v53, v53, v69
    v_add_f32 v54, v54, v70
    v_add_f32 v55, v55, v71
    v_lshlrev_b32 v64, 16, v144
    v_and_b32 v65, 0xffff0000, v144
    v_lshlrev_b32 v66, 16, v145
    v_and_b32 v67, 0xffff0000, v145
    v_lshlrev_b32 v68, 16, v146
    v_and_b32 v69, 0xffff0000, v146
    v_lshlrev_b32 v70, 16, v147
    v_and_b32 v71, 0xffff0000, v147
    v_add_f32 v48, v48, v64
    v_add_f32 v49, v49, v65
    v_add_f32 v50, v50, v66
    v_add_f32 v51, v51, v67
    v_add_f32 v52, v52, v68
    v_add_f32 v53, v53, v69
    v_add_f32 v54, v54, v70
    v_add_f32 v55, v55, v71
    v_lshlrev_b32 v64, 16, v148
    v_and_b32 v65, 0xffff0000, v148
    v_lshlrev_b32 v66, 16, v149
    v_and_b32 v67, 0xffff0000, v149
    v_lshlrev_b32 v68, 16, v150
    v_and_b32 v69, 0xffff0000, v150
    v_lshlrev_b32 v70, 16, v151
    v_and_b32 v71, 0xffff0000, v151
    v_add_f32 v48, v48, v64
    v_add_f32 v49, v49, v65
    v_add_f32 v50, v50, v66
    v_add_f32 v51, v51, v67
    v_add_f32 v52, v52, v68
    v_add_f32 v53, v53, v69
    v_add_f32 v54, v54, v70
    v_add_f32 v55, v55, v71
    v_cvt_pk_bf16_f32 v72, v48, v49
    v_cvt_pk_bf16_f32 v73, v50, v51
    v_cvt_pk_bf16_f32 v74, v52, v53
    v_cvt_pk_bf16_f32 v75, v54, v55
    v_lshlrev_b32 v48, 16, v72
    v_and_b32 v49, 0xffff0000, v72
    v_lshlrev_b32 v50, 16, v73
    v_and_b32 v51, 0xffff0000, v73
    v_lshlrev_b32 v52, 16, v74
    v_and_b32 v53, 0xffff0000, v74
    v_lshlrev_b32 v54, 16, v75
    v_and_b32 v55, 0xffff0000, v75
    v_mul_f32 v64, s68, v48
    v_mul_f32 v65, s68, v49
    v_mul_f32 v66, s68, v50
    v_mul_f32 v67, s68, v51
    v_mul_f32 v68, s68, v52
    v_mul_f32 v69, s68, v53
    v_mul_f32 v70, s68, v54
    v_mul_f32 v71, s68, v55
    v_exp_f32 v64, v64
    v_exp_f32 v65, v65
    v_exp_f32 v66, v66
    v_exp_f32 v67, v67
    v_exp_f32 v68, v68
    v_exp_f32 v69, v69
    v_exp_f32 v70, v70
    v_exp_f32 v71, v71
    v_add_f32 v64, 1.0, v64
    v_add_f32 v65, 1.0, v65
    v_add_f32 v66, 1.0, v66
    v_add_f32 v67, 1.0, v67
    v_add_f32 v68, 1.0, v68
    v_add_f32 v69, 1.0, v69
    v_add_f32 v70, 1.0, v70
    v_add_f32 v71, 1.0, v71
    v_rcp_f32 v64, v64
    v_rcp_f32 v65, v65
    v_rcp_f32 v66, v66
    v_rcp_f32 v67, v67
    v_rcp_f32 v68, v68
    v_rcp_f32 v69, v69
    v_rcp_f32 v70, v70
    v_rcp_f32 v71, v71
    v_mul_f32 v48, v48, v64
    v_mul_f32 v49, v49, v65
    v_mul_f32 v50, v50, v66
    v_mul_f32 v51, v51, v67
    v_mul_f32 v52, v52, v68
    v_mul_f32 v53, v53, v69
    v_mul_f32 v54, v54, v70
    v_mul_f32 v55, v55, v71
    v_cvt_pk_bf16_f32 v72, v48, v49
    v_cvt_pk_bf16_f32 v73, v50, v51
    v_cvt_pk_bf16_f32 v74, v52, v53
    v_cvt_pk_bf16_f32 v75, v54, v55
    v_lshlrev_b32 v48, 16, v72
    v_and_b32 v49, 0xffff0000, v72
    v_lshlrev_b32 v50, 16, v73
    v_and_b32 v51, 0xffff0000, v73
    v_lshlrev_b32 v52, 16, v74
    v_and_b32 v53, 0xffff0000, v74
    v_lshlrev_b32 v54, 16, v75
    v_and_b32 v55, 0xffff0000, v75
    s_waitcnt vmcnt(0)
    v_lshlrev_b32 v56, 16, v152
    v_and_b32 v57, 0xffff0000, v152
    v_lshlrev_b32 v58, 16, v153
    v_and_b32 v59, 0xffff0000, v153
    v_lshlrev_b32 v60, 16, v154
    v_and_b32 v61, 0xffff0000, v154
    v_lshlrev_b32 v62, 16, v155
    v_and_b32 v63, 0xffff0000, v155
    v_lshlrev_b32 v64, 16, v156
    v_and_b32 v65, 0xffff0000, v156
    v_lshlrev_b32 v66, 16, v157
    v_and_b32 v67, 0xffff0000, v157
    v_lshlrev_b32 v68, 16, v158
    v_and_b32 v69, 0xffff0000, v158
    v_lshlrev_b32 v70, 16, v159
    v_and_b32 v71, 0xffff0000, v159
    v_add_f32 v56, v56, v64
    v_add_f32 v57, v57, v65
    v_add_f32 v58, v58, v66
    v_add_f32 v59, v59, v67
    v_add_f32 v60, v60, v68
    v_add_f32 v61, v61, v69
    v_add_f32 v62, v62, v70
    v_add_f32 v63, v63, v71
    v_lshlrev_b32 v64, 16, v160
    v_and_b32 v65, 0xffff0000, v160
    v_lshlrev_b32 v66, 16, v161
    v_and_b32 v67, 0xffff0000, v161
    v_lshlrev_b32 v68, 16, v162
    v_and_b32 v69, 0xffff0000, v162
    v_lshlrev_b32 v70, 16, v163
    v_and_b32 v71, 0xffff0000, v163
    v_add_f32 v56, v56, v64
    v_add_f32 v57, v57, v65
    v_add_f32 v58, v58, v66
    v_add_f32 v59, v59, v67
    v_add_f32 v60, v60, v68
    v_add_f32 v61, v61, v69
    v_add_f32 v62, v62, v70
    v_add_f32 v63, v63, v71
    v_lshlrev_b32 v64, 16, v164
    v_and_b32 v65, 0xffff0000, v164
    v_lshlrev_b32 v66, 16, v165
    v_and_b32 v67, 0xffff0000, v165
    v_lshlrev_b32 v68, 16, v166
    v_and_b32 v69, 0xffff0000, v166
    v_lshlrev_b32 v70, 16, v167
    v_and_b32 v71, 0xffff0000, v167
    v_add_f32 v56, v56, v64
    v_add_f32 v57, v57, v65
    v_add_f32 v58, v58, v66
    v_add_f32 v59, v59, v67
    v_add_f32 v60, v60, v68
    v_add_f32 v61, v61, v69
    v_add_f32 v62, v62, v70
    v_add_f32 v63, v63, v71
    v_lshlrev_b32 v64, 16, v168
    v_and_b32 v65, 0xffff0000, v168
    v_lshlrev_b32 v66, 16, v169
    v_and_b32 v67, 0xffff0000, v169
    v_lshlrev_b32 v68, 16, v170
    v_and_b32 v69, 0xffff0000, v170
    v_lshlrev_b32 v70, 16, v171
    v_and_b32 v71, 0xffff0000, v171
    v_add_f32 v56, v56, v64
    v_add_f32 v57, v57, v65
    v_add_f32 v58, v58, v66
    v_add_f32 v59, v59, v67
    v_add_f32 v60, v60, v68
    v_add_f32 v61, v61, v69
    v_add_f32 v62, v62, v70
    v_add_f32 v63, v63, v71
    v_lshlrev_b32 v64, 16, v172
    v_and_b32 v65, 0xffff0000, v172
    v_lshlrev_b32 v66, 16, v173
    v_and_b32 v67, 0xffff0000, v173
    v_lshlrev_b32 v68, 16, v174
    v_and_b32 v69, 0xffff0000, v174
    v_lshlrev_b32 v70, 16, v175
    v_and_b32 v71, 0xffff0000, v175
    v_add_f32 v56, v56, v64
    v_add_f32 v57, v57, v65
    v_add_f32 v58, v58, v66
    v_add_f32 v59, v59, v67
    v_add_f32 v60, v60, v68
    v_add_f32 v61, v61, v69
    v_add_f32 v62, v62, v70
    v_add_f32 v63, v63, v71
    v_lshlrev_b32 v64, 16, v176
    v_and_b32 v65, 0xffff0000, v176
    v_lshlrev_b32 v66, 16, v177
    v_and_b32 v67, 0xffff0000, v177
    v_lshlrev_b32 v68, 16, v178
    v_and_b32 v69, 0xffff0000, v178
    v_lshlrev_b32 v70, 16, v179
    v_and_b32 v71, 0xffff0000, v179
    v_add_f32 v56, v56, v64
    v_add_f32 v57, v57, v65
    v_add_f32 v58, v58, v66
    v_add_f32 v59, v59, v67
    v_add_f32 v60, v60, v68
    v_add_f32 v61, v61, v69
    v_add_f32 v62, v62, v70
    v_add_f32 v63, v63, v71
    v_lshlrev_b32 v64, 16, v180
    v_and_b32 v65, 0xffff0000, v180
    v_lshlrev_b32 v66, 16, v181
    v_and_b32 v67, 0xffff0000, v181
    v_lshlrev_b32 v68, 16, v182
    v_and_b32 v69, 0xffff0000, v182
    v_lshlrev_b32 v70, 16, v183
    v_and_b32 v71, 0xffff0000, v183
    v_add_f32 v56, v56, v64
    v_add_f32 v57, v57, v65
    v_add_f32 v58, v58, v66
    v_add_f32 v59, v59, v67
    v_add_f32 v60, v60, v68
    v_add_f32 v61, v61, v69
    v_add_f32 v62, v62, v70
    v_add_f32 v63, v63, v71
    v_lshlrev_b32 v64, 16, v184
    v_and_b32 v65, 0xffff0000, v184
    v_lshlrev_b32 v66, 16, v185
    v_and_b32 v67, 0xffff0000, v185
    v_lshlrev_b32 v68, 16, v186
    v_and_b32 v69, 0xffff0000, v186
    v_lshlrev_b32 v70, 16, v187
    v_and_b32 v71, 0xffff0000, v187
    v_add_f32 v56, v56, v64
    v_add_f32 v57, v57, v65
    v_add_f32 v58, v58, v66
    v_add_f32 v59, v59, v67
    v_add_f32 v60, v60, v68
    v_add_f32 v61, v61, v69
    v_add_f32 v62, v62, v70
    v_add_f32 v63, v63, v71
    v_lshlrev_b32 v64, 16, v188
    v_and_b32 v65, 0xffff0000, v188
    v_lshlrev_b32 v66, 16, v189
    v_and_b32 v67, 0xffff0000, v189
    v_lshlrev_b32 v68, 16, v190
    v_and_b32 v69, 0xffff0000, v190
    v_lshlrev_b32 v70, 16, v191
    v_and_b32 v71, 0xffff0000, v191
    v_add_f32 v56, v56, v64
    v_add_f32 v57, v57, v65
    v_add_f32 v58, v58, v66
    v_add_f32 v59, v59, v67
    v_add_f32 v60, v60, v68
    v_add_f32 v61, v61, v69
    v_add_f32 v62, v62, v70
    v_add_f32 v63, v63, v71
    v_lshlrev_b32 v64, 16, v192
    v_and_b32 v65, 0xffff0000, v192
    v_lshlrev_b32 v66, 16, v193
    v_and_b32 v67, 0xffff0000, v193
    v_lshlrev_b32 v68, 16, v194
    v_and_b32 v69, 0xffff0000, v194
    v_lshlrev_b32 v70, 16, v195
    v_and_b32 v71, 0xffff0000, v195
    v_add_f32 v56, v56, v64
    v_add_f32 v57, v57, v65
    v_add_f32 v58, v58, v66
    v_add_f32 v59, v59, v67
    v_add_f32 v60, v60, v68
    v_add_f32 v61, v61, v69
    v_add_f32 v62, v62, v70
    v_add_f32 v63, v63, v71
    v_lshlrev_b32 v64, 16, v196
    v_and_b32 v65, 0xffff0000, v196
    v_lshlrev_b32 v66, 16, v197
    v_and_b32 v67, 0xffff0000, v197
    v_lshlrev_b32 v68, 16, v198
    v_and_b32 v69, 0xffff0000, v198
    v_lshlrev_b32 v70, 16, v199
    v_and_b32 v71, 0xffff0000, v199
    v_add_f32 v56, v56, v64
    v_add_f32 v57, v57, v65
    v_add_f32 v58, v58, v66
    v_add_f32 v59, v59, v67
    v_add_f32 v60, v60, v68
    v_add_f32 v61, v61, v69
    v_add_f32 v62, v62, v70
    v_add_f32 v63, v63, v71
    v_cvt_pk_bf16_f32 v72, v56, v57
    v_cvt_pk_bf16_f32 v73, v58, v59
    v_cvt_pk_bf16_f32 v74, v60, v61
    v_cvt_pk_bf16_f32 v75, v62, v63
    v_lshlrev_b32 v56, 16, v72
    v_and_b32 v57, 0xffff0000, v72
    v_lshlrev_b32 v58, 16, v73
    v_and_b32 v59, 0xffff0000, v73
    v_lshlrev_b32 v60, 16, v74
    v_and_b32 v61, 0xffff0000, v74
    v_lshlrev_b32 v62, 16, v75
    v_and_b32 v63, 0xffff0000, v75
    v_mul_f32 v64, s68, v56
    v_mul_f32 v65, s68, v57
    v_mul_f32 v66, s68, v58
    v_mul_f32 v67, s68, v59
    v_mul_f32 v68, s68, v60
    v_mul_f32 v69, s68, v61
    v_mul_f32 v70, s68, v62
    v_mul_f32 v71, s68, v63
    v_exp_f32 v64, v64
    v_exp_f32 v65, v65
    v_exp_f32 v66, v66
    v_exp_f32 v67, v67
    v_exp_f32 v68, v68
    v_exp_f32 v69, v69
    v_exp_f32 v70, v70
    v_exp_f32 v71, v71
    v_add_f32 v64, 1.0, v64
    v_add_f32 v65, 1.0, v65
    v_add_f32 v66, 1.0, v66
    v_add_f32 v67, 1.0, v67
    v_add_f32 v68, 1.0, v68
    v_add_f32 v69, 1.0, v69
    v_add_f32 v70, 1.0, v70
    v_add_f32 v71, 1.0, v71
    v_rcp_f32 v64, v64
    v_rcp_f32 v65, v65
    v_rcp_f32 v66, v66
    v_rcp_f32 v67, v67
    v_rcp_f32 v68, v68
    v_rcp_f32 v69, v69
    v_rcp_f32 v70, v70
    v_rcp_f32 v71, v71
    v_mul_f32 v56, v56, v64
    v_mul_f32 v57, v57, v65
    v_mul_f32 v58, v58, v66
    v_mul_f32 v59, v59, v67
    v_mul_f32 v60, v60, v68
    v_mul_f32 v61, v61, v69
    v_mul_f32 v62, v62, v70
    v_mul_f32 v63, v63, v71
    v_cvt_pk_bf16_f32 v72, v56, v57
    v_cvt_pk_bf16_f32 v73, v58, v59
    v_cvt_pk_bf16_f32 v74, v60, v61
    v_cvt_pk_bf16_f32 v75, v62, v63
    v_lshlrev_b32 v56, 16, v72
    v_and_b32 v57, 0xffff0000, v72
    v_lshlrev_b32 v58, 16, v73
    v_and_b32 v59, 0xffff0000, v73
    v_lshlrev_b32 v60, 16, v74
    v_and_b32 v61, 0xffff0000, v74
    v_lshlrev_b32 v62, 16, v75
    v_and_b32 v63, 0xffff0000, v75
    s_barrier
    ds_read_b128 v[104:107], v250
    ds_read_b128 v[108:111], v250 offset:1024
    s_waitcnt lgkmcnt(0)
    v_lshlrev_b32 v88, 16, v104
    v_and_b32 v89, 0xffff0000, v104
    v_lshlrev_b32 v90, 16, v105
    v_and_b32 v91, 0xffff0000, v105
    v_lshlrev_b32 v92, 16, v106
    v_and_b32 v93, 0xffff0000, v106
    v_lshlrev_b32 v94, 16, v107
    v_and_b32 v95, 0xffff0000, v107
    v_lshlrev_b32 v96, 16, v108
    v_and_b32 v97, 0xffff0000, v108
    v_lshlrev_b32 v98, 16, v109
    v_and_b32 v99, 0xffff0000, v109
    v_lshlrev_b32 v100, 16, v110
    v_and_b32 v101, 0xffff0000, v110
    v_lshlrev_b32 v102, 16, v111
    v_and_b32 v103, 0xffff0000, v111
    v_cvt_pk_bf16_f32 v72, v88, v89
    v_cvt_pk_bf16_f32 v73, v90, v91
    v_cvt_pk_bf16_f32 v74, v92, v93
    v_cvt_pk_bf16_f32 v75, v94, v95
    v_lshlrev_b32 v88, 16, v72
    v_and_b32 v89, 0xffff0000, v72
    v_lshlrev_b32 v90, 16, v73
    v_and_b32 v91, 0xffff0000, v73
    v_lshlrev_b32 v92, 16, v74
    v_and_b32 v93, 0xffff0000, v74
    v_lshlrev_b32 v94, 16, v75
    v_and_b32 v95, 0xffff0000, v75
    v_mul_f32 v48, v48, v88
    v_mul_f32 v49, v49, v89
    v_mul_f32 v50, v50, v90
    v_mul_f32 v51, v51, v91
    v_mul_f32 v52, v52, v92
    v_mul_f32 v53, v53, v93
    v_mul_f32 v54, v54, v94
    v_mul_f32 v55, v55, v95
    v_cvt_pk_bf16_f32 v72, v48, v49
    v_cvt_pk_bf16_f32 v73, v50, v51
    v_cvt_pk_bf16_f32 v74, v52, v53
    v_cvt_pk_bf16_f32 v75, v54, v55
    v_lshlrev_b32 v48, 16, v72
    v_and_b32 v49, 0xffff0000, v72
    v_lshlrev_b32 v50, 16, v73
    v_and_b32 v51, 0xffff0000, v73
    v_lshlrev_b32 v52, 16, v74
    v_and_b32 v53, 0xffff0000, v74
    v_lshlrev_b32 v54, 16, v75
    v_and_b32 v55, 0xffff0000, v75
    v_lshlrev_b32 v64, 16, v40
    v_and_b32 v65, 0xffff0000, v40
    v_lshlrev_b32 v66, 16, v41
    v_and_b32 v67, 0xffff0000, v41
    v_lshlrev_b32 v68, 16, v42
    v_and_b32 v69, 0xffff0000, v42
    v_lshlrev_b32 v70, 16, v43
    v_and_b32 v71, 0xffff0000, v43
    v_add_f32 v48, v48, v64
    v_add_f32 v49, v49, v65
    v_add_f32 v50, v50, v66
    v_add_f32 v51, v51, v67
    v_add_f32 v52, v52, v68
    v_add_f32 v53, v53, v69
    v_add_f32 v54, v54, v70
    v_add_f32 v55, v55, v71
    v_cvt_pk_bf16_f32 v72, v48, v49
    v_cvt_pk_bf16_f32 v73, v50, v51
    v_cvt_pk_bf16_f32 v74, v52, v53
    v_cvt_pk_bf16_f32 v75, v54, v55
    buffer_store_dwordx2 v[72:73], v13, s[44:47], s64 offen
    buffer_store_dwordx2 v[74:75], v13, s[44:47], s64 offen offset:16
    v_cvt_pk_bf16_f32 v76, v96, v97
    v_cvt_pk_bf16_f32 v77, v98, v99
    v_cvt_pk_bf16_f32 v78, v100, v101
    v_cvt_pk_bf16_f32 v79, v102, v103
    v_lshlrev_b32 v96, 16, v76
    v_and_b32 v97, 0xffff0000, v76
    v_lshlrev_b32 v98, 16, v77
    v_and_b32 v99, 0xffff0000, v77
    v_lshlrev_b32 v100, 16, v78
    v_and_b32 v101, 0xffff0000, v78
    v_lshlrev_b32 v102, 16, v79
    v_and_b32 v103, 0xffff0000, v79
    v_mul_f32 v56, v56, v96
    v_mul_f32 v57, v57, v97
    v_mul_f32 v58, v58, v98
    v_mul_f32 v59, v59, v99
    v_mul_f32 v60, v60, v100
    v_mul_f32 v61, v61, v101
    v_mul_f32 v62, v62, v102
    v_mul_f32 v63, v63, v103
    v_cvt_pk_bf16_f32 v76, v56, v57
    v_cvt_pk_bf16_f32 v77, v58, v59
    v_cvt_pk_bf16_f32 v78, v60, v61
    v_cvt_pk_bf16_f32 v79, v62, v63
    v_lshlrev_b32 v56, 16, v76
    v_and_b32 v57, 0xffff0000, v76
    v_lshlrev_b32 v58, 16, v77
    v_and_b32 v59, 0xffff0000, v77
    v_lshlrev_b32 v60, 16, v78
    v_and_b32 v61, 0xffff0000, v78
    v_lshlrev_b32 v62, 16, v79
    v_and_b32 v63, 0xffff0000, v79
    v_lshlrev_b32 v64, 16, v44
    v_and_b32 v65, 0xffff0000, v44
    v_lshlrev_b32 v66, 16, v45
    v_and_b32 v67, 0xffff0000, v45
    v_lshlrev_b32 v68, 16, v46
    v_and_b32 v69, 0xffff0000, v46
    v_lshlrev_b32 v70, 16, v47
    v_and_b32 v71, 0xffff0000, v47
    v_add_f32 v56, v56, v64
    v_add_f32 v57, v57, v65
    v_add_f32 v58, v58, v66
    v_add_f32 v59, v59, v67
    v_add_f32 v60, v60, v68
    v_add_f32 v61, v61, v69
    v_add_f32 v62, v62, v70
    v_add_f32 v63, v63, v71
    v_cvt_pk_bf16_f32 v76, v56, v57
    v_cvt_pk_bf16_f32 v77, v58, v59
    v_cvt_pk_bf16_f32 v78, v60, v61
    v_cvt_pk_bf16_f32 v79, v62, v63
    buffer_store_dwordx2 v[76:77], v13, s[44:47], s65 offen
    buffer_store_dwordx2 v[78:79], v13, s[44:47], s65 offen offset:16
L_m_fin:
    s_endpgm
L_sgp0:
    s_cmp_eq_u32 s71, 0
    s_cbranch_scc1 L_sgp0_b
    s_lshl_b32 s57, s98, 6
    s_add_u32 s57, s57, 65011712
    s_lshl_b32 s58, s55, 11
    s_add_u32 s57, s57, s58
    s_lshl_b32 s58, s56, 2
    s_add_u32 s57, s57, s58
    v_mov_b32 v14, 1
    v_mov_b32 v0, 0
    s_mov_b64 exec, 1
    buffer_store_dword v14, v0, s[36:39], s57 offen sc1
    s_mov_b64 exec, -1
    s_branch L_sgp0_b
L_sgp1:
    s_cmp_eq_u32 s71, 0
    s_cbranch_scc1 L_sgp1_b
    s_lshl_b32 s57, s98, 6
    s_add_u32 s57, s57, 65011776
    s_lshl_b32 s58, s55, 11
    s_add_u32 s57, s57, s58
    s_lshl_b32 s58, s56, 2
    s_add_u32 s57, s57, s58
    v_mov_b32 v14, 1
    v_mov_b32 v0, 0
    s_mov_b64 exec, 1
    buffer_store_dword v14, v0, s[36:39], s57 offen sc1
    s_mov_b64 exec, -1
    s_branch L_sgp1_b
L_sgp2:
    s_lshl_b32 s57, s98, 6
    s_add_u32 s57, s57, 65011840
    s_lshl_b32 s58, s55, 11
    s_add_u32 s57, s57, s58
    s_lshl_b32 s58, s56, 2
    s_add_u32 s57, s57, s58
    v_mov_b32 v14, 1
    v_mov_b32 v0, 0
    s_mov_b64 exec, 1
    buffer_store_dword v14, v0, s[36:39], s57 offen sc1
    s_mov_b64 exec, -1
    s_branch L_sgp2_b
L_sgpq:
    s_mov_b32 s57, 65011840
    s_lshl_b32 s58, s55, 11
    s_add_u32 s57, s57, s58
    s_lshl_b32 s58, s56, 2
    s_add_u32 s57, s57, s58
    v_mov_b32 v14, 1
    v_mov_b32 v0, 0
    s_mov_b64 exec, 1
    buffer_store_dword v14, v0, s[36:39], s57 offen sc1
    s_mov_b64 exec, -1
    s_branch L_sgpq_b
L_sgp3:
    s_mov_b32 s57, 65012288
    s_lshl_b32 s58, s55, 11
    s_add_u32 s57, s57, s58
    s_lshl_b32 s58, s56, 2
    s_add_u32 s57, s57, s58
    v_mov_b32 v14, 1
    v_mov_b32 v0, 0
    s_mov_b64 exec, 1
    buffer_store_dword v14, v0, s[36:39], s57 offen sc1
    s_mov_b64 exec, -1
    s_branch L_sgp3_b
L_sgp4:
    s_mov_b32 s57, 65012352
    s_lshl_b32 s58, s55, 11
    s_add_u32 s57, s57, s58
    s_lshl_b32 s58, s56, 2
    s_add_u32 s57, s57, s58
    v_mov_b32 v14, 1
    v_mov_b32 v0, 0
    s_mov_b64 exec, 1
    buffer_store_dword v14, v0, s[36:39], s57 offen sc1
    s_mov_b64 exec, -1
    s_branch L_sgp4_b
L_att:
    s_mov_b32 s56, s57
    s_mov_b32 s28, s6
    s_mov_b32 s29, s7
    s_mov_b32 s30, 1990656
    s_mov_b32 s31, 0x20000
    s_mov_b32 s32, s8
    s_mov_b32 s33, s9
    s_mov_b32 s34, 663552
    s_mov_b32 s35, 0x20000
    s_lshl_b32 s57, s56, 3
    s_add_u32 s57, s57, s52
    s_cmp_eq_u32 s57, 0
    s_cbranch_scc0 L_noinit
    v_mov_b32 v16, 0
    v_mov_b32 v17, 0
    v_mov_b32 v18, 0
    v_mov_b32 v19, 0
    s_lshl_b32 s57, s55, 11
    s_add_u32 s57, s57, 65011712
    buffer_store_dwordx4 v[16:19], v2, s[36:39], s57 offen sc1
    s_waitcnt vmcnt(0)
    s_nop 0
    v_mov_b32 v17, 1
    s_lshl_b32 s57, s55, 2
    s_mov_b64 exec, 1
    buffer_store_dword v17, v16, s[40:43], s57 offen offset:64 sc1
    s_mov_b64 exec, -1
L_noinit:
    v_lshrrev_b32 v11, 3, v1
    v_and_b32 v12, 7, v1
    v_lshrrev_b32 v13, 1, v11
    v_xor_b32 v12, v12, v13
    v_mul_u32_u24 v11, 1152, v11
    v_lshl_add_u32 v13, v12, 4, v11
    v_xor_b32 v12, 4, v12
    v_lshl_add_u32 v12, v12, 4, v11
    v_add_u32 v12, 8192, v12
    s_lshl_b32 s57, s55, 7
    s_lshl_b32 s58, s53, 5
    s_add_u32 s57, s57, s58
    s_lshl_b32 s58, s54, 4
    s_add_u32 s57, s57, s58
    s_mul_i32 s57, s57, 1152
    s_lshl_b32 s58, s53, 1
    s_add_u32 s59, s58, s54
    s_mul_i32 s69, s59, 18432
    s_add_u32 s69, s69, 16384
    s_xor_b32 s59, s59, 1
    s_mul_i32 s70, s59, 18432
    s_add_u32 s70, s70, 16384
    s_lshr_b32 s59, s2, 6
    s_lshl_b32 s59, s59, 8
    s_lshl_b32 s60, s59, 4
    s_add_u32 m0, s69, s60
    s_add_u32 s58, s57, s59
    buffer_load_dwordx4 v13, s[24:27], s58 offen lds
    buffer_load_dwordx4 v12, s[24:27], s58 offen offset:1024 lds
    s_add_u32 s59, s59, 128
    s_cmp_eq_u32 s59, 1152
    s_cselect_b32 s59, 0, s59
    s_lshl_b32 s60, s59, 4
    s_add_u32 m0, s69, s60
    s_add_u32 s58, s57, s59
    buffer_load_dwordx4 v13, s[24:27], s58 offen lds
    buffer_load_dwordx4 v12, s[24:27], s58 offen offset:1024 lds
    s_add_u32 s59, s59, 128
    s_cmp_eq_u32 s59, 1152
    s_cselect_b32 s59, 0, s59
    s_lshl_b32 s60, s59, 4
    s_add_u32 m0, s69, s60
    s_add_u32 s58, s57, s59
    buffer_load_dwordx4 v13, s[24:27], s58 offen lds
    buffer_load_dwordx4 v12, s[24:27], s58 offen offset:1024 lds
    s_add_u32 s59, s59, 128
    s_cmp_eq_u32 s59, 1152
    s_cselect_b32 s59, 0, s59
    s_lshl_b32 s60, s59, 4
    s_add_u32 m0, s69, s60
    s_add_u32 s58, s57, s59
    buffer_load_dwordx4 v13, s[24:27], s58 offen lds
    buffer_load_dwordx4 v12, s[24:27], s58 offen offset:1024 lds
    s_add_u32 s59, s59, 128
    s_cmp_eq_u32 s59, 1152
    s_cselect_b32 s59, 0, s59
    s_lshl_b32 s60, s59, 4
    s_add_u32 m0, s69, s60
    s_add_u32 s58, s57, s59
    buffer_load_dwordx4 v13, s[24:27], s58 offen lds
    buffer_load_dwordx4 v12, s[24:27], s58 offen offset:1024 lds
    s_add_u32 s59, s59, 128
    s_cmp_eq_u32 s59, 1152
    s_cselect_b32 s59, 0, s59
    s_lshl_b32 s60, s59, 4
    s_add_u32 m0, s69, s60
    s_add_u32 s58, s57, s59
    buffer_load_dwordx4 v13, s[24:27], s58 offen lds
    buffer_load_dwordx4 v12, s[24:27], s58 offen offset:1024 lds
    s_add_u32 s59, s59, 128
    s_cmp_eq_u32 s59, 1152
    s_cselect_b32 s59, 0, s59
    s_lshl_b32 s60, s59, 4
    s_add_u32 m0, s69, s60
    s_add_u32 s58, s57, s59
    buffer_load_dwordx4 v13, s[24:27], s58 offen lds
    buffer_load_dwordx4 v12, s[24:27], s58 offen offset:1024 lds
    s_add_u32 s59, s59, 128
    s_cmp_eq_u32 s59, 1152
    s_cselect_b32 s59, 0, s59
    s_lshl_b32 s60, s59, 4
    s_add_u32 m0, s69, s60
    s_add_u32 s58, s57, s59
    buffer_load_dwordx4 v13, s[24:27], s58 offen lds
    buffer_load_dwordx4 v12, s[24:27], s58 offen offset:1024 lds
    s_add_u32 s59, s59, 128
    s_cmp_eq_u32 s59, 1152
    s_cselect_b32 s59, 0, s59
    s_lshl_b32 s60, s59, 4
    s_add_u32 m0, s69, s60
    s_add_u32 s58, s57, s59
    buffer_load_dwordx4 v13, s[24:27], s58 offen lds
    buffer_load_dwordx4 v12, s[24:27], s58 offen offset:1024 lds
    s_lshl_b32 s57, s52, 6
    v_add_u32 v82, s57, v1
    v_lshrrev_b32 v83, 3, v82
    v_and_b32 v84, 7, v82
    v_min_u32 v84, 5, v84
    v_lshlrev_b32 v84, 6, v84
    v_min_u32 v84, 284, v84
    v_cmp_gt_u32 vcc, 36, v83
    v_mul_u32_u24 v85, 3456, v83
    v_add_u32 v85, v85, v84
    v_cndmask_b32 v85, -1, v85, vcc
    v_mul_u32_u24 v83, 1152, v83
    v_add_u32 v83, v83, v84
    v_cndmask_b32 v83, -1, v83, vcc
    v_mov_b32 v252, v85
    v_mov_b32 v253, v83
    s_mul_i32 s57, s55, 124416
    s_mul_i32 s58, s56, 288
    s_add_u32 s57, s57, s58
    s_add_u32 s59, s57, 1152
    buffer_load_dword v0, v252, s[28:31], s59 offen
    s_add_u32 s59, s57, 2304
    buffer_load_dword v0, v252, s[28:31], s59 offen
    s_add_u32 s59, s57, 0
    buffer_load_dword v0, v252, s[28:31], s59 offen
    s_mul_i32 s57, s55, 41472
    s_add_u32 s57, s57, s58
    buffer_load_dword v0, v253, s[32:35], s57 offen
    v_add_u32 v82, 0, v1
    v_mul_u32_u24 v83, 3641, v82
    v_lshrrev_b32 v83, 16, v83
    v_mul_u32_u24 v84, 18, v83
    v_sub_u32 v84, v82, v84
    v_mul_u32_u24 v85, 3456, v83
    v_lshl_add_u32 v3, v84, 4, v85
    v_add_u32 v82, 64, v1
    v_mul_u32_u24 v83, 3641, v82
    v_lshrrev_b32 v83, 16, v83
    v_mul_u32_u24 v84, 18, v83
    v_sub_u32 v84, v82, v84
    v_mul_u32_u24 v85, 3456, v83
    v_lshl_add_u32 v4, v84, 4, v85
    v_add_u32 v82, 128, v1
    v_mul_u32_u24 v83, 3641, v82
    v_lshrrev_b32 v83, 16, v83
    v_mul_u32_u24 v84, 18, v83
    v_sub_u32 v84, v82, v84
    v_mul_u32_u24 v85, 3456, v83
    v_lshl_add_u32 v76, v84, 4, v85
    s_mul_i32 s61, s52, 2304
    s_mul_i32 s62, s52, 27648
    s_mul_i32 s58, s56, 288
    s_add_u32 s62, s62, s58
    s_mul_i32 s57, s54, 36
    s_lshl_b32 s59, s53, 3
    s_add_u32 s57, s57, s59
    s_lshr_b32 s59, s53, 1
    s_lshl_b32 s60, s59, 2
    s_add_u32 s57, s57, s60
    s_mul_i32 s63, s57, 1152
    s_add_u32 s63, s63, s58
    s_lshl_b32 s57, s54, 1
    s_add_u32 s57, s57, s59
    s_mul_i32 s57, s57, 144
    s_and_b32 s59, s53, 1
    s_mul_i32 s59, s59, 72
    s_add_u32 s57, s57, s59
    s_add_u32 s57, s57, 16
    s_mul_i32 s68, s57, 1152
    s_add_u32 s68, s68, s58
    v_lshrrev_b32 v82, 2, v1
    v_mul_u32_u24 v82, 288, v82
    v_and_b32 v83, 3, v1
    v_lshl_add_u32 v84, v83, 3, v82
    s_mul_i32 s57, s54, 144
    v_add_u32 v5, s57, v84
    v_mul_u32_u24 v83, 72, v83
    v_add3_u32 v8, v82, v83, 32
    v_add_u32 v6, 49152, v5
    v_add_u32 v9, 49152, v8
    v_add_u32 v7, 98304, v5
    v_add_u32 v10, 98304, v8
    v_lshlrev_b32 v80, 3, v1
    v_mov_b32 v81, 0x3f803f80
    s_lshl_b32 s57, s55, 3
    s_lshl_b32 s58, s53, 1
    s_add_u32 s57, s57, s58
    s_add_u32 s57, s57, s54
    s_mov_b32 s64, s57
    s_xor_b32 s65, s57, 1
    s_lshl_b32 s66, s56, 3
    s_lshl_b32 s58, s54, 2
    s_add_u32 s66, s66, s58
    s_lshl_b32 s66, s66, 16
    s_lshl_b32 s67, s55, 2
    s_add_u32 s67, s67, s53
    s_lshl_b32 s67, s67, 10
    v_and_b32 v40, 15, v1
    v_lshrrev_b32 v41, 4, v1
    v_and_b32 v42, 1, v41
    v_lshlrev_b32 v42, 3, v42
    v_lshl_add_u32 v42, v40, 7, v42
    v_add_u32 v42, s69, v42
    v_lshrrev_b32 v43, 1, v40
    v_lshrrev_b32 v44, 1, v41
    v_xor_b32 v43, v43, v44
    v_xor_b32 v44, 0, v43
    v_lshl_add_u32 v48, v44, 4, v42
    v_xor_b32 v44, 2, v43
    v_lshl_add_u32 v49, v44, 4, v42
    v_xor_b32 v44, 4, v43
    v_lshl_add_u32 v50, v44, 4, v42
    v_xor_b32 v44, 6, v43
    v_lshl_add_u32 v51, v44, 4, v42
    v_mov_b32 v52, 0x3f803f80
    v_mov_b32 v53, 0x3f803f80
    v_mov_b32 v54, 0x3f803f80
    v_mov_b32 v55, 0x3f803f80
    s_waitcnt vmcnt(4)
    ds_read_b64 v[104:105], v48 offset:0
    ds_read_b64 v[106:107], v49 offset:0
    ds_read_b64 v[108:109], v50 offset:0
    ds_read_b64 v[110:111], v51 offset:0
    ds_read_b64 v[112:113], v48 offset:2048
    ds_read_b64 v[114:115], v49 offset:2048
    ds_read_b64 v[116:117], v50 offset:2048
    ds_read_b64 v[118:119], v51 offset:2048
    ds_read_b64 v[120:121], v48 offset:4096
    ds_read_b64 v[122:123], v49 offset:4096
    s_waitcnt lgkmcnt(8)
    v_mfma_f32_16x16x32_bf16 v[56:59], v[52:55], v[104:107], 0
    v_mfma_f32_16x16x32_bf16 v[60:63], v[104:107], v[104:107], 0
    ds_read_b64 v[124:125], v50 offset:4096
    ds_read_b64 v[126:127], v51 offset:4096
    s_waitcnt lgkmcnt(8)
    v_mfma_f32_16x16x32_bf16 v[56:59], v[52:55], v[108:111], v[56:59]
    v_mfma_f32_16x16x32_bf16 v[60:63], v[108:111], v[108:111], v[60:63]
    ds_read_b64 v[128:129], v48 offset:6144
    ds_read_b64 v[130:131], v49 offset:6144
    s_waitcnt lgkmcnt(8)
    v_mfma_f32_16x16x32_bf16 v[56:59], v[52:55], v[112:115], v[56:59]
    v_mfma_f32_16x16x32_bf16 v[60:63], v[112:115], v[112:115], v[60:63]
    ds_read_b64 v[132:133], v50 offset:6144
    ds_read_b64 v[134:135], v51 offset:6144
    s_waitcnt lgkmcnt(8)
    v_mfma_f32_16x16x32_bf16 v[56:59], v[52:55], v[116:119], v[56:59]
    v_mfma_f32_16x16x32_bf16 v[60:63], v[116:119], v[116:119], v[60:63]
    ds_read_b64 v[136:137], v48 offset:8192
    ds_read_b64 v[138:139], v49 offset:8192
    s_waitcnt lgkmcnt(8)
    v_mfma_f32_16x16x32_bf16 v[56:59], v[52:55], v[120:123], v[56:59]
    v_mfma_f32_16x16x32_bf16 v[60:63], v[120:123], v[120:123], v[60:63]
    ds_read_b64 v[140:141], v50 offset:8192
    ds_read_b64 v[142:143], v51 offset:8192
    s_waitcnt lgkmcnt(8)
    v_mfma_f32_16x16x32_bf16 v[56:59], v[52:55], v[124:127], v[56:59]
    v_mfma_f32_16x16x32_bf16 v[60:63], v[124:127], v[124:127], v[60:63]
    ds_read_b64 v[144:145], v48 offset:10240
    ds_read_b64 v[146:147], v49 offset:10240
    s_waitcnt lgkmcnt(8)
    v_mfma_f32_16x16x32_bf16 v[56:59], v[52:55], v[128:131], v[56:59]
    v_mfma_f32_16x16x32_bf16 v[60:63], v[128:131], v[128:131], v[60:63]
    ds_read_b64 v[148:149], v50 offset:10240
    ds_read_b64 v[150:151], v51 offset:10240
    s_waitcnt lgkmcnt(8)
    v_mfma_f32_16x16x32_bf16 v[56:59], v[52:55], v[132:135], v[56:59]
    v_mfma_f32_16x16x32_bf16 v[60:63], v[132:135], v[132:135], v[60:63]
    ds_read_b64 v[152:153], v48 offset:12288
    ds_read_b64 v[154:155], v49 offset:12288
    s_waitcnt lgkmcnt(8)
    v_mfma_f32_16x16x32_bf16 v[56:59], v[52:55], v[136:139], v[56:59]
    v_mfma_f32_16x16x32_bf16 v[60:63], v[136:139], v[136:139], v[60:63]
    ds_read_b64 v[156:157], v50 offset:12288
    ds_read_b64 v[158:159], v51 offset:12288
    s_waitcnt lgkmcnt(8)
    v_mfma_f32_16x16x32_bf16 v[56:59], v[52:55], v[140:143], v[56:59]
    v_mfma_f32_16x16x32_bf16 v[60:63], v[140:143], v[140:143], v[60:63]
    ds_read_b64 v[160:161], v48 offset:14336
    ds_read_b64 v[162:163], v49 offset:14336
    s_waitcnt lgkmcnt(8)
    v_mfma_f32_16x16x32_bf16 v[56:59], v[52:55], v[144:147], v[56:59]
    v_mfma_f32_16x16x32_bf16 v[60:63], v[144:147], v[144:147], v[60:63]
    ds_read_b64 v[164:165], v50 offset:14336
    ds_read_b64 v[166:167], v51 offset:14336
    s_waitcnt lgkmcnt(8)
    v_mfma_f32_16x16x32_bf16 v[56:59], v[52:55], v[148:151], v[56:59]
    v_mfma_f32_16x16x32_bf16 v[60:63], v[148:151], v[148:151], v[60:63]
    ds_read_b64 v[168:169], v48 offset:16384
    ds_read_b64 v[170:171], v49 offset:16384
    s_waitcnt lgkmcnt(8)
    v_mfma_f32_16x16x32_bf16 v[56:59], v[52:55], v[152:155], v[56:59]
    v_mfma_f32_16x16x32_bf16 v[60:63], v[152:155], v[152:155], v[60:63]
    ds_read_b64 v[172:173], v50 offset:16384
    ds_read_b64 v[174:175], v51 offset:16384
    s_waitcnt lgkmcnt(8)
    v_mfma_f32_16x16x32_bf16 v[56:59], v[52:55], v[156:159], v[56:59]
    v_mfma_f32_16x16x32_bf16 v[60:63], v[156:159], v[156:159], v[60:63]
    s_waitcnt lgkmcnt(6)
    v_mfma_f32_16x16x32_bf16 v[56:59], v[52:55], v[160:163], v[56:59]
    v_mfma_f32_16x16x32_bf16 v[60:63], v[160:163], v[160:163], v[60:63]
    s_waitcnt lgkmcnt(4)
    v_mfma_f32_16x16x32_bf16 v[56:59], v[52:55], v[164:167], v[56:59]
    v_mfma_f32_16x16x32_bf16 v[60:63], v[164:167], v[164:167], v[60:63]
    s_waitcnt lgkmcnt(2)
    v_mfma_f32_16x16x32_bf16 v[56:59], v[52:55], v[168:171], v[56:59]
    v_mfma_f32_16x16x32_bf16 v[60:63], v[168:171], v[168:171], v[60:63]
    s_waitcnt lgkmcnt(0)
    v_mfma_f32_16x16x32_bf16 v[56:59], v[52:55], v[172:175], v[56:59]
    v_mfma_f32_16x16x32_bf16 v[60:63], v[172:175], v[172:175], v[60:63]
    v_and_b32 v44, 3, v40
    v_cmp_eq_u32 vcc, 1, v44
    s_nop 5
    v_cndmask_b32 v60, v60, v61, vcc
    v_cmp_eq_u32 vcc, 2, v44
    s_nop 1
    v_cndmask_b32 v60, v60, v62, vcc
    v_cmp_eq_u32 vcc, 3, v44
    s_nop 1
    v_cndmask_b32 v60, v60, v63, vcc
    v_lshrrev_b32 v44, 2, v40
    v_lshl_add_u32 v44, v44, 4, v40
    v_lshlrev_b32 v44, 2, v44
    ds_bpermute_b32 v60, v44, v60
    v_mul_f32 v56, 0x3ae38e39, v56
    s_waitcnt lgkmcnt(0)
    v_mul_f32 v60, 0x3ae38e39, v60
    v_fma_f32 v60, -v56, v56, v60
    v_max_f32 v60, 0, v60
    v_cvt_pk_bf16_f32 v60, v60, v60
    v_lshlrev_b32 v60, 16, v60
    v_add_f32 v60, 0x3727c5ac, v60
    v_cvt_pk_bf16_f32 v60, v60, v60
    v_lshlrev_b32 v60, 16, v60
    v_sqrt_f32 v60, v60
    s_nop 0
    v_cvt_pk_bf16_f32 v60, v60, v60
    v_lshlrev_b32 v60, 16, v60
    v_rcp_f32 v60, v60
    v_cvt_pk_bf16_f32 v56, v56, v56
    v_lshlrev_b32 v56, 16, v56
    v_mul_f32 v56, v56, v60
    v_sub_f32 v56, 0, v56
    v_add_u32 v45, s69, v2
    v_lshlrev_b32 v64, 16, v104
    v_and_b32 v65, 0xffff0000, v104
    v_lshlrev_b32 v66, 16, v105
    v_and_b32 v67, 0xffff0000, v105
    v_lshlrev_b32 v68, 16, v106
    v_and_b32 v69, 0xffff0000, v106
    v_lshlrev_b32 v70, 16, v107
    v_and_b32 v71, 0xffff0000, v107
    v_fma_f32 v64, v64, v60, v56
    v_fma_f32 v65, v65, v60, v56
    v_fma_f32 v66, v66, v60, v56
    v_fma_f32 v67, v67, v60, v56
    v_fma_f32 v68, v68, v60, v56
    v_fma_f32 v69, v69, v60, v56
    v_fma_f32 v70, v70, v60, v56
    v_fma_f32 v71, v71, v60, v56
    v_cvt_pk_bf16_f32 v104, v64, v65
    v_cvt_pk_bf16_f32 v105, v66, v67
    v_cvt_pk_bf16_f32 v106, v68, v69
    v_cvt_pk_bf16_f32 v107, v70, v71
    ds_write_b128 v45, v[104:107] offset:0
    v_lshlrev_b32 v64, 16, v108
    v_and_b32 v65, 0xffff0000, v108
    v_lshlrev_b32 v66, 16, v109
    v_and_b32 v67, 0xffff0000, v109
    v_lshlrev_b32 v68, 16, v110
    v_and_b32 v69, 0xffff0000, v110
    v_lshlrev_b32 v70, 16, v111
    v_and_b32 v71, 0xffff0000, v111
    v_fma_f32 v64, v64, v60, v56
    v_fma_f32 v65, v65, v60, v56
    v_fma_f32 v66, v66, v60, v56
    v_fma_f32 v67, v67, v60, v56
    v_fma_f32 v68, v68, v60, v56
    v_fma_f32 v69, v69, v60, v56
    v_fma_f32 v70, v70, v60, v56
    v_fma_f32 v71, v71, v60, v56
    v_cvt_pk_bf16_f32 v108, v64, v65
    v_cvt_pk_bf16_f32 v109, v66, v67
    v_cvt_pk_bf16_f32 v110, v68, v69
    v_cvt_pk_bf16_f32 v111, v70, v71
    ds_write_b128 v45, v[108:111] offset:1024
    v_lshlrev_b32 v64, 16, v112
    v_and_b32 v65, 0xffff0000, v112
    v_lshlrev_b32 v66, 16, v113
    v_and_b32 v67, 0xffff0000, v113
    v_lshlrev_b32 v68, 16, v114
    v_and_b32 v69, 0xffff0000, v114
    v_lshlrev_b32 v70, 16, v115
    v_and_b32 v71, 0xffff0000, v115
    v_fma_f32 v64, v64, v60, v56
    v_fma_f32 v65, v65, v60, v56
    v_fma_f32 v66, v66, v60, v56
    v_fma_f32 v67, v67, v60, v56
    v_fma_f32 v68, v68, v60, v56
    v_fma_f32 v69, v69, v60, v56
    v_fma_f32 v70, v70, v60, v56
    v_fma_f32 v71, v71, v60, v56
    v_cvt_pk_bf16_f32 v112, v64, v65
    v_cvt_pk_bf16_f32 v113, v66, v67
    v_cvt_pk_bf16_f32 v114, v68, v69
    v_cvt_pk_bf16_f32 v115, v70, v71
    ds_write_b128 v45, v[112:115] offset:2048
    v_lshlrev_b32 v64, 16, v116
    v_and_b32 v65, 0xffff0000, v116
    v_lshlrev_b32 v66, 16, v117
    v_and_b32 v67, 0xffff0000, v117
    v_lshlrev_b32 v68, 16, v118
    v_and_b32 v69, 0xffff0000, v118
    v_lshlrev_b32 v70, 16, v119
    v_and_b32 v71, 0xffff0000, v119
    v_fma_f32 v64, v64, v60, v56
    v_fma_f32 v65, v65, v60, v56
    v_fma_f32 v66, v66, v60, v56
    v_fma_f32 v67, v67, v60, v56
    v_fma_f32 v68, v68, v60, v56
    v_fma_f32 v69, v69, v60, v56
    v_fma_f32 v70, v70, v60, v56
    v_fma_f32 v71, v71, v60, v56
    v_cvt_pk_bf16_f32 v116, v64, v65
    v_cvt_pk_bf16_f32 v117, v66, v67
    v_cvt_pk_bf16_f32 v118, v68, v69
    v_cvt_pk_bf16_f32 v119, v70, v71
    ds_write_b128 v45, v[116:119] offset:3072
    v_lshlrev_b32 v64, 16, v120
    v_and_b32 v65, 0xffff0000, v120
    v_lshlrev_b32 v66, 16, v121
    v_and_b32 v67, 0xffff0000, v121
    v_lshlrev_b32 v68, 16, v122
    v_and_b32 v69, 0xffff0000, v122
    v_lshlrev_b32 v70, 16, v123
    v_and_b32 v71, 0xffff0000, v123
    v_fma_f32 v64, v64, v60, v56
    v_fma_f32 v65, v65, v60, v56
    v_fma_f32 v66, v66, v60, v56
    v_fma_f32 v67, v67, v60, v56
    v_fma_f32 v68, v68, v60, v56
    v_fma_f32 v69, v69, v60, v56
    v_fma_f32 v70, v70, v60, v56
    v_fma_f32 v71, v71, v60, v56
    v_cvt_pk_bf16_f32 v120, v64, v65
    v_cvt_pk_bf16_f32 v121, v66, v67
    v_cvt_pk_bf16_f32 v122, v68, v69
    v_cvt_pk_bf16_f32 v123, v70, v71
    ds_write_b128 v45, v[120:123] offset:4096
    v_lshlrev_b32 v64, 16, v124
    v_and_b32 v65, 0xffff0000, v124
    v_lshlrev_b32 v66, 16, v125
    v_and_b32 v67, 0xffff0000, v125
    v_lshlrev_b32 v68, 16, v126
    v_and_b32 v69, 0xffff0000, v126
    v_lshlrev_b32 v70, 16, v127
    v_and_b32 v71, 0xffff0000, v127
    v_fma_f32 v64, v64, v60, v56
    v_fma_f32 v65, v65, v60, v56
    v_fma_f32 v66, v66, v60, v56
    v_fma_f32 v67, v67, v60, v56
    v_fma_f32 v68, v68, v60, v56
    v_fma_f32 v69, v69, v60, v56
    v_fma_f32 v70, v70, v60, v56
    v_fma_f32 v71, v71, v60, v56
    v_cvt_pk_bf16_f32 v124, v64, v65
    v_cvt_pk_bf16_f32 v125, v66, v67
    v_cvt_pk_bf16_f32 v126, v68, v69
    v_cvt_pk_bf16_f32 v127, v70, v71
    ds_write_b128 v45, v[124:127] offset:5120
    v_lshlrev_b32 v64, 16, v128
    v_and_b32 v65, 0xffff0000, v128
    v_lshlrev_b32 v66, 16, v129
    v_and_b32 v67, 0xffff0000, v129
    v_lshlrev_b32 v68, 16, v130
    v_and_b32 v69, 0xffff0000, v130
    v_lshlrev_b32 v70, 16, v131
    v_and_b32 v71, 0xffff0000, v131
    v_fma_f32 v64, v64, v60, v56
    v_fma_f32 v65, v65, v60, v56
    v_fma_f32 v66, v66, v60, v56
    v_fma_f32 v67, v67, v60, v56
    v_fma_f32 v68, v68, v60, v56
    v_fma_f32 v69, v69, v60, v56
    v_fma_f32 v70, v70, v60, v56
    v_fma_f32 v71, v71, v60, v56
    v_cvt_pk_bf16_f32 v128, v64, v65
    v_cvt_pk_bf16_f32 v129, v66, v67
    v_cvt_pk_bf16_f32 v130, v68, v69
    v_cvt_pk_bf16_f32 v131, v70, v71
    ds_write_b128 v45, v[128:131] offset:6144
    v_lshlrev_b32 v64, 16, v132
    v_and_b32 v65, 0xffff0000, v132
    v_lshlrev_b32 v66, 16, v133
    v_and_b32 v67, 0xffff0000, v133
    v_lshlrev_b32 v68, 16, v134
    v_and_b32 v69, 0xffff0000, v134
    v_lshlrev_b32 v70, 16, v135
    v_and_b32 v71, 0xffff0000, v135
    v_fma_f32 v64, v64, v60, v56
    v_fma_f32 v65, v65, v60, v56
    v_fma_f32 v66, v66, v60, v56
    v_fma_f32 v67, v67, v60, v56
    v_fma_f32 v68, v68, v60, v56
    v_fma_f32 v69, v69, v60, v56
    v_fma_f32 v70, v70, v60, v56
    v_fma_f32 v71, v71, v60, v56
    v_cvt_pk_bf16_f32 v132, v64, v65
    v_cvt_pk_bf16_f32 v133, v66, v67
    v_cvt_pk_bf16_f32 v134, v68, v69
    v_cvt_pk_bf16_f32 v135, v70, v71
    ds_write_b128 v45, v[132:135] offset:7168
    v_lshlrev_b32 v64, 16, v136
    v_and_b32 v65, 0xffff0000, v136
    v_lshlrev_b32 v66, 16, v137
    v_and_b32 v67, 0xffff0000, v137
    v_lshlrev_b32 v68, 16, v138
    v_and_b32 v69, 0xffff0000, v138
    v_lshlrev_b32 v70, 16, v139
    v_and_b32 v71, 0xffff0000, v139
    v_fma_f32 v64, v64, v60, v56
    v_fma_f32 v65, v65, v60, v56
    v_fma_f32 v66, v66, v60, v56
    v_fma_f32 v67, v67, v60, v56
    v_fma_f32 v68, v68, v60, v56
    v_fma_f32 v69, v69, v60, v56
    v_fma_f32 v70, v70, v60, v56
    v_fma_f32 v71, v71, v60, v56
    v_cvt_pk_bf16_f32 v136, v64, v65
    v_cvt_pk_bf16_f32 v137, v66, v67
    v_cvt_pk_bf16_f32 v138, v68, v69
    v_cvt_pk_bf16_f32 v139, v70, v71
    ds_write_b128 v45, v[136:139] offset:8192
    v_lshlrev_b32 v64, 16, v140
    v_and_b32 v65, 0xffff0000, v140
    v_lshlrev_b32 v66, 16, v141
    v_and_b32 v67, 0xffff0000, v141
    v_lshlrev_b32 v68, 16, v142
    v_and_b32 v69, 0xffff0000, v142
    v_lshlrev_b32 v70, 16, v143
    v_and_b32 v71, 0xffff0000, v143
    v_fma_f32 v64, v64, v60, v56
    v_fma_f32 v65, v65, v60, v56
    v_fma_f32 v66, v66, v60, v56
    v_fma_f32 v67, v67, v60, v56
    v_fma_f32 v68, v68, v60, v56
    v_fma_f32 v69, v69, v60, v56
    v_fma_f32 v70, v70, v60, v56
    v_fma_f32 v71, v71, v60, v56
    v_cvt_pk_bf16_f32 v140, v64, v65
    v_cvt_pk_bf16_f32 v141, v66, v67
    v_cvt_pk_bf16_f32 v142, v68, v69
    v_cvt_pk_bf16_f32 v143, v70, v71
    ds_write_b128 v45, v[140:143] offset:9216
    v_lshlrev_b32 v64, 16, v144
    v_and_b32 v65, 0xffff0000, v144
    v_lshlrev_b32 v66, 16, v145
    v_and_b32 v67, 0xffff0000, v145
    v_lshlrev_b32 v68, 16, v146
    v_and_b32 v69, 0xffff0000, v146
    v_lshlrev_b32 v70, 16, v147
    v_and_b32 v71, 0xffff0000, v147
    v_fma_f32 v64, v64, v60, v56
    v_fma_f32 v65, v65, v60, v56
    v_fma_f32 v66, v66, v60, v56
    v_fma_f32 v67, v67, v60, v56
    v_fma_f32 v68, v68, v60, v56
    v_fma_f32 v69, v69, v60, v56
    v_fma_f32 v70, v70, v60, v56
    v_fma_f32 v71, v71, v60, v56
    v_cvt_pk_bf16_f32 v144, v64, v65
    v_cvt_pk_bf16_f32 v145, v66, v67
    v_cvt_pk_bf16_f32 v146, v68, v69
    v_cvt_pk_bf16_f32 v147, v70, v71
    ds_write_b128 v45, v[144:147] offset:10240
    v_lshlrev_b32 v64, 16, v148
    v_and_b32 v65, 0xffff0000, v148
    v_lshlrev_b32 v66, 16, v149
    v_and_b32 v67, 0xffff0000, v149
    v_lshlrev_b32 v68, 16, v150
    v_and_b32 v69, 0xffff0000, v150
    v_lshlrev_b32 v70, 16, v151
    v_and_b32 v71, 0xffff0000, v151
    v_fma_f32 v64, v64, v60, v56
    v_fma_f32 v65, v65, v60, v56
    v_fma_f32 v66, v66, v60, v56
    v_fma_f32 v67, v67, v60, v56
    v_fma_f32 v68, v68, v60, v56
    v_fma_f32 v69, v69, v60, v56
    v_fma_f32 v70, v70, v60, v56
    v_fma_f32 v71, v71, v60, v56
    v_cvt_pk_bf16_f32 v148, v64, v65
    v_cvt_pk_bf16_f32 v149, v66, v67
    v_cvt_pk_bf16_f32 v150, v68, v69
    v_cvt_pk_bf16_f32 v151, v70, v71
    ds_write_b128 v45, v[148:151] offset:11264
    v_lshlrev_b32 v64, 16, v152
    v_and_b32 v65, 0xffff0000, v152
    v_lshlrev_b32 v66, 16, v153
    v_and_b32 v67, 0xffff0000, v153
    v_lshlrev_b32 v68, 16, v154
    v_and_b32 v69, 0xffff0000, v154
    v_lshlrev_b32 v70, 16, v155
    v_and_b32 v71, 0xffff0000, v155
    v_fma_f32 v64, v64, v60, v56
    v_fma_f32 v65, v65, v60, v56
    v_fma_f32 v66, v66, v60, v56
    v_fma_f32 v67, v67, v60, v56
    v_fma_f32 v68, v68, v60, v56
    v_fma_f32 v69, v69, v60, v56
    v_fma_f32 v70, v70, v60, v56
    v_fma_f32 v71, v71, v60, v56
    v_cvt_pk_bf16_f32 v152, v64, v65
    v_cvt_pk_bf16_f32 v153, v66, v67
    v_cvt_pk_bf16_f32 v154, v68, v69
    v_cvt_pk_bf16_f32 v155, v70, v71
    ds_write_b128 v45, v[152:155] offset:12288
    v_lshlrev_b32 v64, 16, v156
    v_and_b32 v65, 0xffff0000, v156
    v_lshlrev_b32 v66, 16, v157
    v_and_b32 v67, 0xffff0000, v157
    v_lshlrev_b32 v68, 16, v158
    v_and_b32 v69, 0xffff0000, v158
    v_lshlrev_b32 v70, 16, v159
    v_and_b32 v71, 0xffff0000, v159
    v_fma_f32 v64, v64, v60, v56
    v_fma_f32 v65, v65, v60, v56
    v_fma_f32 v66, v66, v60, v56
    v_fma_f32 v67, v67, v60, v56
    v_fma_f32 v68, v68, v60, v56
    v_fma_f32 v69, v69, v60, v56
    v_fma_f32 v70, v70, v60, v56
    v_fma_f32 v71, v71, v60, v56
    v_cvt_pk_bf16_f32 v156, v64, v65
    v_cvt_pk_bf16_f32 v157, v66, v67
    v_cvt_pk_bf16_f32 v158, v68, v69
    v_cvt_pk_bf16_f32 v159, v70, v71
    ds_write_b128 v45, v[156:159] offset:13312
    v_lshlrev_b32 v64, 16, v160
    v_and_b32 v65, 0xffff0000, v160
    v_lshlrev_b32 v66, 16, v161
    v_and_b32 v67, 0xffff0000, v161
    v_lshlrev_b32 v68, 16, v162
    v_and_b32 v69, 0xffff0000, v162
    v_lshlrev_b32 v70, 16, v163
    v_and_b32 v71, 0xffff0000, v163
    v_fma_f32 v64, v64, v60, v56
    v_fma_f32 v65, v65, v60, v56
    v_fma_f32 v66, v66, v60, v56
    v_fma_f32 v67, v67, v60, v56
    v_fma_f32 v68, v68, v60, v56
    v_fma_f32 v69, v69, v60, v56
    v_fma_f32 v70, v70, v60, v56
    v_fma_f32 v71, v71, v60, v56
    v_cvt_pk_bf16_f32 v160, v64, v65
    v_cvt_pk_bf16_f32 v161, v66, v67
    v_cvt_pk_bf16_f32 v162, v68, v69
    v_cvt_pk_bf16_f32 v163, v70, v71
    ds_write_b128 v45, v[160:163] offset:14336
    v_lshlrev_b32 v64, 16, v164
    v_and_b32 v65, 0xffff0000, v164
    v_lshlrev_b32 v66, 16, v165
    v_and_b32 v67, 0xffff0000, v165
    v_lshlrev_b32 v68, 16, v166
    v_and_b32 v69, 0xffff0000, v166
    v_lshlrev_b32 v70, 16, v167
    v_and_b32 v71, 0xffff0000, v167
    v_fma_f32 v64, v64, v60, v56
    v_fma_f32 v65, v65, v60, v56
    v_fma_f32 v66, v66, v60, v56
    v_fma_f32 v67, v67, v60, v56
    v_fma_f32 v68, v68, v60, v56
    v_fma_f32 v69, v69, v60, v56
    v_fma_f32 v70, v70, v60, v56
    v_fma_f32 v71, v71, v60, v56
    v_cvt_pk_bf16_f32 v164, v64, v65
    v_cvt_pk_bf16_f32 v165, v66, v67
    v_cvt_pk_bf16_f32 v166, v68, v69
    v_cvt_pk_bf16_f32 v167, v70, v71
    ds_write_b128 v45, v[164:167] offset:15360
    v_lshlrev_b32 v64, 16, v168
    v_and_b32 v65, 0xffff0000, v168
    v_lshlrev_b32 v66, 16, v169
    v_and_b32 v67, 0xffff0000, v169
    v_lshlrev_b32 v68, 16, v170
    v_and_b32 v69, 0xffff0000, v170
    v_lshlrev_b32 v70, 16, v171
    v_and_b32 v71, 0xffff0000, v171
    v_fma_f32 v64, v64, v60, v56
    v_fma_f32 v65, v65, v60, v56
    v_fma_f32 v66, v66, v60, v56
    v_fma_f32 v67, v67, v60, v56
    v_fma_f32 v68, v68, v60, v56
    v_fma_f32 v69, v69, v60, v56
    v_fma_f32 v70, v70, v60, v56
    v_fma_f32 v71, v71, v60, v56
    v_cvt_pk_bf16_f32 v168, v64, v65
    v_cvt_pk_bf16_f32 v169, v66, v67
    v_cvt_pk_bf16_f32 v170, v68, v69
    v_cvt_pk_bf16_f32 v171, v70, v71
    ds_write_b128 v45, v[168:171] offset:16384
    v_lshlrev_b32 v64, 16, v172
    v_and_b32 v65, 0xffff0000, v172
    v_lshlrev_b32 v66, 16, v173
    v_and_b32 v67, 0xffff0000, v173
    v_lshlrev_b32 v68, 16, v174
    v_and_b32 v69, 0xffff0000, v174
    v_lshlrev_b32 v70, 16, v175
    v_and_b32 v71, 0xffff0000, v175
    v_fma_f32 v64, v64, v60, v56
    v_fma_f32 v65, v65, v60, v56
    v_fma_f32 v66, v66, v60, v56
    v_fma_f32 v67, v67, v60, v56
    v_fma_f32 v68, v68, v60, v56
    v_fma_f32 v69, v69, v60, v56
    v_fma_f32 v70, v70, v60, v56
    v_fma_f32 v71, v71, v60, v56
    v_cvt_pk_bf16_f32 v172, v64, v65
    v_cvt_pk_bf16_f32 v173, v66, v67
    v_cvt_pk_bf16_f32 v174, v68, v69
    v_cvt_pk_bf16_f32 v175, v70, v71
    ds_write_b128 v45, v[172:175] offset:17408
    v_add_u32 v45, s70, v2
    s_waitcnt lgkmcnt(0)
    s_barrier
    v_min_u32 v82, 2, v1
    v_sub_u32 v82, s55, v82
    v_max_i32 v82, 0, v82
    v_lshlrev_b32 v82, 2, v82
    buffer_load_dword v83, v82, s[40:43], 0 offen offset:64 sc1
    ds_read_b128 v[176:179], v45 offset:0
    ds_read_b128 v[180:183], v45 offset:1024
    ds_read_b128 v[184:187], v45 offset:2048
    ds_read_b128 v[188:191], v45 offset:3072
    ds_read_b128 v[192:195], v45 offset:4096
    ds_read_b128 v[196:199], v45 offset:5120
    ds_read_b128 v[200:203], v45 offset:6144
    ds_read_b128 v[204:207], v45 offset:7168
    ds_read_b128 v[208:211], v45 offset:8192
    ds_read_b128 v[212:215], v45 offset:9216
    ds_read_b128 v[216:219], v45 offset:10240
    ds_read_b128 v[220:223], v45 offset:11264
    ds_read_b128 v[224:227], v45 offset:12288
    ds_read_b128 v[228:231], v45 offset:13312
    ds_read_b128 v[232:235], v45 offset:14336
    ds_read_b128 v[236:239], v45 offset:15360
    ds_read_b128 v[240:243], v45 offset:16384
    ds_read_b128 v[244:247], v45 offset:17408
    s_waitcnt lgkmcnt(0)
    s_barrier
    s_add_u32 m0, s61, 0
    s_add_u32 s60, s62, 1152
    buffer_load_dwordx4 v3, s[28:31], s60 offen lds
    s_add_u32 m0, s61, 1024
    s_add_u32 s60, s62, 1152
    buffer_load_dwordx4 v4, s[28:31], s60 offen lds
    s_add_u32 m0, s61, 2048
    s_add_u32 s60, s62, 1152
    s_mov_b64 exec, 0xffff
    buffer_load_dwordx4 v76, s[28:31], s60 offen lds
    s_mov_b64 exec, -1
    s_add_u32 m0, s61, 18432
    s_add_u32 s60, s62, 222336
    buffer_load_dwordx4 v3, s[28:31], s60 offen lds
    s_add_u32 m0, s61, 19456
    s_add_u32 s60, s62, 222336
    buffer_load_dwordx4 v4, s[28:31], s60 offen lds
    s_add_u32 m0, s61, 20480
    s_add_u32 s60, s62, 222336
    s_mov_b64 exec, 0xffff
    buffer_load_dwordx4 v76, s[28:31], s60 offen lds
    s_mov_b64 exec, -1
    s_add_u32 m0, s61, 36864
    s_add_u32 s60, s62, 443520
    buffer_load_dwordx4 v3, s[28:31], s60 offen lds
    s_add_u32 m0, s61, 37888
    s_add_u32 s60, s62, 443520
    buffer_load_dwordx4 v4, s[28:31], s60 offen lds
    s_add_u32 m0, s61, 38912
    s_add_u32 s60, s62, 443520
    s_mov_b64 exec, 0xffff
    buffer_load_dwordx4 v76, s[28:31], s60 offen lds
    s_mov_b64 exec, -1
    s_add_u32 m0, s61, 55296
    s_add_u32 s60, s62, 664704
    buffer_load_dwordx4 v3, s[28:31], s60 offen lds
    s_add_u32 m0, s61, 56320
    s_add_u32 s60, s62, 664704
    buffer_load_dwordx4 v4, s[28:31], s60 offen lds
    s_add_u32 m0, s61, 57344
    s_add_u32 s60, s62, 664704
    s_mov_b64 exec, 0xffff
    buffer_load_dwordx4 v76, s[28:31], s60 offen lds
    s_mov_b64 exec, -1
    s_add_u32 m0, s61, 73728
    s_add_u32 s60, s62, 885888
    buffer_load_dwordx4 v3, s[28:31], s60 offen lds
    s_add_u32 m0, s61, 74752
    s_add_u32 s60, s62, 885888
    buffer_load_dwordx4 v4, s[28:31], s60 offen lds
    s_add_u32 m0, s61, 75776
    s_add_u32 s60, s62, 885888
    s_mov_b64 exec, 0xffff
    buffer_load_dwordx4 v76, s[28:31], s60 offen lds
    s_mov_b64 exec, -1
    s_add_u32 m0, s61, 92160
    s_add_u32 s60, s62, 1107072
    buffer_load_dwordx4 v3, s[28:31], s60 offen lds
    s_add_u32 m0, s61, 93184
    s_add_u32 s60, s62, 1107072
    buffer_load_dwordx4 v4, s[28:31], s60 offen lds
    s_add_u32 m0, s61, 94208
    s_add_u32 s60, s62, 1107072
    s_mov_b64 exec, 0xffff
    buffer_load_dwordx4 v76, s[28:31], s60 offen lds
    s_mov_b64 exec, -1
    s_waitcnt vmcnt(18)
    v_cmp_eq_u32 vcc, 0, v83
    s_cbranch_vccz L_ic_a_x
    s_mov_b32 s59, 0
L_ic_a:
    buffer_load_dword v83, v82, s[40:43], 0 offen offset:64 sc1
    s_add_u32 s59, s59, 1
    s_cmp_gt_u32 s59, 0x40000
    s_cbranch_scc1 L_ic_a_x
    s_waitcnt vmcnt(0)
    v_cmp_eq_u32 vcc, 0, v83
    s_cbranch_vccnz L_ic_a
L_ic_a_x:
    s_waitcnt vmcnt(15)
    s_barrier
    ds_read_b64_tr_b16 v[16:17], v5 offset:0
    ds_read_b64_tr_b16 v[18:19], v5 offset:4608
    ds_read_b64_tr_b16 v[20:21], v5 offset:40
    ds_read_b64_tr_b16 v[22:23], v5 offset:4648
    ds_read_b64_tr_b16 v[24:25], v5 offset:72
    ds_read_b64_tr_b16 v[26:27], v5 offset:4680
    ds_read_b64_tr_b16 v[28:29], v5 offset:112
    ds_read_b64_tr_b16 v[30:31], v5 offset:4720
    s_waitcnt lgkmcnt(6)
    v_mfma_f32_16x16x32_bf16 v[40:43], v[16:19], v[104:107], 0
    ds_read_b64_tr_b16 v[32:33], v8 offset:0
    s_add_u32 m0, s61, 110592
    s_add_u32 s60, s62, 1328256
    buffer_load_dwordx4 v3, s[28:31], s60 offen lds
    v_mfma_f32_16x16x32_bf16 v[44:47], v[16:19], v[176:179], 0
    ds_read_b64_tr_b16 v[34:35], v8 offset:4608
    s_waitcnt lgkmcnt(6)
    v_mfma_f32_16x16x32_bf16 v[48:51], v[20:23], v[104:107], 0
    ds_read_b64_tr_b16 v[36:37], v5 offset:9216
    v_mfma_f32_16x16x32_bf16 v[52:55], v[20:23], v[176:179], 0
    ds_read_b64_tr_b16 v[38:39], v5 offset:13824
    s_waitcnt lgkmcnt(6)
    v_mfma_f32_16x16x32_bf16 v[56:59], v[24:27], v[104:107], 0
    ds_read_b64_tr_b16 v[16:17], v5 offset:9256
    s_add_u32 m0, s61, 111616
    s_add_u32 s60, s62, 1328256
    buffer_load_dwordx4 v4, s[28:31], s60 offen lds
    v_mfma_f32_16x16x32_bf16 v[60:63], v[24:27], v[176:179], 0
    ds_read_b64_tr_b16 v[18:19], v5 offset:13864
    s_waitcnt lgkmcnt(6)
    v_mfma_f32_16x16x32_bf16 v[64:67], v[28:31], v[104:107], 0
    ds_read_b64_tr_b16 v[20:21], v5 offset:9288
    v_mfma_f32_16x16x32_bf16 v[68:71], v[28:31], v[176:179], 0
    ds_read_b64_tr_b16 v[22:23], v5 offset:13896
    s_waitcnt lgkmcnt(6)
    v_mfma_f32_16x16x32_bf16 v[72:75], v[32:35], v[104:107], 0
    ds_read_b64_tr_b16 v[24:25], v5 offset:9328
    ds_read_b64_tr_b16 v[26:27], v5 offset:13936
    s_add_u32 m0, s61, 112640
    s_add_u32 s60, s62, 1328256
    s_mov_b64 exec, 0xffff
    buffer_load_dwordx4 v76, s[28:31], s60 offen lds
    s_mov_b64 exec, -1
    s_waitcnt lgkmcnt(6)
    v_mfma_f32_16x16x32_bf16 v[40:43], v[36:39], v[108:111], v[40:43]
    ds_read_b64_tr_b16 v[28:29], v8 offset:9216
    v_mfma_f32_16x16x32_bf16 v[44:47], v[36:39], v[180:183], v[44:47]
    ds_read_b64_tr_b16 v[30:31], v8 offset:13824
    s_waitcnt lgkmcnt(6)
    v_mfma_f32_16x16x32_bf16 v[48:51], v[16:19], v[108:111], v[48:51]
    s_waitcnt vmcnt(15)
    s_barrier
    ds_read_b64_tr_b16 v[32:33], v5 offset:18432
    v_mfma_f32_16x16x32_bf16 v[52:55], v[16:19], v[180:183], v[52:55]
    ds_read_b64_tr_b16 v[34:35], v5 offset:23040
    s_waitcnt lgkmcnt(6)
    v_mfma_f32_16x16x32_bf16 v[56:59], v[20:23], v[108:111], v[56:59]
    ds_read_b64_tr_b16 v[36:37], v5 offset:18472
    v_mfma_f32_16x16x32_bf16 v[60:63], v[20:23], v[180:183], v[60:63]
    ds_read_b64_tr_b16 v[38:39], v5 offset:23080
    s_waitcnt lgkmcnt(6)
    v_mfma_f32_16x16x32_bf16 v[64:67], v[24:27], v[108:111], v[64:67]
    ds_read_b64_tr_b16 v[16:17], v5 offset:18504
    s_add_u32 m0, s61, 129024
    s_add_u32 s60, s62, 1549440
    buffer_load_dwordx4 v3, s[28:31], s60 offen lds
    v_mfma_f32_16x16x32_bf16 v[68:71], v[24:27], v[180:183], v[68:71]
    ds_read_b64_tr_b16 v[18:19], v5 offset:23112
    s_waitcnt lgkmcnt(6)
    v_mfma_f32_16x16x32_bf16 v[72:75], v[28:31], v[108:111], v[72:75]
    ds_read_b64_tr_b16 v[20:21], v5 offset:18544
    ds_read_b64_tr_b16 v[22:23], v5 offset:23152
    s_waitcnt lgkmcnt(6)
    v_mfma_f32_16x16x32_bf16 v[40:43], v[32:35], v[112:115], v[40:43]
    ds_read_b64_tr_b16 v[24:25], v8 offset:18432
    s_add_u32 m0, s61, 130048
    s_add_u32 s60, s62, 1549440
    buffer_load_dwordx4 v4, s[28:31], s60 offen lds
    v_mfma_f32_16x16x32_bf16 v[44:47], v[32:35], v[184:187], v[44:47]
    ds_read_b64_tr_b16 v[26:27], v8 offset:23040
    s_waitcnt lgkmcnt(6)
    v_mfma_f32_16x16x32_bf16 v[48:51], v[36:39], v[112:115], v[48:51]
    ds_read_b64_tr_b16 v[28:29], v5 offset:27648
    v_mfma_f32_16x16x32_bf16 v[52:55], v[36:39], v[184:187], v[52:55]
    ds_read_b64_tr_b16 v[30:31], v5 offset:32256
    s_waitcnt lgkmcnt(6)
    v_mfma_f32_16x16x32_bf16 v[56:59], v[16:19], v[112:115], v[56:59]
    ds_read_b64_tr_b16 v[32:33], v5 offset:27688
    s_add_u32 m0, s61, 131072
    s_add_u32 s60, s62, 1549440
    s_mov_b64 exec, 0xffff
    buffer_load_dwordx4 v76, s[28:31], s60 offen lds
    s_mov_b64 exec, -1
    v_mfma_f32_16x16x32_bf16 v[60:63], v[16:19], v[184:187], v[60:63]
    ds_read_b64_tr_b16 v[34:35], v5 offset:32296
    s_waitcnt lgkmcnt(6)
    v_mfma_f32_16x16x32_bf16 v[64:67], v[20:23], v[112:115], v[64:67]
    ds_read_b64_tr_b16 v[36:37], v5 offset:27720
    v_mfma_f32_16x16x32_bf16 v[68:71], v[20:23], v[184:187], v[68:71]
    ds_read_b64_tr_b16 v[38:39], v5 offset:32328
    s_waitcnt lgkmcnt(6)
    v_mfma_f32_16x16x32_bf16 v[72:75], v[24:27], v[112:115], v[72:75]
    ds_read_b64_tr_b16 v[16:17], v5 offset:27760
    ds_read_b64_tr_b16 v[18:19], v5 offset:32368
    s_waitcnt lgkmcnt(6)
    v_mfma_f32_16x16x32_bf16 v[40:43], v[28:31], v[116:119], v[40:43]
    ds_read_b64_tr_b16 v[20:21], v8 offset:27648
    v_mfma_f32_16x16x32_bf16 v[44:47], v[28:31], v[188:191], v[44:47]
    ds_read_b64_tr_b16 v[22:23], v8 offset:32256
    s_waitcnt lgkmcnt(6)
    v_mfma_f32_16x16x32_bf16 v[48:51], v[32:35], v[116:119], v[48:51]
    s_waitcnt vmcnt(15)
    s_barrier
    ds_read_b64_tr_b16 v[24:25], v5 offset:36864
    v_mfma_f32_16x16x32_bf16 v[52:55], v[32:35], v[188:191], v[52:55]
    ds_read_b64_tr_b16 v[26:27], v5 offset:41472
    s_waitcnt lgkmcnt(6)
    v_mfma_f32_16x16x32_bf16 v[56:59], v[36:39], v[116:119], v[56:59]
    ds_read_b64_tr_b16 v[28:29], v5 offset:36904
    v_mfma_f32_16x16x32_bf16 v[60:63], v[36:39], v[188:191], v[60:63]
    ds_read_b64_tr_b16 v[30:31], v5 offset:41512
    s_waitcnt lgkmcnt(6)
    v_mfma_f32_16x16x32_bf16 v[64:67], v[16:19], v[116:119], v[64:67]
    ds_read_b64_tr_b16 v[32:33], v5 offset:36936
    s_add_u32 m0, s61, 0
    s_add_u32 s60, s62, 1770624
    buffer_load_dwordx4 v3, s[28:31], s60 offen lds
    v_mfma_f32_16x16x32_bf16 v[68:71], v[16:19], v[188:191], v[68:71]
    ds_read_b64_tr_b16 v[34:35], v5 offset:41544
    s_waitcnt lgkmcnt(6)
    v_mfma_f32_16x16x32_bf16 v[72:75], v[20:23], v[116:119], v[72:75]
    ds_read_b64_tr_b16 v[36:37], v5 offset:36976
    ds_read_b64_tr_b16 v[38:39], v5 offset:41584
    s_waitcnt lgkmcnt(6)
    v_mfma_f32_16x16x32_bf16 v[40:43], v[24:27], v[120:123], v[40:43]
    ds_read_b64_tr_b16 v[16:17], v8 offset:36864
    s_add_u32 m0, s61, 1024
    s_add_u32 s60, s62, 1770624
    buffer_load_dwordx4 v4, s[28:31], s60 offen lds
    v_mfma_f32_16x16x32_bf16 v[44:47], v[24:27], v[192:195], v[44:47]
    ds_read_b64_tr_b16 v[18:19], v8 offset:41472
    s_waitcnt lgkmcnt(6)
    v_mfma_f32_16x16x32_bf16 v[48:51], v[28:31], v[120:123], v[48:51]
    ds_read_b64_tr_b16 v[20:21], v5 offset:46080
    v_mfma_f32_16x16x32_bf16 v[52:55], v[28:31], v[192:195], v[52:55]
    ds_read_b64_tr_b16 v[22:23], v5 offset:50688
    s_waitcnt lgkmcnt(6)
    v_mfma_f32_16x16x32_bf16 v[56:59], v[32:35], v[120:123], v[56:59]
    ds_read_b64_tr_b16 v[24:25], v5 offset:46120
    s_add_u32 m0, s61, 2048
    s_add_u32 s60, s62, 1770624
    s_mov_b64 exec, 0xffff
    buffer_load_dwordx4 v76, s[28:31], s60 offen lds
    s_mov_b64 exec, -1
    v_mfma_f32_16x16x32_bf16 v[60:63], v[32:35], v[192:195], v[60:63]
    ds_read_b64_tr_b16 v[26:27], v5 offset:50728
    s_waitcnt lgkmcnt(6)
    v_mfma_f32_16x16x32_bf16 v[64:67], v[36:39], v[120:123], v[64:67]
    ds_read_b64_tr_b16 v[28:29], v5 offset:46152
    v_mfma_f32_16x16x32_bf16 v[68:71], v[36:39], v[192:195], v[68:71]
    ds_read_b64_tr_b16 v[30:31], v5 offset:50760
    s_waitcnt lgkmcnt(6)
    v_mfma_f32_16x16x32_bf16 v[72:75], v[16:19], v[120:123], v[72:75]
    ds_read_b64_tr_b16 v[32:33], v5 offset:46192
    ds_read_b64_tr_b16 v[34:35], v5 offset:50800
    s_waitcnt lgkmcnt(6)
    v_mfma_f32_16x16x32_bf16 v[40:43], v[20:23], v[124:127], v[40:43]
    ds_read_b64_tr_b16 v[36:37], v8 offset:46080
    v_mfma_f32_16x16x32_bf16 v[44:47], v[20:23], v[196:199], v[44:47]
    ds_read_b64_tr_b16 v[38:39], v8 offset:50688
    s_waitcnt lgkmcnt(6)
    v_mfma_f32_16x16x32_bf16 v[48:51], v[24:27], v[124:127], v[48:51]
    s_waitcnt vmcnt(15)
    s_barrier
    ds_read_b64_tr_b16 v[16:17], v6 offset:6144
    v_mfma_f32_16x16x32_bf16 v[52:55], v[24:27], v[196:199], v[52:55]
    ds_read_b64_tr_b16 v[18:19], v6 offset:10752
    s_waitcnt lgkmcnt(6)
    v_mfma_f32_16x16x32_bf16 v[56:59], v[28:31], v[124:127], v[56:59]
    ds_read_b64_tr_b16 v[20:21], v6 offset:6184
    v_mfma_f32_16x16x32_bf16 v[60:63], v[28:31], v[196:199], v[60:63]
    ds_read_b64_tr_b16 v[22:23], v6 offset:10792
    s_waitcnt lgkmcnt(6)
    v_mfma_f32_16x16x32_bf16 v[64:67], v[32:35], v[124:127], v[64:67]
    ds_read_b64_tr_b16 v[24:25], v6 offset:6216
    s_add_u32 m0, s61, 18432
    s_add_u32 s60, s62, 2304
    buffer_load_dwordx4 v3, s[28:31], s60 offen lds
    v_mfma_f32_16x16x32_bf16 v[68:71], v[32:35], v[196:199], v[68:71]
    ds_read_b64_tr_b16 v[26:27], v6 offset:10824
    s_waitcnt lgkmcnt(6)
    v_mfma_f32_16x16x32_bf16 v[72:75], v[36:39], v[124:127], v[72:75]
    ds_read_b64_tr_b16 v[28:29], v6 offset:6256
    ds_read_b64_tr_b16 v[30:31], v6 offset:10864
    s_waitcnt lgkmcnt(6)
    v_mfma_f32_16x16x32_bf16 v[40:43], v[16:19], v[128:131], v[40:43]
    ds_read_b64_tr_b16 v[32:33], v9 offset:6144
    s_add_u32 m0, s61, 19456
    s_add_u32 s60, s62, 2304
    buffer_load_dwordx4 v4, s[28:31], s60 offen lds
    v_mfma_f32_16x16x32_bf16 v[44:47], v[16:19], v[200:203], v[44:47]
    ds_read_b64_tr_b16 v[34:35], v9 offset:10752
    s_waitcnt lgkmcnt(6)
    v_mfma_f32_16x16x32_bf16 v[48:51], v[20:23], v[128:131], v[48:51]
    ds_read_b64_tr_b16 v[36:37], v6 offset:15360
    v_mfma_f32_16x16x32_bf16 v[52:55], v[20:23], v[200:203], v[52:55]
    ds_read_b64_tr_b16 v[38:39], v6 offset:19968
    s_waitcnt lgkmcnt(6)
    v_mfma_f32_16x16x32_bf16 v[56:59], v[24:27], v[128:131], v[56:59]
    ds_read_b64_tr_b16 v[16:17], v6 offset:15400
    s_add_u32 m0, s61, 20480
    s_add_u32 s60, s62, 2304
    s_mov_b64 exec, 0xffff
    buffer_load_dwordx4 v76, s[28:31], s60 offen lds
    s_mov_b64 exec, -1
    v_mfma_f32_16x16x32_bf16 v[60:63], v[24:27], v[200:203], v[60:63]
    ds_read_b64_tr_b16 v[18:19], v6 offset:20008
    s_waitcnt lgkmcnt(6)
    v_mfma_f32_16x16x32_bf16 v[64:67], v[28:31], v[128:131], v[64:67]
    ds_read_b64_tr_b16 v[20:21], v6 offset:15432
    v_mfma_f32_16x16x32_bf16 v[68:71], v[28:31], v[200:203], v[68:71]
    ds_read_b64_tr_b16 v[22:23], v6 offset:20040
    s_waitcnt lgkmcnt(6)
    v_mfma_f32_16x16x32_bf16 v[72:75], v[32:35], v[128:131], v[72:75]
    ds_read_b64_tr_b16 v[24:25], v6 offset:15472
    ds_read_b64_tr_b16 v[26:27], v6 offset:20080
    s_waitcnt lgkmcnt(6)
    v_mfma_f32_16x16x32_bf16 v[40:43], v[36:39], v[132:135], v[40:43]
    ds_read_b64_tr_b16 v[28:29], v9 offset:15360
    v_mfma_f32_16x16x32_bf16 v[44:47], v[36:39], v[204:207], v[44:47]
    ds_read_b64_tr_b16 v[30:31], v9 offset:19968
    s_waitcnt lgkmcnt(6)
    v_mfma_f32_16x16x32_bf16 v[48:51], v[16:19], v[132:135], v[48:51]
    s_waitcnt vmcnt(15)
    s_barrier
    ds_read_b64_tr_b16 v[32:33], v6 offset:24576
    v_mfma_f32_16x16x32_bf16 v[52:55], v[16:19], v[204:207], v[52:55]
    ds_read_b64_tr_b16 v[34:35], v6 offset:29184
    s_waitcnt lgkmcnt(6)
    v_mfma_f32_16x16x32_bf16 v[56:59], v[20:23], v[132:135], v[56:59]
    ds_read_b64_tr_b16 v[36:37], v6 offset:24616
    v_mfma_f32_16x16x32_bf16 v[60:63], v[20:23], v[204:207], v[60:63]
    ds_read_b64_tr_b16 v[38:39], v6 offset:29224
    s_waitcnt lgkmcnt(6)
    v_mfma_f32_16x16x32_bf16 v[64:67], v[24:27], v[132:135], v[64:67]
    ds_read_b64_tr_b16 v[16:17], v6 offset:24648
    s_add_u32 m0, s61, 36864
    s_add_u32 s60, s62, 223488
    buffer_load_dwordx4 v3, s[28:31], s60 offen lds
    v_mfma_f32_16x16x32_bf16 v[68:71], v[24:27], v[204:207], v[68:71]
    ds_read_b64_tr_b16 v[18:19], v6 offset:29256
    s_waitcnt lgkmcnt(6)
    v_mfma_f32_16x16x32_bf16 v[72:75], v[28:31], v[132:135], v[72:75]
    ds_read_b64_tr_b16 v[20:21], v6 offset:24688
    ds_read_b64_tr_b16 v[22:23], v6 offset:29296
    s_waitcnt lgkmcnt(6)
    v_mfma_f32_16x16x32_bf16 v[40:43], v[32:35], v[136:139], v[40:43]
    ds_read_b64_tr_b16 v[24:25], v9 offset:24576
    s_add_u32 m0, s61, 37888
    s_add_u32 s60, s62, 223488
    buffer_load_dwordx4 v4, s[28:31], s60 offen lds
    v_mfma_f32_16x16x32_bf16 v[44:47], v[32:35], v[208:211], v[44:47]
    ds_read_b64_tr_b16 v[26:27], v9 offset:29184
    s_waitcnt lgkmcnt(6)
    v_mfma_f32_16x16x32_bf16 v[48:51], v[36:39], v[136:139], v[48:51]
    ds_read_b64_tr_b16 v[28:29], v6 offset:33792
    v_mfma_f32_16x16x32_bf16 v[52:55], v[36:39], v[208:211], v[52:55]
    ds_read_b64_tr_b16 v[30:31], v6 offset:38400
    s_waitcnt lgkmcnt(6)
    v_mfma_f32_16x16x32_bf16 v[56:59], v[16:19], v[136:139], v[56:59]
    ds_read_b64_tr_b16 v[32:33], v6 offset:33832
    s_add_u32 m0, s61, 38912
    s_add_u32 s60, s62, 223488
    s_mov_b64 exec, 0xffff
    buffer_load_dwordx4 v76, s[28:31], s60 offen lds
    s_mov_b64 exec, -1
    v_mfma_f32_16x16x32_bf16 v[60:63], v[16:19], v[208:211], v[60:63]
    ds_read_b64_tr_b16 v[34:35], v6 offset:38440
    s_waitcnt lgkmcnt(6)
    v_mfma_f32_16x16x32_bf16 v[64:67], v[20:23], v[136:139], v[64:67]
    ds_read_b64_tr_b16 v[36:37], v6 offset:33864
    v_mfma_f32_16x16x32_bf16 v[68:71], v[20:23], v[208:211], v[68:71]
    ds_read_b64_tr_b16 v[38:39], v6 offset:38472
    s_waitcnt lgkmcnt(6)
    v_mfma_f32_16x16x32_bf16 v[72:75], v[24:27], v[136:139], v[72:75]
    ds_read_b64_tr_b16 v[16:17], v6 offset:33904
    ds_read_b64_tr_b16 v[18:19], v6 offset:38512
    s_waitcnt lgkmcnt(6)
    v_mfma_f32_16x16x32_bf16 v[40:43], v[28:31], v[140:143], v[40:43]
    ds_read_b64_tr_b16 v[20:21], v9 offset:33792
    v_mfma_f32_16x16x32_bf16 v[44:47], v[28:31], v[212:215], v[44:47]
    ds_read_b64_tr_b16 v[22:23], v9 offset:38400
    s_waitcnt lgkmcnt(6)
    v_mfma_f32_16x16x32_bf16 v[48:51], v[32:35], v[140:143], v[48:51]
    s_waitcnt vmcnt(15)
    s_barrier
    ds_read_b64_tr_b16 v[24:25], v6 offset:43008
    v_mfma_f32_16x16x32_bf16 v[52:55], v[32:35], v[212:215], v[52:55]
    ds_read_b64_tr_b16 v[26:27], v6 offset:47616
    s_waitcnt lgkmcnt(6)
    v_mfma_f32_16x16x32_bf16 v[56:59], v[36:39], v[140:143], v[56:59]
    ds_read_b64_tr_b16 v[28:29], v6 offset:43048
    v_mfma_f32_16x16x32_bf16 v[60:63], v[36:39], v[212:215], v[60:63]
    ds_read_b64_tr_b16 v[30:31], v6 offset:47656
    s_waitcnt lgkmcnt(6)
    v_mfma_f32_16x16x32_bf16 v[64:67], v[16:19], v[140:143], v[64:67]
    ds_read_b64_tr_b16 v[32:33], v6 offset:43080
    s_add_u32 m0, s61, 55296
    s_add_u32 s60, s62, 444672
    buffer_load_dwordx4 v3, s[28:31], s60 offen lds
    v_mfma_f32_16x16x32_bf16 v[68:71], v[16:19], v[212:215], v[68:71]
    ds_read_b64_tr_b16 v[34:35], v6 offset:47688
    s_waitcnt lgkmcnt(6)
    v_mfma_f32_16x16x32_bf16 v[72:75], v[20:23], v[140:143], v[72:75]
    ds_read_b64_tr_b16 v[36:37], v6 offset:43120
    ds_read_b64_tr_b16 v[38:39], v6 offset:47728
    s_waitcnt lgkmcnt(6)
    v_mfma_f32_16x16x32_bf16 v[40:43], v[24:27], v[144:147], v[40:43]
    ds_read_b64_tr_b16 v[16:17], v9 offset:43008
    s_add_u32 m0, s61, 56320
    s_add_u32 s60, s62, 444672
    buffer_load_dwordx4 v4, s[28:31], s60 offen lds
    v_mfma_f32_16x16x32_bf16 v[44:47], v[24:27], v[216:219], v[44:47]
    ds_read_b64_tr_b16 v[18:19], v9 offset:47616
    s_waitcnt lgkmcnt(6)
    v_mfma_f32_16x16x32_bf16 v[48:51], v[28:31], v[144:147], v[48:51]
    ds_read_b64_tr_b16 v[20:21], v7 offset:3072
    v_mfma_f32_16x16x32_bf16 v[52:55], v[28:31], v[216:219], v[52:55]
    ds_read_b64_tr_b16 v[22:23], v7 offset:7680
    s_waitcnt lgkmcnt(6)
    v_mfma_f32_16x16x32_bf16 v[56:59], v[32:35], v[144:147], v[56:59]
    ds_read_b64_tr_b16 v[24:25], v7 offset:3112
    s_add_u32 m0, s61, 57344
    s_add_u32 s60, s62, 444672
    s_mov_b64 exec, 0xffff
    buffer_load_dwordx4 v76, s[28:31], s60 offen lds
    s_mov_b64 exec, -1
    v_mfma_f32_16x16x32_bf16 v[60:63], v[32:35], v[216:219], v[60:63]
    ds_read_b64_tr_b16 v[26:27], v7 offset:7720
    s_waitcnt lgkmcnt(6)
    v_mfma_f32_16x16x32_bf16 v[64:67], v[36:39], v[144:147], v[64:67]
    ds_read_b64_tr_b16 v[28:29], v7 offset:3144
    v_mfma_f32_16x16x32_bf16 v[68:71], v[36:39], v[216:219], v[68:71]
    ds_read_b64_tr_b16 v[30:31], v7 offset:7752
    s_waitcnt lgkmcnt(6)
    v_mfma_f32_16x16x32_bf16 v[72:75], v[16:19], v[144:147], v[72:75]
    ds_read_b64_tr_b16 v[32:33], v7 offset:3184
    ds_read_b64_tr_b16 v[34:35], v7 offset:7792
    s_waitcnt lgkmcnt(6)
    v_mfma_f32_16x16x32_bf16 v[40:43], v[20:23], v[148:151], v[40:43]
    ds_read_b64_tr_b16 v[36:37], v10 offset:3072
    v_mfma_f32_16x16x32_bf16 v[44:47], v[20:23], v[220:223], v[44:47]
    ds_read_b64_tr_b16 v[38:39], v10 offset:7680
    s_waitcnt lgkmcnt(6)
    v_mfma_f32_16x16x32_bf16 v[48:51], v[24:27], v[148:151], v[48:51]
    s_waitcnt vmcnt(15)
    s_barrier
    ds_read_b64_tr_b16 v[16:17], v7 offset:12288
    v_mfma_f32_16x16x32_bf16 v[52:55], v[24:27], v[220:223], v[52:55]
    ds_read_b64_tr_b16 v[18:19], v7 offset:16896
    s_waitcnt lgkmcnt(6)
    v_mfma_f32_16x16x32_bf16 v[56:59], v[28:31], v[148:151], v[56:59]
    ds_read_b64_tr_b16 v[20:21], v7 offset:12328
    v_mfma_f32_16x16x32_bf16 v[60:63], v[28:31], v[220:223], v[60:63]
    ds_read_b64_tr_b16 v[22:23], v7 offset:16936
    s_waitcnt lgkmcnt(6)
    v_mfma_f32_16x16x32_bf16 v[64:67], v[32:35], v[148:151], v[64:67]
    ds_read_b64_tr_b16 v[24:25], v7 offset:12360
    s_add_u32 m0, s61, 73728
    s_add_u32 s60, s62, 665856
    buffer_load_dwordx4 v3, s[28:31], s60 offen lds
    v_mfma_f32_16x16x32_bf16 v[68:71], v[32:35], v[220:223], v[68:71]
    ds_read_b64_tr_b16 v[26:27], v7 offset:16968
    s_waitcnt lgkmcnt(6)
    v_mfma_f32_16x16x32_bf16 v[72:75], v[36:39], v[148:151], v[72:75]
    ds_read_b64_tr_b16 v[28:29], v7 offset:12400
    ds_read_b64_tr_b16 v[30:31], v7 offset:17008
    s_waitcnt lgkmcnt(6)
    v_mfma_f32_16x16x32_bf16 v[40:43], v[16:19], v[152:155], v[40:43]
    ds_read_b64_tr_b16 v[32:33], v10 offset:12288
    s_add_u32 m0, s61, 74752
    s_add_u32 s60, s62, 665856
    buffer_load_dwordx4 v4, s[28:31], s60 offen lds
    v_mfma_f32_16x16x32_bf16 v[44:47], v[16:19], v[224:227], v[44:47]
    ds_read_b64_tr_b16 v[34:35], v10 offset:16896
    s_waitcnt lgkmcnt(6)
    v_mfma_f32_16x16x32_bf16 v[48:51], v[20:23], v[152:155], v[48:51]
    ds_read_b64_tr_b16 v[36:37], v7 offset:21504
    v_mfma_f32_16x16x32_bf16 v[52:55], v[20:23], v[224:227], v[52:55]
    ds_read_b64_tr_b16 v[38:39], v7 offset:26112
    s_waitcnt lgkmcnt(6)
    v_mfma_f32_16x16x32_bf16 v[56:59], v[24:27], v[152:155], v[56:59]
    ds_read_b64_tr_b16 v[16:17], v7 offset:21544
    s_add_u32 m0, s61, 75776
    s_add_u32 s60, s62, 665856
    s_mov_b64 exec, 0xffff
    buffer_load_dwordx4 v76, s[28:31], s60 offen lds
    s_mov_b64 exec, -1
    v_mfma_f32_16x16x32_bf16 v[60:63], v[24:27], v[224:227], v[60:63]
    ds_read_b64_tr_b16 v[18:19], v7 offset:26152
    s_waitcnt lgkmcnt(6)
    v_mfma_f32_16x16x32_bf16 v[64:67], v[28:31], v[152:155], v[64:67]
    ds_read_b64_tr_b16 v[20:21], v7 offset:21576
    v_mfma_f32_16x16x32_bf16 v[68:71], v[28:31], v[224:227], v[68:71]
    ds_read_b64_tr_b16 v[22:23], v7 offset:26184
    s_waitcnt lgkmcnt(6)
    v_mfma_f32_16x16x32_bf16 v[72:75], v[32:35], v[152:155], v[72:75]
    ds_read_b64_tr_b16 v[24:25], v7 offset:21616
    ds_read_b64_tr_b16 v[26:27], v7 offset:26224
    s_waitcnt lgkmcnt(6)
    v_mfma_f32_16x16x32_bf16 v[40:43], v[36:39], v[156:159], v[40:43]
    ds_read_b64_tr_b16 v[28:29], v10 offset:21504
    v_mfma_f32_16x16x32_bf16 v[44:47], v[36:39], v[228:231], v[44:47]
    ds_read_b64_tr_b16 v[30:31], v10 offset:26112
    s_waitcnt lgkmcnt(6)
    v_mfma_f32_16x16x32_bf16 v[48:51], v[16:19], v[156:159], v[48:51]
    s_waitcnt vmcnt(15)
    s_barrier
    ds_read_b64_tr_b16 v[32:33], v7 offset:30720
    v_mfma_f32_16x16x32_bf16 v[52:55], v[16:19], v[228:231], v[52:55]
    ds_read_b64_tr_b16 v[34:35], v7 offset:35328
    s_waitcnt lgkmcnt(6)
    v_mfma_f32_16x16x32_bf16 v[56:59], v[20:23], v[156:159], v[56:59]
    ds_read_b64_tr_b16 v[36:37], v7 offset:30760
    v_mfma_f32_16x16x32_bf16 v[60:63], v[20:23], v[228:231], v[60:63]
    ds_read_b64_tr_b16 v[38:39], v7 offset:35368
    s_waitcnt lgkmcnt(6)
    v_mfma_f32_16x16x32_bf16 v[64:67], v[24:27], v[156:159], v[64:67]
    ds_read_b64_tr_b16 v[16:17], v7 offset:30792
    s_add_u32 m0, s61, 92160
    s_add_u32 s60, s62, 887040
    buffer_load_dwordx4 v3, s[28:31], s60 offen lds
    v_mfma_f32_16x16x32_bf16 v[68:71], v[24:27], v[228:231], v[68:71]
    ds_read_b64_tr_b16 v[18:19], v7 offset:35400
    s_waitcnt lgkmcnt(6)
    v_mfma_f32_16x16x32_bf16 v[72:75], v[28:31], v[156:159], v[72:75]
    ds_read_b64_tr_b16 v[20:21], v7 offset:30832
    ds_read_b64_tr_b16 v[22:23], v7 offset:35440
    s_waitcnt lgkmcnt(6)
    v_mfma_f32_16x16x32_bf16 v[40:43], v[32:35], v[160:163], v[40:43]
    ds_read_b64_tr_b16 v[24:25], v10 offset:30720
    s_add_u32 m0, s61, 93184
    s_add_u32 s60, s62, 887040
    buffer_load_dwordx4 v4, s[28:31], s60 offen lds
    v_mfma_f32_16x16x32_bf16 v[44:47], v[32:35], v[232:235], v[44:47]
    ds_read_b64_tr_b16 v[26:27], v10 offset:35328
    s_waitcnt lgkmcnt(6)
    v_mfma_f32_16x16x32_bf16 v[48:51], v[36:39], v[160:163], v[48:51]
    ds_read_b64_tr_b16 v[28:29], v7 offset:39936
    v_mfma_f32_16x16x32_bf16 v[52:55], v[36:39], v[232:235], v[52:55]
    ds_read_b64_tr_b16 v[30:31], v7 offset:44544
    s_waitcnt lgkmcnt(6)
    v_mfma_f32_16x16x32_bf16 v[56:59], v[16:19], v[160:163], v[56:59]
    ds_read_b64_tr_b16 v[32:33], v7 offset:39976
    s_add_u32 m0, s61, 94208
    s_add_u32 s60, s62, 887040
    s_mov_b64 exec, 0xffff
    buffer_load_dwordx4 v76, s[28:31], s60 offen lds
    s_mov_b64 exec, -1
    v_mfma_f32_16x16x32_bf16 v[60:63], v[16:19], v[232:235], v[60:63]
    ds_read_b64_tr_b16 v[34:35], v7 offset:44584
    s_waitcnt lgkmcnt(6)
    v_mfma_f32_16x16x32_bf16 v[64:67], v[20:23], v[160:163], v[64:67]
    ds_read_b64_tr_b16 v[36:37], v7 offset:40008
    v_mfma_f32_16x16x32_bf16 v[68:71], v[20:23], v[232:235], v[68:71]
    ds_read_b64_tr_b16 v[38:39], v7 offset:44616
    s_waitcnt lgkmcnt(6)
    v_mfma_f32_16x16x32_bf16 v[72:75], v[24:27], v[160:163], v[72:75]
    ds_read_b64_tr_b16 v[16:17], v7 offset:40048
    ds_read_b64_tr_b16 v[18:19], v7 offset:44656
    s_waitcnt lgkmcnt(6)
    v_mfma_f32_16x16x32_bf16 v[40:43], v[28:31], v[164:167], v[40:43]
    ds_read_b64_tr_b16 v[20:21], v10 offset:39936
    v_mfma_f32_16x16x32_bf16 v[44:47], v[28:31], v[236:239], v[44:47]
    ds_read_b64_tr_b16 v[22:23], v10 offset:44544
    s_waitcnt lgkmcnt(6)
    v_mfma_f32_16x16x32_bf16 v[48:51], v[32:35], v[164:167], v[48:51]
    s_waitcnt vmcnt(15)
    s_barrier
    ds_read_b64_tr_b16 v[24:25], v5 offset:0
    v_mfma_f32_16x16x32_bf16 v[52:55], v[32:35], v[236:239], v[52:55]
    ds_read_b64_tr_b16 v[26:27], v5 offset:4608
    s_waitcnt lgkmcnt(6)
    v_mfma_f32_16x16x32_bf16 v[56:59], v[36:39], v[164:167], v[56:59]
    ds_read_b64_tr_b16 v[28:29], v5 offset:40
    v_mfma_f32_16x16x32_bf16 v[60:63], v[36:39], v[236:239], v[60:63]
    ds_read_b64_tr_b16 v[30:31], v5 offset:4648
    s_waitcnt lgkmcnt(6)
    v_mfma_f32_16x16x32_bf16 v[64:67], v[16:19], v[164:167], v[64:67]
    ds_read_b64_tr_b16 v[32:33], v5 offset:72
    s_add_u32 m0, s61, 110592
    s_add_u32 s60, s62, 1108224
    buffer_load_dwordx4 v3, s[28:31], s60 offen lds
    v_mfma_f32_16x16x32_bf16 v[68:71], v[16:19], v[236:239], v[68:71]
    ds_read_b64_tr_b16 v[34:35], v5 offset:4680
    s_waitcnt lgkmcnt(6)
    v_mfma_f32_16x16x32_bf16 v[72:75], v[20:23], v[164:167], v[72:75]
    ds_read_b64_tr_b16 v[36:37], v5 offset:112
    ds_read_b64_tr_b16 v[38:39], v5 offset:4720
    s_waitcnt lgkmcnt(6)
    v_mfma_f32_16x16x32_bf16 v[40:43], v[24:27], v[168:171], v[40:43]
    ds_read_b64_tr_b16 v[16:17], v8 offset:0
    s_add_u32 m0, s61, 111616
    s_add_u32 s60, s62, 1108224
    buffer_load_dwordx4 v4, s[28:31], s60 offen lds
    v_mfma_f32_16x16x32_bf16 v[44:47], v[24:27], v[240:243], v[44:47]
    ds_read_b64_tr_b16 v[18:19], v8 offset:4608
    s_waitcnt lgkmcnt(6)
    v_mfma_f32_16x16x32_bf16 v[48:51], v[28:31], v[168:171], v[48:51]
    ds_read_b64_tr_b16 v[20:21], v5 offset:9216
    v_mfma_f32_16x16x32_bf16 v[52:55], v[28:31], v[240:243], v[52:55]
    ds_read_b64_tr_b16 v[22:23], v5 offset:13824
    s_waitcnt lgkmcnt(6)
    v_mfma_f32_16x16x32_bf16 v[56:59], v[32:35], v[168:171], v[56:59]
    ds_read_b64_tr_b16 v[24:25], v5 offset:9256
    s_add_u32 m0, s61, 112640
    s_add_u32 s60, s62, 1108224
    s_mov_b64 exec, 0xffff
    buffer_load_dwordx4 v76, s[28:31], s60 offen lds
    s_mov_b64 exec, -1
    v_mfma_f32_16x16x32_bf16 v[60:63], v[32:35], v[240:243], v[60:63]
    ds_read_b64_tr_b16 v[26:27], v5 offset:13864
    s_waitcnt lgkmcnt(6)
    v_mfma_f32_16x16x32_bf16 v[64:67], v[36:39], v[168:171], v[64:67]
    ds_read_b64_tr_b16 v[28:29], v5 offset:9288
    v_mfma_f32_16x16x32_bf16 v[68:71], v[36:39], v[240:243], v[68:71]
    ds_read_b64_tr_b16 v[30:31], v5 offset:13896
    s_waitcnt lgkmcnt(6)
    v_mfma_f32_16x16x32_bf16 v[72:75], v[16:19], v[168:171], v[72:75]
    ds_read_b64_tr_b16 v[32:33], v5 offset:9328
    ds_read_b64_tr_b16 v[34:35], v5 offset:13936
    s_waitcnt lgkmcnt(6)
    v_mfma_f32_16x16x32_bf16 v[40:43], v[20:23], v[172:175], v[40:43]
    ds_read_b64_tr_b16 v[36:37], v8 offset:9216
    v_mfma_f32_16x16x32_bf16 v[44:47], v[20:23], v[244:247], v[44:47]
    ds_read_b64_tr_b16 v[38:39], v8 offset:13824
    s_waitcnt lgkmcnt(6)
    v_mfma_f32_16x16x32_bf16 v[48:51], v[24:27], v[172:175], v[48:51]
    v_mfma_f32_16x16x32_bf16 v[52:55], v[24:27], v[244:247], v[52:55]
    s_waitcnt lgkmcnt(4)
    v_mfma_f32_16x16x32_bf16 v[56:59], v[28:31], v[172:175], v[56:59]
    v_mfma_f32_16x16x32_bf16 v[60:63], v[28:31], v[244:247], v[60:63]
    s_waitcnt lgkmcnt(2)
    v_mfma_f32_16x16x32_bf16 v[64:67], v[32:35], v[172:175], v[64:67]
    v_mfma_f32_16x16x32_bf16 v[68:71], v[32:35], v[244:247], v[68:71]
    s_waitcnt lgkmcnt(0)
    v_mfma_f32_16x16x32_bf16 v[72:75], v[36:39], v[172:175], v[72:75]
    s_cmp_eq_u32 s54, 0
    s_cbranch_scc0 L_pp_k1
    v_cvt_pk_bf16_f32 v40, v40, v41
    v_cvt_pk_bf16_f32 v41, v42, v43
    v_cvt_pk_bf16_f32 v42, v44, v45
    v_cvt_pk_bf16_f32 v43, v46, v47
    v_cvt_pk_bf16_f32 v48, v48, v49
    v_cvt_pk_bf16_f32 v49, v50, v51
    v_cvt_pk_bf16_f32 v50, v52, v53
    v_cvt_pk_bf16_f32 v51, v54, v55
    v_cvt_pk_bf16_f32 v56, v56, v57
    v_cvt_pk_bf16_f32 v57, v58, v59
    v_cvt_pk_bf16_f32 v58, v60, v61
    v_cvt_pk_bf16_f32 v59, v62, v63
    v_cvt_pk_bf16_f32 v64, v64, v65
    v_cvt_pk_bf16_f32 v65, v66, v67
    v_cvt_pk_bf16_f32 v66, v68, v69
    v_cvt_pk_bf16_f32 v67, v70, v71
    s_branch L_pp_kx
L_pp_k1:
    s_nop 7
    v_cvt_pk_bf16_f32 v43, v42, v43
    v_cvt_pk_bf16_f32 v42, v40, v41
    v_cvt_pk_bf16_f32 v40, v44, v45
    v_cvt_pk_bf16_f32 v41, v46, v47
    v_cvt_pk_bf16_f32 v51, v50, v51
    v_cvt_pk_bf16_f32 v50, v48, v49
    v_cvt_pk_bf16_f32 v48, v52, v53
    v_cvt_pk_bf16_f32 v49, v54, v55
    v_cvt_pk_bf16_f32 v59, v58, v59
    v_cvt_pk_bf16_f32 v58, v56, v57
    v_cvt_pk_bf16_f32 v56, v60, v61
    v_cvt_pk_bf16_f32 v57, v62, v63
    v_cvt_pk_bf16_f32 v67, v66, v67
    v_cvt_pk_bf16_f32 v66, v64, v65
    v_cvt_pk_bf16_f32 v64, v68, v69
    v_cvt_pk_bf16_f32 v65, v70, v71
L_pp_kx:
    s_add_u32 s57, s67, s66
    s_add_u32 s57, s57, 54525952
    buffer_store_dwordx4 v[40:43], v2, s[36:39], s57 offen sc1
    s_add_u32 s57, s67, s66
    s_add_u32 s57, s57, 54591488
    buffer_store_dwordx4 v[48:51], v2, s[36:39], s57 offen sc1
    s_add_u32 s57, s67, s66
    s_add_u32 s57, s57, 54657024
    buffer_store_dwordx4 v[56:59], v2, s[36:39], s57 offen sc1
    s_add_u32 s57, s67, s66
    s_add_u32 s57, s57, 54722560
    buffer_store_dwordx4 v[64:67], v2, s[36:39], s57 offen sc1
    v_cvt_pk_bf16_f32 v72, v72, v73
    v_cvt_pk_bf16_f32 v73, v74, v75
    s_lshl_b32 s57, s64, 9
    s_lshl_b32 s58, s56, 16
    s_add_u32 s57, s57, s58
    s_add_u32 s57, s57, 58720256
    buffer_store_dwordx2 v[72:73], v80, s[36:39], s57 offen sc1
    s_waitcnt vmcnt(20)
    s_barrier
    ds_read_b64_tr_b16 v[16:17], v5 offset:18432
    ds_read_b64_tr_b16 v[18:19], v5 offset:23040
    ds_read_b64_tr_b16 v[20:21], v5 offset:18472
    ds_read_b64_tr_b16 v[22:23], v5 offset:23080
    ds_read_b64_tr_b16 v[24:25], v5 offset:18504
    ds_read_b64_tr_b16 v[26:27], v5 offset:23112
    ds_read_b64_tr_b16 v[28:29], v5 offset:18544
    ds_read_b64_tr_b16 v[30:31], v5 offset:23152
    s_waitcnt lgkmcnt(6)
    v_mfma_f32_16x16x32_bf16 v[40:43], v[104:107], v[16:19], 0
    ds_read_b64_tr_b16 v[32:33], v8 offset:18432
    s_add_u32 m0, s61, 129024
    s_add_u32 s60, s62, 1329408
    buffer_load_dwordx4 v3, s[28:31], s60 offen lds
    v_mfma_f32_16x16x32_bf16 v[44:47], v[176:179], v[16:19], 0
    ds_read_b64_tr_b16 v[34:35], v8 offset:23040
    s_waitcnt lgkmcnt(6)
    v_mfma_f32_16x16x32_bf16 v[48:51], v[104:107], v[20:23], 0
    ds_read_b64_tr_b16 v[36:37], v5 offset:27648
    v_mfma_f32_16x16x32_bf16 v[52:55], v[176:179], v[20:23], 0
    ds_read_b64_tr_b16 v[38:39], v5 offset:32256
    s_waitcnt lgkmcnt(6)
    v_mfma_f32_16x16x32_bf16 v[56:59], v[104:107], v[24:27], 0
    ds_read_b64_tr_b16 v[16:17], v5 offset:27688
    s_add_u32 m0, s61, 130048
    s_add_u32 s60, s62, 1329408
    buffer_load_dwordx4 v4, s[28:31], s60 offen lds
    v_mfma_f32_16x16x32_bf16 v[60:63], v[176:179], v[24:27], 0
    ds_read_b64_tr_b16 v[18:19], v5 offset:32296
    s_waitcnt lgkmcnt(6)
    v_mfma_f32_16x16x32_bf16 v[64:67], v[104:107], v[28:31], 0
    ds_read_b64_tr_b16 v[20:21], v5 offset:27720
    v_mfma_f32_16x16x32_bf16 v[68:71], v[176:179], v[28:31], 0
    ds_read_b64_tr_b16 v[22:23], v5 offset:32328
    s_waitcnt lgkmcnt(6)
    v_mfma_f32_16x16x32_bf16 v[72:75], v[104:107], v[32:35], 0
    ds_read_b64_tr_b16 v[24:25], v5 offset:27760
    ds_read_b64_tr_b16 v[26:27], v5 offset:32368
    s_add_u32 m0, s61, 131072
    s_add_u32 s60, s62, 1329408
    s_mov_b64 exec, 0xffff
    buffer_load_dwordx4 v76, s[28:31], s60 offen lds
    s_mov_b64 exec, -1
    s_waitcnt lgkmcnt(6)
    v_mfma_f32_16x16x32_bf16 v[40:43], v[108:111], v[36:39], v[40:43]
    ds_read_b64_tr_b16 v[28:29], v8 offset:27648
    v_mfma_f32_16x16x32_bf16 v[44:47], v[180:183], v[36:39], v[44:47]
    ds_read_b64_tr_b16 v[30:31], v8 offset:32256
    s_waitcnt lgkmcnt(6)
    v_mfma_f32_16x16x32_bf16 v[48:51], v[108:111], v[16:19], v[48:51]
    s_waitcnt vmcnt(20)
    s_barrier
    ds_read_b64_tr_b16 v[32:33], v5 offset:36864
    v_mfma_f32_16x16x32_bf16 v[52:55], v[180:183], v[16:19], v[52:55]
    ds_read_b64_tr_b16 v[34:35], v5 offset:41472
    s_waitcnt lgkmcnt(6)
    v_mfma_f32_16x16x32_bf16 v[56:59], v[108:111], v[20:23], v[56:59]
    ds_read_b64_tr_b16 v[36:37], v5 offset:36904
    v_mfma_f32_16x16x32_bf16 v[60:63], v[180:183], v[20:23], v[60:63]
    ds_read_b64_tr_b16 v[38:39], v5 offset:41512
    s_waitcnt lgkmcnt(6)
    v_mfma_f32_16x16x32_bf16 v[64:67], v[108:111], v[24:27], v[64:67]
    ds_read_b64_tr_b16 v[16:17], v5 offset:36936
    s_add_u32 m0, s61, 0
    s_add_u32 s60, s62, 1550592
    buffer_load_dwordx4 v3, s[28:31], s60 offen lds
    v_mfma_f32_16x16x32_bf16 v[68:71], v[180:183], v[24:27], v[68:71]
    ds_read_b64_tr_b16 v[18:19], v5 offset:41544
    s_waitcnt lgkmcnt(6)
    v_mfma_f32_16x16x32_bf16 v[72:75], v[108:111], v[28:31], v[72:75]
    ds_read_b64_tr_b16 v[20:21], v5 offset:36976
    ds_read_b64_tr_b16 v[22:23], v5 offset:41584
    s_waitcnt lgkmcnt(6)
    v_mfma_f32_16x16x32_bf16 v[40:43], v[112:115], v[32:35], v[40:43]
    ds_read_b64_tr_b16 v[24:25], v8 offset:36864
    s_add_u32 m0, s61, 1024
    s_add_u32 s60, s62, 1550592
    buffer_load_dwordx4 v4, s[28:31], s60 offen lds
    v_mfma_f32_16x16x32_bf16 v[44:47], v[184:187], v[32:35], v[44:47]
    ds_read_b64_tr_b16 v[26:27], v8 offset:41472
    s_waitcnt lgkmcnt(6)
    v_mfma_f32_16x16x32_bf16 v[48:51], v[112:115], v[36:39], v[48:51]
    ds_read_b64_tr_b16 v[28:29], v5 offset:46080
    v_mfma_f32_16x16x32_bf16 v[52:55], v[184:187], v[36:39], v[52:55]
    ds_read_b64_tr_b16 v[30:31], v5 offset:50688
    s_waitcnt lgkmcnt(6)
    v_mfma_f32_16x16x32_bf16 v[56:59], v[112:115], v[16:19], v[56:59]
    ds_read_b64_tr_b16 v[32:33], v5 offset:46120
    s_add_u32 m0, s61, 2048
    s_add_u32 s60, s62, 1550592
    s_mov_b64 exec, 0xffff
    buffer_load_dwordx4 v76, s[28:31], s60 offen lds
    s_mov_b64 exec, -1
    v_mfma_f32_16x16x32_bf16 v[60:63], v[184:187], v[16:19], v[60:63]
    ds_read_b64_tr_b16 v[34:35], v5 offset:50728
    s_waitcnt lgkmcnt(6)
    v_mfma_f32_16x16x32_bf16 v[64:67], v[112:115], v[20:23], v[64:67]
    ds_read_b64_tr_b16 v[36:37], v5 offset:46152
    v_mfma_f32_16x16x32_bf16 v[68:71], v[184:187], v[20:23], v[68:71]
    ds_read_b64_tr_b16 v[38:39], v5 offset:50760
    s_waitcnt lgkmcnt(6)
    v_mfma_f32_16x16x32_bf16 v[72:75], v[112:115], v[24:27], v[72:75]
    ds_read_b64_tr_b16 v[16:17], v5 offset:46192
    ds_read_b64_tr_b16 v[18:19], v5 offset:50800
    s_waitcnt lgkmcnt(6)
    v_mfma_f32_16x16x32_bf16 v[40:43], v[116:119], v[28:31], v[40:43]
    ds_read_b64_tr_b16 v[20:21], v8 offset:46080
    v_mfma_f32_16x16x32_bf16 v[44:47], v[188:191], v[28:31], v[44:47]
    ds_read_b64_tr_b16 v[22:23], v8 offset:50688
    s_waitcnt lgkmcnt(6)
    v_mfma_f32_16x16x32_bf16 v[48:51], v[116:119], v[32:35], v[48:51]
    s_waitcnt vmcnt(20)
    s_barrier
    ds_read_b64_tr_b16 v[24:25], v6 offset:6144
    v_mfma_f32_16x16x32_bf16 v[52:55], v[188:191], v[32:35], v[52:55]
    ds_read_b64_tr_b16 v[26:27], v6 offset:10752
    s_waitcnt lgkmcnt(6)
    v_mfma_f32_16x16x32_bf16 v[56:59], v[116:119], v[36:39], v[56:59]
    ds_read_b64_tr_b16 v[28:29], v6 offset:6184
    v_mfma_f32_16x16x32_bf16 v[60:63], v[188:191], v[36:39], v[60:63]
    ds_read_b64_tr_b16 v[30:31], v6 offset:10792
    s_waitcnt lgkmcnt(6)
    v_mfma_f32_16x16x32_bf16 v[64:67], v[116:119], v[16:19], v[64:67]
    ds_read_b64_tr_b16 v[32:33], v6 offset:6216
    s_add_u32 m0, s61, 18432
    s_add_u32 s60, s62, 1771776
    buffer_load_dwordx4 v3, s[28:31], s60 offen lds
    v_mfma_f32_16x16x32_bf16 v[68:71], v[188:191], v[16:19], v[68:71]
    ds_read_b64_tr_b16 v[34:35], v6 offset:10824
    s_waitcnt lgkmcnt(6)
    v_mfma_f32_16x16x32_bf16 v[72:75], v[116:119], v[20:23], v[72:75]
    ds_read_b64_tr_b16 v[36:37], v6 offset:6256
    ds_read_b64_tr_b16 v[38:39], v6 offset:10864
    s_waitcnt lgkmcnt(6)
    v_mfma_f32_16x16x32_bf16 v[40:43], v[120:123], v[24:27], v[40:43]
    ds_read_b64_tr_b16 v[16:17], v9 offset:6144
    s_add_u32 m0, s61, 19456
    s_add_u32 s60, s62, 1771776
    buffer_load_dwordx4 v4, s[28:31], s60 offen lds
    v_mfma_f32_16x16x32_bf16 v[44:47], v[192:195], v[24:27], v[44:47]
    ds_read_b64_tr_b16 v[18:19], v9 offset:10752
    s_waitcnt lgkmcnt(6)
    v_mfma_f32_16x16x32_bf16 v[48:51], v[120:123], v[28:31], v[48:51]
    ds_read_b64_tr_b16 v[20:21], v6 offset:15360
    v_mfma_f32_16x16x32_bf16 v[52:55], v[192:195], v[28:31], v[52:55]
    ds_read_b64_tr_b16 v[22:23], v6 offset:19968
    s_waitcnt lgkmcnt(6)
    v_mfma_f32_16x16x32_bf16 v[56:59], v[120:123], v[32:35], v[56:59]
    ds_read_b64_tr_b16 v[24:25], v6 offset:15400
    s_add_u32 m0, s61, 20480
    s_add_u32 s60, s62, 1771776
    s_mov_b64 exec, 0xffff
    buffer_load_dwordx4 v76, s[28:31], s60 offen lds
    s_mov_b64 exec, -1
    v_mfma_f32_16x16x32_bf16 v[60:63], v[192:195], v[32:35], v[60:63]
    ds_read_b64_tr_b16 v[26:27], v6 offset:20008
    s_waitcnt lgkmcnt(6)
    v_mfma_f32_16x16x32_bf16 v[64:67], v[120:123], v[36:39], v[64:67]
    ds_read_b64_tr_b16 v[28:29], v6 offset:15432
    v_mfma_f32_16x16x32_bf16 v[68:71], v[192:195], v[36:39], v[68:71]
    ds_read_b64_tr_b16 v[30:31], v6 offset:20040
    s_waitcnt lgkmcnt(6)
    v_mfma_f32_16x16x32_bf16 v[72:75], v[120:123], v[16:19], v[72:75]
    ds_read_b64_tr_b16 v[32:33], v6 offset:15472
    ds_read_b64_tr_b16 v[34:35], v6 offset:20080
    s_waitcnt lgkmcnt(6)
    v_mfma_f32_16x16x32_bf16 v[40:43], v[124:127], v[20:23], v[40:43]
    ds_read_b64_tr_b16 v[36:37], v9 offset:15360
    v_mfma_f32_16x16x32_bf16 v[44:47], v[196:199], v[20:23], v[44:47]
    ds_read_b64_tr_b16 v[38:39], v9 offset:19968
    s_waitcnt lgkmcnt(6)
    v_mfma_f32_16x16x32_bf16 v[48:51], v[124:127], v[24:27], v[48:51]
    s_waitcnt vmcnt(20)
    s_barrier
    ds_read_b64_tr_b16 v[16:17], v6 offset:24576
    v_mfma_f32_16x16x32_bf16 v[52:55], v[196:199], v[24:27], v[52:55]
    ds_read_b64_tr_b16 v[18:19], v6 offset:29184
    s_waitcnt lgkmcnt(6)
    v_mfma_f32_16x16x32_bf16 v[56:59], v[124:127], v[28:31], v[56:59]
    ds_read_b64_tr_b16 v[20:21], v6 offset:24616
    v_mfma_f32_16x16x32_bf16 v[60:63], v[196:199], v[28:31], v[60:63]
    ds_read_b64_tr_b16 v[22:23], v6 offset:29224
    s_waitcnt lgkmcnt(6)
    v_mfma_f32_16x16x32_bf16 v[64:67], v[124:127], v[32:35], v[64:67]
    ds_read_b64_tr_b16 v[24:25], v6 offset:24648
    s_add_u32 m0, s61, 36864
    s_add_u32 s60, s62, 0
    buffer_load_dwordx4 v3, s[28:31], s60 offen lds
    v_mfma_f32_16x16x32_bf16 v[68:71], v[196:199], v[32:35], v[68:71]
    ds_read_b64_tr_b16 v[26:27], v6 offset:29256
    s_waitcnt lgkmcnt(6)
    v_mfma_f32_16x16x32_bf16 v[72:75], v[124:127], v[36:39], v[72:75]
    ds_read_b64_tr_b16 v[28:29], v6 offset:24688
    ds_read_b64_tr_b16 v[30:31], v6 offset:29296
    s_waitcnt lgkmcnt(6)
    v_mfma_f32_16x16x32_bf16 v[40:43], v[128:131], v[16:19], v[40:43]
    ds_read_b64_tr_b16 v[32:33], v9 offset:24576
    s_add_u32 m0, s61, 37888
    s_add_u32 s60, s62, 0
    buffer_load_dwordx4 v4, s[28:31], s60 offen lds
    v_mfma_f32_16x16x32_bf16 v[44:47], v[200:203], v[16:19], v[44:47]
    ds_read_b64_tr_b16 v[34:35], v9 offset:29184
    s_waitcnt lgkmcnt(6)
    v_mfma_f32_16x16x32_bf16 v[48:51], v[128:131], v[20:23], v[48:51]
    ds_read_b64_tr_b16 v[36:37], v6 offset:33792
    v_mfma_f32_16x16x32_bf16 v[52:55], v[200:203], v[20:23], v[52:55]
    ds_read_b64_tr_b16 v[38:39], v6 offset:38400
    s_waitcnt lgkmcnt(6)
    v_mfma_f32_16x16x32_bf16 v[56:59], v[128:131], v[24:27], v[56:59]
    ds_read_b64_tr_b16 v[16:17], v6 offset:33832
    s_add_u32 m0, s61, 38912
    s_add_u32 s60, s62, 0
    s_mov_b64 exec, 0xffff
    buffer_load_dwordx4 v76, s[28:31], s60 offen lds
    s_mov_b64 exec, -1
    v_mfma_f32_16x16x32_bf16 v[60:63], v[200:203], v[24:27], v[60:63]
    ds_read_b64_tr_b16 v[18:19], v6 offset:38440
    s_waitcnt lgkmcnt(6)
    v_mfma_f32_16x16x32_bf16 v[64:67], v[128:131], v[28:31], v[64:67]
    ds_read_b64_tr_b16 v[20:21], v6 offset:33864
    v_mfma_f32_16x16x32_bf16 v[68:71], v[200:203], v[28:31], v[68:71]
    ds_read_b64_tr_b16 v[22:23], v6 offset:38472
    s_waitcnt lgkmcnt(6)
    v_mfma_f32_16x16x32_bf16 v[72:75], v[128:131], v[32:35], v[72:75]
    ds_read_b64_tr_b16 v[24:25], v6 offset:33904
    ds_read_b64_tr_b16 v[26:27], v6 offset:38512
    s_waitcnt lgkmcnt(6)
    v_mfma_f32_16x16x32_bf16 v[40:43], v[132:135], v[36:39], v[40:43]
    ds_read_b64_tr_b16 v[28:29], v9 offset:33792
    v_mfma_f32_16x16x32_bf16 v[44:47], v[204:207], v[36:39], v[44:47]
    ds_read_b64_tr_b16 v[30:31], v9 offset:38400
    s_waitcnt lgkmcnt(6)
    v_mfma_f32_16x16x32_bf16 v[48:51], v[132:135], v[16:19], v[48:51]
    s_waitcnt vmcnt(20)
    s_barrier
    ds_read_b64_tr_b16 v[32:33], v6 offset:43008
    v_mfma_f32_16x16x32_bf16 v[52:55], v[204:207], v[16:19], v[52:55]
    ds_read_b64_tr_b16 v[34:35], v6 offset:47616
    s_waitcnt lgkmcnt(6)
    v_mfma_f32_16x16x32_bf16 v[56:59], v[132:135], v[20:23], v[56:59]
    ds_read_b64_tr_b16 v[36:37], v6 offset:43048
    v_mfma_f32_16x16x32_bf16 v[60:63], v[204:207], v[20:23], v[60:63]
    ds_read_b64_tr_b16 v[38:39], v6 offset:47656
    s_waitcnt lgkmcnt(6)
    v_mfma_f32_16x16x32_bf16 v[64:67], v[132:135], v[24:27], v[64:67]
    ds_read_b64_tr_b16 v[16:17], v6 offset:43080
    s_add_u32 m0, s61, 55296
    s_add_u32 s60, s62, 221184
    buffer_load_dwordx4 v3, s[28:31], s60 offen lds
    v_mfma_f32_16x16x32_bf16 v[68:71], v[204:207], v[24:27], v[68:71]
    ds_read_b64_tr_b16 v[18:19], v6 offset:47688
    s_waitcnt lgkmcnt(6)
    v_mfma_f32_16x16x32_bf16 v[72:75], v[132:135], v[28:31], v[72:75]
    ds_read_b64_tr_b16 v[20:21], v6 offset:43120
    ds_read_b64_tr_b16 v[22:23], v6 offset:47728
    s_waitcnt lgkmcnt(6)
    v_mfma_f32_16x16x32_bf16 v[40:43], v[136:139], v[32:35], v[40:43]
    ds_read_b64_tr_b16 v[24:25], v9 offset:43008
    s_add_u32 m0, s61, 56320
    s_add_u32 s60, s62, 221184
    buffer_load_dwordx4 v4, s[28:31], s60 offen lds
    v_mfma_f32_16x16x32_bf16 v[44:47], v[208:211], v[32:35], v[44:47]
    ds_read_b64_tr_b16 v[26:27], v9 offset:47616
    s_waitcnt lgkmcnt(6)
    v_mfma_f32_16x16x32_bf16 v[48:51], v[136:139], v[36:39], v[48:51]
    ds_read_b64_tr_b16 v[28:29], v7 offset:3072
    v_mfma_f32_16x16x32_bf16 v[52:55], v[208:211], v[36:39], v[52:55]
    ds_read_b64_tr_b16 v[30:31], v7 offset:7680
    s_waitcnt lgkmcnt(6)
    v_mfma_f32_16x16x32_bf16 v[56:59], v[136:139], v[16:19], v[56:59]
    ds_read_b64_tr_b16 v[32:33], v7 offset:3112
    s_add_u32 m0, s61, 57344
    s_add_u32 s60, s62, 221184
    s_mov_b64 exec, 0xffff
    buffer_load_dwordx4 v76, s[28:31], s60 offen lds
    s_mov_b64 exec, -1
    v_mfma_f32_16x16x32_bf16 v[60:63], v[208:211], v[16:19], v[60:63]
    ds_read_b64_tr_b16 v[34:35], v7 offset:7720
    s_waitcnt lgkmcnt(6)
    v_mfma_f32_16x16x32_bf16 v[64:67], v[136:139], v[20:23], v[64:67]
    ds_read_b64_tr_b16 v[36:37], v7 offset:3144
    v_mfma_f32_16x16x32_bf16 v[68:71], v[208:211], v[20:23], v[68:71]
    ds_read_b64_tr_b16 v[38:39], v7 offset:7752
    s_waitcnt lgkmcnt(6)
    v_mfma_f32_16x16x32_bf16 v[72:75], v[136:139], v[24:27], v[72:75]
    ds_read_b64_tr_b16 v[16:17], v7 offset:3184
    ds_read_b64_tr_b16 v[18:19], v7 offset:7792
    s_waitcnt lgkmcnt(6)
    v_mfma_f32_16x16x32_bf16 v[40:43], v[140:143], v[28:31], v[40:43]
    ds_read_b64_tr_b16 v[20:21], v10 offset:3072
    v_mfma_f32_16x16x32_bf16 v[44:47], v[212:215], v[28:31], v[44:47]
    ds_read_b64_tr_b16 v[22:23], v10 offset:7680
    s_waitcnt lgkmcnt(6)
    v_mfma_f32_16x16x32_bf16 v[48:51], v[140:143], v[32:35], v[48:51]
    s_waitcnt vmcnt(20)
    s_barrier
    ds_read_b64_tr_b16 v[24:25], v7 offset:12288
    v_mfma_f32_16x16x32_bf16 v[52:55], v[212:215], v[32:35], v[52:55]
    ds_read_b64_tr_b16 v[26:27], v7 offset:16896
    s_waitcnt lgkmcnt(6)
    v_mfma_f32_16x16x32_bf16 v[56:59], v[140:143], v[36:39], v[56:59]
    ds_read_b64_tr_b16 v[28:29], v7 offset:12328
    v_mfma_f32_16x16x32_bf16 v[60:63], v[212:215], v[36:39], v[60:63]
    ds_read_b64_tr_b16 v[30:31], v7 offset:16936
    s_waitcnt lgkmcnt(6)
    v_mfma_f32_16x16x32_bf16 v[64:67], v[140:143], v[16:19], v[64:67]
    ds_read_b64_tr_b16 v[32:33], v7 offset:12360
    s_add_u32 m0, s61, 73728
    s_add_u32 s60, s62, 442368
    buffer_load_dwordx4 v3, s[28:31], s60 offen lds
    v_mfma_f32_16x16x32_bf16 v[68:71], v[212:215], v[16:19], v[68:71]
    ds_read_b64_tr_b16 v[34:35], v7 offset:16968
    s_waitcnt lgkmcnt(6)
    v_mfma_f32_16x16x32_bf16 v[72:75], v[140:143], v[20:23], v[72:75]
    ds_read_b64_tr_b16 v[36:37], v7 offset:12400
    ds_read_b64_tr_b16 v[38:39], v7 offset:17008
    s_waitcnt lgkmcnt(6)
    v_mfma_f32_16x16x32_bf16 v[40:43], v[144:147], v[24:27], v[40:43]
    ds_read_b64_tr_b16 v[16:17], v10 offset:12288
    s_add_u32 m0, s61, 74752
    s_add_u32 s60, s62, 442368
    buffer_load_dwordx4 v4, s[28:31], s60 offen lds
    v_mfma_f32_16x16x32_bf16 v[44:47], v[216:219], v[24:27], v[44:47]
    ds_read_b64_tr_b16 v[18:19], v10 offset:16896
    s_waitcnt lgkmcnt(6)
    v_mfma_f32_16x16x32_bf16 v[48:51], v[144:147], v[28:31], v[48:51]
    ds_read_b64_tr_b16 v[20:21], v7 offset:21504
    v_mfma_f32_16x16x32_bf16 v[52:55], v[216:219], v[28:31], v[52:55]
    ds_read_b64_tr_b16 v[22:23], v7 offset:26112
    s_waitcnt lgkmcnt(6)
    v_mfma_f32_16x16x32_bf16 v[56:59], v[144:147], v[32:35], v[56:59]
    ds_read_b64_tr_b16 v[24:25], v7 offset:21544
    s_add_u32 m0, s61, 75776
    s_add_u32 s60, s62, 442368
    s_mov_b64 exec, 0xffff
    buffer_load_dwordx4 v76, s[28:31], s60 offen lds
    s_mov_b64 exec, -1
    v_mfma_f32_16x16x32_bf16 v[60:63], v[216:219], v[32:35], v[60:63]
    ds_read_b64_tr_b16 v[26:27], v7 offset:26152
    s_waitcnt lgkmcnt(6)
    v_mfma_f32_16x16x32_bf16 v[64:67], v[144:147], v[36:39], v[64:67]
    ds_read_b64_tr_b16 v[28:29], v7 offset:21576
    v_mfma_f32_16x16x32_bf16 v[68:71], v[216:219], v[36:39], v[68:71]
    ds_read_b64_tr_b16 v[30:31], v7 offset:26184
    s_waitcnt lgkmcnt(6)
    v_mfma_f32_16x16x32_bf16 v[72:75], v[144:147], v[16:19], v[72:75]
    ds_read_b64_tr_b16 v[32:33], v7 offset:21616
    ds_read_b64_tr_b16 v[34:35], v7 offset:26224
    s_waitcnt lgkmcnt(6)
    v_mfma_f32_16x16x32_bf16 v[40:43], v[148:151], v[20:23], v[40:43]
    ds_read_b64_tr_b16 v[36:37], v10 offset:21504
    v_mfma_f32_16x16x32_bf16 v[44:47], v[220:223], v[20:23], v[44:47]
    ds_read_b64_tr_b16 v[38:39], v10 offset:26112
    s_waitcnt lgkmcnt(6)
    v_mfma_f32_16x16x32_bf16 v[48:51], v[148:151], v[24:27], v[48:51]
    s_waitcnt vmcnt(15)
    s_barrier
    ds_read_b64_tr_b16 v[16:17], v7 offset:30720
    v_mfma_f32_16x16x32_bf16 v[52:55], v[220:223], v[24:27], v[52:55]
    ds_read_b64_tr_b16 v[18:19], v7 offset:35328
    s_waitcnt lgkmcnt(6)
    v_mfma_f32_16x16x32_bf16 v[56:59], v[148:151], v[28:31], v[56:59]
    ds_read_b64_tr_b16 v[20:21], v7 offset:30760
    v_mfma_f32_16x16x32_bf16 v[60:63], v[220:223], v[28:31], v[60:63]
    ds_read_b64_tr_b16 v[22:23], v7 offset:35368
    s_waitcnt lgkmcnt(6)
    v_mfma_f32_16x16x32_bf16 v[64:67], v[148:151], v[32:35], v[64:67]
    ds_read_b64_tr_b16 v[24:25], v7 offset:30792
    s_add_u32 m0, s61, 92160
    s_add_u32 s60, s62, 663552
    buffer_load_dwordx4 v3, s[28:31], s60 offen lds
    v_mfma_f32_16x16x32_bf16 v[68:71], v[220:223], v[32:35], v[68:71]
    ds_read_b64_tr_b16 v[26:27], v7 offset:35400
    s_waitcnt lgkmcnt(6)
    v_mfma_f32_16x16x32_bf16 v[72:75], v[148:151], v[36:39], v[72:75]
    ds_read_b64_tr_b16 v[28:29], v7 offset:30832
    ds_read_b64_tr_b16 v[30:31], v7 offset:35440
    s_waitcnt lgkmcnt(6)
    v_mfma_f32_16x16x32_bf16 v[40:43], v[152:155], v[16:19], v[40:43]
    ds_read_b64_tr_b16 v[32:33], v10 offset:30720
    s_add_u32 m0, s61, 93184
    s_add_u32 s60, s62, 663552
    buffer_load_dwordx4 v4, s[28:31], s60 offen lds
    v_mfma_f32_16x16x32_bf16 v[44:47], v[224:227], v[16:19], v[44:47]
    ds_read_b64_tr_b16 v[34:35], v10 offset:35328
    s_waitcnt lgkmcnt(6)
    v_mfma_f32_16x16x32_bf16 v[48:51], v[152:155], v[20:23], v[48:51]
    ds_read_b64_tr_b16 v[36:37], v7 offset:39936
    v_mfma_f32_16x16x32_bf16 v[52:55], v[224:227], v[20:23], v[52:55]
    ds_read_b64_tr_b16 v[38:39], v7 offset:44544
    s_waitcnt lgkmcnt(6)
    v_mfma_f32_16x16x32_bf16 v[56:59], v[152:155], v[24:27], v[56:59]
    ds_read_b64_tr_b16 v[16:17], v7 offset:39976
    s_add_u32 m0, s61, 94208
    s_add_u32 s60, s62, 663552
    s_mov_b64 exec, 0xffff
    buffer_load_dwordx4 v76, s[28:31], s60 offen lds
    s_mov_b64 exec, -1
    v_mfma_f32_16x16x32_bf16 v[60:63], v[224:227], v[24:27], v[60:63]
    ds_read_b64_tr_b16 v[18:19], v7 offset:44584
    s_waitcnt lgkmcnt(6)
    v_mfma_f32_16x16x32_bf16 v[64:67], v[152:155], v[28:31], v[64:67]
    ds_read_b64_tr_b16 v[20:21], v7 offset:40008
    v_mfma_f32_16x16x32_bf16 v[68:71], v[224:227], v[28:31], v[68:71]
    ds_read_b64_tr_b16 v[22:23], v7 offset:44616
    s_waitcnt lgkmcnt(6)
    v_mfma_f32_16x16x32_bf16 v[72:75], v[152:155], v[32:35], v[72:75]
    ds_read_b64_tr_b16 v[24:25], v7 offset:40048
    ds_read_b64_tr_b16 v[26:27], v7 offset:44656
    s_waitcnt lgkmcnt(6)
    v_mfma_f32_16x16x32_bf16 v[40:43], v[156:159], v[36:39], v[40:43]
    ds_read_b64_tr_b16 v[28:29], v10 offset:39936
    v_mfma_f32_16x16x32_bf16 v[44:47], v[228:231], v[36:39], v[44:47]
    ds_read_b64_tr_b16 v[30:31], v10 offset:44544
    s_waitcnt lgkmcnt(6)
    v_mfma_f32_16x16x32_bf16 v[48:51], v[156:159], v[16:19], v[48:51]
    s_waitcnt vmcnt(15)
    s_barrier
    ds_read_b64_tr_b16 v[32:33], v5 offset:0
    v_mfma_f32_16x16x32_bf16 v[52:55], v[228:231], v[16:19], v[52:55]
    ds_read_b64_tr_b16 v[34:35], v5 offset:4608
    s_waitcnt lgkmcnt(6)
    v_mfma_f32_16x16x32_bf16 v[56:59], v[156:159], v[20:23], v[56:59]
    ds_read_b64_tr_b16 v[36:37], v5 offset:40
    v_mfma_f32_16x16x32_bf16 v[60:63], v[228:231], v[20:23], v[60:63]
    ds_read_b64_tr_b16 v[38:39], v5 offset:4648
    s_waitcnt lgkmcnt(6)
    v_mfma_f32_16x16x32_bf16 v[64:67], v[156:159], v[24:27], v[64:67]
    ds_read_b64_tr_b16 v[16:17], v5 offset:72
    s_add_u32 m0, s61, 110592
    s_add_u32 s60, s62, 884736
    buffer_load_dwordx4 v3, s[28:31], s60 offen lds
    v_mfma_f32_16x16x32_bf16 v[68:71], v[228:231], v[24:27], v[68:71]
    ds_read_b64_tr_b16 v[18:19], v5 offset:4680
    s_waitcnt lgkmcnt(6)
    v_mfma_f32_16x16x32_bf16 v[72:75], v[156:159], v[28:31], v[72:75]
    ds_read_b64_tr_b16 v[20:21], v5 offset:112
    ds_read_b64_tr_b16 v[22:23], v5 offset:4720
    s_waitcnt lgkmcnt(6)
    v_mfma_f32_16x16x32_bf16 v[40:43], v[160:163], v[32:35], v[40:43]
    ds_read_b64_tr_b16 v[24:25], v8 offset:0
    s_add_u32 m0, s61, 111616
    s_add_u32 s60, s62, 884736
    buffer_load_dwordx4 v4, s[28:31], s60 offen lds
    v_mfma_f32_16x16x32_bf16 v[44:47], v[232:235], v[32:35], v[44:47]
    ds_read_b64_tr_b16 v[26:27], v8 offset:4608
    s_waitcnt lgkmcnt(6)
    v_mfma_f32_16x16x32_bf16 v[48:51], v[160:163], v[36:39], v[48:51]
    ds_read_b64_tr_b16 v[28:29], v5 offset:9216
    v_mfma_f32_16x16x32_bf16 v[52:55], v[232:235], v[36:39], v[52:55]
    ds_read_b64_tr_b16 v[30:31], v5 offset:13824
    s_waitcnt lgkmcnt(6)
    v_mfma_f32_16x16x32_bf16 v[56:59], v[160:163], v[16:19], v[56:59]
    ds_read_b64_tr_b16 v[32:33], v5 offset:9256
    s_add_u32 m0, s61, 112640
    s_add_u32 s60, s62, 884736
    s_mov_b64 exec, 0xffff
    buffer_load_dwordx4 v76, s[28:31], s60 offen lds
    s_mov_b64 exec, -1
    v_mfma_f32_16x16x32_bf16 v[60:63], v[232:235], v[16:19], v[60:63]
    ds_read_b64_tr_b16 v[34:35], v5 offset:13864
    s_waitcnt lgkmcnt(6)
    v_mfma_f32_16x16x32_bf16 v[64:67], v[160:163], v[20:23], v[64:67]
    ds_read_b64_tr_b16 v[36:37], v5 offset:9288
    v_mfma_f32_16x16x32_bf16 v[68:71], v[232:235], v[20:23], v[68:71]
    ds_read_b64_tr_b16 v[38:39], v5 offset:13896
    s_waitcnt lgkmcnt(6)
    v_mfma_f32_16x16x32_bf16 v[72:75], v[160:163], v[24:27], v[72:75]
    ds_read_b64_tr_b16 v[16:17], v5 offset:9328
    ds_read_b64_tr_b16 v[18:19], v5 offset:13936
    s_waitcnt lgkmcnt(6)
    v_mfma_f32_16x16x32_bf16 v[40:43], v[164:167], v[28:31], v[40:43]
    ds_read_b64_tr_b16 v[20:21], v8 offset:9216
    v_mfma_f32_16x16x32_bf16 v[44:47], v[236:239], v[28:31], v[44:47]
    ds_read_b64_tr_b16 v[22:23], v8 offset:13824
    s_waitcnt lgkmcnt(6)
    v_mfma_f32_16x16x32_bf16 v[48:51], v[164:167], v[32:35], v[48:51]
    s_waitcnt vmcnt(15)
    s_barrier
    ds_read_b64_tr_b16 v[24:25], v5 offset:18432
    v_mfma_f32_16x16x32_bf16 v[52:55], v[236:239], v[32:35], v[52:55]
    ds_read_b64_tr_b16 v[26:27], v5 offset:23040
    s_waitcnt lgkmcnt(6)
    v_mfma_f32_16x16x32_bf16 v[56:59], v[164:167], v[36:39], v[56:59]
    ds_read_b64_tr_b16 v[28:29], v5 offset:18472
    v_mfma_f32_16x16x32_bf16 v[60:63], v[236:239], v[36:39], v[60:63]
    ds_read_b64_tr_b16 v[30:31], v5 offset:23080
    s_waitcnt lgkmcnt(6)
    v_mfma_f32_16x16x32_bf16 v[64:67], v[164:167], v[16:19], v[64:67]
    ds_read_b64_tr_b16 v[32:33], v5 offset:18504
    s_add_u32 m0, s61, 129024
    s_add_u32 s60, s62, 1105920
    buffer_load_dwordx4 v3, s[28:31], s60 offen lds
    v_mfma_f32_16x16x32_bf16 v[68:71], v[236:239], v[16:19], v[68:71]
    ds_read_b64_tr_b16 v[34:35], v5 offset:23112
    s_waitcnt lgkmcnt(6)
    v_mfma_f32_16x16x32_bf16 v[72:75], v[164:167], v[20:23], v[72:75]
    ds_read_b64_tr_b16 v[36:37], v5 offset:18544
    ds_read_b64_tr_b16 v[38:39], v5 offset:23152
    s_waitcnt lgkmcnt(6)
    v_mfma_f32_16x16x32_bf16 v[40:43], v[168:171], v[24:27], v[40:43]
    ds_read_b64_tr_b16 v[16:17], v8 offset:18432
    s_add_u32 m0, s61, 130048
    s_add_u32 s60, s62, 1105920
    buffer_load_dwordx4 v4, s[28:31], s60 offen lds
    v_mfma_f32_16x16x32_bf16 v[44:47], v[240:243], v[24:27], v[44:47]
    ds_read_b64_tr_b16 v[18:19], v8 offset:23040
    s_waitcnt lgkmcnt(6)
    v_mfma_f32_16x16x32_bf16 v[48:51], v[168:171], v[28:31], v[48:51]
    ds_read_b64_tr_b16 v[20:21], v5 offset:27648
    v_mfma_f32_16x16x32_bf16 v[52:55], v[240:243], v[28:31], v[52:55]
    ds_read_b64_tr_b16 v[22:23], v5 offset:32256
    s_waitcnt lgkmcnt(6)
    v_mfma_f32_16x16x32_bf16 v[56:59], v[168:171], v[32:35], v[56:59]
    ds_read_b64_tr_b16 v[24:25], v5 offset:27688
    s_add_u32 m0, s61, 131072
    s_add_u32 s60, s62, 1105920
    s_mov_b64 exec, 0xffff
    buffer_load_dwordx4 v76, s[28:31], s60 offen lds
    s_mov_b64 exec, -1
    v_mfma_f32_16x16x32_bf16 v[60:63], v[240:243], v[32:35], v[60:63]
    ds_read_b64_tr_b16 v[26:27], v5 offset:32296
    s_waitcnt lgkmcnt(6)
    v_mfma_f32_16x16x32_bf16 v[64:67], v[168:171], v[36:39], v[64:67]
    ds_read_b64_tr_b16 v[28:29], v5 offset:27720
    v_mfma_f32_16x16x32_bf16 v[68:71], v[240:243], v[36:39], v[68:71]
    ds_read_b64_tr_b16 v[30:31], v5 offset:32328
    s_waitcnt lgkmcnt(6)
    v_mfma_f32_16x16x32_bf16 v[72:75], v[168:171], v[16:19], v[72:75]
    ds_read_b64_tr_b16 v[32:33], v5 offset:27760
    ds_read_b64_tr_b16 v[34:35], v5 offset:32368
    s_waitcnt lgkmcnt(6)
    v_mfma_f32_16x16x32_bf16 v[40:43], v[172:175], v[20:23], v[40:43]
    ds_read_b64_tr_b16 v[36:37], v8 offset:27648
    v_mfma_f32_16x16x32_bf16 v[44:47], v[244:247], v[20:23], v[44:47]
    ds_read_b64_tr_b16 v[38:39], v8 offset:32256
    s_waitcnt lgkmcnt(6)
    v_mfma_f32_16x16x32_bf16 v[48:51], v[172:175], v[24:27], v[48:51]
    v_mfma_f32_16x16x32_bf16 v[52:55], v[244:247], v[24:27], v[52:55]
    s_waitcnt lgkmcnt(4)
    v_mfma_f32_16x16x32_bf16 v[56:59], v[172:175], v[28:31], v[56:59]
    v_mfma_f32_16x16x32_bf16 v[60:63], v[244:247], v[28:31], v[60:63]
    s_waitcnt lgkmcnt(2)
    v_mfma_f32_16x16x32_bf16 v[64:67], v[172:175], v[32:35], v[64:67]
    v_mfma_f32_16x16x32_bf16 v[68:71], v[244:247], v[32:35], v[68:71]
    s_waitcnt lgkmcnt(0)
    v_mfma_f32_16x16x32_bf16 v[72:75], v[172:175], v[36:39], v[72:75]
    s_cmp_eq_u32 s54, 0
    s_cbranch_scc0 L_pp_v1
    v_cvt_pk_bf16_f32 v40, v40, v41
    v_cvt_pk_bf16_f32 v41, v42, v43
    v_cvt_pk_bf16_f32 v42, v44, v45
    v_cvt_pk_bf16_f32 v43, v46, v47
    v_cvt_pk_bf16_f32 v48, v48, v49
    v_cvt_pk_bf16_f32 v49, v50, v51
    v_cvt_pk_bf16_f32 v50, v52, v53
    v_cvt_pk_bf16_f32 v51, v54, v55
    v_cvt_pk_bf16_f32 v56, v56, v57
    v_cvt_pk_bf16_f32 v57, v58, v59
    v_cvt_pk_bf16_f32 v58, v60, v61
    v_cvt_pk_bf16_f32 v59, v62, v63
    v_cvt_pk_bf16_f32 v64, v64, v65
    v_cvt_pk_bf16_f32 v65, v66, v67
    v_cvt_pk_bf16_f32 v66, v68, v69
    v_cvt_pk_bf16_f32 v67, v70, v71
    s_branch L_pp_vx
L_pp_v1:
    s_nop 7
    v_cvt_pk_bf16_f32 v43, v42, v43
    v_cvt_pk_bf16_f32 v42, v40, v41
    v_cvt_pk_bf16_f32 v40, v44, v45
    v_cvt_pk_bf16_f32 v41, v46, v47
    v_cvt_pk_bf16_f32 v51, v50, v51
    v_cvt_pk_bf16_f32 v50, v48, v49
    v_cvt_pk_bf16_f32 v48, v52, v53
    v_cvt_pk_bf16_f32 v49, v54, v55
    v_cvt_pk_bf16_f32 v59, v58, v59
    v_cvt_pk_bf16_f32 v58, v56, v57
    v_cvt_pk_bf16_f32 v56, v60, v61
    v_cvt_pk_bf16_f32 v57, v62, v63
    v_cvt_pk_bf16_f32 v67, v66, v67
    v_cvt_pk_bf16_f32 v66, v64, v65
    v_cvt_pk_bf16_f32 v64, v68, v69
    v_cvt_pk_bf16_f32 v65, v70, v71
L_pp_vx:
    s_add_u32 s57, s67, s66
    s_add_u32 s57, s57, 56623104
    buffer_store_dwordx4 v[40:43], v2, s[36:39], s57 offen sc1
    s_add_u32 s57, s67, s66
    s_add_u32 s57, s57, 56688640
    buffer_store_dwordx4 v[48:51], v2, s[36:39], s57 offen sc1
    s_add_u32 s57, s67, s66
    s_add_u32 s57, s57, 56754176
    buffer_store_dwordx4 v[56:59], v2, s[36:39], s57 offen sc1
    s_add_u32 s57, s67, s66
    s_add_u32 s57, s57, 56819712
    buffer_store_dwordx4 v[64:67], v2, s[36:39], s57 offen sc1
    v_cvt_pk_bf16_f32 v72, v72, v73
    v_cvt_pk_bf16_f32 v73, v74, v75
    v_and_b32 v82, 8, v1
    v_cmp_eq_u32 vcc, 0, v82
    s_nop 1
    v_cndmask_b32 v74, v81, v72, vcc
    v_cndmask_b32 v75, v81, v73, vcc
    v_cndmask_b32 v72, v72, v81, vcc
    v_cndmask_b32 v73, v73, v81, vcc
    s_lshl_b32 s57, s54, 3
    s_add_u32 s57, s57, s67
    s_lshl_b32 s58, s56, 17
    s_add_u32 s57, s57, s58
    s_add_u32 s57, s57, 58982400
    buffer_store_dwordx2 v[74:75], v2, s[36:39], s57 offen sc1
    s_add_u32 s57, s57, 65536
    buffer_store_dwordx2 v[72:73], v2, s[36:39], s57 offen sc1
    s_waitcnt vmcnt(21)
    s_barrier
    ds_read_b64_tr_b16 v[16:17], v5 offset:36864
    ds_read_b64_tr_b16 v[18:19], v5 offset:41472
    ds_read_b64_tr_b16 v[20:21], v5 offset:36904
    ds_read_b64_tr_b16 v[22:23], v5 offset:41512
    ds_read_b64_tr_b16 v[24:25], v5 offset:36936
    ds_read_b64_tr_b16 v[26:27], v5 offset:41544
    ds_read_b64_tr_b16 v[28:29], v5 offset:36976
    ds_read_b64_tr_b16 v[30:31], v5 offset:41584
    s_waitcnt lgkmcnt(6)
    v_mfma_f32_16x16x32_bf16 v[40:43], v[16:19], v[104:107], 0
    ds_read_b64_tr_b16 v[32:33], v8 offset:36864
    s_add_u32 m0, s61, 0
    s_add_u32 s60, s62, 1327104
    buffer_load_dwordx4 v3, s[28:31], s60 offen lds
    v_mfma_f32_16x16x32_bf16 v[44:47], v[16:19], v[176:179], 0
    ds_read_b64_tr_b16 v[34:35], v8 offset:41472
    s_waitcnt lgkmcnt(6)
    v_mfma_f32_16x16x32_bf16 v[48:51], v[20:23], v[104:107], 0
    ds_read_b64_tr_b16 v[36:37], v5 offset:46080
    v_mfma_f32_16x16x32_bf16 v[52:55], v[20:23], v[176:179], 0
    ds_read_b64_tr_b16 v[38:39], v5 offset:50688
    s_waitcnt lgkmcnt(6)
    v_mfma_f32_16x16x32_bf16 v[56:59], v[24:27], v[104:107], 0
    ds_read_b64_tr_b16 v[16:17], v5 offset:46120
    s_add_u32 m0, s61, 1024
    s_add_u32 s60, s62, 1327104
    buffer_load_dwordx4 v4, s[28:31], s60 offen lds
    v_mfma_f32_16x16x32_bf16 v[60:63], v[24:27], v[176:179], 0
    ds_read_b64_tr_b16 v[18:19], v5 offset:50728
    s_waitcnt lgkmcnt(6)
    v_mfma_f32_16x16x32_bf16 v[64:67], v[28:31], v[104:107], 0
    ds_read_b64_tr_b16 v[20:21], v5 offset:46152
    v_mfma_f32_16x16x32_bf16 v[68:71], v[28:31], v[176:179], 0
    ds_read_b64_tr_b16 v[22:23], v5 offset:50760
    s_waitcnt lgkmcnt(6)
    v_mfma_f32_16x16x32_bf16 v[72:75], v[32:35], v[104:107], 0
    ds_read_b64_tr_b16 v[24:25], v5 offset:46192
    ds_read_b64_tr_b16 v[26:27], v5 offset:50800
    s_add_u32 m0, s61, 2048
    s_add_u32 s60, s62, 1327104
    s_mov_b64 exec, 0xffff
    buffer_load_dwordx4 v76, s[28:31], s60 offen lds
    s_mov_b64 exec, -1
    s_waitcnt lgkmcnt(6)
    v_mfma_f32_16x16x32_bf16 v[40:43], v[36:39], v[108:111], v[40:43]
    ds_read_b64_tr_b16 v[28:29], v8 offset:46080
    v_mfma_f32_16x16x32_bf16 v[44:47], v[36:39], v[180:183], v[44:47]
    ds_read_b64_tr_b16 v[30:31], v8 offset:50688
    s_waitcnt lgkmcnt(6)
    v_mfma_f32_16x16x32_bf16 v[48:51], v[16:19], v[108:111], v[48:51]
    s_waitcnt vmcnt(21)
    s_barrier
    ds_read_b64_tr_b16 v[32:33], v6 offset:6144
    v_mfma_f32_16x16x32_bf16 v[52:55], v[16:19], v[180:183], v[52:55]
    ds_read_b64_tr_b16 v[34:35], v6 offset:10752
    s_waitcnt lgkmcnt(6)
    v_mfma_f32_16x16x32_bf16 v[56:59], v[20:23], v[108:111], v[56:59]
    ds_read_b64_tr_b16 v[36:37], v6 offset:6184
    v_mfma_f32_16x16x32_bf16 v[60:63], v[20:23], v[180:183], v[60:63]
    ds_read_b64_tr_b16 v[38:39], v6 offset:10792
    s_waitcnt lgkmcnt(6)
    v_mfma_f32_16x16x32_bf16 v[64:67], v[24:27], v[108:111], v[64:67]
    ds_read_b64_tr_b16 v[16:17], v6 offset:6216
    s_add_u32 m0, s61, 18432
    s_add_u32 s60, s62, 1548288
    buffer_load_dwordx4 v3, s[28:31], s60 offen lds
    v_mfma_f32_16x16x32_bf16 v[68:71], v[24:27], v[180:183], v[68:71]
    ds_read_b64_tr_b16 v[18:19], v6 offset:10824
    s_waitcnt lgkmcnt(6)
    v_mfma_f32_16x16x32_bf16 v[72:75], v[28:31], v[108:111], v[72:75]
    ds_read_b64_tr_b16 v[20:21], v6 offset:6256
    ds_read_b64_tr_b16 v[22:23], v6 offset:10864
    s_waitcnt lgkmcnt(6)
    v_mfma_f32_16x16x32_bf16 v[40:43], v[32:35], v[112:115], v[40:43]
    ds_read_b64_tr_b16 v[24:25], v9 offset:6144
    s_add_u32 m0, s61, 19456
    s_add_u32 s60, s62, 1548288
    buffer_load_dwordx4 v4, s[28:31], s60 offen lds
    v_mfma_f32_16x16x32_bf16 v[44:47], v[32:35], v[184:187], v[44:47]
    ds_read_b64_tr_b16 v[26:27], v9 offset:10752
    s_waitcnt lgkmcnt(6)
    v_mfma_f32_16x16x32_bf16 v[48:51], v[36:39], v[112:115], v[48:51]
    ds_read_b64_tr_b16 v[28:29], v6 offset:15360
    v_mfma_f32_16x16x32_bf16 v[52:55], v[36:39], v[184:187], v[52:55]
    ds_read_b64_tr_b16 v[30:31], v6 offset:19968
    s_waitcnt lgkmcnt(6)
    v_mfma_f32_16x16x32_bf16 v[56:59], v[16:19], v[112:115], v[56:59]
    ds_read_b64_tr_b16 v[32:33], v6 offset:15400
    s_add_u32 m0, s61, 20480
    s_add_u32 s60, s62, 1548288
    s_mov_b64 exec, 0xffff
    buffer_load_dwordx4 v76, s[28:31], s60 offen lds
    s_mov_b64 exec, -1
    v_mfma_f32_16x16x32_bf16 v[60:63], v[16:19], v[184:187], v[60:63]
    ds_read_b64_tr_b16 v[34:35], v6 offset:20008
    s_waitcnt lgkmcnt(6)
    v_mfma_f32_16x16x32_bf16 v[64:67], v[20:23], v[112:115], v[64:67]
    ds_read_b64_tr_b16 v[36:37], v6 offset:15432
    v_mfma_f32_16x16x32_bf16 v[68:71], v[20:23], v[184:187], v[68:71]
    ds_read_b64_tr_b16 v[38:39], v6 offset:20040
    s_waitcnt lgkmcnt(6)
    v_mfma_f32_16x16x32_bf16 v[72:75], v[24:27], v[112:115], v[72:75]
    ds_read_b64_tr_b16 v[16:17], v6 offset:15472
    ds_read_b64_tr_b16 v[18:19], v6 offset:20080
    s_waitcnt lgkmcnt(6)
    v_mfma_f32_16x16x32_bf16 v[40:43], v[28:31], v[116:119], v[40:43]
    ds_read_b64_tr_b16 v[20:21], v9 offset:15360
    v_mfma_f32_16x16x32_bf16 v[44:47], v[28:31], v[188:191], v[44:47]
    ds_read_b64_tr_b16 v[22:23], v9 offset:19968
    s_waitcnt lgkmcnt(6)
    v_mfma_f32_16x16x32_bf16 v[48:51], v[32:35], v[116:119], v[48:51]
    s_waitcnt vmcnt(21)
    s_barrier
    ds_read_b64_tr_b16 v[24:25], v6 offset:24576
    v_mfma_f32_16x16x32_bf16 v[52:55], v[32:35], v[188:191], v[52:55]
    ds_read_b64_tr_b16 v[26:27], v6 offset:29184
    s_waitcnt lgkmcnt(6)
    v_mfma_f32_16x16x32_bf16 v[56:59], v[36:39], v[116:119], v[56:59]
    ds_read_b64_tr_b16 v[28:29], v6 offset:24616
    v_mfma_f32_16x16x32_bf16 v[60:63], v[36:39], v[188:191], v[60:63]
    ds_read_b64_tr_b16 v[30:31], v6 offset:29224
    s_waitcnt lgkmcnt(6)
    v_mfma_f32_16x16x32_bf16 v[64:67], v[16:19], v[116:119], v[64:67]
    ds_read_b64_tr_b16 v[32:33], v6 offset:24648
    s_add_u32 m0, s61, 36864
    s_add_u32 s60, s62, 1769472
    buffer_load_dwordx4 v3, s[28:31], s60 offen lds
    v_mfma_f32_16x16x32_bf16 v[68:71], v[16:19], v[188:191], v[68:71]
    ds_read_b64_tr_b16 v[34:35], v6 offset:29256
    s_waitcnt lgkmcnt(6)
    v_mfma_f32_16x16x32_bf16 v[72:75], v[20:23], v[116:119], v[72:75]
    ds_read_b64_tr_b16 v[36:37], v6 offset:24688
    ds_read_b64_tr_b16 v[38:39], v6 offset:29296
    s_waitcnt lgkmcnt(6)
    v_mfma_f32_16x16x32_bf16 v[40:43], v[24:27], v[120:123], v[40:43]
    ds_read_b64_tr_b16 v[16:17], v9 offset:24576
    s_add_u32 m0, s61, 37888
    s_add_u32 s60, s62, 1769472
    buffer_load_dwordx4 v4, s[28:31], s60 offen lds
    v_mfma_f32_16x16x32_bf16 v[44:47], v[24:27], v[192:195], v[44:47]
    ds_read_b64_tr_b16 v[18:19], v9 offset:29184
    s_waitcnt lgkmcnt(6)
    v_mfma_f32_16x16x32_bf16 v[48:51], v[28:31], v[120:123], v[48:51]
    ds_read_b64_tr_b16 v[20:21], v6 offset:33792
    v_mfma_f32_16x16x32_bf16 v[52:55], v[28:31], v[192:195], v[52:55]
    ds_read_b64_tr_b16 v[22:23], v6 offset:38400
    s_waitcnt lgkmcnt(6)
    v_mfma_f32_16x16x32_bf16 v[56:59], v[32:35], v[120:123], v[56:59]
    ds_read_b64_tr_b16 v[24:25], v6 offset:33832
    s_add_u32 m0, s61, 38912
    s_add_u32 s60, s62, 1769472
    s_mov_b64 exec, 0xffff
    buffer_load_dwordx4 v76, s[28:31], s60 offen lds
    s_mov_b64 exec, -1
    v_mfma_f32_16x16x32_bf16 v[60:63], v[32:35], v[192:195], v[60:63]
    ds_read_b64_tr_b16 v[26:27], v6 offset:38440
    s_waitcnt lgkmcnt(6)
    v_mfma_f32_16x16x32_bf16 v[64:67], v[36:39], v[120:123], v[64:67]
    ds_read_b64_tr_b16 v[28:29], v6 offset:33864
    v_mfma_f32_16x16x32_bf16 v[68:71], v[36:39], v[192:195], v[68:71]
    ds_read_b64_tr_b16 v[30:31], v6 offset:38472
    s_waitcnt lgkmcnt(6)
    v_mfma_f32_16x16x32_bf16 v[72:75], v[16:19], v[120:123], v[72:75]
    ds_read_b64_tr_b16 v[32:33], v6 offset:33904
    ds_read_b64_tr_b16 v[34:35], v6 offset:38512
    s_waitcnt lgkmcnt(6)
    v_mfma_f32_16x16x32_bf16 v[40:43], v[20:23], v[124:127], v[40:43]
    ds_read_b64_tr_b16 v[36:37], v9 offset:33792
    v_mfma_f32_16x16x32_bf16 v[44:47], v[20:23], v[196:199], v[44:47]
    ds_read_b64_tr_b16 v[38:39], v9 offset:38400
    s_waitcnt lgkmcnt(6)
    v_mfma_f32_16x16x32_bf16 v[48:51], v[24:27], v[124:127], v[48:51]
    s_waitcnt vmcnt(9)
    s_barrier
    s_cmp_eq_u32 s52, 0
    s_cbranch_scc0 L_fl_kv
    s_lshl_b32 s57, s55, 11
    s_lshl_b32 s58, s56, 2
    s_add_u32 s57, s57, s58
    s_add_u32 s57, s57, 65011712
    v_mov_b32 v82, 1
    v_mov_b32 v83, 0
    s_mov_b64 exec, 1
    buffer_store_dword v82, v83, s[36:39], s57 offen sc1
    s_mov_b64 exec, -1
L_fl_kv:
    ds_read_b64_tr_b16 v[16:17], v6 offset:43008
    v_mfma_f32_16x16x32_bf16 v[52:55], v[24:27], v[196:199], v[52:55]
    ds_read_b64_tr_b16 v[18:19], v6 offset:47616
    s_waitcnt lgkmcnt(6)
    v_mfma_f32_16x16x32_bf16 v[56:59], v[28:31], v[124:127], v[56:59]
    ds_read_b64_tr_b16 v[20:21], v6 offset:43048
    v_mfma_f32_16x16x32_bf16 v[60:63], v[28:31], v[196:199], v[60:63]
    ds_read_b64_tr_b16 v[22:23], v6 offset:47656
    s_waitcnt lgkmcnt(6)
    v_mfma_f32_16x16x32_bf16 v[64:67], v[32:35], v[124:127], v[64:67]
    ds_read_b64_tr_b16 v[24:25], v6 offset:43080
    s_lshr_b32 s71, s52, 1
    s_lshl_b32 s73, s55, 3
    s_sub_u32 s73, s73, 16
    s_add_u32 s57, s73, 0
    s_lshl_b32 s75, s57, 9
    s_cmp_lt_i32 s57, 0
    s_cselect_b32 s75, 0x70000000, s75
    s_add_u32 s57, s73, 8
    s_lshl_b32 s69, s57, 9
    s_cmp_lt_i32 s57, 0
    s_cselect_b32 s69, 0x70000000, s69
    s_add_u32 s57, s73, 16
    s_lshl_b32 s70, s57, 9
    s_cmp_lt_i32 s57, 0
    s_cselect_b32 s70, 0x70000000, s70
    s_lshl_b32 s57, s56, 16
    s_add_u32 s57, s57, 58720256
    s_add_u32 s24, s22, s57
    s_addc_u32 s25, s23, 0
    s_mov_b32 s26, 65536
    s_mov_b32 s27, 0x20000
    s_lshl_b32 s57, s56, 1
    s_add_u32 s57, s57, s54
    s_lshl_b32 s57, s57, 16
    s_add_u32 s57, s57, 58982400
    s_add_u32 s28, s22, s57
    s_addc_u32 s29, s23, 0
    s_mov_b32 s30, 65536
    s_mov_b32 s31, 0x20000
    s_lshl_b32 s58, s56, 3
    s_add_u32 s58, s58, s52
    s_lshl_b32 s58, s58, 16
    s_add_u32 s57, s58, 54525952
    s_add_u32 s44, s22, s57
    s_addc_u32 s45, s23, 0
    s_mov_b32 s46, 65536
    s_mov_b32 s47, 0x20000
    s_add_u32 s57, s58, 56623104
    s_add_u32 s48, s22, s57
    s_addc_u32 s49, s23, 0
    s_mov_b32 s50, 65536
    s_mov_b32 s51, 0x20000
    s_lshl_b32 s59, s52, 9
    v_add_u32 v250, s59, v80
    s_lshl_b32 s59, s53, 10
    v_add_u32 v251, s59, v2
    v_mfma_f32_16x16x32_bf16 v[68:71], v[32:35], v[196:199], v[68:71]
    ds_read_b64_tr_b16 v[26:27], v6 offset:47688
    s_waitcnt lgkmcnt(6)
    v_mfma_f32_16x16x32_bf16 v[72:75], v[36:39], v[124:127], v[72:75]
    ds_read_b64_tr_b16 v[28:29], v6 offset:43120
    ds_read_b64_tr_b16 v[30:31], v6 offset:47728
    s_waitcnt lgkmcnt(6)
    v_mfma_f32_16x16x32_bf16 v[40:43], v[16:19], v[128:131], v[40:43]
    ds_read_b64_tr_b16 v[32:33], v9 offset:43008
    buffer_load_dwordx2 v[90:91], v250, s[24:27], s70 offen sc1
    buffer_load_dwordx4 v[100:103], v251, s[28:31], s70 offen sc1
    v_mfma_f32_16x16x32_bf16 v[44:47], v[16:19], v[200:203], v[44:47]
    ds_read_b64_tr_b16 v[34:35], v9 offset:47616
    s_waitcnt lgkmcnt(6)
    v_mfma_f32_16x16x32_bf16 v[48:51], v[20:23], v[128:131], v[48:51]
    ds_read_b64_tr_b16 v[36:37], v7 offset:3072
    buffer_load_dwordx4 v[104:107], v2, s[44:47], s70 offen offset:0 sc1
    v_mfma_f32_16x16x32_bf16 v[52:55], v[20:23], v[200:203], v[52:55]
    ds_read_b64_tr_b16 v[38:39], v7 offset:7680
    s_waitcnt lgkmcnt(6)
    v_mfma_f32_16x16x32_bf16 v[56:59], v[24:27], v[128:131], v[56:59]
    ds_read_b64_tr_b16 v[16:17], v7 offset:3112
    buffer_load_dwordx4 v[176:179], v2, s[48:51], s70 offen offset:0 sc1
    v_mfma_f32_16x16x32_bf16 v[60:63], v[24:27], v[200:203], v[60:63]
    ds_read_b64_tr_b16 v[18:19], v7 offset:7720
    s_waitcnt lgkmcnt(6)
    v_mfma_f32_16x16x32_bf16 v[64:67], v[28:31], v[128:131], v[64:67]
    ds_read_b64_tr_b16 v[20:21], v7 offset:3144
    buffer_load_dwordx4 v[108:111], v2, s[44:47], s70 offen offset:1024 sc1
    v_mfma_f32_16x16x32_bf16 v[68:71], v[28:31], v[200:203], v[68:71]
    ds_read_b64_tr_b16 v[22:23], v7 offset:7752
    s_waitcnt lgkmcnt(6)
    v_mfma_f32_16x16x32_bf16 v[72:75], v[32:35], v[128:131], v[72:75]
    ds_read_b64_tr_b16 v[24:25], v7 offset:3184
    ds_read_b64_tr_b16 v[26:27], v7 offset:7792
    buffer_load_dwordx4 v[180:183], v2, s[48:51], s70 offen offset:1024 sc1
    s_waitcnt lgkmcnt(6)
    v_mfma_f32_16x16x32_bf16 v[40:43], v[36:39], v[132:135], v[40:43]
    ds_read_b64_tr_b16 v[28:29], v10 offset:3072
    buffer_load_dwordx4 v[112:115], v2, s[44:47], s70 offen offset:2048 sc1
    v_mfma_f32_16x16x32_bf16 v[44:47], v[36:39], v[204:207], v[44:47]
    ds_read_b64_tr_b16 v[30:31], v10 offset:7680
    s_waitcnt lgkmcnt(6)
    v_mfma_f32_16x16x32_bf16 v[48:51], v[16:19], v[132:135], v[48:51]
    s_barrier
    ds_read_b64_tr_b16 v[32:33], v7 offset:12288
    buffer_load_dwordx4 v[184:187], v2, s[48:51], s70 offen offset:2048 sc1
    v_mfma_f32_16x16x32_bf16 v[52:55], v[16:19], v[204:207], v[52:55]
    ds_read_b64_tr_b16 v[34:35], v7 offset:16896
    s_waitcnt lgkmcnt(6)
    v_mfma_f32_16x16x32_bf16 v[56:59], v[20:23], v[132:135], v[56:59]
    ds_read_b64_tr_b16 v[36:37], v7 offset:12328
    buffer_load_dwordx4 v[116:119], v2, s[44:47], s70 offen offset:3072 sc1
    v_mfma_f32_16x16x32_bf16 v[60:63], v[20:23], v[204:207], v[60:63]
    ds_read_b64_tr_b16 v[38:39], v7 offset:16936
    s_waitcnt lgkmcnt(6)
    v_mfma_f32_16x16x32_bf16 v[64:67], v[24:27], v[132:135], v[64:67]
    ds_read_b64_tr_b16 v[16:17], v7 offset:12360
    buffer_load_dwordx4 v[188:191], v2, s[48:51], s70 offen offset:3072 sc1
    v_mfma_f32_16x16x32_bf16 v[68:71], v[24:27], v[204:207], v[68:71]
    ds_read_b64_tr_b16 v[18:19], v7 offset:16968
    s_waitcnt lgkmcnt(6)
    v_mfma_f32_16x16x32_bf16 v[72:75], v[28:31], v[132:135], v[72:75]
    ds_read_b64_tr_b16 v[20:21], v7 offset:12400
    ds_read_b64_tr_b16 v[22:23], v7 offset:17008
    s_waitcnt lgkmcnt(6)
    v_mfma_f32_16x16x32_bf16 v[40:43], v[32:35], v[136:139], v[40:43]
    ds_read_b64_tr_b16 v[24:25], v10 offset:12288
    v_mfma_f32_16x16x32_bf16 v[44:47], v[32:35], v[208:211], v[44:47]
    ds_read_b64_tr_b16 v[26:27], v10 offset:16896
    s_waitcnt lgkmcnt(6)
    v_mfma_f32_16x16x32_bf16 v[48:51], v[36:39], v[136:139], v[48:51]
    ds_read_b64_tr_b16 v[28:29], v7 offset:21504
    v_mfma_f32_16x16x32_bf16 v[52:55], v[36:39], v[208:211], v[52:55]
    ds_read_b64_tr_b16 v[30:31], v7 offset:26112
    s_waitcnt lgkmcnt(6)
    v_mfma_f32_16x16x32_bf16 v[56:59], v[16:19], v[136:139], v[56:59]
    ds_read_b64_tr_b16 v[32:33], v7 offset:21544
    v_mfma_f32_16x16x32_bf16 v[60:63], v[16:19], v[208:211], v[60:63]
    ds_read_b64_tr_b16 v[34:35], v7 offset:26152
    s_waitcnt lgkmcnt(6)
    v_mfma_f32_16x16x32_bf16 v[64:67], v[20:23], v[136:139], v[64:67]
    ds_read_b64_tr_b16 v[36:37], v7 offset:21576
    v_mfma_f32_16x16x32_bf16 v[68:71], v[20:23], v[208:211], v[68:71]
    ds_read_b64_tr_b16 v[38:39], v7 offset:26184
    s_waitcnt lgkmcnt(6)
    v_mfma_f32_16x16x32_bf16 v[72:75], v[24:27], v[136:139], v[72:75]
    ds_read_b64_tr_b16 v[16:17], v7 offset:21616
    ds_read_b64_tr_b16 v[18:19], v7 offset:26224
    s_waitcnt lgkmcnt(6)
    v_mfma_f32_16x16x32_bf16 v[40:43], v[28:31], v[140:143], v[40:43]
    ds_read_b64_tr_b16 v[20:21], v10 offset:21504
    v_mfma_f32_16x16x32_bf16 v[44:47], v[28:31], v[212:215], v[44:47]
    ds_read_b64_tr_b16 v[22:23], v10 offset:26112
    s_waitcnt lgkmcnt(6)
    v_mfma_f32_16x16x32_bf16 v[48:51], v[32:35], v[140:143], v[48:51]
    s_barrier
    ds_read_b64_tr_b16 v[24:25], v7 offset:30720
    v_mfma_f32_16x16x32_bf16 v[52:55], v[32:35], v[212:215], v[52:55]
    ds_read_b64_tr_b16 v[26:27], v7 offset:35328
    s_waitcnt lgkmcnt(6)
    v_mfma_f32_16x16x32_bf16 v[56:59], v[36:39], v[140:143], v[56:59]
    ds_read_b64_tr_b16 v[28:29], v7 offset:30760
    v_mfma_f32_16x16x32_bf16 v[60:63], v[36:39], v[212:215], v[60:63]
    ds_read_b64_tr_b16 v[30:31], v7 offset:35368
    s_waitcnt lgkmcnt(6)
    v_mfma_f32_16x16x32_bf16 v[64:67], v[16:19], v[140:143], v[64:67]
    ds_read_b64_tr_b16 v[32:33], v7 offset:30792
    v_mfma_f32_16x16x32_bf16 v[68:71], v[16:19], v[212:215], v[68:71]
    ds_read_b64_tr_b16 v[34:35], v7 offset:35400
    s_waitcnt lgkmcnt(6)
    v_mfma_f32_16x16x32_bf16 v[72:75], v[20:23], v[140:143], v[72:75]
    ds_read_b64_tr_b16 v[36:37], v7 offset:30832
    ds_read_b64_tr_b16 v[38:39], v7 offset:35440
    s_waitcnt lgkmcnt(6)
    v_mfma_f32_16x16x32_bf16 v[40:43], v[24:27], v[144:147], v[40:43]
    ds_read_b64_tr_b16 v[16:17], v10 offset:30720
    v_mfma_f32_16x16x32_bf16 v[44:47], v[24:27], v[216:219], v[44:47]
    ds_read_b64_tr_b16 v[18:19], v10 offset:35328
    s_waitcnt lgkmcnt(6)
    v_mfma_f32_16x16x32_bf16 v[48:51], v[28:31], v[144:147], v[48:51]
    ds_read_b64_tr_b16 v[20:21], v7 offset:39936
    v_mfma_f32_16x16x32_bf16 v[52:55], v[28:31], v[216:219], v[52:55]
    ds_read_b64_tr_b16 v[22:23], v7 offset:44544
    s_waitcnt lgkmcnt(6)
    v_mfma_f32_16x16x32_bf16 v[56:59], v[32:35], v[144:147], v[56:59]
    ds_read_b64_tr_b16 v[24:25], v7 offset:39976
    v_mfma_f32_16x16x32_bf16 v[60:63], v[32:35], v[216:219], v[60:63]
    ds_read_b64_tr_b16 v[26:27], v7 offset:44584
    s_waitcnt lgkmcnt(6)
    v_mfma_f32_16x16x32_bf16 v[64:67], v[36:39], v[144:147], v[64:67]
    ds_read_b64_tr_b16 v[28:29], v7 offset:40008
    v_mfma_f32_16x16x32_bf16 v[68:71], v[36:39], v[216:219], v[68:71]
    ds_read_b64_tr_b16 v[30:31], v7 offset:44616
    s_waitcnt lgkmcnt(6)
    v_mfma_f32_16x16x32_bf16 v[72:75], v[16:19], v[144:147], v[72:75]
    ds_read_b64_tr_b16 v[32:33], v7 offset:40048
    ds_read_b64_tr_b16 v[34:35], v7 offset:44656
    s_waitcnt lgkmcnt(6)
    v_mfma_f32_16x16x32_bf16 v[40:43], v[20:23], v[148:151], v[40:43]
    ds_read_b64_tr_b16 v[36:37], v10 offset:39936
    v_mfma_f32_16x16x32_bf16 v[44:47], v[20:23], v[220:223], v[44:47]
    ds_read_b64_tr_b16 v[38:39], v10 offset:44544
    s_waitcnt lgkmcnt(6)
    v_mfma_f32_16x16x32_bf16 v[48:51], v[24:27], v[148:151], v[48:51]
    s_waitcnt vmcnt(16)
    s_barrier
    ds_read_b64_tr_b16 v[16:17], v5 offset:0
    v_mfma_f32_16x16x32_bf16 v[52:55], v[24:27], v[220:223], v[52:55]
    ds_read_b64_tr_b16 v[18:19], v5 offset:4608
    s_waitcnt lgkmcnt(6)
    v_mfma_f32_16x16x32_bf16 v[56:59], v[28:31], v[148:151], v[56:59]
    ds_read_b64_tr_b16 v[20:21], v5 offset:40
    v_mfma_f32_16x16x32_bf16 v[60:63], v[28:31], v[220:223], v[60:63]
    ds_read_b64_tr_b16 v[22:23], v5 offset:4648
    s_waitcnt lgkmcnt(6)
    v_mfma_f32_16x16x32_bf16 v[64:67], v[32:35], v[148:151], v[64:67]
    ds_read_b64_tr_b16 v[24:25], v5 offset:72
    v_mfma_f32_16x16x32_bf16 v[68:71], v[32:35], v[220:223], v[68:71]
    ds_read_b64_tr_b16 v[26:27], v5 offset:4680
    s_waitcnt lgkmcnt(6)
    v_mfma_f32_16x16x32_bf16 v[72:75], v[36:39], v[148:151], v[72:75]
    ds_read_b64_tr_b16 v[28:29], v5 offset:112
    ds_read_b64_tr_b16 v[30:31], v5 offset:4720
    s_waitcnt lgkmcnt(6)
    v_mfma_f32_16x16x32_bf16 v[40:43], v[16:19], v[152:155], v[40:43]
    ds_read_b64_tr_b16 v[32:33], v8 offset:0
    v_and_b32 v82, 1, v1
    v_add_u32 v82, 1, v82
    v_sub_u32 v82, s55, v82
    v_max_i32 v82, 0, v82
    v_lshlrev_b32 v82, 11, v82
    s_lshl_b32 s57, s56, 2
    v_add_u32 v82, s57, v82
    s_mov_b32 s59, 0
    s_mov_b32 s57, 65011712
L_poll_kv:
    buffer_load_dword v83, v82, s[36:39], s57 offen sc1
    s_add_u32 s59, s59, 1
    s_cmp_gt_u32 s59, 0x40000
    s_cbranch_scc1 L_poll_kv_x
    s_waitcnt vmcnt(0)
    v_cmp_gt_u32 vcc, 1, v83
    s_cbranch_vccz L_poll_kv_x
    s_sleep 2
    s_branch L_poll_kv
L_poll_kv_x:
    v_mfma_f32_16x16x32_bf16 v[44:47], v[16:19], v[224:227], v[44:47]
    ds_read_b64_tr_b16 v[34:35], v8 offset:4608
    s_waitcnt lgkmcnt(6)
    v_mfma_f32_16x16x32_bf16 v[48:51], v[20:23], v[152:155], v[48:51]
    ds_read_b64_tr_b16 v[36:37], v5 offset:9216
    buffer_load_dwordx2 v[88:89], v250, s[24:27], s69 offen sc1
    buffer_load_dwordx4 v[96:99], v251, s[28:31], s69 offen sc1
    v_mfma_f32_16x16x32_bf16 v[52:55], v[20:23], v[224:227], v[52:55]
    ds_read_b64_tr_b16 v[38:39], v5 offset:13824
    s_waitcnt lgkmcnt(6)
    v_mfma_f32_16x16x32_bf16 v[56:59], v[24:27], v[152:155], v[56:59]
    ds_read_b64_tr_b16 v[16:17], v5 offset:9256
    buffer_load_dwordx2 v[86:87], v250, s[24:27], s75 offen sc1
    buffer_load_dwordx4 v[92:95], v251, s[28:31], s75 offen sc1
    v_mfma_f32_16x16x32_bf16 v[60:63], v[24:27], v[224:227], v[60:63]
    ds_read_b64_tr_b16 v[18:19], v5 offset:13864
    s_waitcnt lgkmcnt(6)
    v_mfma_f32_16x16x32_bf16 v[64:67], v[28:31], v[152:155], v[64:67]
    ds_read_b64_tr_b16 v[20:21], v5 offset:9288
    buffer_load_dwordx4 v[120:123], v2, s[44:47], s69 offen offset:0 sc1
    v_mfma_f32_16x16x32_bf16 v[68:71], v[28:31], v[224:227], v[68:71]
    ds_read_b64_tr_b16 v[22:23], v5 offset:13896
    s_waitcnt lgkmcnt(6)
    v_mfma_f32_16x16x32_bf16 v[72:75], v[32:35], v[152:155], v[72:75]
    ds_read_b64_tr_b16 v[24:25], v5 offset:9328
    ds_read_b64_tr_b16 v[26:27], v5 offset:13936
    buffer_load_dwordx4 v[192:195], v2, s[48:51], s69 offen offset:0 sc1
    s_waitcnt lgkmcnt(6)
    v_mfma_f32_16x16x32_bf16 v[40:43], v[36:39], v[156:159], v[40:43]
    ds_read_b64_tr_b16 v[28:29], v8 offset:9216
    buffer_load_dwordx4 v[124:127], v2, s[44:47], s69 offen offset:1024 sc1
    v_mfma_f32_16x16x32_bf16 v[44:47], v[36:39], v[228:231], v[44:47]
    ds_read_b64_tr_b16 v[30:31], v8 offset:13824
    s_waitcnt lgkmcnt(6)
    v_mfma_f32_16x16x32_bf16 v[48:51], v[16:19], v[156:159], v[48:51]
    s_waitcnt vmcnt(20)
    s_barrier
    ds_read_b64_tr_b16 v[32:33], v5 offset:18432
    buffer_load_dwordx4 v[196:199], v2, s[48:51], s69 offen offset:1024 sc1
    v_mfma_f32_16x16x32_bf16 v[52:55], v[16:19], v[228:231], v[52:55]
    ds_read_b64_tr_b16 v[34:35], v5 offset:23040
    s_waitcnt lgkmcnt(6)
    v_mfma_f32_16x16x32_bf16 v[56:59], v[20:23], v[156:159], v[56:59]
    ds_read_b64_tr_b16 v[36:37], v5 offset:18472
    buffer_load_dwordx4 v[128:131], v2, s[44:47], s69 offen offset:2048 sc1
    v_mfma_f32_16x16x32_bf16 v[60:63], v[20:23], v[228:231], v[60:63]
    ds_read_b64_tr_b16 v[38:39], v5 offset:23080
    s_waitcnt lgkmcnt(6)
    v_mfma_f32_16x16x32_bf16 v[64:67], v[24:27], v[156:159], v[64:67]
    ds_read_b64_tr_b16 v[16:17], v5 offset:18504
    buffer_load_dwordx4 v[200:203], v2, s[48:51], s69 offen offset:2048 sc1
    v_mfma_f32_16x16x32_bf16 v[68:71], v[24:27], v[228:231], v[68:71]
    ds_read_b64_tr_b16 v[18:19], v5 offset:23112
    s_waitcnt lgkmcnt(6)
    v_mfma_f32_16x16x32_bf16 v[72:75], v[28:31], v[156:159], v[72:75]
    ds_read_b64_tr_b16 v[20:21], v5 offset:18544
    ds_read_b64_tr_b16 v[22:23], v5 offset:23152
    buffer_load_dwordx4 v[132:135], v2, s[44:47], s69 offen offset:3072 sc1
    s_waitcnt lgkmcnt(6)
    v_mfma_f32_16x16x32_bf16 v[40:43], v[32:35], v[160:163], v[40:43]
    ds_read_b64_tr_b16 v[24:25], v8 offset:18432
    buffer_load_dwordx4 v[204:207], v2, s[48:51], s69 offen offset:3072 sc1
    v_mfma_f32_16x16x32_bf16 v[44:47], v[32:35], v[232:235], v[44:47]
    ds_read_b64_tr_b16 v[26:27], v8 offset:23040
    s_waitcnt lgkmcnt(6)
    v_mfma_f32_16x16x32_bf16 v[48:51], v[36:39], v[160:163], v[48:51]
    ds_read_b64_tr_b16 v[28:29], v5 offset:27648
    buffer_load_dwordx4 v[136:139], v2, s[44:47], s75 offen offset:0 sc1
    v_mfma_f32_16x16x32_bf16 v[52:55], v[36:39], v[232:235], v[52:55]
    ds_read_b64_tr_b16 v[30:31], v5 offset:32256
    s_waitcnt lgkmcnt(6)
    v_mfma_f32_16x16x32_bf16 v[56:59], v[16:19], v[160:163], v[56:59]
    ds_read_b64_tr_b16 v[32:33], v5 offset:27688
    buffer_load_dwordx4 v[208:211], v2, s[48:51], s75 offen offset:0 sc1
    v_mfma_f32_16x16x32_bf16 v[60:63], v[16:19], v[232:235], v[60:63]
    ds_read_b64_tr_b16 v[34:35], v5 offset:32296
    s_waitcnt lgkmcnt(6)
    v_mfma_f32_16x16x32_bf16 v[64:67], v[20:23], v[160:163], v[64:67]
    ds_read_b64_tr_b16 v[36:37], v5 offset:27720
    buffer_load_dwordx4 v[140:143], v2, s[44:47], s75 offen offset:1024 sc1
    v_mfma_f32_16x16x32_bf16 v[68:71], v[20:23], v[232:235], v[68:71]
    ds_read_b64_tr_b16 v[38:39], v5 offset:32328
    s_waitcnt lgkmcnt(6)
    v_mfma_f32_16x16x32_bf16 v[72:75], v[24:27], v[160:163], v[72:75]
    ds_read_b64_tr_b16 v[16:17], v5 offset:27760
    ds_read_b64_tr_b16 v[18:19], v5 offset:32368
    buffer_load_dwordx4 v[212:215], v2, s[48:51], s75 offen offset:1024 sc1
    s_waitcnt lgkmcnt(6)
    v_mfma_f32_16x16x32_bf16 v[40:43], v[28:31], v[164:167], v[40:43]
    ds_read_b64_tr_b16 v[20:21], v8 offset:27648
    buffer_load_dwordx4 v[144:147], v2, s[44:47], s75 offen offset:2048 sc1
    v_mfma_f32_16x16x32_bf16 v[44:47], v[28:31], v[236:239], v[44:47]
    ds_read_b64_tr_b16 v[22:23], v8 offset:32256
    s_waitcnt lgkmcnt(6)
    v_mfma_f32_16x16x32_bf16 v[48:51], v[32:35], v[164:167], v[48:51]
    s_waitcnt vmcnt(27)
    s_barrier
    ds_read_b64_tr_b16 v[24:25], v5 offset:36864
    buffer_load_dwordx4 v[216:219], v2, s[48:51], s75 offen offset:2048 sc1
    v_mfma_f32_16x16x32_bf16 v[52:55], v[32:35], v[236:239], v[52:55]
    ds_read_b64_tr_b16 v[26:27], v5 offset:41472
    s_waitcnt lgkmcnt(6)
    v_mfma_f32_16x16x32_bf16 v[56:59], v[36:39], v[164:167], v[56:59]
    ds_read_b64_tr_b16 v[28:29], v5 offset:36904
    buffer_load_dwordx4 v[148:151], v2, s[44:47], s75 offen offset:3072 sc1
    v_mfma_f32_16x16x32_bf16 v[60:63], v[36:39], v[236:239], v[60:63]
    ds_read_b64_tr_b16 v[30:31], v5 offset:41512
    s_waitcnt lgkmcnt(6)
    v_mfma_f32_16x16x32_bf16 v[64:67], v[16:19], v[164:167], v[64:67]
    ds_read_b64_tr_b16 v[32:33], v5 offset:36936
    buffer_load_dwordx4 v[220:223], v2, s[48:51], s75 offen offset:3072 sc1
    v_mfma_f32_16x16x32_bf16 v[68:71], v[16:19], v[236:239], v[68:71]
    ds_read_b64_tr_b16 v[34:35], v5 offset:41544
    s_waitcnt lgkmcnt(6)
    v_mfma_f32_16x16x32_bf16 v[72:75], v[20:23], v[164:167], v[72:75]
    ds_read_b64_tr_b16 v[36:37], v5 offset:36976
    ds_read_b64_tr_b16 v[38:39], v5 offset:41584
    s_waitcnt lgkmcnt(6)
    v_mfma_f32_16x16x32_bf16 v[40:43], v[24:27], v[168:171], v[40:43]
    ds_read_b64_tr_b16 v[16:17], v8 offset:36864
    v_mfma_f32_16x16x32_bf16 v[44:47], v[24:27], v[240:243], v[44:47]
    ds_read_b64_tr_b16 v[18:19], v8 offset:41472
    s_waitcnt lgkmcnt(6)
    v_mfma_f32_16x16x32_bf16 v[48:51], v[28:31], v[168:171], v[48:51]
    ds_read_b64_tr_b16 v[20:21], v5 offset:46080
    v_mfma_f32_16x16x32_bf16 v[52:55], v[28:31], v[240:243], v[52:55]
    ds_read_b64_tr_b16 v[22:23], v5 offset:50688
    s_waitcnt lgkmcnt(6)
    v_mfma_f32_16x16x32_bf16 v[56:59], v[32:35], v[168:171], v[56:59]
    ds_read_b64_tr_b16 v[24:25], v5 offset:46120
    v_mfma_f32_16x16x32_bf16 v[60:63], v[32:35], v[240:243], v[60:63]
    ds_read_b64_tr_b16 v[26:27], v5 offset:50728
    s_waitcnt lgkmcnt(6)
    v_mfma_f32_16x16x32_bf16 v[64:67], v[36:39], v[168:171], v[64:67]
    ds_read_b64_tr_b16 v[28:29], v5 offset:46152
    v_mfma_f32_16x16x32_bf16 v[68:71], v[36:39], v[240:243], v[68:71]
    ds_read_b64_tr_b16 v[30:31], v5 offset:50760
    s_waitcnt lgkmcnt(6)
    v_mfma_f32_16x16x32_bf16 v[72:75], v[16:19], v[168:171], v[72:75]
    ds_read_b64_tr_b16 v[32:33], v5 offset:46192
    ds_read_b64_tr_b16 v[34:35], v5 offset:50800
    s_waitcnt lgkmcnt(6)
    v_mfma_f32_16x16x32_bf16 v[40:43], v[20:23], v[172:175], v[40:43]
    ds_read_b64_tr_b16 v[36:37], v8 offset:46080
    v_mfma_f32_16x16x32_bf16 v[44:47], v[20:23], v[244:247], v[44:47]
    ds_read_b64_tr_b16 v[38:39], v8 offset:50688
    s_waitcnt lgkmcnt(6)
    v_mfma_f32_16x16x32_bf16 v[48:51], v[24:27], v[172:175], v[48:51]
    v_mfma_f32_16x16x32_bf16 v[52:55], v[24:27], v[244:247], v[52:55]
    s_waitcnt lgkmcnt(4)
    v_mfma_f32_16x16x32_bf16 v[56:59], v[28:31], v[172:175], v[56:59]
    v_mfma_f32_16x16x32_bf16 v[60:63], v[28:31], v[244:247], v[60:63]
    s_waitcnt lgkmcnt(2)
    v_mfma_f32_16x16x32_bf16 v[64:67], v[32:35], v[172:175], v[64:67]
    v_mfma_f32_16x16x32_bf16 v[68:71], v[32:35], v[244:247], v[68:71]
    s_waitcnt lgkmcnt(0)
    v_mfma_f32_16x16x32_bf16 v[72:75], v[36:39], v[172:175], v[72:75]
    v_mul_f32 v40, 0x3eae1a93, v40
    v_mul_f32 v41, 0x3eae1a93, v41
    v_mul_f32 v42, 0x3eae1a93, v42
    v_mul_f32 v43, 0x3eae1a93, v43
    v_cvt_pk_bf16_f32 v40, v40, v41
    v_cvt_pk_bf16_f32 v41, v42, v43
    v_mul_f32 v44, 0x3eae1a93, v44
    v_mul_f32 v45, 0x3eae1a93, v45
    v_mul_f32 v46, 0x3eae1a93, v46
    v_mul_f32 v47, 0x3eae1a93, v47
    v_cvt_pk_bf16_f32 v44, v44, v45
    v_cvt_pk_bf16_f32 v45, v46, v47
    v_mul_f32 v48, 0x3eae1a93, v48
    v_mul_f32 v49, 0x3eae1a93, v49
    v_mul_f32 v50, 0x3eae1a93, v50
    v_mul_f32 v51, 0x3eae1a93, v51
    v_cvt_pk_bf16_f32 v48, v48, v49
    v_cvt_pk_bf16_f32 v49, v50, v51
    v_mul_f32 v52, 0x3eae1a93, v52
    v_mul_f32 v53, 0x3eae1a93, v53
    v_mul_f32 v54, 0x3eae1a93, v54
    v_mul_f32 v55, 0x3eae1a93, v55
    v_cvt_pk_bf16_f32 v52, v52, v53
    v_cvt_pk_bf16_f32 v53, v54, v55
    v_mul_f32 v56, 0x3eae1a93, v56
    v_mul_f32 v57, 0x3eae1a93, v57
    v_mul_f32 v58, 0x3eae1a93, v58
    v_mul_f32 v59, 0x3eae1a93, v59
    v_cvt_pk_bf16_f32 v56, v56, v57
    v_cvt_pk_bf16_f32 v57, v58, v59
    v_mul_f32 v60, 0x3eae1a93, v60
    v_mul_f32 v61, 0x3eae1a93, v61
    v_mul_f32 v62, 0x3eae1a93, v62
    v_mul_f32 v63, 0x3eae1a93, v63
    v_cvt_pk_bf16_f32 v60, v60, v61
    v_cvt_pk_bf16_f32 v61, v62, v63
    v_mul_f32 v64, 0x3eae1a93, v64
    v_mul_f32 v65, 0x3eae1a93, v65
    v_mul_f32 v66, 0x3eae1a93, v66
    v_mul_f32 v67, 0x3eae1a93, v67
    v_cvt_pk_bf16_f32 v64, v64, v65
    v_cvt_pk_bf16_f32 v65, v66, v67
    v_mul_f32 v68, 0x3eae1a93, v68
    v_mul_f32 v69, 0x3eae1a93, v69
    v_mul_f32 v70, 0x3eae1a93, v70
    v_mul_f32 v71, 0x3eae1a93, v71
    v_cvt_pk_bf16_f32 v68, v68, v69
    v_cvt_pk_bf16_f32 v69, v70, v71
    v_mul_f32 v72, 0x3eae1a93, v72
    v_mul_f32 v73, 0x3eae1a93, v73
    v_mul_f32 v74, 0x3eae1a93, v74
    v_mul_f32 v75, 0x3eae1a93, v75
    v_cvt_pk_bf16_f32 v72, v72, v73
    v_cvt_pk_bf16_f32 v73, v74, v75
    s_and_b32 s57, s64, 7
    s_lshl_b32 s57, s57, 9
    v_add_u32 v252, s57, v80
    s_lshl_b32 s58, s54, 14
    v_add_u32 v253, s58, v252
    v_xor_b32 v254, 512, v253
    s_waitcnt lgkmcnt(0)
    s_barrier
    ds_write_b64 v253, v[40:41] offset:0
    ds_write_b64 v254, v[44:45] offset:0
    ds_write_b64 v253, v[48:49] offset:4096
    ds_write_b64 v254, v[52:53] offset:4096
    ds_write_b64 v253, v[56:57] offset:8192
    ds_write_b64 v254, v[60:61] offset:8192
    ds_write_b64 v253, v[64:65] offset:12288
    ds_write_b64 v254, v[68:69] offset:12288
    ds_write_b64 v252, v[72:73] offset:32768
    s_mul_i32 s58, s54, 12288
    v_add_u32 v251, s58, v251
    s_waitcnt vmcnt(16)
    ds_write_b64 v250, v[86:87] offset:36864
    ds_write_b128 v251, v[92:95] offset:49152
    ds_write_b64 v250, v[88:89] offset:40960
    ds_write_b128 v251, v[96:99] offset:53248
    ds_write_b64 v250, v[90:91] offset:45056
    ds_write_b128 v251, v[100:103] offset:57344
    s_waitcnt lgkmcnt(0)
    v_mov_b32 v86, 0xf149f2ca
    v_mov_b32 v253, 0x71800000
    v_and_b32 v88, 15, v1
    v_lshrrev_b32 v89, 4, v1
    v_cmp_eq_u32 s[100:101], s71, v89
    v_lshlrev_b32 v89, 2, v89
    v_add_u32 v87, 0, v89
    v_cmp_gt_u32 s[4:5], v87, v88
    v_add_u32 v87, 1, v89
    v_cmp_gt_u32 s[6:7], v87, v88
    v_add_u32 v87, 2, v89
    v_cmp_gt_u32 s[8:9], v87, v88
    v_add_u32 v87, 3, v89
    v_cmp_gt_u32 s[10:11], v87, v88
    s_cmp_lt_u32 s71, 2
    s_cselect_b64 s[16:17], -1, 0
    s_bitcmp0_b32 s52, 0
    s_cselect_b64 s[12:13], s[100:101], 0
    s_cselect_b64 s[14:15], 0, s[100:101]
    s_cselect_b64 s[18:19], 0, -1
    s_lshl_b32 s57, s52, 12
    v_add_u32 v248, s57, v80
    s_mul_i32 s57, s54, 12288
    s_add_u32 s57, s57, 49152
    v_add_u32 v249, s57, v2
    s_mul_i32 s57, s55, 147456
    s_add_u32 s57, s57, 59768832
    s_lshl_b32 s58, s56, 3
    s_add_u32 s58, s58, s52
    s_lshl_b32 s58, s58, 10
    s_add_u32 s72, s58, s57
    s_add_u32 s58, s56, 32
    s_lshl_b32 s58, s58, 10
    s_and_b32 s60, s52, 1
    s_lshl_b32 s59, s60, 2
    s_add_u32 s58, s58, s59
    s_add_u32 s74, s58, s57
    v_bfe_u32 v89, v1, 4, 1
    v_lshlrev_b32 v252, 9, v89
    v_lshl_add_u32 v252, v88, 4, v252
    v_lshrrev_b32 v89, 5, v1
    v_lshl_add_u32 v252, v89, 3, v252
    s_waitcnt lgkmcnt(0)
    s_barrier
    s_waitcnt vmcnt(0)
    v_mov_b32 v152, v138
    v_mov_b32 v153, v139
    v_mov_b32 v224, v142
    v_mov_b32 v225, v143
    v_mov_b32 v156, v146
    v_mov_b32 v157, v147
    v_mov_b32 v228, v150
    v_mov_b32 v229, v151
    v_mov_b32 v160, v122
    v_mov_b32 v161, v123
    v_mov_b32 v232, v126
    v_mov_b32 v233, v127
    v_mov_b32 v164, v130
    v_mov_b32 v165, v131
    v_mov_b32 v236, v134
    v_mov_b32 v237, v135
    v_mov_b32 v168, v106
    v_mov_b32 v169, v107
    v_mov_b32 v240, v110
    v_mov_b32 v241, v111
    v_mov_b32 v172, v114
    v_mov_b32 v173, v115
    v_mov_b32 v244, v118
    v_mov_b32 v245, v119
    ds_read_b64 v[138:139], v80 offset:36864
    ds_read_b64 v[154:155], v80 offset:37376
    ds_read_b64 v[142:143], v80 offset:37888
    ds_read_b64 v[226:227], v80 offset:38400
    ds_read_b64 v[146:147], v80 offset:38912
    ds_read_b64 v[158:159], v80 offset:39424
    ds_read_b64 v[150:151], v80 offset:39936
    ds_read_b64 v[230:231], v80 offset:40448
    ds_read_b64 v[122:123], v80 offset:40960
    ds_read_b64 v[162:163], v80 offset:41472
    ds_read_b64 v[126:127], v80 offset:41984
    ds_read_b64 v[234:235], v80 offset:42496
    ds_read_b64 v[130:131], v80 offset:43008
    ds_read_b64 v[166:167], v80 offset:43520
    ds_read_b64 v[134:135], v80 offset:44032
    ds_read_b64 v[238:239], v80 offset:44544
    ds_read_b64 v[106:107], v80 offset:45056
    ds_read_b64 v[170:171], v80 offset:45568
    ds_read_b64 v[110:111], v80 offset:46080
    ds_read_b64 v[242:243], v80 offset:46592
    ds_read_b64 v[114:115], v80 offset:47104
    ds_read_b64 v[174:175], v80 offset:47616
    ds_read_b64 v[118:119], v80 offset:48128
    ds_read_b64 v[246:247], v80 offset:48640
    ds_read_b64 v[60:61], v248 offset:0
    ds_read_b64 v[62:63], v80 offset:32768
    s_waitcnt lgkmcnt(0)
    s_cmp_lt_i32 s73, 0
    s_cbranch_scc1 L_head_neg
L_head:
    s_mov_b32 s67, 0
    v_cndmask_b32 v62, 0, v62, s[12:13]
    v_cndmask_b32 v63, 0, v63, s[14:15]
    ds_read_b64 v[64:65], v248 offset:512
    ds_read_b64 v[66:67], v80 offset:33280
    v_mfma_f32_16x16x32_bf16 v[16:19], v[104:107], v[60:63], 0
    ds_read_b128 v[92:95], v249 offset:0
    ds_read_b128 v[96:99], v249 offset:1024
    s_nop 5
    v_cndmask_b32 v16, v16, v86, s[4:5]
    v_cndmask_b32 v17, v17, v86, s[6:7]
    v_cndmask_b32 v18, v18, v86, s[8:9]
    v_cndmask_b32 v19, v19, v86, s[10:11]
    v_max_f32 v87, v16, v17
    v_max_f32 v88, v18, v19
    v_max_f32 v87, v87, v88
    v_mov_b32 v88, v87
    s_nop 1
    v_permlane32_swap_b32 v87, v88
    v_max_f32 v87, v87, v88
    v_mov_b32 v88, v87
    s_nop 1
    v_permlane16_swap_b32 v87, v88
    v_max_f32 v87, v87, v88
    v_sub_f32 v48, 0, v87
    v_sub_f32 v49, 0, v87
    v_sub_f32 v50, 0, v87
    v_sub_f32 v51, 0, v87
    s_nop 1
    v_mfma_f32_16x16x32_bf16 v[16:19], v[136:139], v[60:63], v[48:51]
    v_mfma_f32_16x16x32_bf16 v[20:23], v[152:155], v[60:63], v[48:51]
    v_mfma_f32_16x16x32_bf16 v[24:27], v[140:143], v[60:63], v[48:51]
    v_mfma_f32_16x16x32_bf16 v[28:31], v[224:227], v[60:63], v[48:51]
    v_mfma_f32_16x16x32_bf16 v[32:35], v[144:147], v[60:63], v[48:51]
    s_nop 3
    v_cndmask_b32 v16, v86, v16, s[4:5]
    v_cndmask_b32 v17, v86, v17, s[6:7]
    v_cndmask_b32 v18, v86, v18, s[8:9]
    v_cndmask_b32 v19, v86, v19, s[10:11]
    v_exp_f32 v16, v16
    v_exp_f32 v17, v17
    v_exp_f32 v18, v18
    v_exp_f32 v19, v19
    v_mfma_f32_16x16x32_bf16 v[36:39], v[156:159], v[60:63], v[48:51]
    v_exp_f32 v20, v20
    v_exp_f32 v21, v21
    v_exp_f32 v22, v22
    v_exp_f32 v23, v23
    v_cvt_pk_bf16_f32 v16, v16, v17
    v_cvt_pk_bf16_f32 v17, v18, v19
    v_cvt_pk_bf16_f32 v18, v20, v21
    v_cvt_pk_bf16_f32 v19, v22, v23
    ds_read_b128 v[100:103], v249 offset:2048
    s_waitcnt lgkmcnt(2)
    v_mfma_f32_16x16x32_bf16 v[68:71], v[208:211], v[16:19], 0
    v_exp_f32 v24, v24
    v_exp_f32 v25, v25
    v_exp_f32 v26, v26
    v_mfma_f32_16x16x32_bf16 v[12:15], v[92:95], v[16:19], 0
    v_exp_f32 v27, v27
    v_exp_f32 v28, v28
    v_exp_f32 v29, v29
    v_mfma_f32_16x16x32_bf16 v[40:43], v[148:151], v[60:63], v[48:51]
    v_exp_f32 v30, v30
    v_exp_f32 v31, v31
    v_cvt_pk_bf16_f32 v24, v24, v25
    v_mfma_f32_16x16x32_bf16 v[44:47], v[228:231], v[60:63], v[48:51]
    v_cvt_pk_bf16_f32 v25, v26, v27
    v_cvt_pk_bf16_f32 v26, v28, v29
    v_cvt_pk_bf16_f32 v27, v30, v31
    ds_read_b128 v[92:95], v249 offset:3072
    s_waitcnt lgkmcnt(2)
    v_mfma_f32_16x16x32_bf16 v[68:71], v[212:215], v[24:27], v[68:71]
    v_exp_f32 v32, v32
    v_exp_f32 v33, v33
    v_exp_f32 v34, v34
    v_mfma_f32_16x16x32_bf16 v[12:15], v[96:99], v[24:27], v[12:15]
    v_exp_f32 v35, v35
    v_exp_f32 v36, v36
    v_exp_f32 v37, v37
    v_mfma_f32_16x16x32_bf16 v[16:19], v[120:123], v[60:63], v[48:51]
    v_exp_f32 v38, v38
    v_exp_f32 v39, v39
    v_cvt_pk_bf16_f32 v32, v32, v33
    v_mfma_f32_16x16x32_bf16 v[20:23], v[160:163], v[60:63], v[48:51]
    v_cvt_pk_bf16_f32 v33, v34, v35
    v_cvt_pk_bf16_f32 v34, v36, v37
    v_cvt_pk_bf16_f32 v35, v38, v39
    ds_read_b128 v[96:99], v249 offset:4096
    s_waitcnt lgkmcnt(2)
    v_mfma_f32_16x16x32_bf16 v[68:71], v[216:219], v[32:35], v[68:71]
    v_exp_f32 v40, v40
    v_exp_f32 v41, v41
    v_exp_f32 v42, v42
    v_mfma_f32_16x16x32_bf16 v[12:15], v[100:103], v[32:35], v[12:15]
    v_exp_f32 v43, v43
    v_exp_f32 v44, v44
    v_exp_f32 v45, v45
    v_mfma_f32_16x16x32_bf16 v[24:27], v[124:127], v[60:63], v[48:51]
    v_exp_f32 v46, v46
    v_exp_f32 v47, v47
    v_cvt_pk_bf16_f32 v40, v40, v41
    v_mfma_f32_16x16x32_bf16 v[28:31], v[232:235], v[60:63], v[48:51]
    v_cvt_pk_bf16_f32 v41, v42, v43
    v_cvt_pk_bf16_f32 v42, v44, v45
    v_cvt_pk_bf16_f32 v43, v46, v47
    ds_read_b128 v[100:103], v249 offset:5120
    s_waitcnt lgkmcnt(2)
    v_mfma_f32_16x16x32_bf16 v[68:71], v[220:223], v[40:43], v[68:71]
    v_exp_f32 v16, v16
    v_exp_f32 v17, v17
    v_exp_f32 v18, v18
    v_mfma_f32_16x16x32_bf16 v[12:15], v[92:95], v[40:43], v[12:15]
    v_exp_f32 v19, v19
    v_exp_f32 v20, v20
    v_exp_f32 v21, v21
    v_mfma_f32_16x16x32_bf16 v[32:35], v[128:131], v[60:63], v[48:51]
    v_exp_f32 v22, v22
    v_exp_f32 v23, v23
    v_cvt_pk_bf16_f32 v16, v16, v17
    v_mfma_f32_16x16x32_bf16 v[36:39], v[164:167], v[60:63], v[48:51]
    v_cvt_pk_bf16_f32 v17, v18, v19
    v_cvt_pk_bf16_f32 v18, v20, v21
    v_cvt_pk_bf16_f32 v19, v22, v23
    ds_read_b128 v[92:95], v249 offset:6144
    s_waitcnt lgkmcnt(2)
    v_mfma_f32_16x16x32_bf16 v[68:71], v[192:195], v[16:19], v[68:71]
    v_exp_f32 v24, v24
    v_exp_f32 v25, v25
    v_exp_f32 v26, v26
    v_mfma_f32_16x16x32_bf16 v[12:15], v[96:99], v[16:19], v[12:15]
    v_exp_f32 v27, v27
    v_exp_f32 v28, v28
    v_exp_f32 v29, v29
    v_mfma_f32_16x16x32_bf16 v[40:43], v[132:135], v[60:63], v[48:51]
    v_exp_f32 v30, v30
    v_exp_f32 v31, v31
    v_cvt_pk_bf16_f32 v24, v24, v25
    v_mfma_f32_16x16x32_bf16 v[44:47], v[236:239], v[60:63], v[48:51]
    v_cvt_pk_bf16_f32 v25, v26, v27
    v_cvt_pk_bf16_f32 v26, v28, v29
    v_cvt_pk_bf16_f32 v27, v30, v31
    ds_read_b128 v[96:99], v249 offset:7168
    s_waitcnt lgkmcnt(2)
    v_mfma_f32_16x16x32_bf16 v[68:71], v[196:199], v[24:27], v[68:71]
    v_exp_f32 v32, v32
    v_exp_f32 v33, v33
    v_exp_f32 v34, v34
    v_exp_f32 v35, v35
    v_mfma_f32_16x16x32_bf16 v[12:15], v[100:103], v[24:27], v[12:15]
    v_exp_f32 v36, v36
    v_exp_f32 v37, v37
    v_exp_f32 v38, v38
    v_exp_f32 v39, v39
    v_mfma_f32_16x16x32_bf16 v[16:19], v[104:107], v[60:63], v[48:51]
    v_cvt_pk_bf16_f32 v32, v32, v33
    v_cvt_pk_bf16_f32 v33, v34, v35
    v_cvt_pk_bf16_f32 v34, v36, v37
    v_cvt_pk_bf16_f32 v35, v38, v39
    ds_read_b128 v[100:103], v249 offset:8192
    s_waitcnt lgkmcnt(2)
    v_mfma_f32_16x16x32_bf16 v[68:71], v[200:203], v[32:35], v[68:71]
    v_exp_f32 v40, v40
    v_exp_f32 v41, v41
    v_exp_f32 v42, v42
    v_exp_f32 v43, v43
    v_exp_f32 v44, v44
    v_exp_f32 v45, v45
    v_mfma_f32_16x16x32_bf16 v[12:15], v[92:95], v[32:35], v[12:15]
    v_exp_f32 v46, v46
    v_exp_f32 v47, v47
    v_cvt_pk_bf16_f32 v40, v40, v41
    v_cvt_pk_bf16_f32 v41, v42, v43
    v_cvt_pk_bf16_f32 v42, v44, v45
    v_cvt_pk_bf16_f32 v43, v46, v47
    s_waitcnt lgkmcnt(1)
    s_nop 0
    v_mfma_f32_16x16x32_bf16 v[68:71], v[204:207], v[40:43], v[68:71]
    v_cndmask_b32 v16, v16, v86, s[4:5]
    v_cndmask_b32 v17, v17, v86, s[6:7]
    v_cndmask_b32 v18, v18, v86, s[8:9]
    v_cndmask_b32 v19, v19, v86, s[10:11]
    v_exp_f32 v16, v16
    v_exp_f32 v17, v17
    v_mfma_f32_16x16x32_bf16 v[12:15], v[96:99], v[40:43], v[12:15]
    v_exp_f32 v18, v18
    v_exp_f32 v19, v19
    v_cvt_pk_bf16_f32 v16, v16, v17
    v_cvt_pk_bf16_f32 v17, v18, v19
    v_mov_b32 v18, 0
    v_mov_b32 v19, 0
    s_waitcnt lgkmcnt(0)
    s_nop 0
    v_mfma_f32_16x16x32_bf16 v[68:71], v[176:179], v[16:19], v[68:71]
    v_mfma_f32_16x16x32_bf16 v[12:15], v[100:103], v[16:19], v[12:15]
    s_nop 6
    v_add_f32 v250, |v68|, |v69|
    v_add_f32 v251, |v70|, |v71|
    v_add_f32 v88, |v12|, |v13|
    v_add_f32 v89, |v14|, |v15|
    v_add_f32 v250, v250, v251
    v_add_f32 v88, v88, v89
    v_add_f32 v250, v250, v88
    v_cmp_nle_f32 vcc, v250, v253
    s_cbranch_vccnz L_slowq0
L_cont0:
    v_mov_b32 v88, v12
    v_mov_b32 v89, v12
    s_nop 1
    v_permlane32_swap_b32 v88, v89
    v_cndmask_b32 v88, v88, v89, s[16:17]
    v_rcp_f32 v88, v88
    v_cndmask_b32 v12, v12, v14, s[18:19]
    v_cndmask_b32 v13, v13, v15, s[18:19]
    v_mul_f32 v68, v68, v88
    v_mul_f32 v69, v69, v88
    v_mul_f32 v70, v70, v88
    v_mul_f32 v71, v71, v88
    v_mul_f32 v12, v12, v88
    v_mul_f32 v13, v13, v88
    v_cvt_pk_bf16_f32 v90, v68, v69
    v_cvt_pk_bf16_f32 v91, v70, v71
    v_cvt_pk_bf16_f32 v89, v12, v13
    s_add_u32 s58, s72, 0
    buffer_store_dwordx2 v[90:91], v252, s[36:39], s58 offen sc1
    s_add_u32 s58, s74, 0
    s_mov_b64 exec, s[100:101]
    buffer_store_dword v89, v252, s[36:39], s58 offen sc1
    s_mov_b64 exec, -1
    v_cndmask_b32 v66, 0, v66, s[12:13]
    v_cndmask_b32 v67, 0, v67, s[14:15]
    ds_read_b64 v[60:61], v248 offset:1024
    ds_read_b64 v[62:63], v80 offset:33792
    v_mfma_f32_16x16x32_bf16 v[16:19], v[168:171], v[64:67], 0
    ds_read_b128 v[92:95], v249 offset:0
    ds_read_b128 v[96:99], v249 offset:1024
    s_nop 5
    v_cndmask_b32 v16, v16, v86, s[4:5]
    v_cndmask_b32 v17, v17, v86, s[6:7]
    v_cndmask_b32 v18, v18, v86, s[8:9]
    v_cndmask_b32 v19, v19, v86, s[10:11]
    v_max_f32 v87, v16, v17
    v_max_f32 v88, v18, v19
    v_max_f32 v87, v87, v88
    v_mov_b32 v88, v87
    s_nop 1
    v_permlane32_swap_b32 v87, v88
    v_max_f32 v87, v87, v88
    v_mov_b32 v88, v87
    s_nop 1
    v_permlane16_swap_b32 v87, v88
    v_max_f32 v87, v87, v88
    v_sub_f32 v48, 0, v87
    v_sub_f32 v49, 0, v87
    v_sub_f32 v50, 0, v87
    v_sub_f32 v51, 0, v87
    s_nop 1
    v_mfma_f32_16x16x32_bf16 v[20:23], v[152:155], v[64:67], v[48:51]
    v_mfma_f32_16x16x32_bf16 v[24:27], v[140:143], v[64:67], v[48:51]
    v_mfma_f32_16x16x32_bf16 v[28:31], v[224:227], v[64:67], v[48:51]
    v_mfma_f32_16x16x32_bf16 v[32:35], v[144:147], v[64:67], v[48:51]
    s_nop 4
    v_cndmask_b32 v20, v86, v20, s[4:5]
    v_cndmask_b32 v21, v86, v21, s[6:7]
    v_cndmask_b32 v22, v86, v22, s[8:9]
    v_cndmask_b32 v23, v86, v23, s[10:11]
    v_exp_f32 v20, v20
    v_exp_f32 v21, v21
    v_mfma_f32_16x16x32_bf16 v[36:39], v[156:159], v[64:67], v[48:51]
    v_exp_f32 v22, v22
    v_exp_f32 v23, v23
    v_mov_b32 v16, 0
    v_mov_b32 v17, 0
    v_cvt_pk_bf16_f32 v18, v20, v21
    v_cvt_pk_bf16_f32 v19, v22, v23
    ds_read_b128 v[100:103], v249 offset:2048
    s_waitcnt lgkmcnt(2)
    v_mfma_f32_16x16x32_bf16 v[68:71], v[208:211], v[16:19], 0
    v_exp_f32 v24, v24
    v_exp_f32 v25, v25
    v_exp_f32 v26, v26
    v_mfma_f32_16x16x32_bf16 v[12:15], v[92:95], v[16:19], 0
    v_exp_f32 v27, v27
    v_exp_f32 v28, v28
    v_exp_f32 v29, v29
    v_mfma_f32_16x16x32_bf16 v[40:43], v[148:151], v[64:67], v[48:51]
    v_exp_f32 v30, v30
    v_exp_f32 v31, v31
    v_cvt_pk_bf16_f32 v24, v24, v25
    v_mfma_f32_16x16x32_bf16 v[44:47], v[228:231], v[64:67], v[48:51]
    v_cvt_pk_bf16_f32 v25, v26, v27
    v_cvt_pk_bf16_f32 v26, v28, v29
    v_cvt_pk_bf16_f32 v27, v30, v31
    ds_read_b128 v[92:95], v249 offset:3072
    s_waitcnt lgkmcnt(2)
    v_mfma_f32_16x16x32_bf16 v[68:71], v[212:215], v[24:27], v[68:71]
    v_exp_f32 v32, v32
    v_exp_f32 v33, v33
    v_exp_f32 v34, v34
    v_mfma_f32_16x16x32_bf16 v[12:15], v[96:99], v[24:27], v[12:15]
    v_exp_f32 v35, v35
    v_exp_f32 v36, v36
    v_exp_f32 v37, v37
    v_mfma_f32_16x16x32_bf16 v[16:19], v[120:123], v[64:67], v[48:51]
    v_exp_f32 v38, v38
    v_exp_f32 v39, v39
    v_cvt_pk_bf16_f32 v32, v32, v33
    v_mfma_f32_16x16x32_bf16 v[20:23], v[160:163], v[64:67], v[48:51]
    v_cvt_pk_bf16_f32 v33, v34, v35
    v_cvt_pk_bf16_f32 v34, v36, v37
    v_cvt_pk_bf16_f32 v35, v38, v39
    ds_read_b128 v[96:99], v249 offset:4096
    s_waitcnt lgkmcnt(2)
    v_mfma_f32_16x16x32_bf16 v[68:71], v[216:219], v[32:35], v[68:71]
    v_exp_f32 v40, v40
    v_exp_f32 v41, v41
    v_exp_f32 v42, v42
    v_mfma_f32_16x16x32_bf16 v[12:15], v[100:103], v[32:35], v[12:15]
    v_exp_f32 v43, v43
    v_exp_f32 v44, v44
    v_exp_f32 v45, v45
    v_mfma_f32_16x16x32_bf16 v[24:27], v[124:127], v[64:67], v[48:51]
    v_exp_f32 v46, v46
    v_exp_f32 v47, v47
    v_cvt_pk_bf16_f32 v40, v40, v41
    v_mfma_f32_16x16x32_bf16 v[28:31], v[232:235], v[64:67], v[48:51]
    v_cvt_pk_bf16_f32 v41, v42, v43
    v_cvt_pk_bf16_f32 v42, v44, v45
    v_cvt_pk_bf16_f32 v43, v46, v47
    ds_read_b128 v[100:103], v249 offset:5120
    s_waitcnt lgkmcnt(2)
    v_mfma_f32_16x16x32_bf16 v[68:71], v[220:223], v[40:43], v[68:71]
    v_exp_f32 v16, v16
    v_exp_f32 v17, v17
    v_exp_f32 v18, v18
    v_mfma_f32_16x16x32_bf16 v[12:15], v[92:95], v[40:43], v[12:15]
    v_exp_f32 v19, v19
    v_exp_f32 v20, v20
    v_exp_f32 v21, v21
    v_mfma_f32_16x16x32_bf16 v[32:35], v[128:131], v[64:67], v[48:51]
    v_exp_f32 v22, v22
    v_exp_f32 v23, v23
    v_cvt_pk_bf16_f32 v16, v16, v17
    v_mfma_f32_16x16x32_bf16 v[36:39], v[164:167], v[64:67], v[48:51]
    v_cvt_pk_bf16_f32 v17, v18, v19
    v_cvt_pk_bf16_f32 v18, v20, v21
    v_cvt_pk_bf16_f32 v19, v22, v23
    ds_read_b128 v[92:95], v249 offset:6144
    s_waitcnt lgkmcnt(2)
    v_mfma_f32_16x16x32_bf16 v[68:71], v[192:195], v[16:19], v[68:71]
    v_exp_f32 v24, v24
    v_exp_f32 v25, v25
    v_exp_f32 v26, v26
    v_mfma_f32_16x16x32_bf16 v[12:15], v[96:99], v[16:19], v[12:15]
    v_exp_f32 v27, v27
    v_exp_f32 v28, v28
    v_exp_f32 v29, v29
    v_mfma_f32_16x16x32_bf16 v[40:43], v[132:135], v[64:67], v[48:51]
    v_exp_f32 v30, v30
    v_exp_f32 v31, v31
    v_cvt_pk_bf16_f32 v24, v24, v25
    v_mfma_f32_16x16x32_bf16 v[44:47], v[236:239], v[64:67], v[48:51]
    v_cvt_pk_bf16_f32 v25, v26, v27
    v_cvt_pk_bf16_f32 v26, v28, v29
    v_cvt_pk_bf16_f32 v27, v30, v31
    ds_read_b128 v[96:99], v249 offset:7168
    s_waitcnt lgkmcnt(2)
    v_mfma_f32_16x16x32_bf16 v[68:71], v[196:199], v[24:27], v[68:71]
    v_exp_f32 v32, v32
    v_exp_f32 v33, v33
    v_exp_f32 v34, v34
    v_mfma_f32_16x16x32_bf16 v[12:15], v[100:103], v[24:27], v[12:15]
    v_exp_f32 v35, v35
    v_exp_f32 v36, v36
    v_exp_f32 v37, v37
    v_mfma_f32_16x16x32_bf16 v[16:19], v[104:107], v[64:67], v[48:51]
    v_exp_f32 v38, v38
    v_exp_f32 v39, v39
    v_cvt_pk_bf16_f32 v32, v32, v33
    v_mfma_f32_16x16x32_bf16 v[20:23], v[168:171], v[64:67], v[48:51]
    v_cvt_pk_bf16_f32 v33, v34, v35
    v_cvt_pk_bf16_f32 v34, v36, v37
    v_cvt_pk_bf16_f32 v35, v38, v39
    ds_read_b128 v[100:103], v249 offset:8192
    s_waitcnt lgkmcnt(2)
    v_mfma_f32_16x16x32_bf16 v[68:71], v[200:203], v[32:35], v[68:71]
    v_exp_f32 v40, v40
    v_exp_f32 v41, v41
    v_exp_f32 v42, v42
    v_exp_f32 v43, v43
    v_exp_f32 v44, v44
    v_exp_f32 v45, v45
    v_mfma_f32_16x16x32_bf16 v[12:15], v[92:95], v[32:35], v[12:15]
    v_exp_f32 v46, v46
    v_exp_f32 v47, v47
    v_cvt_pk_bf16_f32 v40, v40, v41
    v_cvt_pk_bf16_f32 v41, v42, v43
    v_cvt_pk_bf16_f32 v42, v44, v45
    v_cvt_pk_bf16_f32 v43, v46, v47
    s_waitcnt lgkmcnt(1)
    s_nop 0
    v_mfma_f32_16x16x32_bf16 v[68:71], v[204:207], v[40:43], v[68:71]
    v_exp_f32 v16, v16
    v_exp_f32 v17, v17
    v_exp_f32 v18, v18
    v_exp_f32 v19, v19
    v_cndmask_b32 v20, v20, v86, s[4:5]
    v_cndmask_b32 v21, v21, v86, s[6:7]
    v_cndmask_b32 v22, v22, v86, s[8:9]
    v_cndmask_b32 v23, v23, v86, s[10:11]
    v_mfma_f32_16x16x32_bf16 v[12:15], v[96:99], v[40:43], v[12:15]
    v_exp_f32 v20, v20
    v_exp_f32 v21, v21
    v_exp_f32 v22, v22
    v_exp_f32 v23, v23
    v_cvt_pk_bf16_f32 v16, v16, v17
    v_cvt_pk_bf16_f32 v17, v18, v19
    v_cvt_pk_bf16_f32 v18, v20, v21
    v_cvt_pk_bf16_f32 v19, v22, v23
    s_waitcnt lgkmcnt(0)
    s_nop 0
    v_mfma_f32_16x16x32_bf16 v[68:71], v[176:179], v[16:19], v[68:71]
    v_mfma_f32_16x16x32_bf16 v[12:15], v[100:103], v[16:19], v[12:15]
    s_nop 6
    v_add_f32 v250, |v68|, |v69|
    v_add_f32 v251, |v70|, |v71|
    v_add_f32 v88, |v12|, |v13|
    v_add_f32 v89, |v14|, |v15|
    v_add_f32 v250, v250, v251
    v_add_f32 v88, v88, v89
    v_add_f32 v250, v250, v88
    v_cmp_nle_f32 vcc, v250, v253
    s_cbranch_vccnz L_slowq1
L_cont1:
    v_mov_b32 v88, v12
    v_mov_b32 v89, v12
    s_nop 1
    v_permlane32_swap_b32 v88, v89
    v_cndmask_b32 v88, v88, v89, s[16:17]
    v_rcp_f32 v88, v88
    v_cndmask_b32 v12, v12, v14, s[18:19]
    v_cndmask_b32 v13, v13, v15, s[18:19]
    v_mul_f32 v68, v68, v88
    v_mul_f32 v69, v69, v88
    v_mul_f32 v70, v70, v88
    v_mul_f32 v71, v71, v88
    v_mul_f32 v12, v12, v88
    v_mul_f32 v13, v13, v88
    v_cvt_pk_bf16_f32 v90, v68, v69
    v_cvt_pk_bf16_f32 v91, v70, v71
    v_cvt_pk_bf16_f32 v89, v12, v13
    s_add_u32 s58, s72, 256
    buffer_store_dwordx2 v[90:91], v252, s[36:39], s58 offen sc1
    s_add_u32 s58, s74, 256
    s_mov_b64 exec, s[100:101]
    buffer_store_dword v89, v252, s[36:39], s58 offen sc1
    s_mov_b64 exec, -1
    v_cndmask_b32 v62, 0, v62, s[12:13]
    v_cndmask_b32 v63, 0, v63, s[14:15]
    ds_read_b64 v[64:65], v248 offset:1536
    ds_read_b64 v[66:67], v80 offset:34304
    v_mfma_f32_16x16x32_bf16 v[16:19], v[108:111], v[60:63], 0
    ds_read_b128 v[92:95], v249 offset:1024
    ds_read_b128 v[96:99], v249 offset:2048
    s_nop 5
    v_cndmask_b32 v16, v16, v86, s[4:5]
    v_cndmask_b32 v17, v17, v86, s[6:7]
    v_cndmask_b32 v18, v18, v86, s[8:9]
    v_cndmask_b32 v19, v19, v86, s[10:11]
    v_max_f32 v87, v16, v17
    v_max_f32 v88, v18, v19
    v_max_f32 v87, v87, v88
    v_mov_b32 v88, v87
    s_nop 1
    v_permlane32_swap_b32 v87, v88
    v_max_f32 v87, v87, v88
    v_mov_b32 v88, v87
    s_nop 1
    v_permlane16_swap_b32 v87, v88
    v_max_f32 v87, v87, v88
    v_sub_f32 v48, 0, v87
    v_sub_f32 v49, 0, v87
    v_sub_f32 v50, 0, v87
    v_sub_f32 v51, 0, v87
    s_nop 1
    v_mfma_f32_16x16x32_bf16 v[16:19], v[140:143], v[60:63], v[48:51]
    v_mfma_f32_16x16x32_bf16 v[20:23], v[224:227], v[60:63], v[48:51]
    v_mfma_f32_16x16x32_bf16 v[24:27], v[144:147], v[60:63], v[48:51]
    v_mfma_f32_16x16x32_bf16 v[28:31], v[156:159], v[60:63], v[48:51]
    v_mfma_f32_16x16x32_bf16 v[32:35], v[148:151], v[60:63], v[48:51]
    s_nop 3
    v_cndmask_b32 v16, v86, v16, s[4:5]
    v_cndmask_b32 v17, v86, v17, s[6:7]
    v_cndmask_b32 v18, v86, v18, s[8:9]
    v_cndmask_b32 v19, v86, v19, s[10:11]
    v_exp_f32 v16, v16
    v_exp_f32 v17, v17
    v_exp_f32 v18, v18
    v_exp_f32 v19, v19
    v_mfma_f32_16x16x32_bf16 v[36:39], v[228:231], v[60:63], v[48:51]
    v_exp_f32 v20, v20
    v_exp_f32 v21, v21
    v_exp_f32 v22, v22
    v_exp_f32 v23, v23
    v_cvt_pk_bf16_f32 v16, v16, v17
    v_cvt_pk_bf16_f32 v17, v18, v19
    v_cvt_pk_bf16_f32 v18, v20, v21
    v_cvt_pk_bf16_f32 v19, v22, v23
    ds_read_b128 v[100:103], v249 offset:3072
    s_waitcnt lgkmcnt(2)
    v_mfma_f32_16x16x32_bf16 v[68:71], v[212:215], v[16:19], 0
    v_exp_f32 v24, v24
    v_exp_f32 v25, v25
    v_exp_f32 v26, v26
    v_mfma_f32_16x16x32_bf16 v[12:15], v[92:95], v[16:19], 0
    v_exp_f32 v27, v27
    v_exp_f32 v28, v28
    v_exp_f32 v29, v29
    v_mfma_f32_16x16x32_bf16 v[40:43], v[120:123], v[60:63], v[48:51]
    v_exp_f32 v30, v30
    v_exp_f32 v31, v31
    v_cvt_pk_bf16_f32 v24, v24, v25
    v_mfma_f32_16x16x32_bf16 v[44:47], v[160:163], v[60:63], v[48:51]
    v_cvt_pk_bf16_f32 v25, v26, v27
    v_cvt_pk_bf16_f32 v26, v28, v29
    v_cvt_pk_bf16_f32 v27, v30, v31
    ds_read_b128 v[92:95], v249 offset:4096
    s_waitcnt lgkmcnt(2)
    v_mfma_f32_16x16x32_bf16 v[68:71], v[216:219], v[24:27], v[68:71]
    v_exp_f32 v32, v32
    v_exp_f32 v33, v33
    v_exp_f32 v34, v34
    v_mfma_f32_16x16x32_bf16 v[12:15], v[96:99], v[24:27], v[12:15]
    v_exp_f32 v35, v35
    v_exp_f32 v36, v36
    v_exp_f32 v37, v37
    v_mfma_f32_16x16x32_bf16 v[16:19], v[124:127], v[60:63], v[48:51]
    v_exp_f32 v38, v38
    v_exp_f32 v39, v39
    v_cvt_pk_bf16_f32 v32, v32, v33
    v_mfma_f32_16x16x32_bf16 v[20:23], v[232:235], v[60:63], v[48:51]
    v_cvt_pk_bf16_f32 v33, v34, v35
    v_cvt_pk_bf16_f32 v34, v36, v37
    v_cvt_pk_bf16_f32 v35, v38, v39
    ds_read_b128 v[96:99], v249 offset:5120
    s_waitcnt lgkmcnt(2)
    v_mfma_f32_16x16x32_bf16 v[68:71], v[220:223], v[32:35], v[68:71]
    v_exp_f32 v40, v40
    v_exp_f32 v41, v41
    v_exp_f32 v42, v42
    v_mfma_f32_16x16x32_bf16 v[12:15], v[100:103], v[32:35], v[12:15]
    v_exp_f32 v43, v43
    v_exp_f32 v44, v44
    v_exp_f32 v45, v45
    v_mfma_f32_16x16x32_bf16 v[24:27], v[128:131], v[60:63], v[48:51]
    v_exp_f32 v46, v46
    v_exp_f32 v47, v47
    v_cvt_pk_bf16_f32 v40, v40, v41
    v_mfma_f32_16x16x32_bf16 v[28:31], v[164:167], v[60:63], v[48:51]
    v_cvt_pk_bf16_f32 v41, v42, v43
    v_cvt_pk_bf16_f32 v42, v44, v45
    v_cvt_pk_bf16_f32 v43, v46, v47
    ds_read_b128 v[100:103], v249 offset:6144
    s_waitcnt lgkmcnt(2)
    v_mfma_f32_16x16x32_bf16 v[68:71], v[192:195], v[40:43], v[68:71]
    v_exp_f32 v16, v16
    v_exp_f32 v17, v17
    v_exp_f32 v18, v18
    v_mfma_f32_16x16x32_bf16 v[12:15], v[92:95], v[40:43], v[12:15]
    v_exp_f32 v19, v19
    v_exp_f32 v20, v20
    v_exp_f32 v21, v21
    v_mfma_f32_16x16x32_bf16 v[32:35], v[132:135], v[60:63], v[48:51]
    v_exp_f32 v22, v22
    v_exp_f32 v23, v23
    v_cvt_pk_bf16_f32 v16, v16, v17
    v_mfma_f32_16x16x32_bf16 v[36:39], v[236:239], v[60:63], v[48:51]
    v_cvt_pk_bf16_f32 v17, v18, v19
    v_cvt_pk_bf16_f32 v18, v20, v21
    v_cvt_pk_bf16_f32 v19, v22, v23
    ds_read_b128 v[92:95], v249 offset:7168
    s_waitcnt lgkmcnt(2)
    v_mfma_f32_16x16x32_bf16 v[68:71], v[196:199], v[16:19], v[68:71]
    v_exp_f32 v24, v24
    v_exp_f32 v25, v25
    v_exp_f32 v26, v26
    v_mfma_f32_16x16x32_bf16 v[12:15], v[96:99], v[16:19], v[12:15]
    v_exp_f32 v27, v27
    v_exp_f32 v28, v28
    v_exp_f32 v29, v29
    v_mfma_f32_16x16x32_bf16 v[40:43], v[104:107], v[60:63], v[48:51]
    v_exp_f32 v30, v30
    v_exp_f32 v31, v31
    v_cvt_pk_bf16_f32 v24, v24, v25
    v_mfma_f32_16x16x32_bf16 v[44:47], v[168:171], v[60:63], v[48:51]
    v_cvt_pk_bf16_f32 v25, v26, v27
    v_cvt_pk_bf16_f32 v26, v28, v29
    v_cvt_pk_bf16_f32 v27, v30, v31
    ds_read_b128 v[96:99], v249 offset:8192
    s_waitcnt lgkmcnt(2)
    v_mfma_f32_16x16x32_bf16 v[68:71], v[200:203], v[24:27], v[68:71]
    v_exp_f32 v32, v32
    v_exp_f32 v33, v33
    v_exp_f32 v34, v34
    v_exp_f32 v35, v35
    v_mfma_f32_16x16x32_bf16 v[12:15], v[100:103], v[24:27], v[12:15]
    v_exp_f32 v36, v36
    v_exp_f32 v37, v37
    v_exp_f32 v38, v38
    v_exp_f32 v39, v39
    v_mfma_f32_16x16x32_bf16 v[16:19], v[108:111], v[60:63], v[48:51]
    v_cvt_pk_bf16_f32 v32, v32, v33
    v_cvt_pk_bf16_f32 v33, v34, v35
    v_cvt_pk_bf16_f32 v34, v36, v37
    v_cvt_pk_bf16_f32 v35, v38, v39
    ds_read_b128 v[100:103], v249 offset:9216
    s_waitcnt lgkmcnt(2)
    v_mfma_f32_16x16x32_bf16 v[68:71], v[204:207], v[32:35], v[68:71]
    v_exp_f32 v40, v40
    v_exp_f32 v41, v41
    v_exp_f32 v42, v42
    v_exp_f32 v43, v43
    v_exp_f32 v44, v44
    v_exp_f32 v45, v45
    v_mfma_f32_16x16x32_bf16 v[12:15], v[92:95], v[32:35], v[12:15]
    v_exp_f32 v46, v46
    v_exp_f32 v47, v47
    v_cvt_pk_bf16_f32 v40, v40, v41
    v_cvt_pk_bf16_f32 v41, v42, v43
    v_cvt_pk_bf16_f32 v42, v44, v45
    v_cvt_pk_bf16_f32 v43, v46, v47
    s_waitcnt lgkmcnt(1)
    s_nop 0
    v_mfma_f32_16x16x32_bf16 v[68:71], v[176:179], v[40:43], v[68:71]
    v_cndmask_b32 v16, v16, v86, s[4:5]
    v_cndmask_b32 v17, v17, v86, s[6:7]
    v_cndmask_b32 v18, v18, v86, s[8:9]
    v_cndmask_b32 v19, v19, v86, s[10:11]
    v_exp_f32 v16, v16
    v_exp_f32 v17, v17
    v_mfma_f32_16x16x32_bf16 v[12:15], v[96:99], v[40:43], v[12:15]
    v_exp_f32 v18, v18
    v_exp_f32 v19, v19
    v_cvt_pk_bf16_f32 v16, v16, v17
    v_cvt_pk_bf16_f32 v17, v18, v19
    v_mov_b32 v18, 0
    v_mov_b32 v19, 0
    s_waitcnt lgkmcnt(0)
    s_nop 0
    v_mfma_f32_16x16x32_bf16 v[68:71], v[180:183], v[16:19], v[68:71]
    v_mfma_f32_16x16x32_bf16 v[12:15], v[100:103], v[16:19], v[12:15]
    s_nop 6
    v_add_f32 v250, |v68|, |v69|
    v_add_f32 v251, |v70|, |v71|
    v_add_f32 v88, |v12|, |v13|
    v_add_f32 v89, |v14|, |v15|
    v_add_f32 v250, v250, v251
    v_add_f32 v88, v88, v89
    v_add_f32 v250, v250, v88
    v_cmp_nle_f32 vcc, v250, v253
    s_cbranch_vccnz L_slowq2
L_cont2:
    v_mov_b32 v88, v12
    v_mov_b32 v89, v12
    s_nop 1
    v_permlane32_swap_b32 v88, v89
    v_cndmask_b32 v88, v88, v89, s[16:17]
    v_rcp_f32 v88, v88
    v_cndmask_b32 v12, v12, v14, s[18:19]
    v_cndmask_b32 v13, v13, v15, s[18:19]
    v_mul_f32 v68, v68, v88
    v_mul_f32 v69, v69, v88
    v_mul_f32 v70, v70, v88
    v_mul_f32 v71, v71, v88
    v_mul_f32 v12, v12, v88
    v_mul_f32 v13, v13, v88
    v_cvt_pk_bf16_f32 v90, v68, v69
    v_cvt_pk_bf16_f32 v91, v70, v71
    v_cvt_pk_bf16_f32 v89, v12, v13
    s_add_u32 s58, s72, 36864
    buffer_store_dwordx2 v[90:91], v252, s[36:39], s58 offen sc1
    s_add_u32 s58, s74, 36864
    s_mov_b64 exec, s[100:101]
    buffer_store_dword v89, v252, s[36:39], s58 offen sc1
    s_mov_b64 exec, -1
    v_cndmask_b32 v66, 0, v66, s[12:13]
    v_cndmask_b32 v67, 0, v67, s[14:15]
    ds_read_b64 v[60:61], v248 offset:2048
    ds_read_b64 v[62:63], v80 offset:34816
    v_mfma_f32_16x16x32_bf16 v[16:19], v[240:243], v[64:67], 0
    ds_read_b128 v[92:95], v249 offset:1024
    ds_read_b128 v[96:99], v249 offset:2048
    s_nop 5
    v_cndmask_b32 v16, v16, v86, s[4:5]
    v_cndmask_b32 v17, v17, v86, s[6:7]
    v_cndmask_b32 v18, v18, v86, s[8:9]
    v_cndmask_b32 v19, v19, v86, s[10:11]
    v_max_f32 v87, v16, v17
    v_max_f32 v88, v18, v19
    v_max_f32 v87, v87, v88
    v_mov_b32 v88, v87
    s_nop 1
    v_permlane32_swap_b32 v87, v88
    v_max_f32 v87, v87, v88
    v_mov_b32 v88, v87
    s_nop 1
    v_permlane16_swap_b32 v87, v88
    v_max_f32 v87, v87, v88
    v_sub_f32 v48, 0, v87
    v_sub_f32 v49, 0, v87
    v_sub_f32 v50, 0, v87
    v_sub_f32 v51, 0, v87
    s_nop 1
    v_mfma_f32_16x16x32_bf16 v[20:23], v[224:227], v[64:67], v[48:51]
    v_mfma_f32_16x16x32_bf16 v[24:27], v[144:147], v[64:67], v[48:51]
    v_mfma_f32_16x16x32_bf16 v[28:31], v[156:159], v[64:67], v[48:51]
    v_mfma_f32_16x16x32_bf16 v[32:35], v[148:151], v[64:67], v[48:51]
    s_nop 4
    v_cndmask_b32 v20, v86, v20, s[4:5]
    v_cndmask_b32 v21, v86, v21, s[6:7]
    v_cndmask_b32 v22, v86, v22, s[8:9]
    v_cndmask_b32 v23, v86, v23, s[10:11]
    v_exp_f32 v20, v20
    v_exp_f32 v21, v21
    v_mfma_f32_16x16x32_bf16 v[36:39], v[228:231], v[64:67], v[48:51]
    v_exp_f32 v22, v22
    v_exp_f32 v23, v23
    v_mov_b32 v16, 0
    v_mov_b32 v17, 0
    v_cvt_pk_bf16_f32 v18, v20, v21
    v_cvt_pk_bf16_f32 v19, v22, v23
    ds_read_b128 v[100:103], v249 offset:3072
    s_waitcnt lgkmcnt(2)
    v_mfma_f32_16x16x32_bf16 v[68:71], v[212:215], v[16:19], 0
    v_exp_f32 v24, v24
    v_exp_f32 v25, v25
    v_exp_f32 v26, v26
    v_mfma_f32_16x16x32_bf16 v[12:15], v[92:95], v[16:19], 0
    v_exp_f32 v27, v27
    v_exp_f32 v28, v28
    v_exp_f32 v29, v29
    v_mfma_f32_16x16x32_bf16 v[40:43], v[120:123], v[64:67], v[48:51]
    v_exp_f32 v30, v30
    v_exp_f32 v31, v31
    v_cvt_pk_bf16_f32 v24, v24, v25
    v_mfma_f32_16x16x32_bf16 v[44:47], v[160:163], v[64:67], v[48:51]
    v_cvt_pk_bf16_f32 v25, v26, v27
    v_cvt_pk_bf16_f32 v26, v28, v29
    v_cvt_pk_bf16_f32 v27, v30, v31
    ds_read_b128 v[92:95], v249 offset:4096
    s_waitcnt lgkmcnt(2)
    v_mfma_f32_16x16x32_bf16 v[68:71], v[216:219], v[24:27], v[68:71]
    v_exp_f32 v32, v32
    v_exp_f32 v33, v33
    v_exp_f32 v34, v34
    v_mfma_f32_16x16x32_bf16 v[12:15], v[96:99], v[24:27], v[12:15]
    v_exp_f32 v35, v35
    v_exp_f32 v36, v36
    v_exp_f32 v37, v37
    v_mfma_f32_16x16x32_bf16 v[16:19], v[124:127], v[64:67], v[48:51]
    v_exp_f32 v38, v38
    v_exp_f32 v39, v39
    v_cvt_pk_bf16_f32 v32, v32, v33
    v_mfma_f32_16x16x32_bf16 v[20:23], v[232:235], v[64:67], v[48:51]
    v_cvt_pk_bf16_f32 v33, v34, v35
    v_cvt_pk_bf16_f32 v34, v36, v37
    v_cvt_pk_bf16_f32 v35, v38, v39
    ds_read_b128 v[96:99], v249 offset:5120
    s_waitcnt lgkmcnt(2)
    v_mfma_f32_16x16x32_bf16 v[68:71], v[220:223], v[32:35], v[68:71]
    v_exp_f32 v40, v40
    v_exp_f32 v41, v41
    v_exp_f32 v42, v42
    v_mfma_f32_16x16x32_bf16 v[12:15], v[100:103], v[32:35], v[12:15]
    v_exp_f32 v43, v43
    v_exp_f32 v44, v44
    v_exp_f32 v45, v45
    v_mfma_f32_16x16x32_bf16 v[24:27], v[128:131], v[64:67], v[48:51]
    v_exp_f32 v46, v46
    v_exp_f32 v47, v47
    v_cvt_pk_bf16_f32 v40, v40, v41
    v_mfma_f32_16x16x32_bf16 v[28:31], v[164:167], v[64:67], v[48:51]
    v_cvt_pk_bf16_f32 v41, v42, v43
    v_cvt_pk_bf16_f32 v42, v44, v45
    v_cvt_pk_bf16_f32 v43, v46, v47
    ds_read_b128 v[100:103], v249 offset:6144
    s_waitcnt lgkmcnt(2)
    v_mfma_f32_16x16x32_bf16 v[68:71], v[192:195], v[40:43], v[68:71]
    v_exp_f32 v16, v16
    v_exp_f32 v17, v17
    v_exp_f32 v18, v18
    v_mfma_f32_16x16x32_bf16 v[12:15], v[92:95], v[40:43], v[12:15]
    v_exp_f32 v19, v19
    v_exp_f32 v20, v20
    v_exp_f32 v21, v21
    v_mfma_f32_16x16x32_bf16 v[32:35], v[132:135], v[64:67], v[48:51]
    v_exp_f32 v22, v22
    v_exp_f32 v23, v23
    v_cvt_pk_bf16_f32 v16, v16, v17
    v_mfma_f32_16x16x32_bf16 v[36:39], v[236:239], v[64:67], v[48:51]
    v_cvt_pk_bf16_f32 v17, v18, v19
    v_cvt_pk_bf16_f32 v18, v20, v21
    v_cvt_pk_bf16_f32 v19, v22, v23
    ds_read_b128 v[92:95], v249 offset:7168
    s_waitcnt lgkmcnt(2)
    v_mfma_f32_16x16x32_bf16 v[68:71], v[196:199], v[16:19], v[68:71]
    v_exp_f32 v24, v24
    v_exp_f32 v25, v25
    v_exp_f32 v26, v26
    v_mfma_f32_16x16x32_bf16 v[12:15], v[96:99], v[16:19], v[12:15]
    v_exp_f32 v27, v27
    v_exp_f32 v28, v28
    v_exp_f32 v29, v29
    v_mfma_f32_16x16x32_bf16 v[40:43], v[104:107], v[64:67], v[48:51]
    v_exp_f32 v30, v30
    v_exp_f32 v31, v31
    v_cvt_pk_bf16_f32 v24, v24, v25
    v_mfma_f32_16x16x32_bf16 v[44:47], v[168:171], v[64:67], v[48:51]
    v_cvt_pk_bf16_f32 v25, v26, v27
    v_cvt_pk_bf16_f32 v26, v28, v29
    v_cvt_pk_bf16_f32 v27, v30, v31
    ds_read_b128 v[96:99], v249 offset:8192
    s_waitcnt lgkmcnt(2)
    v_mfma_f32_16x16x32_bf16 v[68:71], v[200:203], v[24:27], v[68:71]
    v_exp_f32 v32, v32
    v_exp_f32 v33, v33
    v_exp_f32 v34, v34
    v_mfma_f32_16x16x32_bf16 v[12:15], v[100:103], v[24:27], v[12:15]
    v_exp_f32 v35, v35
    v_exp_f32 v36, v36
    v_exp_f32 v37, v37
    v_mfma_f32_16x16x32_bf16 v[16:19], v[108:111], v[64:67], v[48:51]
    v_exp_f32 v38, v38
    v_exp_f32 v39, v39
    v_cvt_pk_bf16_f32 v32, v32, v33
    v_mfma_f32_16x16x32_bf16 v[20:23], v[240:243], v[64:67], v[48:51]
    v_cvt_pk_bf16_f32 v33, v34, v35
    v_cvt_pk_bf16_f32 v34, v36, v37
    v_cvt_pk_bf16_f32 v35, v38, v39
    ds_read_b128 v[100:103], v249 offset:9216
    s_waitcnt lgkmcnt(2)
    v_mfma_f32_16x16x32_bf16 v[68:71], v[204:207], v[32:35], v[68:71]
    v_exp_f32 v40, v40
    v_exp_f32 v41, v41
    v_exp_f32 v42, v42
    v_exp_f32 v43, v43
    v_exp_f32 v44, v44
    v_exp_f32 v45, v45
    v_mfma_f32_16x16x32_bf16 v[12:15], v[92:95], v[32:35], v[12:15]
    v_exp_f32 v46, v46
    v_exp_f32 v47, v47
    v_cvt_pk_bf16_f32 v40, v40, v41
    v_cvt_pk_bf16_f32 v41, v42, v43
    v_cvt_pk_bf16_f32 v42, v44, v45
    v_cvt_pk_bf16_f32 v43, v46, v47
    s_waitcnt lgkmcnt(1)
    s_nop 0
    v_mfma_f32_16x16x32_bf16 v[68:71], v[176:179], v[40:43], v[68:71]
    v_exp_f32 v16, v16
    v_exp_f32 v17, v17
    v_exp_f32 v18, v18
    v_exp_f32 v19, v19
    v_cndmask_b32 v20, v20, v86, s[4:5]
    v_cndmask_b32 v21, v21, v86, s[6:7]
    v_cndmask_b32 v22, v22, v86, s[8:9]
    v_cndmask_b32 v23, v23, v86, s[10:11]
    v_mfma_f32_16x16x32_bf16 v[12:15], v[96:99], v[40:43], v[12:15]
    v_exp_f32 v20, v20
    v_exp_f32 v21, v21
    v_exp_f32 v22, v22
    v_exp_f32 v23, v23
    v_cvt_pk_bf16_f32 v16, v16, v17
    v_cvt_pk_bf16_f32 v17, v18, v19
    v_cvt_pk_bf16_f32 v18, v20, v21
    v_cvt_pk_bf16_f32 v19, v22, v23
    s_waitcnt lgkmcnt(0)
    s_nop 0
    v_mfma_f32_16x16x32_bf16 v[68:71], v[180:183], v[16:19], v[68:71]
    v_mfma_f32_16x16x32_bf16 v[12:15], v[100:103], v[16:19], v[12:15]
    s_nop 6
    v_add_f32 v250, |v68|, |v69|
    v_add_f32 v251, |v70|, |v71|
    v_add_f32 v88, |v12|, |v13|
    v_add_f32 v89, |v14|, |v15|
    v_add_f32 v250, v250, v251
    v_add_f32 v88, v88, v89
    v_add_f32 v250, v250, v88
    v_cmp_nle_f32 vcc, v250, v253
    s_cbranch_vccnz L_slowq3
L_cont3:
    v_mov_b32 v88, v12
    v_mov_b32 v89, v12
    s_nop 1
    v_permlane32_swap_b32 v88, v89
    v_cndmask_b32 v88, v88, v89, s[16:17]
    v_rcp_f32 v88, v88
    v_cndmask_b32 v12, v12, v14, s[18:19]
    v_cndmask_b32 v13, v13, v15, s[18:19]
    v_mul_f32 v68, v68, v88
    v_mul_f32 v69, v69, v88
    v_mul_f32 v70, v70, v88
    v_mul_f32 v71, v71, v88
    v_mul_f32 v12, v12, v88
    v_mul_f32 v13, v13, v88
    v_cvt_pk_bf16_f32 v90, v68, v69
    v_cvt_pk_bf16_f32 v91, v70, v71
    v_cvt_pk_bf16_f32 v89, v12, v13
    s_add_u32 s58, s72, 37120
    buffer_store_dwordx2 v[90:91], v252, s[36:39], s58 offen sc1
    s_add_u32 s58, s74, 37120
    s_mov_b64 exec, s[100:101]
    buffer_store_dword v89, v252, s[36:39], s58 offen sc1
    s_mov_b64 exec, -1
    v_cndmask_b32 v62, 0, v62, s[12:13]
    v_cndmask_b32 v63, 0, v63, s[14:15]
    ds_read_b64 v[64:65], v248 offset:2560
    ds_read_b64 v[66:67], v80 offset:35328
    v_mfma_f32_16x16x32_bf16 v[16:19], v[112:115], v[60:63], 0
    ds_read_b128 v[92:95], v249 offset:2048
    ds_read_b128 v[96:99], v249 offset:3072
    s_nop 5
    v_cndmask_b32 v16, v16, v86, s[4:5]
    v_cndmask_b32 v17, v17, v86, s[6:7]
    v_cndmask_b32 v18, v18, v86, s[8:9]
    v_cndmask_b32 v19, v19, v86, s[10:11]
    v_max_f32 v87, v16, v17
    v_max_f32 v88, v18, v19
    v_max_f32 v87, v87, v88
    v_mov_b32 v88, v87
    s_nop 1
    v_permlane32_swap_b32 v87, v88
    v_max_f32 v87, v87, v88
    v_mov_b32 v88, v87
    s_nop 1
    v_permlane16_swap_b32 v87, v88
    v_max_f32 v87, v87, v88
    v_sub_f32 v48, 0, v87
    v_sub_f32 v49, 0, v87
    v_sub_f32 v50, 0, v87
    v_sub_f32 v51, 0, v87
    s_nop 1
    v_mfma_f32_16x16x32_bf16 v[16:19], v[144:147], v[60:63], v[48:51]
    v_mfma_f32_16x16x32_bf16 v[20:23], v[156:159], v[60:63], v[48:51]
    v_mfma_f32_16x16x32_bf16 v[24:27], v[148:151], v[60:63], v[48:51]
    v_mfma_f32_16x16x32_bf16 v[28:31], v[228:231], v[60:63], v[48:51]
    v_mfma_f32_16x16x32_bf16 v[32:35], v[120:123], v[60:63], v[48:51]
    s_nop 3
    v_cndmask_b32 v16, v86, v16, s[4:5]
    v_cndmask_b32 v17, v86, v17, s[6:7]
    v_cndmask_b32 v18, v86, v18, s[8:9]
    v_cndmask_b32 v19, v86, v19, s[10:11]
    v_exp_f32 v16, v16
    v_exp_f32 v17, v17
    v_exp_f32 v18, v18
    v_exp_f32 v19, v19
    v_mfma_f32_16x16x32_bf16 v[36:39], v[160:163], v[60:63], v[48:51]
    v_exp_f32 v20, v20
    v_exp_f32 v21, v21
    v_exp_f32 v22, v22
    v_exp_f32 v23, v23
    v_cvt_pk_bf16_f32 v16, v16, v17
    v_cvt_pk_bf16_f32 v17, v18, v19
    v_cvt_pk_bf16_f32 v18, v20, v21
    v_cvt_pk_bf16_f32 v19, v22, v23
    ds_read_b128 v[100:103], v249 offset:4096
    s_waitcnt lgkmcnt(2)
    v_mfma_f32_16x16x32_bf16 v[68:71], v[216:219], v[16:19], 0
    v_exp_f32 v24, v24
    v_exp_f32 v25, v25
    v_exp_f32 v26, v26
    v_mfma_f32_16x16x32_bf16 v[12:15], v[92:95], v[16:19], 0
    v_exp_f32 v27, v27
    v_exp_f32 v28, v28
    v_exp_f32 v29, v29
    v_mfma_f32_16x16x32_bf16 v[40:43], v[124:127], v[60:63], v[48:51]
    v_exp_f32 v30, v30
    v_exp_f32 v31, v31
    v_cvt_pk_bf16_f32 v24, v24, v25
    v_mfma_f32_16x16x32_bf16 v[44:47], v[232:235], v[60:63], v[48:51]
    v_cvt_pk_bf16_f32 v25, v26, v27
    v_cvt_pk_bf16_f32 v26, v28, v29
    v_cvt_pk_bf16_f32 v27, v30, v31
    ds_read_b128 v[92:95], v249 offset:5120
    s_waitcnt lgkmcnt(2)
    v_mfma_f32_16x16x32_bf16 v[68:71], v[220:223], v[24:27], v[68:71]
    v_exp_f32 v32, v32
    v_exp_f32 v33, v33
    v_exp_f32 v34, v34
    v_mfma_f32_16x16x32_bf16 v[12:15], v[96:99], v[24:27], v[12:15]
    v_exp_f32 v35, v35
    v_exp_f32 v36, v36
    v_exp_f32 v37, v37
    v_mfma_f32_16x16x32_bf16 v[16:19], v[128:131], v[60:63], v[48:51]
    v_exp_f32 v38, v38
    v_exp_f32 v39, v39
    v_cvt_pk_bf16_f32 v32, v32, v33
    v_mfma_f32_16x16x32_bf16 v[20:23], v[164:167], v[60:63], v[48:51]
    v_cvt_pk_bf16_f32 v33, v34, v35
    v_cvt_pk_bf16_f32 v34, v36, v37
    v_cvt_pk_bf16_f32 v35, v38, v39
    ds_read_b128 v[96:99], v249 offset:6144
    s_waitcnt lgkmcnt(2)
    v_mfma_f32_16x16x32_bf16 v[68:71], v[192:195], v[32:35], v[68:71]
    v_exp_f32 v40, v40
    v_exp_f32 v41, v41
    v_exp_f32 v42, v42
    v_mfma_f32_16x16x32_bf16 v[12:15], v[100:103], v[32:35], v[12:15]
    v_exp_f32 v43, v43
    v_exp_f32 v44, v44
    v_exp_f32 v45, v45
    v_mfma_f32_16x16x32_bf16 v[24:27], v[132:135], v[60:63], v[48:51]
    v_exp_f32 v46, v46
    v_exp_f32 v47, v47
    v_cvt_pk_bf16_f32 v40, v40, v41
    v_mfma_f32_16x16x32_bf16 v[28:31], v[236:239], v[60:63], v[48:51]
    v_cvt_pk_bf16_f32 v41, v42, v43
    v_cvt_pk_bf16_f32 v42, v44, v45
    v_cvt_pk_bf16_f32 v43, v46, v47
    ds_read_b128 v[100:103], v249 offset:7168
    s_waitcnt lgkmcnt(2)
    v_mfma_f32_16x16x32_bf16 v[68:71], v[196:199], v[40:43], v[68:71]
    v_exp_f32 v16, v16
    v_exp_f32 v17, v17
    v_exp_f32 v18, v18
    v_mfma_f32_16x16x32_bf16 v[12:15], v[92:95], v[40:43], v[12:15]
    v_exp_f32 v19, v19
    v_exp_f32 v20, v20
    v_exp_f32 v21, v21
    v_mfma_f32_16x16x32_bf16 v[32:35], v[104:107], v[60:63], v[48:51]
    v_exp_f32 v22, v22
    v_exp_f32 v23, v23
    v_cvt_pk_bf16_f32 v16, v16, v17
    v_mfma_f32_16x16x32_bf16 v[36:39], v[168:171], v[60:63], v[48:51]
    v_cvt_pk_bf16_f32 v17, v18, v19
    v_cvt_pk_bf16_f32 v18, v20, v21
    v_cvt_pk_bf16_f32 v19, v22, v23
    ds_read_b128 v[92:95], v249 offset:8192
    s_waitcnt lgkmcnt(2)
    v_mfma_f32_16x16x32_bf16 v[68:71], v[200:203], v[16:19], v[68:71]
    v_exp_f32 v24, v24
    v_exp_f32 v25, v25
    v_exp_f32 v26, v26
    v_mfma_f32_16x16x32_bf16 v[12:15], v[96:99], v[16:19], v[12:15]
    v_exp_f32 v27, v27
    v_exp_f32 v28, v28
    v_exp_f32 v29, v29
    v_mfma_f32_16x16x32_bf16 v[40:43], v[108:111], v[60:63], v[48:51]
    v_exp_f32 v30, v30
    v_exp_f32 v31, v31
    v_cvt_pk_bf16_f32 v24, v24, v25
    v_mfma_f32_16x16x32_bf16 v[44:47], v[240:243], v[60:63], v[48:51]
    v_cvt_pk_bf16_f32 v25, v26, v27
    v_cvt_pk_bf16_f32 v26, v28, v29
    v_cvt_pk_bf16_f32 v27, v30, v31
    ds_read_b128 v[96:99], v249 offset:9216
    s_waitcnt lgkmcnt(2)
    v_mfma_f32_16x16x32_bf16 v[68:71], v[204:207], v[24:27], v[68:71]
    v_exp_f32 v32, v32
    v_exp_f32 v33, v33
    v_exp_f32 v34, v34
    v_exp_f32 v35, v35
    v_mfma_f32_16x16x32_bf16 v[12:15], v[100:103], v[24:27], v[12:15]
    v_exp_f32 v36, v36
    v_exp_f32 v37, v37
    v_exp_f32 v38, v38
    v_exp_f32 v39, v39
    v_mfma_f32_16x16x32_bf16 v[16:19], v[112:115], v[60:63], v[48:51]
    v_cvt_pk_bf16_f32 v32, v32, v33
    v_cvt_pk_bf16_f32 v33, v34, v35
    v_cvt_pk_bf16_f32 v34, v36, v37
    v_cvt_pk_bf16_f32 v35, v38, v39
    ds_read_b128 v[100:103], v249 offset:10240
    s_waitcnt lgkmcnt(2)
    v_mfma_f32_16x16x32_bf16 v[68:71], v[176:179], v[32:35], v[68:71]
    v_exp_f32 v40, v40
    v_exp_f32 v41, v41
    v_exp_f32 v42, v42
    v_exp_f32 v43, v43
    v_exp_f32 v44, v44
    v_exp_f32 v45, v45
    v_mfma_f32_16x16x32_bf16 v[12:15], v[92:95], v[32:35], v[12:15]
    v_exp_f32 v46, v46
    v_exp_f32 v47, v47
    v_cvt_pk_bf16_f32 v40, v40, v41
    v_cvt_pk_bf16_f32 v41, v42, v43
    v_cvt_pk_bf16_f32 v42, v44, v45
    v_cvt_pk_bf16_f32 v43, v46, v47
    s_waitcnt lgkmcnt(1)
    s_nop 0
    v_mfma_f32_16x16x32_bf16 v[68:71], v[180:183], v[40:43], v[68:71]
    v_cndmask_b32 v16, v16, v86, s[4:5]
    v_cndmask_b32 v17, v17, v86, s[6:7]
    v_cndmask_b32 v18, v18, v86, s[8:9]
    v_cndmask_b32 v19, v19, v86, s[10:11]
    v_exp_f32 v16, v16
    v_exp_f32 v17, v17
    v_mfma_f32_16x16x32_bf16 v[12:15], v[96:99], v[40:43], v[12:15]
    v_exp_f32 v18, v18
    v_exp_f32 v19, v19
    v_cvt_pk_bf16_f32 v16, v16, v17
    v_cvt_pk_bf16_f32 v17, v18, v19
    v_mov_b32 v18, 0
    v_mov_b32 v19, 0
    s_waitcnt lgkmcnt(0)
    s_nop 0
    v_mfma_f32_16x16x32_bf16 v[68:71], v[184:187], v[16:19], v[68:71]
    v_mfma_f32_16x16x32_bf16 v[12:15], v[100:103], v[16:19], v[12:15]
    s_nop 6
    v_add_f32 v250, |v68|, |v69|
    v_add_f32 v251, |v70|, |v71|
    v_add_f32 v88, |v12|, |v13|
    v_add_f32 v89, |v14|, |v15|
    v_add_f32 v250, v250, v251
    v_add_f32 v88, v88, v89
    v_add_f32 v250, v250, v88
    v_cmp_nle_f32 vcc, v250, v253
    s_cbranch_vccnz L_slowq4
L_cont4:
    v_mov_b32 v88, v12
    v_mov_b32 v89, v12
    s_nop 1
    v_permlane32_swap_b32 v88, v89
    v_cndmask_b32 v88, v88, v89, s[16:17]
    v_rcp_f32 v88, v88
    v_cndmask_b32 v12, v12, v14, s[18:19]
    v_cndmask_b32 v13, v13, v15, s[18:19]
    v_mul_f32 v68, v68, v88
    v_mul_f32 v69, v69, v88
    v_mul_f32 v70, v70, v88
    v_mul_f32 v71, v71, v88
    v_mul_f32 v12, v12, v88
    v_mul_f32 v13, v13, v88
    v_cvt_pk_bf16_f32 v90, v68, v69
    v_cvt_pk_bf16_f32 v91, v70, v71
    v_cvt_pk_bf16_f32 v89, v12, v13
    s_add_u32 s58, s72, 73728
    buffer_store_dwordx2 v[90:91], v252, s[36:39], s58 offen sc1
    s_add_u32 s58, s74, 73728
    s_mov_b64 exec, s[100:101]
    buffer_store_dword v89, v252, s[36:39], s58 offen sc1
    s_mov_b64 exec, -1
    v_cndmask_b32 v66, 0, v66, s[12:13]
    v_cndmask_b32 v67, 0, v67, s[14:15]
    ds_read_b64 v[60:61], v248 offset:3072
    ds_read_b64 v[62:63], v80 offset:35840
    v_mfma_f32_16x16x32_bf16 v[16:19], v[172:175], v[64:67], 0
    ds_read_b128 v[92:95], v249 offset:2048
    ds_read_b128 v[96:99], v249 offset:3072
    s_nop 5
    v_cndmask_b32 v16, v16, v86, s[4:5]
    v_cndmask_b32 v17, v17, v86, s[6:7]
    v_cndmask_b32 v18, v18, v86, s[8:9]
    v_cndmask_b32 v19, v19, v86, s[10:11]
    v_max_f32 v87, v16, v17
    v_max_f32 v88, v18, v19
    v_max_f32 v87, v87, v88
    v_mov_b32 v88, v87
    s_nop 1
    v_permlane32_swap_b32 v87, v88
    v_max_f32 v87, v87, v88
    v_mov_b32 v88, v87
    s_nop 1
    v_permlane16_swap_b32 v87, v88
    v_max_f32 v87, v87, v88
    v_sub_f32 v48, 0, v87
    v_sub_f32 v49, 0, v87
    v_sub_f32 v50, 0, v87
    v_sub_f32 v51, 0, v87
    s_nop 1
    v_mfma_f32_16x16x32_bf16 v[20:23], v[156:159], v[64:67], v[48:51]
    v_mfma_f32_16x16x32_bf16 v[24:27], v[148:151], v[64:67], v[48:51]
    v_mfma_f32_16x16x32_bf16 v[28:31], v[228:231], v[64:67], v[48:51]
    v_mfma_f32_16x16x32_bf16 v[32:35], v[120:123], v[64:67], v[48:51]
    s_nop 4
    v_cndmask_b32 v20, v86, v20, s[4:5]
    v_cndmask_b32 v21, v86, v21, s[6:7]
    v_cndmask_b32 v22, v86, v22, s[8:9]
    v_cndmask_b32 v23, v86, v23, s[10:11]
    v_exp_f32 v20, v20
    v_exp_f32 v21, v21
    v_mfma_f32_16x16x32_bf16 v[36:39], v[160:163], v[64:67], v[48:51]
    v_exp_f32 v22, v22
    v_exp_f32 v23, v23
    v_mov_b32 v16, 0
    v_mov_b32 v17, 0
    v_cvt_pk_bf16_f32 v18, v20, v21
    v_cvt_pk_bf16_f32 v19, v22, v23
    ds_read_b128 v[100:103], v249 offset:4096
    s_waitcnt lgkmcnt(2)
    v_mfma_f32_16x16x32_bf16 v[68:71], v[216:219], v[16:19], 0
    v_exp_f32 v24, v24
    v_exp_f32 v25, v25
    v_exp_f32 v26, v26
    v_mfma_f32_16x16x32_bf16 v[12:15], v[92:95], v[16:19], 0
    v_exp_f32 v27, v27
    v_exp_f32 v28, v28
    v_exp_f32 v29, v29
    v_mfma_f32_16x16x32_bf16 v[40:43], v[124:127], v[64:67], v[48:51]
    v_exp_f32 v30, v30
    v_exp_f32 v31, v31
    v_cvt_pk_bf16_f32 v24, v24, v25
    v_mfma_f32_16x16x32_bf16 v[44:47], v[232:235], v[64:67], v[48:51]
    v_cvt_pk_bf16_f32 v25, v26, v27
    v_cvt_pk_bf16_f32 v26, v28, v29
    v_cvt_pk_bf16_f32 v27, v30, v31
    ds_read_b128 v[92:95], v249 offset:5120
    s_waitcnt lgkmcnt(2)
    v_mfma_f32_16x16x32_bf16 v[68:71], v[220:223], v[24:27], v[68:71]
    v_exp_f32 v32, v32
    v_exp_f32 v33, v33
    v_exp_f32 v34, v34
    v_mfma_f32_16x16x32_bf16 v[12:15], v[96:99], v[24:27], v[12:15]
    v_exp_f32 v35, v35
    v_exp_f32 v36, v36
    v_exp_f32 v37, v37
    v_mfma_f32_16x16x32_bf16 v[16:19], v[128:131], v[64:67], v[48:51]
    v_exp_f32 v38, v38
    v_exp_f32 v39, v39
    v_cvt_pk_bf16_f32 v32, v32, v33
    v_mfma_f32_16x16x32_bf16 v[20:23], v[164:167], v[64:67], v[48:51]
    v_cvt_pk_bf16_f32 v33, v34, v35
    v_cvt_pk_bf16_f32 v34, v36, v37
    v_cvt_pk_bf16_f32 v35, v38, v39
    ds_read_b128 v[96:99], v249 offset:6144
    s_waitcnt lgkmcnt(2)
    v_mfma_f32_16x16x32_bf16 v[68:71], v[192:195], v[32:35], v[68:71]
    v_exp_f32 v40, v40
    v_exp_f32 v41, v41
    v_exp_f32 v42, v42
    v_mfma_f32_16x16x32_bf16 v[12:15], v[100:103], v[32:35], v[12:15]
    v_exp_f32 v43, v43
    v_exp_f32 v44, v44
    v_exp_f32 v45, v45
    v_mfma_f32_16x16x32_bf16 v[24:27], v[132:135], v[64:67], v[48:51]
    v_exp_f32 v46, v46
    v_exp_f32 v47, v47
    v_cvt_pk_bf16_f32 v40, v40, v41
    v_mfma_f32_16x16x32_bf16 v[28:31], v[236:239], v[64:67], v[48:51]
    v_cvt_pk_bf16_f32 v41, v42, v43
    v_cvt_pk_bf16_f32 v42, v44, v45
    v_cvt_pk_bf16_f32 v43, v46, v47
    ds_read_b128 v[100:103], v249 offset:7168
    s_waitcnt lgkmcnt(2)
    v_mfma_f32_16x16x32_bf16 v[68:71], v[196:199], v[40:43], v[68:71]
    v_exp_f32 v16, v16
    v_exp_f32 v17, v17
    v_exp_f32 v18, v18
    v_mfma_f32_16x16x32_bf16 v[12:15], v[92:95], v[40:43], v[12:15]
    v_exp_f32 v19, v19
    v_exp_f32 v20, v20
    v_exp_f32 v21, v21
    v_mfma_f32_16x16x32_bf16 v[32:35], v[104:107], v[64:67], v[48:51]
    v_exp_f32 v22, v22
    v_exp_f32 v23, v23
    v_cvt_pk_bf16_f32 v16, v16, v17
    v_mfma_f32_16x16x32_bf16 v[36:39], v[168:171], v[64:67], v[48:51]
    v_cvt_pk_bf16_f32 v17, v18, v19
    v_cvt_pk_bf16_f32 v18, v20, v21
    v_cvt_pk_bf16_f32 v19, v22, v23
    ds_read_b128 v[92:95], v249 offset:8192
    s_waitcnt lgkmcnt(2)
    v_mfma_f32_16x16x32_bf16 v[68:71], v[200:203], v[16:19], v[68:71]
    v_exp_f32 v24, v24
    v_exp_f32 v25, v25
    v_exp_f32 v26, v26
    v_mfma_f32_16x16x32_bf16 v[12:15], v[96:99], v[16:19], v[12:15]
    v_exp_f32 v27, v27
    v_exp_f32 v28, v28
    v_exp_f32 v29, v29
    v_mfma_f32_16x16x32_bf16 v[40:43], v[108:111], v[64:67], v[48:51]
    v_exp_f32 v30, v30
    v_exp_f32 v31, v31
    v_cvt_pk_bf16_f32 v24, v24, v25
    v_mfma_f32_16x16x32_bf16 v[44:47], v[240:243], v[64:67], v[48:51]
    v_cvt_pk_bf16_f32 v25, v26, v27
    v_cvt_pk_bf16_f32 v26, v28, v29
    v_cvt_pk_bf16_f32 v27, v30, v31
    ds_read_b128 v[96:99], v249 offset:9216
    s_waitcnt lgkmcnt(2)
    v_mfma_f32_16x16x32_bf16 v[68:71], v[204:207], v[24:27], v[68:71]
    v_exp_f32 v32, v32
    v_exp_f32 v33, v33
    v_exp_f32 v34, v34
    v_mfma_f32_16x16x32_bf16 v[12:15], v[100:103], v[24:27], v[12:15]
    v_exp_f32 v35, v35
    v_exp_f32 v36, v36
    v_exp_f32 v37, v37
    v_mfma_f32_16x16x32_bf16 v[16:19], v[112:115], v[64:67], v[48:51]
    v_exp_f32 v38, v38
    v_exp_f32 v39, v39
    v_cvt_pk_bf16_f32 v32, v32, v33
    v_mfma_f32_16x16x32_bf16 v[20:23], v[172:175], v[64:67], v[48:51]
    v_cvt_pk_bf16_f32 v33, v34, v35
    v_cvt_pk_bf16_f32 v34, v36, v37
    v_cvt_pk_bf16_f32 v35, v38, v39
    ds_read_b128 v[100:103], v249 offset:10240
    s_waitcnt lgkmcnt(2)
    v_mfma_f32_16x16x32_bf16 v[68:71], v[176:179], v[32:35], v[68:71]
    v_exp_f32 v40, v40
    v_exp_f32 v41, v41
    v_exp_f32 v42, v42
    v_exp_f32 v43, v43
    v_exp_f32 v44, v44
    v_exp_f32 v45, v45
    v_mfma_f32_16x16x32_bf16 v[12:15], v[92:95], v[32:35], v[12:15]
    v_exp_f32 v46, v46
    v_exp_f32 v47, v47
    v_cvt_pk_bf16_f32 v40, v40, v41
    v_cvt_pk_bf16_f32 v41, v42, v43
    v_cvt_pk_bf16_f32 v42, v44, v45
    v_cvt_pk_bf16_f32 v43, v46, v47
    s_waitcnt lgkmcnt(1)
    s_nop 0
    v_mfma_f32_16x16x32_bf16 v[68:71], v[180:183], v[40:43], v[68:71]
    v_exp_f32 v16, v16
    v_exp_f32 v17, v17
    v_exp_f32 v18, v18
    v_exp_f32 v19, v19
    v_cndmask_b32 v20, v20, v86, s[4:5]
    v_cndmask_b32 v21, v21, v86, s[6:7]
    v_cndmask_b32 v22, v22, v86, s[8:9]
    v_cndmask_b32 v23, v23, v86, s[10:11]
    v_mfma_f32_16x16x32_bf16 v[12:15], v[96:99], v[40:43], v[12:15]
    v_exp_f32 v20, v20
    v_exp_f32 v21, v21
    v_exp_f32 v22, v22
    v_exp_f32 v23, v23
    v_cvt_pk_bf16_f32 v16, v16, v17
    v_cvt_pk_bf16_f32 v17, v18, v19
    v_cvt_pk_bf16_f32 v18, v20, v21
    v_cvt_pk_bf16_f32 v19, v22, v23
    s_waitcnt lgkmcnt(0)
    s_nop 0
    v_mfma_f32_16x16x32_bf16 v[68:71], v[184:187], v[16:19], v[68:71]
    v_mfma_f32_16x16x32_bf16 v[12:15], v[100:103], v[16:19], v[12:15]
    s_nop 6
    v_add_f32 v250, |v68|, |v69|
    v_add_f32 v251, |v70|, |v71|
    v_add_f32 v88, |v12|, |v13|
    v_add_f32 v89, |v14|, |v15|
    v_add_f32 v250, v250, v251
    v_add_f32 v88, v88, v89
    v_add_f32 v250, v250, v88
    v_cmp_nle_f32 vcc, v250, v253
    s_cbranch_vccnz L_slowq5
L_cont5:
    v_mov_b32 v88, v12
    v_mov_b32 v89, v12
    s_nop 1
    v_permlane32_swap_b32 v88, v89
    v_cndmask_b32 v88, v88, v89, s[16:17]
    v_rcp_f32 v88, v88
    v_cndmask_b32 v12, v12, v14, s[18:19]
    v_cndmask_b32 v13, v13, v15, s[18:19]
    v_mul_f32 v68, v68, v88
    v_mul_f32 v69, v69, v88
    v_mul_f32 v70, v70, v88
    v_mul_f32 v71, v71, v88
    v_mul_f32 v12, v12, v88
    v_mul_f32 v13, v13, v88
    v_cvt_pk_bf16_f32 v90, v68, v69
    v_cvt_pk_bf16_f32 v91, v70, v71
    v_cvt_pk_bf16_f32 v89, v12, v13
    s_add_u32 s58, s72, 73984
    buffer_store_dwordx2 v[90:91], v252, s[36:39], s58 offen sc1
    s_add_u32 s58, s74, 73984
    s_mov_b64 exec, s[100:101]
    buffer_store_dword v89, v252, s[36:39], s58 offen sc1
    s_mov_b64 exec, -1
    v_cndmask_b32 v62, 0, v62, s[12:13]
    v_cndmask_b32 v63, 0, v63, s[14:15]
    ds_read_b64 v[64:65], v248 offset:3584
    ds_read_b64 v[66:67], v80 offset:36352
    v_mfma_f32_16x16x32_bf16 v[16:19], v[116:119], v[60:63], 0
    ds_read_b128 v[92:95], v249 offset:3072
    ds_read_b128 v[96:99], v249 offset:4096
    s_nop 5
    v_cndmask_b32 v16, v16, v86, s[4:5]
    v_cndmask_b32 v17, v17, v86, s[6:7]
    v_cndmask_b32 v18, v18, v86, s[8:9]
    v_cndmask_b32 v19, v19, v86, s[10:11]
    v_max_f32 v87, v16, v17
    v_max_f32 v88, v18, v19
    v_max_f32 v87, v87, v88
    v_mov_b32 v88, v87
    s_nop 1
    v_permlane32_swap_b32 v87, v88
    v_max_f32 v87, v87, v88
    v_mov_b32 v88, v87
    s_nop 1
    v_permlane16_swap_b32 v87, v88
    v_max_f32 v87, v87, v88
    v_sub_f32 v48, 0, v87
    v_sub_f32 v49, 0, v87
    v_sub_f32 v50, 0, v87
    v_sub_f32 v51, 0, v87
    s_nop 1
    v_mfma_f32_16x16x32_bf16 v[16:19], v[148:151], v[60:63], v[48:51]
    v_mfma_f32_16x16x32_bf16 v[20:23], v[228:231], v[60:63], v[48:51]
    v_mfma_f32_16x16x32_bf16 v[24:27], v[120:123], v[60:63], v[48:51]
    v_mfma_f32_16x16x32_bf16 v[28:31], v[160:163], v[60:63], v[48:51]
    v_mfma_f32_16x16x32_bf16 v[32:35], v[124:127], v[60:63], v[48:51]
    s_nop 3
    v_cndmask_b32 v16, v86, v16, s[4:5]
    v_cndmask_b32 v17, v86, v17, s[6:7]
    v_cndmask_b32 v18, v86, v18, s[8:9]
    v_cndmask_b32 v19, v86, v19, s[10:11]
    v_exp_f32 v16, v16
    v_exp_f32 v17, v17
    v_exp_f32 v18, v18
    v_exp_f32 v19, v19
    v_mfma_f32_16x16x32_bf16 v[36:39], v[232:235], v[60:63], v[48:51]
    v_exp_f32 v20, v20
    v_exp_f32 v21, v21
    v_exp_f32 v22, v22
    v_exp_f32 v23, v23
    v_cvt_pk_bf16_f32 v16, v16, v17
    v_cvt_pk_bf16_f32 v17, v18, v19
    v_cvt_pk_bf16_f32 v18, v20, v21
    v_cvt_pk_bf16_f32 v19, v22, v23
    ds_read_b128 v[100:103], v249 offset:5120
    s_waitcnt lgkmcnt(2)
    v_mfma_f32_16x16x32_bf16 v[68:71], v[220:223], v[16:19], 0
    v_exp_f32 v24, v24
    v_exp_f32 v25, v25
    v_exp_f32 v26, v26
    v_mfma_f32_16x16x32_bf16 v[12:15], v[92:95], v[16:19], 0
    v_exp_f32 v27, v27
    v_exp_f32 v28, v28
    v_exp_f32 v29, v29
    v_mfma_f32_16x16x32_bf16 v[40:43], v[128:131], v[60:63], v[48:51]
    v_exp_f32 v30, v30
    v_exp_f32 v31, v31
    v_cvt_pk_bf16_f32 v24, v24, v25
    v_mfma_f32_16x16x32_bf16 v[44:47], v[164:167], v[60:63], v[48:51]
    v_cvt_pk_bf16_f32 v25, v26, v27
    v_cvt_pk_bf16_f32 v26, v28, v29
    v_cvt_pk_bf16_f32 v27, v30, v31
    ds_read_b128 v[92:95], v249 offset:6144
    s_waitcnt lgkmcnt(2)
    v_mfma_f32_16x16x32_bf16 v[68:71], v[192:195], v[24:27], v[68:71]
    v_exp_f32 v32, v32
    v_exp_f32 v33, v33
    v_exp_f32 v34, v34
    v_mfma_f32_16x16x32_bf16 v[12:15], v[96:99], v[24:27], v[12:15]
    v_exp_f32 v35, v35
    v_exp_f32 v36, v36
    v_exp_f32 v37, v37
    v_mfma_f32_16x16x32_bf16 v[16:19], v[132:135], v[60:63], v[48:51]
    v_exp_f32 v38, v38
    v_exp_f32 v39, v39
    v_cvt_pk_bf16_f32 v32, v32, v33
    v_mfma_f32_16x16x32_bf16 v[20:23], v[236:239], v[60:63], v[48:51]
    v_cvt_pk_bf16_f32 v33, v34, v35
    v_cvt_pk_bf16_f32 v34, v36, v37
    v_cvt_pk_bf16_f32 v35, v38, v39
    ds_read_b128 v[96:99], v249 offset:7168
    s_waitcnt lgkmcnt(2)
    v_mfma_f32_16x16x32_bf16 v[68:71], v[196:199], v[32:35], v[68:71]
    v_exp_f32 v40, v40
    v_exp_f32 v41, v41
    v_exp_f32 v42, v42
    v_mfma_f32_16x16x32_bf16 v[12:15], v[100:103], v[32:35], v[12:15]
    v_exp_f32 v43, v43
    v_exp_f32 v44, v44
    v_exp_f32 v45, v45
    v_mfma_f32_16x16x32_bf16 v[24:27], v[104:107], v[60:63], v[48:51]
    v_exp_f32 v46, v46
    v_exp_f32 v47, v47
    v_cvt_pk_bf16_f32 v40, v40, v41
    v_mfma_f32_16x16x32_bf16 v[28:31], v[168:171], v[60:63], v[48:51]
    v_cvt_pk_bf16_f32 v41, v42, v43
    v_cvt_pk_bf16_f32 v42, v44, v45
    v_cvt_pk_bf16_f32 v43, v46, v47
    ds_read_b128 v[100:103], v249 offset:8192
    s_waitcnt lgkmcnt(2)
    v_mfma_f32_16x16x32_bf16 v[68:71], v[200:203], v[40:43], v[68:71]
    v_exp_f32 v16, v16
    v_exp_f32 v17, v17
    v_exp_f32 v18, v18
    v_mfma_f32_16x16x32_bf16 v[12:15], v[92:95], v[40:43], v[12:15]
    v_exp_f32 v19, v19
    v_exp_f32 v20, v20
    v_exp_f32 v21, v21
    v_mfma_f32_16x16x32_bf16 v[32:35], v[108:111], v[60:63], v[48:51]
    v_exp_f32 v22, v22
    v_exp_f32 v23, v23
    v_cvt_pk_bf16_f32 v16, v16, v17
    v_mfma_f32_16x16x32_bf16 v[36:39], v[240:243], v[60:63], v[48:51]
    v_cvt_pk_bf16_f32 v17, v18, v19
    v_cvt_pk_bf16_f32 v18, v20, v21
    v_cvt_pk_bf16_f32 v19, v22, v23
    ds_read_b128 v[92:95], v249 offset:9216
    s_waitcnt lgkmcnt(2)
    v_mfma_f32_16x16x32_bf16 v[68:71], v[204:207], v[16:19], v[68:71]
    v_exp_f32 v24, v24
    v_exp_f32 v25, v25
    v_exp_f32 v26, v26
    v_mfma_f32_16x16x32_bf16 v[12:15], v[96:99], v[16:19], v[12:15]
    v_exp_f32 v27, v27
    v_exp_f32 v28, v28
    v_exp_f32 v29, v29
    v_mfma_f32_16x16x32_bf16 v[40:43], v[112:115], v[60:63], v[48:51]
    v_exp_f32 v30, v30
    v_exp_f32 v31, v31
    v_cvt_pk_bf16_f32 v24, v24, v25
    v_mfma_f32_16x16x32_bf16 v[44:47], v[172:175], v[60:63], v[48:51]
    v_cvt_pk_bf16_f32 v25, v26, v27
    v_cvt_pk_bf16_f32 v26, v28, v29
    v_cvt_pk_bf16_f32 v27, v30, v31
    ds_read_b128 v[96:99], v249 offset:10240
    s_waitcnt lgkmcnt(2)
    v_mfma_f32_16x16x32_bf16 v[68:71], v[176:179], v[24:27], v[68:71]
    v_exp_f32 v32, v32
    v_exp_f32 v33, v33
    v_exp_f32 v34, v34
    v_exp_f32 v35, v35
    v_mfma_f32_16x16x32_bf16 v[12:15], v[100:103], v[24:27], v[12:15]
    v_exp_f32 v36, v36
    v_exp_f32 v37, v37
    v_exp_f32 v38, v38
    v_exp_f32 v39, v39
    v_mfma_f32_16x16x32_bf16 v[16:19], v[116:119], v[60:63], v[48:51]
    v_cvt_pk_bf16_f32 v32, v32, v33
    v_cvt_pk_bf16_f32 v33, v34, v35
    v_cvt_pk_bf16_f32 v34, v36, v37
    v_cvt_pk_bf16_f32 v35, v38, v39
    ds_read_b128 v[100:103], v249 offset:11264
    s_waitcnt lgkmcnt(2)
    v_mfma_f32_16x16x32_bf16 v[68:71], v[180:183], v[32:35], v[68:71]
    v_exp_f32 v40, v40
    v_exp_f32 v41, v41
    v_exp_f32 v42, v42
    v_exp_f32 v43, v43
    v_exp_f32 v44, v44
    v_exp_f32 v45, v45
    v_mfma_f32_16x16x32_bf16 v[12:15], v[92:95], v[32:35], v[12:15]
    v_exp_f32 v46, v46
    v_exp_f32 v47, v47
    v_cvt_pk_bf16_f32 v40, v40, v41
    v_cvt_pk_bf16_f32 v41, v42, v43
    v_cvt_pk_bf16_f32 v42, v44, v45
    v_cvt_pk_bf16_f32 v43, v46, v47
    s_waitcnt lgkmcnt(1)
    s_nop 0
    v_mfma_f32_16x16x32_bf16 v[68:71], v[184:187], v[40:43], v[68:71]
    v_cndmask_b32 v16, v16, v86, s[4:5]
    v_cndmask_b32 v17, v17, v86, s[6:7]
    v_cndmask_b32 v18, v18, v86, s[8:9]
    v_cndmask_b32 v19, v19, v86, s[10:11]
    v_exp_f32 v16, v16
    v_exp_f32 v17, v17
    v_mfma_f32_16x16x32_bf16 v[12:15], v[96:99], v[40:43], v[12:15]
    v_exp_f32 v18, v18
    v_exp_f32 v19, v19
    v_cvt_pk_bf16_f32 v16, v16, v17
    v_cvt_pk_bf16_f32 v17, v18, v19
    v_mov_b32 v18, 0
    v_mov_b32 v19, 0
    s_waitcnt lgkmcnt(0)
    s_nop 0
    v_mfma_f32_16x16x32_bf16 v[68:71], v[188:191], v[16:19], v[68:71]
    v_mfma_f32_16x16x32_bf16 v[12:15], v[100:103], v[16:19], v[12:15]
    s_nop 6
    v_add_f32 v250, |v68|, |v69|
    v_add_f32 v251, |v70|, |v71|
    v_add_f32 v88, |v12|, |v13|
    v_add_f32 v89, |v14|, |v15|
    v_add_f32 v250, v250, v251
    v_add_f32 v88, v88, v89
    v_add_f32 v250, v250, v88
    v_cmp_nle_f32 vcc, v250, v253
    s_cbranch_vccnz L_slowq6
L_cont6:
    v_mov_b32 v88, v12
    v_mov_b32 v89, v12
    s_nop 1
    v_permlane32_swap_b32 v88, v89
    v_cndmask_b32 v88, v88, v89, s[16:17]
    v_rcp_f32 v88, v88
    v_cndmask_b32 v12, v12, v14, s[18:19]
    v_cndmask_b32 v13, v13, v15, s[18:19]
    v_mul_f32 v68, v68, v88
    v_mul_f32 v69, v69, v88
    v_mul_f32 v70, v70, v88
    v_mul_f32 v71, v71, v88
    v_mul_f32 v12, v12, v88
    v_mul_f32 v13, v13, v88
    v_cvt_pk_bf16_f32 v90, v68, v69
    v_cvt_pk_bf16_f32 v91, v70, v71
    v_cvt_pk_bf16_f32 v89, v12, v13
    s_add_u32 s58, s72, 110592
    buffer_store_dwordx2 v[90:91], v252, s[36:39], s58 offen sc1
    s_add_u32 s58, s74, 110592
    s_mov_b64 exec, s[100:101]
    buffer_store_dword v89, v252, s[36:39], s58 offen sc1
    s_mov_b64 exec, -1
    v_cndmask_b32 v66, 0, v66, s[12:13]
    v_cndmask_b32 v67, 0, v67, s[14:15]
    s_nop 1
    v_mfma_f32_16x16x32_bf16 v[16:19], v[244:247], v[64:67], 0
    ds_read_b128 v[92:95], v249 offset:3072
    ds_read_b128 v[96:99], v249 offset:4096
    s_nop 5
    v_cndmask_b32 v16, v16, v86, s[4:5]
    v_cndmask_b32 v17, v17, v86, s[6:7]
    v_cndmask_b32 v18, v18, v86, s[8:9]
    v_cndmask_b32 v19, v19, v86, s[10:11]
    v_max_f32 v87, v16, v17
    v_max_f32 v88, v18, v19
    v_max_f32 v87, v87, v88
    v_mov_b32 v88, v87
    s_nop 1
    v_permlane32_swap_b32 v87, v88
    v_max_f32 v87, v87, v88
    v_mov_b32 v88, v87
    s_nop 1
    v_permlane16_swap_b32 v87, v88
    v_max_f32 v87, v87, v88
    v_sub_f32 v48, 0, v87
    v_sub_f32 v49, 0, v87
    v_sub_f32 v50, 0, v87
    v_sub_f32 v51, 0, v87
    s_nop 1
    v_mfma_f32_16x16x32_bf16 v[20:23], v[228:231], v[64:67], v[48:51]
    v_mfma_f32_16x16x32_bf16 v[24:27], v[120:123], v[64:67], v[48:51]
    v_mfma_f32_16x16x32_bf16 v[28:31], v[160:163], v[64:67], v[48:51]
    v_mfma_f32_16x16x32_bf16 v[32:35], v[124:127], v[64:67], v[48:51]
    s_nop 4
    v_cndmask_b32 v20, v86, v20, s[4:5]
    v_cndmask_b32 v21, v86, v21, s[6:7]
    v_cndmask_b32 v22, v86, v22, s[8:9]
    v_cndmask_b32 v23, v86, v23, s[10:11]
    v_exp_f32 v20, v20
    v_exp_f32 v21, v21
    v_mfma_f32_16x16x32_bf16 v[36:39], v[232:235], v[64:67], v[48:51]
    v_exp_f32 v22, v22
    v_exp_f32 v23, v23
    v_mov_b32 v16, 0
    v_mov_b32 v17, 0
    v_cvt_pk_bf16_f32 v18, v20, v21
    v_cvt_pk_bf16_f32 v19, v22, v23
    ds_read_b128 v[100:103], v249 offset:5120
    s_waitcnt lgkmcnt(2)
    v_mfma_f32_16x16x32_bf16 v[68:71], v[220:223], v[16:19], 0
    v_exp_f32 v24, v24
    v_exp_f32 v25, v25
    v_exp_f32 v26, v26
    v_mfma_f32_16x16x32_bf16 v[12:15], v[92:95], v[16:19], 0
    v_exp_f32 v27, v27
    v_exp_f32 v28, v28
    v_exp_f32 v29, v29
    v_mfma_f32_16x16x32_bf16 v[40:43], v[128:131], v[64:67], v[48:51]
    v_exp_f32 v30, v30
    v_exp_f32 v31, v31
    v_cvt_pk_bf16_f32 v24, v24, v25
    v_mfma_f32_16x16x32_bf16 v[44:47], v[164:167], v[64:67], v[48:51]
    v_cvt_pk_bf16_f32 v25, v26, v27
    v_cvt_pk_bf16_f32 v26, v28, v29
    v_cvt_pk_bf16_f32 v27, v30, v31
    ds_read_b128 v[92:95], v249 offset:6144
    s_waitcnt lgkmcnt(2)
    v_mfma_f32_16x16x32_bf16 v[68:71], v[192:195], v[24:27], v[68:71]
    v_exp_f32 v32, v32
    v_exp_f32 v33, v33
    v_exp_f32 v34, v34
    v_mfma_f32_16x16x32_bf16 v[12:15], v[96:99], v[24:27], v[12:15]
    v_exp_f32 v35, v35
    v_exp_f32 v36, v36
    v_exp_f32 v37, v37
    v_mfma_f32_16x16x32_bf16 v[16:19], v[132:135], v[64:67], v[48:51]
    v_exp_f32 v38, v38
    v_exp_f32 v39, v39
    v_cvt_pk_bf16_f32 v32, v32, v33
    v_mfma_f32_16x16x32_bf16 v[20:23], v[236:239], v[64:67], v[48:51]
    v_cvt_pk_bf16_f32 v33, v34, v35
    v_cvt_pk_bf16_f32 v34, v36, v37
    v_cvt_pk_bf16_f32 v35, v38, v39
    ds_read_b128 v[96:99], v249 offset:7168
    s_waitcnt lgkmcnt(2)
    v_mfma_f32_16x16x32_bf16 v[68:71], v[196:199], v[32:35], v[68:71]
    v_exp_f32 v40, v40
    v_exp_f32 v41, v41
    v_exp_f32 v42, v42
    v_mfma_f32_16x16x32_bf16 v[12:15], v[100:103], v[32:35], v[12:15]
    v_exp_f32 v43, v43
    v_exp_f32 v44, v44
    v_exp_f32 v45, v45
    v_mfma_f32_16x16x32_bf16 v[24:27], v[104:107], v[64:67], v[48:51]
    v_exp_f32 v46, v46
    v_exp_f32 v47, v47
    v_cvt_pk_bf16_f32 v40, v40, v41
    v_mfma_f32_16x16x32_bf16 v[28:31], v[168:171], v[64:67], v[48:51]
    v_cvt_pk_bf16_f32 v41, v42, v43
    v_cvt_pk_bf16_f32 v42, v44, v45
    v_cvt_pk_bf16_f32 v43, v46, v47
    ds_read_b128 v[100:103], v249 offset:8192
    s_waitcnt lgkmcnt(2)
    v_mfma_f32_16x16x32_bf16 v[68:71], v[200:203], v[40:43], v[68:71]
    v_exp_f32 v16, v16
    v_exp_f32 v17, v17
    v_exp_f32 v18, v18
    v_mfma_f32_16x16x32_bf16 v[12:15], v[92:95], v[40:43], v[12:15]
    v_exp_f32 v19, v19
    v_exp_f32 v20, v20
    v_exp_f32 v21, v21
    v_mfma_f32_16x16x32_bf16 v[32:35], v[108:111], v[64:67], v[48:51]
    v_exp_f32 v22, v22
    v_exp_f32 v23, v23
    v_cvt_pk_bf16_f32 v16, v16, v17
    v_mfma_f32_16x16x32_bf16 v[36:39], v[240:243], v[64:67], v[48:51]
    v_cvt_pk_bf16_f32 v17, v18, v19
    v_cvt_pk_bf16_f32 v18, v20, v21
    v_cvt_pk_bf16_f32 v19, v22, v23
    ds_read_b128 v[92:95], v249 offset:9216
    s_waitcnt lgkmcnt(2)
    v_mfma_f32_16x16x32_bf16 v[68:71], v[204:207], v[16:19], v[68:71]
    v_exp_f32 v24, v24
    v_exp_f32 v25, v25
    v_exp_f32 v26, v26
    v_mfma_f32_16x16x32_bf16 v[12:15], v[96:99], v[16:19], v[12:15]
    v_exp_f32 v27, v27
    v_exp_f32 v28, v28
    v_exp_f32 v29, v29
    v_mfma_f32_16x16x32_bf16 v[40:43], v[112:115], v[64:67], v[48:51]
    v_exp_f32 v30, v30
    v_exp_f32 v31, v31
    v_cvt_pk_bf16_f32 v24, v24, v25
    v_mfma_f32_16x16x32_bf16 v[44:47], v[172:175], v[64:67], v[48:51]
    v_cvt_pk_bf16_f32 v25, v26, v27
    v_cvt_pk_bf16_f32 v26, v28, v29
    v_cvt_pk_bf16_f32 v27, v30, v31
    ds_read_b128 v[96:99], v249 offset:10240
    s_waitcnt lgkmcnt(2)
    v_mfma_f32_16x16x32_bf16 v[68:71], v[176:179], v[24:27], v[68:71]
    v_exp_f32 v32, v32
    v_exp_f32 v33, v33
    v_exp_f32 v34, v34
    v_mfma_f32_16x16x32_bf16 v[12:15], v[100:103], v[24:27], v[12:15]
    v_exp_f32 v35, v35
    v_exp_f32 v36, v36
    v_exp_f32 v37, v37
    v_mfma_f32_16x16x32_bf16 v[16:19], v[116:119], v[64:67], v[48:51]
    v_exp_f32 v38, v38
    v_exp_f32 v39, v39
    v_cvt_pk_bf16_f32 v32, v32, v33
    v_mfma_f32_16x16x32_bf16 v[20:23], v[244:247], v[64:67], v[48:51]
    v_cvt_pk_bf16_f32 v33, v34, v35
    v_cvt_pk_bf16_f32 v34, v36, v37
    v_cvt_pk_bf16_f32 v35, v38, v39
    ds_read_b128 v[100:103], v249 offset:11264
    s_waitcnt lgkmcnt(2)
    v_mfma_f32_16x16x32_bf16 v[68:71], v[180:183], v[32:35], v[68:71]
    v_exp_f32 v40, v40
    v_exp_f32 v41, v41
    v_exp_f32 v42, v42
    v_exp_f32 v43, v43
    v_exp_f32 v44, v44
    v_exp_f32 v45, v45
    v_mfma_f32_16x16x32_bf16 v[12:15], v[92:95], v[32:35], v[12:15]
    v_exp_f32 v46, v46
    v_exp_f32 v47, v47
    v_cvt_pk_bf16_f32 v40, v40, v41
    v_cvt_pk_bf16_f32 v41, v42, v43
    v_cvt_pk_bf16_f32 v42, v44, v45
    v_cvt_pk_bf16_f32 v43, v46, v47
    s_waitcnt lgkmcnt(1)
    s_nop 0
    v_mfma_f32_16x16x32_bf16 v[68:71], v[184:187], v[40:43], v[68:71]
    v_exp_f32 v16, v16
    v_exp_f32 v17, v17
    v_exp_f32 v18, v18
    v_exp_f32 v19, v19
    v_cndmask_b32 v20, v20, v86, s[4:5]
    v_cndmask_b32 v21, v21, v86, s[6:7]
    v_cndmask_b32 v22, v22, v86, s[8:9]
    v_cndmask_b32 v23, v23, v86, s[10:11]
    v_mfma_f32_16x16x32_bf16 v[12:15], v[96:99], v[40:43], v[12:15]
    v_exp_f32 v20, v20
    v_exp_f32 v21, v21
    v_exp_f32 v22, v22
    v_exp_f32 v23, v23
    v_cvt_pk_bf16_f32 v16, v16, v17
    v_cvt_pk_bf16_f32 v17, v18, v19
    v_cvt_pk_bf16_f32 v18, v20, v21
    v_cvt_pk_bf16_f32 v19, v22, v23
    s_waitcnt lgkmcnt(0)
    s_nop 0
    v_mfma_f32_16x16x32_bf16 v[68:71], v[188:191], v[16:19], v[68:71]
    v_mfma_f32_16x16x32_bf16 v[12:15], v[100:103], v[16:19], v[12:15]
    s_nop 6
    v_add_f32 v250, |v68|, |v69|
    v_add_f32 v251, |v70|, |v71|
    v_add_f32 v88, |v12|, |v13|
    v_add_f32 v89, |v14|, |v15|
    v_add_f32 v250, v250, v251
    v_add_f32 v88, v88, v89
    v_add_f32 v250, v250, v88
    v_cmp_nle_f32 vcc, v250, v253
    s_cbranch_vccnz L_slowq7
L_cont7:
    v_mov_b32 v88, v12
    v_mov_b32 v89, v12
    s_nop 1
    v_permlane32_swap_b32 v88, v89
    v_cndmask_b32 v88, v88, v89, s[16:17]
    v_rcp_f32 v88, v88
    v_cndmask_b32 v12, v12, v14, s[18:19]
    v_cndmask_b32 v13, v13, v15, s[18:19]
    v_mul_f32 v68, v68, v88
    v_mul_f32 v69, v69, v88
    v_mul_f32 v70, v70, v88
    v_mul_f32 v71, v71, v88
    v_mul_f32 v12, v12, v88
    v_mul_f32 v13, v13, v88
    v_cvt_pk_bf16_f32 v90, v68, v69
    v_cvt_pk_bf16_f32 v91, v70, v71
    v_cvt_pk_bf16_f32 v89, v12, v13
    s_add_u32 s58, s72, 110848
    buffer_store_dwordx2 v[90:91], v252, s[36:39], s58 offen sc1
    s_add_u32 s58, s74, 110848
    s_mov_b64 exec, s[100:101]
    buffer_store_dword v89, v252, s[36:39], s58 offen sc1
    s_mov_b64 exec, -1
    s_branch L_att_done
L_head_neg:
    s_mov_b32 s67, 1
    v_cndmask_b32 v62, 0, v62, s[12:13]
    v_cndmask_b32 v63, 0, v63, s[14:15]
    ds_read_b64 v[64:65], v248 offset:512
    ds_read_b64 v[66:67], v80 offset:33280
    s_cmp_eq_u32 s75, 0x70000000
    s_cselect_b32 s57, 0xf149f2ca, 0
    v_mov_b32 v52, s57
    v_mov_b32 v53, s57
    v_mov_b32 v54, s57
    v_mov_b32 v55, s57
    s_cmp_eq_u32 s69, 0x70000000
    s_cselect_b32 s57, 0xf149f2ca, 0
    v_mov_b32 v56, s57
    v_mov_b32 v57, s57
    v_mov_b32 v58, s57
    v_mov_b32 v59, s57
    v_mfma_f32_16x16x32_bf16 v[16:19], v[104:107], v[60:63], 0
    ds_read_b128 v[92:95], v249 offset:0
    ds_read_b128 v[96:99], v249 offset:1024
    s_nop 5
    v_cndmask_b32 v16, v16, v86, s[4:5]
    v_cndmask_b32 v17, v17, v86, s[6:7]
    v_cndmask_b32 v18, v18, v86, s[8:9]
    v_cndmask_b32 v19, v19, v86, s[10:11]
    v_max_f32 v87, v16, v17
    v_max_f32 v88, v18, v19
    v_max_f32 v87, v87, v88
    v_mov_b32 v88, v87
    s_nop 1
    v_permlane32_swap_b32 v87, v88
    v_max_f32 v87, v87, v88
    v_mov_b32 v88, v87
    s_nop 1
    v_permlane16_swap_b32 v87, v88
    v_max_f32 v87, v87, v88
    v_sub_f32 v48, 0, v87
    v_sub_f32 v49, 0, v87
    v_sub_f32 v50, 0, v87
    v_sub_f32 v51, 0, v87
    v_add_f32 v52, v52, v48
    v_add_f32 v53, v53, v48
    v_add_f32 v54, v54, v48
    v_add_f32 v55, v55, v48
    v_add_f32 v56, v56, v48
    v_add_f32 v57, v57, v48
    v_add_f32 v58, v58, v48
    v_add_f32 v59, v59, v48
    v_mfma_f32_16x16x32_bf16 v[16:19], v[136:139], v[60:63], v[52:55]
    v_mfma_f32_16x16x32_bf16 v[20:23], v[152:155], v[60:63], v[52:55]
    v_mfma_f32_16x16x32_bf16 v[24:27], v[140:143], v[60:63], v[52:55]
    v_mfma_f32_16x16x32_bf16 v[28:31], v[224:227], v[60:63], v[52:55]
    v_mfma_f32_16x16x32_bf16 v[32:35], v[144:147], v[60:63], v[52:55]
    s_nop 3
    v_cndmask_b32 v16, v86, v16, s[4:5]
    v_cndmask_b32 v17, v86, v17, s[6:7]
    v_cndmask_b32 v18, v86, v18, s[8:9]
    v_cndmask_b32 v19, v86, v19, s[10:11]
    v_exp_f32 v16, v16
    v_exp_f32 v17, v17
    v_exp_f32 v18, v18
    v_exp_f32 v19, v19
    v_mfma_f32_16x16x32_bf16 v[36:39], v[156:159], v[60:63], v[52:55]
    v_exp_f32 v20, v20
    v_exp_f32 v21, v21
    v_exp_f32 v22, v22
    v_exp_f32 v23, v23
    v_cvt_pk_bf16_f32 v16, v16, v17
    v_cvt_pk_bf16_f32 v17, v18, v19
    v_cvt_pk_bf16_f32 v18, v20, v21
    v_cvt_pk_bf16_f32 v19, v22, v23
    ds_read_b128 v[100:103], v249 offset:2048
    s_waitcnt lgkmcnt(2)
    v_mfma_f32_16x16x32_bf16 v[68:71], v[208:211], v[16:19], 0
    v_exp_f32 v24, v24
    v_exp_f32 v25, v25
    v_exp_f32 v26, v26
    v_mfma_f32_16x16x32_bf16 v[12:15], v[92:95], v[16:19], 0
    v_exp_f32 v27, v27
    v_exp_f32 v28, v28
    v_exp_f32 v29, v29
    v_mfma_f32_16x16x32_bf16 v[40:43], v[148:151], v[60:63], v[52:55]
    v_exp_f32 v30, v30
    v_exp_f32 v31, v31
    v_cvt_pk_bf16_f32 v24, v24, v25
    v_mfma_f32_16x16x32_bf16 v[44:47], v[228:231], v[60:63], v[52:55]
    v_cvt_pk_bf16_f32 v25, v26, v27
    v_cvt_pk_bf16_f32 v26, v28, v29
    v_cvt_pk_bf16_f32 v27, v30, v31
    ds_read_b128 v[92:95], v249 offset:3072
    s_waitcnt lgkmcnt(2)
    v_mfma_f32_16x16x32_bf16 v[68:71], v[212:215], v[24:27], v[68:71]
    v_exp_f32 v32, v32
    v_exp_f32 v33, v33
    v_exp_f32 v34, v34
    v_mfma_f32_16x16x32_bf16 v[12:15], v[96:99], v[24:27], v[12:15]
    v_exp_f32 v35, v35
    v_exp_f32 v36, v36
    v_exp_f32 v37, v37
    v_mfma_f32_16x16x32_bf16 v[16:19], v[120:123], v[60:63], v[56:59]
    v_exp_f32 v38, v38
    v_exp_f32 v39, v39
    v_cvt_pk_bf16_f32 v32, v32, v33
    v_mfma_f32_16x16x32_bf16 v[20:23], v[160:163], v[60:63], v[56:59]
    v_cvt_pk_bf16_f32 v33, v34, v35
    v_cvt_pk_bf16_f32 v34, v36, v37
    v_cvt_pk_bf16_f32 v35, v38, v39
    ds_read_b128 v[96:99], v249 offset:4096
    s_waitcnt lgkmcnt(2)
    v_mfma_f32_16x16x32_bf16 v[68:71], v[216:219], v[32:35], v[68:71]
    v_exp_f32 v40, v40
    v_exp_f32 v41, v41
    v_exp_f32 v42, v42
    v_mfma_f32_16x16x32_bf16 v[12:15], v[100:103], v[32:35], v[12:15]
    v_exp_f32 v43, v43
    v_exp_f32 v44, v44
    v_exp_f32 v45, v45
    v_mfma_f32_16x16x32_bf16 v[24:27], v[124:127], v[60:63], v[56:59]
    v_exp_f32 v46, v46
    v_exp_f32 v47, v47
    v_cvt_pk_bf16_f32 v40, v40, v41
    v_mfma_f32_16x16x32_bf16 v[28:31], v[232:235], v[60:63], v[56:59]
    v_cvt_pk_bf16_f32 v41, v42, v43
    v_cvt_pk_bf16_f32 v42, v44, v45
    v_cvt_pk_bf16_f32 v43, v46, v47
    ds_read_b128 v[100:103], v249 offset:5120
    s_waitcnt lgkmcnt(2)
    v_mfma_f32_16x16x32_bf16 v[68:71], v[220:223], v[40:43], v[68:71]
    v_exp_f32 v16, v16
    v_exp_f32 v17, v17
    v_exp_f32 v18, v18
    v_mfma_f32_16x16x32_bf16 v[12:15], v[92:95], v[40:43], v[12:15]
    v_exp_f32 v19, v19
    v_exp_f32 v20, v20
    v_exp_f32 v21, v21
    v_mfma_f32_16x16x32_bf16 v[32:35], v[128:131], v[60:63], v[56:59]
    v_exp_f32 v22, v22
    v_exp_f32 v23, v23
    v_cvt_pk_bf16_f32 v16, v16, v17
    v_mfma_f32_16x16x32_bf16 v[36:39], v[164:167], v[60:63], v[56:59]
    v_cvt_pk_bf16_f32 v17, v18, v19
    v_cvt_pk_bf16_f32 v18, v20, v21
    v_cvt_pk_bf16_f32 v19, v22, v23
    ds_read_b128 v[92:95], v249 offset:6144
    s_waitcnt lgkmcnt(2)
    v_mfma_f32_16x16x32_bf16 v[68:71], v[192:195], v[16:19], v[68:71]
    v_exp_f32 v24, v24
    v_exp_f32 v25, v25
    v_exp_f32 v26, v26
    v_mfma_f32_16x16x32_bf16 v[12:15], v[96:99], v[16:19], v[12:15]
    v_exp_f32 v27, v27
    v_exp_f32 v28, v28
    v_exp_f32 v29, v29
    v_mfma_f32_16x16x32_bf16 v[40:43], v[132:135], v[60:63], v[56:59]
    v_exp_f32 v30, v30
    v_exp_f32 v31, v31
    v_cvt_pk_bf16_f32 v24, v24, v25
    v_mfma_f32_16x16x32_bf16 v[44:47], v[236:239], v[60:63], v[56:59]
    v_cvt_pk_bf16_f32 v25, v26, v27
    v_cvt_pk_bf16_f32 v26, v28, v29
    v_cvt_pk_bf16_f32 v27, v30, v31
    ds_read_b128 v[96:99], v249 offset:7168
    s_waitcnt lgkmcnt(2)
    v_mfma_f32_16x16x32_bf16 v[68:71], v[196:199], v[24:27], v[68:71]
    v_exp_f32 v32, v32
    v_exp_f32 v33, v33
    v_exp_f32 v34, v34
    v_exp_f32 v35, v35
    v_mfma_f32_16x16x32_bf16 v[12:15], v[100:103], v[24:27], v[12:15]
    v_exp_f32 v36, v36
    v_exp_f32 v37, v37
    v_exp_f32 v38, v38
    v_exp_f32 v39, v39
    v_mfma_f32_16x16x32_bf16 v[16:19], v[104:107], v[60:63], v[48:51]
    v_cvt_pk_bf16_f32 v32, v32, v33
    v_cvt_pk_bf16_f32 v33, v34, v35
    v_cvt_pk_bf16_f32 v34, v36, v37
    v_cvt_pk_bf16_f32 v35, v38, v39
    ds_read_b128 v[100:103], v249 offset:8192
    s_waitcnt lgkmcnt(2)
    v_mfma_f32_16x16x32_bf16 v[68:71], v[200:203], v[32:35], v[68:71]
    v_exp_f32 v40, v40
    v_exp_f32 v41, v41
    v_exp_f32 v42, v42
    v_exp_f32 v43, v43
    v_exp_f32 v44, v44
    v_exp_f32 v45, v45
    v_mfma_f32_16x16x32_bf16 v[12:15], v[92:95], v[32:35], v[12:15]
    v_exp_f32 v46, v46
    v_exp_f32 v47, v47
    v_cvt_pk_bf16_f32 v40, v40, v41
    v_cvt_pk_bf16_f32 v41, v42, v43
    v_cvt_pk_bf16_f32 v42, v44, v45
    v_cvt_pk_bf16_f32 v43, v46, v47
    s_waitcnt lgkmcnt(1)
    s_nop 0
    v_mfma_f32_16x16x32_bf16 v[68:71], v[204:207], v[40:43], v[68:71]
    v_cndmask_b32 v16, v16, v86, s[4:5]
    v_cndmask_b32 v17, v17, v86, s[6:7]
    v_cndmask_b32 v18, v18, v86, s[8:9]
    v_cndmask_b32 v19, v19, v86, s[10:11]
    v_exp_f32 v16, v16
    v_exp_f32 v17, v17
    v_mfma_f32_16x16x32_bf16 v[12:15], v[96:99], v[40:43], v[12:15]
    v_exp_f32 v18, v18
    v_exp_f32 v19, v19
    v_cvt_pk_bf16_f32 v16, v16, v17
    v_cvt_pk_bf16_f32 v17, v18, v19
    v_mov_b32 v18, 0
    v_mov_b32 v19, 0
    s_waitcnt lgkmcnt(0)
    s_nop 0
    v_mfma_f32_16x16x32_bf16 v[68:71], v[176:179], v[16:19], v[68:71]
    v_mfma_f32_16x16x32_bf16 v[12:15], v[100:103], v[16:19], v[12:15]
    s_nop 6
    v_add_f32 v250, |v68|, |v69|
    v_add_f32 v251, |v70|, |v71|
    v_add_f32 v88, |v12|, |v13|
    v_add_f32 v89, |v14|, |v15|
    v_add_f32 v250, v250, v251
    v_add_f32 v88, v88, v89
    v_add_f32 v250, v250, v88
    v_cmp_nle_f32 vcc, v250, v253
    s_cbranch_vccnz L_slowq0
L_cont_neg0:
    v_mov_b32 v88, v12
    v_mov_b32 v89, v12
    s_nop 1
    v_permlane32_swap_b32 v88, v89
    v_cndmask_b32 v88, v88, v89, s[16:17]
    v_rcp_f32 v88, v88
    v_cndmask_b32 v12, v12, v14, s[18:19]
    v_cndmask_b32 v13, v13, v15, s[18:19]
    v_mul_f32 v68, v68, v88
    v_mul_f32 v69, v69, v88
    v_mul_f32 v70, v70, v88
    v_mul_f32 v71, v71, v88
    v_mul_f32 v12, v12, v88
    v_mul_f32 v13, v13, v88
    v_cvt_pk_bf16_f32 v90, v68, v69
    v_cvt_pk_bf16_f32 v91, v70, v71
    v_cvt_pk_bf16_f32 v89, v12, v13
    s_add_u32 s58, s72, 0
    buffer_store_dwordx2 v[90:91], v252, s[36:39], s58 offen sc1
    s_add_u32 s58, s74, 0
    s_mov_b64 exec, s[100:101]
    buffer_store_dword v89, v252, s[36:39], s58 offen sc1
    s_mov_b64 exec, -1
    v_cndmask_b32 v66, 0, v66, s[12:13]
    v_cndmask_b32 v67, 0, v67, s[14:15]
    ds_read_b64 v[60:61], v248 offset:1024
    ds_read_b64 v[62:63], v80 offset:33792
    s_cmp_eq_u32 s75, 0x70000000
    s_cselect_b32 s57, 0xf149f2ca, 0
    v_mov_b32 v52, s57
    v_mov_b32 v53, s57
    v_mov_b32 v54, s57
    v_mov_b32 v55, s57
    s_cmp_eq_u32 s69, 0x70000000
    s_cselect_b32 s57, 0xf149f2ca, 0
    v_mov_b32 v56, s57
    v_mov_b32 v57, s57
    v_mov_b32 v58, s57
    v_mov_b32 v59, s57
    v_mfma_f32_16x16x32_bf16 v[16:19], v[168:171], v[64:67], 0
    ds_read_b128 v[92:95], v249 offset:0
    ds_read_b128 v[96:99], v249 offset:1024
    s_nop 5
    v_cndmask_b32 v16, v16, v86, s[4:5]
    v_cndmask_b32 v17, v17, v86, s[6:7]
    v_cndmask_b32 v18, v18, v86, s[8:9]
    v_cndmask_b32 v19, v19, v86, s[10:11]
    v_max_f32 v87, v16, v17
    v_max_f32 v88, v18, v19
    v_max_f32 v87, v87, v88
    v_mov_b32 v88, v87
    s_nop 1
    v_permlane32_swap_b32 v87, v88
    v_max_f32 v87, v87, v88
    v_mov_b32 v88, v87
    s_nop 1
    v_permlane16_swap_b32 v87, v88
    v_max_f32 v87, v87, v88
    v_sub_f32 v48, 0, v87
    v_sub_f32 v49, 0, v87
    v_sub_f32 v50, 0, v87
    v_sub_f32 v51, 0, v87
    v_add_f32 v52, v52, v48
    v_add_f32 v53, v53, v48
    v_add_f32 v54, v54, v48
    v_add_f32 v55, v55, v48
    v_add_f32 v56, v56, v48
    v_add_f32 v57, v57, v48
    v_add_f32 v58, v58, v48
    v_add_f32 v59, v59, v48
    v_mfma_f32_16x16x32_bf16 v[20:23], v[152:155], v[64:67], v[52:55]
    v_mfma_f32_16x16x32_bf16 v[24:27], v[140:143], v[64:67], v[52:55]
    v_mfma_f32_16x16x32_bf16 v[28:31], v[224:227], v[64:67], v[52:55]
    v_mfma_f32_16x16x32_bf16 v[32:35], v[144:147], v[64:67], v[52:55]
    s_nop 4
    v_cndmask_b32 v20, v86, v20, s[4:5]
    v_cndmask_b32 v21, v86, v21, s[6:7]
    v_cndmask_b32 v22, v86, v22, s[8:9]
    v_cndmask_b32 v23, v86, v23, s[10:11]
    v_exp_f32 v20, v20
    v_exp_f32 v21, v21
    v_mfma_f32_16x16x32_bf16 v[36:39], v[156:159], v[64:67], v[52:55]
    v_exp_f32 v22, v22
    v_exp_f32 v23, v23
    v_mov_b32 v16, 0
    v_mov_b32 v17, 0
    v_cvt_pk_bf16_f32 v18, v20, v21
    v_cvt_pk_bf16_f32 v19, v22, v23
    ds_read_b128 v[100:103], v249 offset:2048
    s_waitcnt lgkmcnt(2)
    v_mfma_f32_16x16x32_bf16 v[68:71], v[208:211], v[16:19], 0
    v_exp_f32 v24, v24
    v_exp_f32 v25, v25
    v_exp_f32 v26, v26
    v_mfma_f32_16x16x32_bf16 v[12:15], v[92:95], v[16:19], 0
    v_exp_f32 v27, v27
    v_exp_f32 v28, v28
    v_exp_f32 v29, v29
    v_mfma_f32_16x16x32_bf16 v[40:43], v[148:151], v[64:67], v[52:55]
    v_exp_f32 v30, v30
    v_exp_f32 v31, v31
    v_cvt_pk_bf16_f32 v24, v24, v25
    v_mfma_f32_16x16x32_bf16 v[44:47], v[228:231], v[64:67], v[52:55]
    v_cvt_pk_bf16_f32 v25, v26, v27
    v_cvt_pk_bf16_f32 v26, v28, v29
    v_cvt_pk_bf16_f32 v27, v30, v31
    ds_read_b128 v[92:95], v249 offset:3072
    s_waitcnt lgkmcnt(2)
    v_mfma_f32_16x16x32_bf16 v[68:71], v[212:215], v[24:27], v[68:71]
    v_exp_f32 v32, v32
    v_exp_f32 v33, v33
    v_exp_f32 v34, v34
    v_mfma_f32_16x16x32_bf16 v[12:15], v[96:99], v[24:27], v[12:15]
    v_exp_f32 v35, v35
    v_exp_f32 v36, v36
    v_exp_f32 v37, v37
    v_mfma_f32_16x16x32_bf16 v[16:19], v[120:123], v[64:67], v[56:59]
    v_exp_f32 v38, v38
    v_exp_f32 v39, v39
    v_cvt_pk_bf16_f32 v32, v32, v33
    v_mfma_f32_16x16x32_bf16 v[20:23], v[160:163], v[64:67], v[56:59]
    v_cvt_pk_bf16_f32 v33, v34, v35
    v_cvt_pk_bf16_f32 v34, v36, v37
    v_cvt_pk_bf16_f32 v35, v38, v39
    ds_read_b128 v[96:99], v249 offset:4096
    s_waitcnt lgkmcnt(2)
    v_mfma_f32_16x16x32_bf16 v[68:71], v[216:219], v[32:35], v[68:71]
    v_exp_f32 v40, v40
    v_exp_f32 v41, v41
    v_exp_f32 v42, v42
    v_mfma_f32_16x16x32_bf16 v[12:15], v[100:103], v[32:35], v[12:15]
    v_exp_f32 v43, v43
    v_exp_f32 v44, v44
    v_exp_f32 v45, v45
    v_mfma_f32_16x16x32_bf16 v[24:27], v[124:127], v[64:67], v[56:59]
    v_exp_f32 v46, v46
    v_exp_f32 v47, v47
    v_cvt_pk_bf16_f32 v40, v40, v41
    v_mfma_f32_16x16x32_bf16 v[28:31], v[232:235], v[64:67], v[56:59]
    v_cvt_pk_bf16_f32 v41, v42, v43
    v_cvt_pk_bf16_f32 v42, v44, v45
    v_cvt_pk_bf16_f32 v43, v46, v47
    ds_read_b128 v[100:103], v249 offset:5120
    s_waitcnt lgkmcnt(2)
    v_mfma_f32_16x16x32_bf16 v[68:71], v[220:223], v[40:43], v[68:71]
    v_exp_f32 v16, v16
    v_exp_f32 v17, v17
    v_exp_f32 v18, v18
    v_mfma_f32_16x16x32_bf16 v[12:15], v[92:95], v[40:43], v[12:15]
    v_exp_f32 v19, v19
    v_exp_f32 v20, v20
    v_exp_f32 v21, v21
    v_mfma_f32_16x16x32_bf16 v[32:35], v[128:131], v[64:67], v[56:59]
    v_exp_f32 v22, v22
    v_exp_f32 v23, v23
    v_cvt_pk_bf16_f32 v16, v16, v17
    v_mfma_f32_16x16x32_bf16 v[36:39], v[164:167], v[64:67], v[56:59]
    v_cvt_pk_bf16_f32 v17, v18, v19
    v_cvt_pk_bf16_f32 v18, v20, v21
    v_cvt_pk_bf16_f32 v19, v22, v23
    ds_read_b128 v[92:95], v249 offset:6144
    s_waitcnt lgkmcnt(2)
    v_mfma_f32_16x16x32_bf16 v[68:71], v[192:195], v[16:19], v[68:71]
    v_exp_f32 v24, v24
    v_exp_f32 v25, v25
    v_exp_f32 v26, v26
    v_mfma_f32_16x16x32_bf16 v[12:15], v[96:99], v[16:19], v[12:15]
    v_exp_f32 v27, v27
    v_exp_f32 v28, v28
    v_exp_f32 v29, v29
    v_mfma_f32_16x16x32_bf16 v[40:43], v[132:135], v[64:67], v[56:59]
    v_exp_f32 v30, v30
    v_exp_f32 v31, v31
    v_cvt_pk_bf16_f32 v24, v24, v25
    v_mfma_f32_16x16x32_bf16 v[44:47], v[236:239], v[64:67], v[56:59]
    v_cvt_pk_bf16_f32 v25, v26, v27
    v_cvt_pk_bf16_f32 v26, v28, v29
    v_cvt_pk_bf16_f32 v27, v30, v31
    ds_read_b128 v[96:99], v249 offset:7168
    s_waitcnt lgkmcnt(2)
    v_mfma_f32_16x16x32_bf16 v[68:71], v[196:199], v[24:27], v[68:71]
    v_exp_f32 v32, v32
    v_exp_f32 v33, v33
    v_exp_f32 v34, v34
    v_mfma_f32_16x16x32_bf16 v[12:15], v[100:103], v[24:27], v[12:15]
    v_exp_f32 v35, v35
    v_exp_f32 v36, v36
    v_exp_f32 v37, v37
    v_mfma_f32_16x16x32_bf16 v[16:19], v[104:107], v[64:67], v[48:51]
    v_exp_f32 v38, v38
    v_exp_f32 v39, v39
    v_cvt_pk_bf16_f32 v32, v32, v33
    v_mfma_f32_16x16x32_bf16 v[20:23], v[168:171], v[64:67], v[48:51]
    v_cvt_pk_bf16_f32 v33, v34, v35
    v_cvt_pk_bf16_f32 v34, v36, v37
    v_cvt_pk_bf16_f32 v35, v38, v39
    ds_read_b128 v[100:103], v249 offset:8192
    s_waitcnt lgkmcnt(2)
    v_mfma_f32_16x16x32_bf16 v[68:71], v[200:203], v[32:35], v[68:71]
    v_exp_f32 v40, v40
    v_exp_f32 v41, v41
    v_exp_f32 v42, v42
    v_exp_f32 v43, v43
    v_exp_f32 v44, v44
    v_exp_f32 v45, v45
    v_mfma_f32_16x16x32_bf16 v[12:15], v[92:95], v[32:35], v[12:15]
    v_exp_f32 v46, v46
    v_exp_f32 v47, v47
    v_cvt_pk_bf16_f32 v40, v40, v41
    v_cvt_pk_bf16_f32 v41, v42, v43
    v_cvt_pk_bf16_f32 v42, v44, v45
    v_cvt_pk_bf16_f32 v43, v46, v47
    s_waitcnt lgkmcnt(1)
    s_nop 0
    v_mfma_f32_16x16x32_bf16 v[68:71], v[204:207], v[40:43], v[68:71]
    v_exp_f32 v16, v16
    v_exp_f32 v17, v17
    v_exp_f32 v18, v18
    v_exp_f32 v19, v19
    v_cndmask_b32 v20, v20, v86, s[4:5]
    v_cndmask_b32 v21, v21, v86, s[6:7]
    v_cndmask_b32 v22, v22, v86, s[8:9]
    v_cndmask_b32 v23, v23, v86, s[10:11]
    v_mfma_f32_16x16x32_bf16 v[12:15], v[96:99], v[40:43], v[12:15]
    v_exp_f32 v20, v20
    v_exp_f32 v21, v21
    v_exp_f32 v22, v22
    v_exp_f32 v23, v23
    v_cvt_pk_bf16_f32 v16, v16, v17
    v_cvt_pk_bf16_f32 v17, v18, v19
    v_cvt_pk_bf16_f32 v18, v20, v21
    v_cvt_pk_bf16_f32 v19, v22, v23
    s_waitcnt lgkmcnt(0)
    s_nop 0
    v_mfma_f32_16x16x32_bf16 v[68:71], v[176:179], v[16:19], v[68:71]
    v_mfma_f32_16x16x32_bf16 v[12:15], v[100:103], v[16:19], v[12:15]
    s_nop 6
    v_add_f32 v250, |v68|, |v69|
    v_add_f32 v251, |v70|, |v71|
    v_add_f32 v88, |v12|, |v13|
    v_add_f32 v89, |v14|, |v15|
    v_add_f32 v250, v250, v251
    v_add_f32 v88, v88, v89
    v_add_f32 v250, v250, v88
    v_cmp_nle_f32 vcc, v250, v253
    s_cbranch_vccnz L_slowq1
L_cont_neg1:
    v_mov_b32 v88, v12
    v_mov_b32 v89, v12
    s_nop 1
    v_permlane32_swap_b32 v88, v89
    v_cndmask_b32 v88, v88, v89, s[16:17]
    v_rcp_f32 v88, v88
    v_cndmask_b32 v12, v12, v14, s[18:19]
    v_cndmask_b32 v13, v13, v15, s[18:19]
    v_mul_f32 v68, v68, v88
    v_mul_f32 v69, v69, v88
    v_mul_f32 v70, v70, v88
    v_mul_f32 v71, v71, v88
    v_mul_f32 v12, v12, v88
    v_mul_f32 v13, v13, v88
    v_cvt_pk_bf16_f32 v90, v68, v69
    v_cvt_pk_bf16_f32 v91, v70, v71
    v_cvt_pk_bf16_f32 v89, v12, v13
    s_add_u32 s58, s72, 256
    buffer_store_dwordx2 v[90:91], v252, s[36:39], s58 offen sc1
    s_add_u32 s58, s74, 256
    s_mov_b64 exec, s[100:101]
    buffer_store_dword v89, v252, s[36:39], s58 offen sc1
    s_mov_b64 exec, -1
    v_cndmask_b32 v62, 0, v62, s[12:13]
    v_cndmask_b32 v63, 0, v63, s[14:15]
    ds_read_b64 v[64:65], v248 offset:1536
    ds_read_b64 v[66:67], v80 offset:34304
    s_cmp_eq_u32 s75, 0x70000000
    s_cselect_b32 s57, 0xf149f2ca, 0
    v_mov_b32 v52, s57
    v_mov_b32 v53, s57
    v_mov_b32 v54, s57
    v_mov_b32 v55, s57
    s_cmp_eq_u32 s69, 0x70000000
    s_cselect_b32 s57, 0xf149f2ca, 0
    v_mov_b32 v56, s57
    v_mov_b32 v57, s57
    v_mov_b32 v58, s57
    v_mov_b32 v59, s57
    v_mfma_f32_16x16x32_bf16 v[16:19], v[108:111], v[60:63], 0
    ds_read_b128 v[92:95], v249 offset:1024
    ds_read_b128 v[96:99], v249 offset:2048
    s_nop 5
    v_cndmask_b32 v16, v16, v86, s[4:5]
    v_cndmask_b32 v17, v17, v86, s[6:7]
    v_cndmask_b32 v18, v18, v86, s[8:9]
    v_cndmask_b32 v19, v19, v86, s[10:11]
    v_max_f32 v87, v16, v17
    v_max_f32 v88, v18, v19
    v_max_f32 v87, v87, v88
    v_mov_b32 v88, v87
    s_nop 1
    v_permlane32_swap_b32 v87, v88
    v_max_f32 v87, v87, v88
    v_mov_b32 v88, v87
    s_nop 1
    v_permlane16_swap_b32 v87, v88
    v_max_f32 v87, v87, v88
    v_sub_f32 v48, 0, v87
    v_sub_f32 v49, 0, v87
    v_sub_f32 v50, 0, v87
    v_sub_f32 v51, 0, v87
    v_add_f32 v52, v52, v48
    v_add_f32 v53, v53, v48
    v_add_f32 v54, v54, v48
    v_add_f32 v55, v55, v48
    v_add_f32 v56, v56, v48
    v_add_f32 v57, v57, v48
    v_add_f32 v58, v58, v48
    v_add_f32 v59, v59, v48
    v_mfma_f32_16x16x32_bf16 v[16:19], v[140:143], v[60:63], v[52:55]
    v_mfma_f32_16x16x32_bf16 v[20:23], v[224:227], v[60:63], v[52:55]
    v_mfma_f32_16x16x32_bf16 v[24:27], v[144:147], v[60:63], v[52:55]
    v_mfma_f32_16x16x32_bf16 v[28:31], v[156:159], v[60:63], v[52:55]
    v_mfma_f32_16x16x32_bf16 v[32:35], v[148:151], v[60:63], v[52:55]
    s_nop 3
    v_cndmask_b32 v16, v86, v16, s[4:5]
    v_cndmask_b32 v17, v86, v17, s[6:7]
    v_cndmask_b32 v18, v86, v18, s[8:9]
    v_cndmask_b32 v19, v86, v19, s[10:11]
    v_exp_f32 v16, v16
    v_exp_f32 v17, v17
    v_exp_f32 v18, v18
    v_exp_f32 v19, v19
    v_mfma_f32_16x16x32_bf16 v[36:39], v[228:231], v[60:63], v[52:55]
    v_exp_f32 v20, v20
    v_exp_f32 v21, v21
    v_exp_f32 v22, v22
    v_exp_f32 v23, v23
    v_cvt_pk_bf16_f32 v16, v16, v17
    v_cvt_pk_bf16_f32 v17, v18, v19
    v_cvt_pk_bf16_f32 v18, v20, v21
    v_cvt_pk_bf16_f32 v19, v22, v23
    ds_read_b128 v[100:103], v249 offset:3072
    s_waitcnt lgkmcnt(2)
    v_mfma_f32_16x16x32_bf16 v[68:71], v[212:215], v[16:19], 0
    v_exp_f32 v24, v24
    v_exp_f32 v25, v25
    v_exp_f32 v26, v26
    v_mfma_f32_16x16x32_bf16 v[12:15], v[92:95], v[16:19], 0
    v_exp_f32 v27, v27
    v_exp_f32 v28, v28
    v_exp_f32 v29, v29
    v_mfma_f32_16x16x32_bf16 v[40:43], v[120:123], v[60:63], v[56:59]
    v_exp_f32 v30, v30
    v_exp_f32 v31, v31
    v_cvt_pk_bf16_f32 v24, v24, v25
    v_mfma_f32_16x16x32_bf16 v[44:47], v[160:163], v[60:63], v[56:59]
    v_cvt_pk_bf16_f32 v25, v26, v27
    v_cvt_pk_bf16_f32 v26, v28, v29
    v_cvt_pk_bf16_f32 v27, v30, v31
    ds_read_b128 v[92:95], v249 offset:4096
    s_waitcnt lgkmcnt(2)
    v_mfma_f32_16x16x32_bf16 v[68:71], v[216:219], v[24:27], v[68:71]
    v_exp_f32 v32, v32
    v_exp_f32 v33, v33
    v_exp_f32 v34, v34
    v_mfma_f32_16x16x32_bf16 v[12:15], v[96:99], v[24:27], v[12:15]
    v_exp_f32 v35, v35
    v_exp_f32 v36, v36
    v_exp_f32 v37, v37
    v_mfma_f32_16x16x32_bf16 v[16:19], v[124:127], v[60:63], v[56:59]
    v_exp_f32 v38, v38
    v_exp_f32 v39, v39
    v_cvt_pk_bf16_f32 v32, v32, v33
    v_mfma_f32_16x16x32_bf16 v[20:23], v[232:235], v[60:63], v[56:59]
    v_cvt_pk_bf16_f32 v33, v34, v35
    v_cvt_pk_bf16_f32 v34, v36, v37
    v_cvt_pk_bf16_f32 v35, v38, v39
    ds_read_b128 v[96:99], v249 offset:5120
    s_waitcnt lgkmcnt(2)
    v_mfma_f32_16x16x32_bf16 v[68:71], v[220:223], v[32:35], v[68:71]
    v_exp_f32 v40, v40
    v_exp_f32 v41, v41
    v_exp_f32 v42, v42
    v_mfma_f32_16x16x32_bf16 v[12:15], v[100:103], v[32:35], v[12:15]
    v_exp_f32 v43, v43
    v_exp_f32 v44, v44
    v_exp_f32 v45, v45
    v_mfma_f32_16x16x32_bf16 v[24:27], v[128:131], v[60:63], v[56:59]
    v_exp_f32 v46, v46
    v_exp_f32 v47, v47
    v_cvt_pk_bf16_f32 v40, v40, v41
    v_mfma_f32_16x16x32_bf16 v[28:31], v[164:167], v[60:63], v[56:59]
    v_cvt_pk_bf16_f32 v41, v42, v43
    v_cvt_pk_bf16_f32 v42, v44, v45
    v_cvt_pk_bf16_f32 v43, v46, v47
    ds_read_b128 v[100:103], v249 offset:6144
    s_waitcnt lgkmcnt(2)
    v_mfma_f32_16x16x32_bf16 v[68:71], v[192:195], v[40:43], v[68:71]
    v_exp_f32 v16, v16
    v_exp_f32 v17, v17
    v_exp_f32 v18, v18
    v_mfma_f32_16x16x32_bf16 v[12:15], v[92:95], v[40:43], v[12:15]
    v_exp_f32 v19, v19
    v_exp_f32 v20, v20
    v_exp_f32 v21, v21
    v_mfma_f32_16x16x32_bf16 v[32:35], v[132:135], v[60:63], v[56:59]
    v_exp_f32 v22, v22
    v_exp_f32 v23, v23
    v_cvt_pk_bf16_f32 v16, v16, v17
    v_mfma_f32_16x16x32_bf16 v[36:39], v[236:239], v[60:63], v[56:59]
    v_cvt_pk_bf16_f32 v17, v18, v19
    v_cvt_pk_bf16_f32 v18, v20, v21
    v_cvt_pk_bf16_f32 v19, v22, v23
    ds_read_b128 v[92:95], v249 offset:7168
    s_waitcnt lgkmcnt(2)
    v_mfma_f32_16x16x32_bf16 v[68:71], v[196:199], v[16:19], v[68:71]
    v_exp_f32 v24, v24
    v_exp_f32 v25, v25
    v_exp_f32 v26, v26
    v_mfma_f32_16x16x32_bf16 v[12:15], v[96:99], v[16:19], v[12:15]
    v_exp_f32 v27, v27
    v_exp_f32 v28, v28
    v_exp_f32 v29, v29
    v_mfma_f32_16x16x32_bf16 v[40:43], v[104:107], v[60:63], v[48:51]
    v_exp_f32 v30, v30
    v_exp_f32 v31, v31
    v_cvt_pk_bf16_f32 v24, v24, v25
    v_mfma_f32_16x16x32_bf16 v[44:47], v[168:171], v[60:63], v[48:51]
    v_cvt_pk_bf16_f32 v25, v26, v27
    v_cvt_pk_bf16_f32 v26, v28, v29
    v_cvt_pk_bf16_f32 v27, v30, v31
    ds_read_b128 v[96:99], v249 offset:8192
    s_waitcnt lgkmcnt(2)
    v_mfma_f32_16x16x32_bf16 v[68:71], v[200:203], v[24:27], v[68:71]
    v_exp_f32 v32, v32
    v_exp_f32 v33, v33
    v_exp_f32 v34, v34
    v_exp_f32 v35, v35
    v_mfma_f32_16x16x32_bf16 v[12:15], v[100:103], v[24:27], v[12:15]
    v_exp_f32 v36, v36
    v_exp_f32 v37, v37
    v_exp_f32 v38, v38
    v_exp_f32 v39, v39
    v_mfma_f32_16x16x32_bf16 v[16:19], v[108:111], v[60:63], v[48:51]
    v_cvt_pk_bf16_f32 v32, v32, v33
    v_cvt_pk_bf16_f32 v33, v34, v35
    v_cvt_pk_bf16_f32 v34, v36, v37
    v_cvt_pk_bf16_f32 v35, v38, v39
    ds_read_b128 v[100:103], v249 offset:9216
    s_waitcnt lgkmcnt(2)
    v_mfma_f32_16x16x32_bf16 v[68:71], v[204:207], v[32:35], v[68:71]
    v_exp_f32 v40, v40
    v_exp_f32 v41, v41
    v_exp_f32 v42, v42
    v_exp_f32 v43, v43
    v_exp_f32 v44, v44
    v_exp_f32 v45, v45
    v_mfma_f32_16x16x32_bf16 v[12:15], v[92:95], v[32:35], v[12:15]
    v_exp_f32 v46, v46
    v_exp_f32 v47, v47
    v_cvt_pk_bf16_f32 v40, v40, v41
    v_cvt_pk_bf16_f32 v41, v42, v43
    v_cvt_pk_bf16_f32 v42, v44, v45
    v_cvt_pk_bf16_f32 v43, v46, v47
    s_waitcnt lgkmcnt(1)
    s_nop 0
    v_mfma_f32_16x16x32_bf16 v[68:71], v[176:179], v[40:43], v[68:71]
    v_cndmask_b32 v16, v16, v86, s[4:5]
    v_cndmask_b32 v17, v17, v86, s[6:7]
    v_cndmask_b32 v18, v18, v86, s[8:9]
    v_cndmask_b32 v19, v19, v86, s[10:11]
    v_exp_f32 v16, v16
    v_exp_f32 v17, v17
    v_mfma_f32_16x16x32_bf16 v[12:15], v[96:99], v[40:43], v[12:15]
    v_exp_f32 v18, v18
    v_exp_f32 v19, v19
    v_cvt_pk_bf16_f32 v16, v16, v17
    v_cvt_pk_bf16_f32 v17, v18, v19
    v_mov_b32 v18, 0
    v_mov_b32 v19, 0
    s_waitcnt lgkmcnt(0)
    s_nop 0
    v_mfma_f32_16x16x32_bf16 v[68:71], v[180:183], v[16:19], v[68:71]
    v_mfma_f32_16x16x32_bf16 v[12:15], v[100:103], v[16:19], v[12:15]
    s_nop 6
    v_add_f32 v250, |v68|, |v69|
    v_add_f32 v251, |v70|, |v71|
    v_add_f32 v88, |v12|, |v13|
    v_add_f32 v89, |v14|, |v15|
    v_add_f32 v250, v250, v251
    v_add_f32 v88, v88, v89
    v_add_f32 v250, v250, v88
    v_cmp_nle_f32 vcc, v250, v253
    s_cbranch_vccnz L_slowq2
L_cont_neg2:
    v_mov_b32 v88, v12
    v_mov_b32 v89, v12
    s_nop 1
    v_permlane32_swap_b32 v88, v89
    v_cndmask_b32 v88, v88, v89, s[16:17]
    v_rcp_f32 v88, v88
    v_cndmask_b32 v12, v12, v14, s[18:19]
    v_cndmask_b32 v13, v13, v15, s[18:19]
    v_mul_f32 v68, v68, v88
    v_mul_f32 v69, v69, v88
    v_mul_f32 v70, v70, v88
    v_mul_f32 v71, v71, v88
    v_mul_f32 v12, v12, v88
    v_mul_f32 v13, v13, v88
    v_cvt_pk_bf16_f32 v90, v68, v69
    v_cvt_pk_bf16_f32 v91, v70, v71
    v_cvt_pk_bf16_f32 v89, v12, v13
    s_add_u32 s58, s72, 36864
    buffer_store_dwordx2 v[90:91], v252, s[36:39], s58 offen sc1
    s_add_u32 s58, s74, 36864
    s_mov_b64 exec, s[100:101]
    buffer_store_dword v89, v252, s[36:39], s58 offen sc1
    s_mov_b64 exec, -1
    v_cndmask_b32 v66, 0, v66, s[12:13]
    v_cndmask_b32 v67, 0, v67, s[14:15]
    ds_read_b64 v[60:61], v248 offset:2048
    ds_read_b64 v[62:63], v80 offset:34816
    s_cmp_eq_u32 s75, 0x70000000
    s_cselect_b32 s57, 0xf149f2ca, 0
    v_mov_b32 v52, s57
    v_mov_b32 v53, s57
    v_mov_b32 v54, s57
    v_mov_b32 v55, s57
    s_cmp_eq_u32 s69, 0x70000000
    s_cselect_b32 s57, 0xf149f2ca, 0
    v_mov_b32 v56, s57
    v_mov_b32 v57, s57
    v_mov_b32 v58, s57
    v_mov_b32 v59, s57
    v_mfma_f32_16x16x32_bf16 v[16:19], v[240:243], v[64:67], 0
    ds_read_b128 v[92:95], v249 offset:1024
    ds_read_b128 v[96:99], v249 offset:2048
    s_nop 5
    v_cndmask_b32 v16, v16, v86, s[4:5]
    v_cndmask_b32 v17, v17, v86, s[6:7]
    v_cndmask_b32 v18, v18, v86, s[8:9]
    v_cndmask_b32 v19, v19, v86, s[10:11]
    v_max_f32 v87, v16, v17
    v_max_f32 v88, v18, v19
    v_max_f32 v87, v87, v88
    v_mov_b32 v88, v87
    s_nop 1
    v_permlane32_swap_b32 v87, v88
    v_max_f32 v87, v87, v88
    v_mov_b32 v88, v87
    s_nop 1
    v_permlane16_swap_b32 v87, v88
    v_max_f32 v87, v87, v88
    v_sub_f32 v48, 0, v87
    v_sub_f32 v49, 0, v87
    v_sub_f32 v50, 0, v87
    v_sub_f32 v51, 0, v87
    v_add_f32 v52, v52, v48
    v_add_f32 v53, v53, v48
    v_add_f32 v54, v54, v48
    v_add_f32 v55, v55, v48
    v_add_f32 v56, v56, v48
    v_add_f32 v57, v57, v48
    v_add_f32 v58, v58, v48
    v_add_f32 v59, v59, v48
    v_mfma_f32_16x16x32_bf16 v[20:23], v[224:227], v[64:67], v[52:55]
    v_mfma_f32_16x16x32_bf16 v[24:27], v[144:147], v[64:67], v[52:55]
    v_mfma_f32_16x16x32_bf16 v[28:31], v[156:159], v[64:67], v[52:55]
    v_mfma_f32_16x16x32_bf16 v[32:35], v[148:151], v[64:67], v[52:55]
    s_nop 4
    v_cndmask_b32 v20, v86, v20, s[4:5]
    v_cndmask_b32 v21, v86, v21, s[6:7]
    v_cndmask_b32 v22, v86, v22, s[8:9]
    v_cndmask_b32 v23, v86, v23, s[10:11]
    v_exp_f32 v20, v20
    v_exp_f32 v21, v21
    v_mfma_f32_16x16x32_bf16 v[36:39], v[228:231], v[64:67], v[52:55]
    v_exp_f32 v22, v22
    v_exp_f32 v23, v23
    v_mov_b32 v16, 0
    v_mov_b32 v17, 0
    v_cvt_pk_bf16_f32 v18, v20, v21
    v_cvt_pk_bf16_f32 v19, v22, v23
    ds_read_b128 v[100:103], v249 offset:3072
    s_waitcnt lgkmcnt(2)
    v_mfma_f32_16x16x32_bf16 v[68:71], v[212:215], v[16:19], 0
    v_exp_f32 v24, v24
    v_exp_f32 v25, v25
    v_exp_f32 v26, v26
    v_mfma_f32_16x16x32_bf16 v[12:15], v[92:95], v[16:19], 0
    v_exp_f32 v27, v27
    v_exp_f32 v28, v28
    v_exp_f32 v29, v29
    v_mfma_f32_16x16x32_bf16 v[40:43], v[120:123], v[64:67], v[56:59]
    v_exp_f32 v30, v30
    v_exp_f32 v31, v31
    v_cvt_pk_bf16_f32 v24, v24, v25
    v_mfma_f32_16x16x32_bf16 v[44:47], v[160:163], v[64:67], v[56:59]
    v_cvt_pk_bf16_f32 v25, v26, v27
    v_cvt_pk_bf16_f32 v26, v28, v29
    v_cvt_pk_bf16_f32 v27, v30, v31
    ds_read_b128 v[92:95], v249 offset:4096
    s_waitcnt lgkmcnt(2)
    v_mfma_f32_16x16x32_bf16 v[68:71], v[216:219], v[24:27], v[68:71]
    v_exp_f32 v32, v32
    v_exp_f32 v33, v33
    v_exp_f32 v34, v34
    v_mfma_f32_16x16x32_bf16 v[12:15], v[96:99], v[24:27], v[12:15]
    v_exp_f32 v35, v35
    v_exp_f32 v36, v36
    v_exp_f32 v37, v37
    v_mfma_f32_16x16x32_bf16 v[16:19], v[124:127], v[64:67], v[56:59]
    v_exp_f32 v38, v38
    v_exp_f32 v39, v39
    v_cvt_pk_bf16_f32 v32, v32, v33
    v_mfma_f32_16x16x32_bf16 v[20:23], v[232:235], v[64:67], v[56:59]
    v_cvt_pk_bf16_f32 v33, v34, v35
    v_cvt_pk_bf16_f32 v34, v36, v37
    v_cvt_pk_bf16_f32 v35, v38, v39
    ds_read_b128 v[96:99], v249 offset:5120
    s_waitcnt lgkmcnt(2)
    v_mfma_f32_16x16x32_bf16 v[68:71], v[220:223], v[32:35], v[68:71]
    v_exp_f32 v40, v40
    v_exp_f32 v41, v41
    v_exp_f32 v42, v42
    v_mfma_f32_16x16x32_bf16 v[12:15], v[100:103], v[32:35], v[12:15]
    v_exp_f32 v43, v43
    v_exp_f32 v44, v44
    v_exp_f32 v45, v45
    v_mfma_f32_16x16x32_bf16 v[24:27], v[128:131], v[64:67], v[56:59]
    v_exp_f32 v46, v46
    v_exp_f32 v47, v47
    v_cvt_pk_bf16_f32 v40, v40, v41
    v_mfma_f32_16x16x32_bf16 v[28:31], v[164:167], v[64:67], v[56:59]
    v_cvt_pk_bf16_f32 v41, v42, v43
    v_cvt_pk_bf16_f32 v42, v44, v45
    v_cvt_pk_bf16_f32 v43, v46, v47
    ds_read_b128 v[100:103], v249 offset:6144
    s_waitcnt lgkmcnt(2)
    v_mfma_f32_16x16x32_bf16 v[68:71], v[192:195], v[40:43], v[68:71]
    v_exp_f32 v16, v16
    v_exp_f32 v17, v17
    v_exp_f32 v18, v18
    v_mfma_f32_16x16x32_bf16 v[12:15], v[92:95], v[40:43], v[12:15]
    v_exp_f32 v19, v19
    v_exp_f32 v20, v20
    v_exp_f32 v21, v21
    v_mfma_f32_16x16x32_bf16 v[32:35], v[132:135], v[64:67], v[56:59]
    v_exp_f32 v22, v22
    v_exp_f32 v23, v23
    v_cvt_pk_bf16_f32 v16, v16, v17
    v_mfma_f32_16x16x32_bf16 v[36:39], v[236:239], v[64:67], v[56:59]
    v_cvt_pk_bf16_f32 v17, v18, v19
    v_cvt_pk_bf16_f32 v18, v20, v21
    v_cvt_pk_bf16_f32 v19, v22, v23
    ds_read_b128 v[92:95], v249 offset:7168
    s_waitcnt lgkmcnt(2)
    v_mfma_f32_16x16x32_bf16 v[68:71], v[196:199], v[16:19], v[68:71]
    v_exp_f32 v24, v24
    v_exp_f32 v25, v25
    v_exp_f32 v26, v26
    v_mfma_f32_16x16x32_bf16 v[12:15], v[96:99], v[16:19], v[12:15]
    v_exp_f32 v27, v27
    v_exp_f32 v28, v28
    v_exp_f32 v29, v29
    v_mfma_f32_16x16x32_bf16 v[40:43], v[104:107], v[64:67], v[48:51]
    v_exp_f32 v30, v30
    v_exp_f32 v31, v31
    v_cvt_pk_bf16_f32 v24, v24, v25
    v_mfma_f32_16x16x32_bf16 v[44:47], v[168:171], v[64:67], v[48:51]
    v_cvt_pk_bf16_f32 v25, v26, v27
    v_cvt_pk_bf16_f32 v26, v28, v29
    v_cvt_pk_bf16_f32 v27, v30, v31
    ds_read_b128 v[96:99], v249 offset:8192
    s_waitcnt lgkmcnt(2)
    v_mfma_f32_16x16x32_bf16 v[68:71], v[200:203], v[24:27], v[68:71]
    v_exp_f32 v32, v32
    v_exp_f32 v33, v33
    v_exp_f32 v34, v34
    v_mfma_f32_16x16x32_bf16 v[12:15], v[100:103], v[24:27], v[12:15]
    v_exp_f32 v35, v35
    v_exp_f32 v36, v36
    v_exp_f32 v37, v37
    v_mfma_f32_16x16x32_bf16 v[16:19], v[108:111], v[64:67], v[48:51]
    v_exp_f32 v38, v38
    v_exp_f32 v39, v39
    v_cvt_pk_bf16_f32 v32, v32, v33
    v_mfma_f32_16x16x32_bf16 v[20:23], v[240:243], v[64:67], v[48:51]
    v_cvt_pk_bf16_f32 v33, v34, v35
    v_cvt_pk_bf16_f32 v34, v36, v37
    v_cvt_pk_bf16_f32 v35, v38, v39
    ds_read_b128 v[100:103], v249 offset:9216
    s_waitcnt lgkmcnt(2)
    v_mfma_f32_16x16x32_bf16 v[68:71], v[204:207], v[32:35], v[68:71]
    v_exp_f32 v40, v40
    v_exp_f32 v41, v41
    v_exp_f32 v42, v42
    v_exp_f32 v43, v43
    v_exp_f32 v44, v44
    v_exp_f32 v45, v45
    v_mfma_f32_16x16x32_bf16 v[12:15], v[92:95], v[32:35], v[12:15]
    v_exp_f32 v46, v46
    v_exp_f32 v47, v47
    v_cvt_pk_bf16_f32 v40, v40, v41
    v_cvt_pk_bf16_f32 v41, v42, v43
    v_cvt_pk_bf16_f32 v42, v44, v45
    v_cvt_pk_bf16_f32 v43, v46, v47
    s_waitcnt lgkmcnt(1)
    s_nop 0
    v_mfma_f32_16x16x32_bf16 v[68:71], v[176:179], v[40:43], v[68:71]
    v_exp_f32 v16, v16
    v_exp_f32 v17, v17
    v_exp_f32 v18, v18
    v_exp_f32 v19, v19
    v_cndmask_b32 v20, v20, v86, s[4:5]
    v_cndmask_b32 v21, v21, v86, s[6:7]
    v_cndmask_b32 v22, v22, v86, s[8:9]
    v_cndmask_b32 v23, v23, v86, s[10:11]
    v_mfma_f32_16x16x32_bf16 v[12:15], v[96:99], v[40:43], v[12:15]
    v_exp_f32 v20, v20
    v_exp_f32 v21, v21
    v_exp_f32 v22, v22
    v_exp_f32 v23, v23
    v_cvt_pk_bf16_f32 v16, v16, v17
    v_cvt_pk_bf16_f32 v17, v18, v19
    v_cvt_pk_bf16_f32 v18, v20, v21
    v_cvt_pk_bf16_f32 v19, v22, v23
    s_waitcnt lgkmcnt(0)
    s_nop 0
    v_mfma_f32_16x16x32_bf16 v[68:71], v[180:183], v[16:19], v[68:71]
    v_mfma_f32_16x16x32_bf16 v[12:15], v[100:103], v[16:19], v[12:15]
    s_nop 6
    v_add_f32 v250, |v68|, |v69|
    v_add_f32 v251, |v70|, |v71|
    v_add_f32 v88, |v12|, |v13|
    v_add_f32 v89, |v14|, |v15|
    v_add_f32 v250, v250, v251
    v_add_f32 v88, v88, v89
    v_add_f32 v250, v250, v88
    v_cmp_nle_f32 vcc, v250, v253
    s_cbranch_vccnz L_slowq3
L_cont_neg3:
    v_mov_b32 v88, v12
    v_mov_b32 v89, v12
    s_nop 1
    v_permlane32_swap_b32 v88, v89
    v_cndmask_b32 v88, v88, v89, s[16:17]
    v_rcp_f32 v88, v88
    v_cndmask_b32 v12, v12, v14, s[18:19]
    v_cndmask_b32 v13, v13, v15, s[18:19]
    v_mul_f32 v68, v68, v88
    v_mul_f32 v69, v69, v88
    v_mul_f32 v70, v70, v88
    v_mul_f32 v71, v71, v88
    v_mul_f32 v12, v12, v88
    v_mul_f32 v13, v13, v88
    v_cvt_pk_bf16_f32 v90, v68, v69
    v_cvt_pk_bf16_f32 v91, v70, v71
    v_cvt_pk_bf16_f32 v89, v12, v13
    s_add_u32 s58, s72, 37120
    buffer_store_dwordx2 v[90:91], v252, s[36:39], s58 offen sc1
    s_add_u32 s58, s74, 37120
    s_mov_b64 exec, s[100:101]
    buffer_store_dword v89, v252, s[36:39], s58 offen sc1
    s_mov_b64 exec, -1
    v_cndmask_b32 v62, 0, v62, s[12:13]
    v_cndmask_b32 v63, 0, v63, s[14:15]
    ds_read_b64 v[64:65], v248 offset:2560
    ds_read_b64 v[66:67], v80 offset:35328
    s_cmp_eq_u32 s75, 0x70000000
    s_cselect_b32 s57, 0xf149f2ca, 0
    v_mov_b32 v52, s57
    v_mov_b32 v53, s57
    v_mov_b32 v54, s57
    v_mov_b32 v55, s57
    s_cmp_eq_u32 s69, 0x70000000
    s_cselect_b32 s57, 0xf149f2ca, 0
    v_mov_b32 v56, s57
    v_mov_b32 v57, s57
    v_mov_b32 v58, s57
    v_mov_b32 v59, s57
    v_mfma_f32_16x16x32_bf16 v[16:19], v[112:115], v[60:63], 0
    ds_read_b128 v[92:95], v249 offset:2048
    ds_read_b128 v[96:99], v249 offset:3072
    s_nop 5
    v_cndmask_b32 v16, v16, v86, s[4:5]
    v_cndmask_b32 v17, v17, v86, s[6:7]
    v_cndmask_b32 v18, v18, v86, s[8:9]
    v_cndmask_b32 v19, v19, v86, s[10:11]
    v_max_f32 v87, v16, v17
    v_max_f32 v88, v18, v19
    v_max_f32 v87, v87, v88
    v_mov_b32 v88, v87
    s_nop 1
    v_permlane32_swap_b32 v87, v88
    v_max_f32 v87, v87, v88
    v_mov_b32 v88, v87
    s_nop 1
    v_permlane16_swap_b32 v87, v88
    v_max_f32 v87, v87, v88
    v_sub_f32 v48, 0, v87
    v_sub_f32 v49, 0, v87
    v_sub_f32 v50, 0, v87
    v_sub_f32 v51, 0, v87
    v_add_f32 v52, v52, v48
    v_add_f32 v53, v53, v48
    v_add_f32 v54, v54, v48
    v_add_f32 v55, v55, v48
    v_add_f32 v56, v56, v48
    v_add_f32 v57, v57, v48
    v_add_f32 v58, v58, v48
    v_add_f32 v59, v59, v48
    v_mfma_f32_16x16x32_bf16 v[16:19], v[144:147], v[60:63], v[52:55]
    v_mfma_f32_16x16x32_bf16 v[20:23], v[156:159], v[60:63], v[52:55]
    v_mfma_f32_16x16x32_bf16 v[24:27], v[148:151], v[60:63], v[52:55]
    v_mfma_f32_16x16x32_bf16 v[28:31], v[228:231], v[60:63], v[52:55]
    v_mfma_f32_16x16x32_bf16 v[32:35], v[120:123], v[60:63], v[56:59]
    s_nop 3
    v_cndmask_b32 v16, v86, v16, s[4:5]
    v_cndmask_b32 v17, v86, v17, s[6:7]
    v_cndmask_b32 v18, v86, v18, s[8:9]
    v_cndmask_b32 v19, v86, v19, s[10:11]
    v_exp_f32 v16, v16
    v_exp_f32 v17, v17
    v_exp_f32 v18, v18
    v_exp_f32 v19, v19
    v_mfma_f32_16x16x32_bf16 v[36:39], v[160:163], v[60:63], v[56:59]
    v_exp_f32 v20, v20
    v_exp_f32 v21, v21
    v_exp_f32 v22, v22
    v_exp_f32 v23, v23
    v_cvt_pk_bf16_f32 v16, v16, v17
    v_cvt_pk_bf16_f32 v17, v18, v19
    v_cvt_pk_bf16_f32 v18, v20, v21
    v_cvt_pk_bf16_f32 v19, v22, v23
    ds_read_b128 v[100:103], v249 offset:4096
    s_waitcnt lgkmcnt(2)
    v_mfma_f32_16x16x32_bf16 v[68:71], v[216:219], v[16:19], 0
    v_exp_f32 v24, v24
    v_exp_f32 v25, v25
    v_exp_f32 v26, v26
    v_mfma_f32_16x16x32_bf16 v[12:15], v[92:95], v[16:19], 0
    v_exp_f32 v27, v27
    v_exp_f32 v28, v28
    v_exp_f32 v29, v29
    v_mfma_f32_16x16x32_bf16 v[40:43], v[124:127], v[60:63], v[56:59]
    v_exp_f32 v30, v30
    v_exp_f32 v31, v31
    v_cvt_pk_bf16_f32 v24, v24, v25
    v_mfma_f32_16x16x32_bf16 v[44:47], v[232:235], v[60:63], v[56:59]
    v_cvt_pk_bf16_f32 v25, v26, v27
    v_cvt_pk_bf16_f32 v26, v28, v29
    v_cvt_pk_bf16_f32 v27, v30, v31
    ds_read_b128 v[92:95], v249 offset:5120
    s_waitcnt lgkmcnt(2)
    v_mfma_f32_16x16x32_bf16 v[68:71], v[220:223], v[24:27], v[68:71]
    v_exp_f32 v32, v32
    v_exp_f32 v33, v33
    v_exp_f32 v34, v34
    v_mfma_f32_16x16x32_bf16 v[12:15], v[96:99], v[24:27], v[12:15]
    v_exp_f32 v35, v35
    v_exp_f32 v36, v36
    v_exp_f32 v37, v37
    v_mfma_f32_16x16x32_bf16 v[16:19], v[128:131], v[60:63], v[56:59]
    v_exp_f32 v38, v38
    v_exp_f32 v39, v39
    v_cvt_pk_bf16_f32 v32, v32, v33
    v_mfma_f32_16x16x32_bf16 v[20:23], v[164:167], v[60:63], v[56:59]
    v_cvt_pk_bf16_f32 v33, v34, v35
    v_cvt_pk_bf16_f32 v34, v36, v37
    v_cvt_pk_bf16_f32 v35, v38, v39
    ds_read_b128 v[96:99], v249 offset:6144
    s_waitcnt lgkmcnt(2)
    v_mfma_f32_16x16x32_bf16 v[68:71], v[192:195], v[32:35], v[68:71]
    v_exp_f32 v40, v40
    v_exp_f32 v41, v41
    v_exp_f32 v42, v42
    v_mfma_f32_16x16x32_bf16 v[12:15], v[100:103], v[32:35], v[12:15]
    v_exp_f32 v43, v43
    v_exp_f32 v44, v44
    v_exp_f32 v45, v45
    v_mfma_f32_16x16x32_bf16 v[24:27], v[132:135], v[60:63], v[56:59]
    v_exp_f32 v46, v46
    v_exp_f32 v47, v47
    v_cvt_pk_bf16_f32 v40, v40, v41
    v_mfma_f32_16x16x32_bf16 v[28:31], v[236:239], v[60:63], v[56:59]
    v_cvt_pk_bf16_f32 v41, v42, v43
    v_cvt_pk_bf16_f32 v42, v44, v45
    v_cvt_pk_bf16_f32 v43, v46, v47
    ds_read_b128 v[100:103], v249 offset:7168
    s_waitcnt lgkmcnt(2)
    v_mfma_f32_16x16x32_bf16 v[68:71], v[196:199], v[40:43], v[68:71]
    v_exp_f32 v16, v16
    v_exp_f32 v17, v17
    v_exp_f32 v18, v18
    v_mfma_f32_16x16x32_bf16 v[12:15], v[92:95], v[40:43], v[12:15]
    v_exp_f32 v19, v19
    v_exp_f32 v20, v20
    v_exp_f32 v21, v21
    v_mfma_f32_16x16x32_bf16 v[32:35], v[104:107], v[60:63], v[48:51]
    v_exp_f32 v22, v22
    v_exp_f32 v23, v23
    v_cvt_pk_bf16_f32 v16, v16, v17
    v_mfma_f32_16x16x32_bf16 v[36:39], v[168:171], v[60:63], v[48:51]
    v_cvt_pk_bf16_f32 v17, v18, v19
    v_cvt_pk_bf16_f32 v18, v20, v21
    v_cvt_pk_bf16_f32 v19, v22, v23
    ds_read_b128 v[92:95], v249 offset:8192
    s_waitcnt lgkmcnt(2)
    v_mfma_f32_16x16x32_bf16 v[68:71], v[200:203], v[16:19], v[68:71]
    v_exp_f32 v24, v24
    v_exp_f32 v25, v25
    v_exp_f32 v26, v26
    v_mfma_f32_16x16x32_bf16 v[12:15], v[96:99], v[16:19], v[12:15]
    v_exp_f32 v27, v27
    v_exp_f32 v28, v28
    v_exp_f32 v29, v29
    v_mfma_f32_16x16x32_bf16 v[40:43], v[108:111], v[60:63], v[48:51]
    v_exp_f32 v30, v30
    v_exp_f32 v31, v31
    v_cvt_pk_bf16_f32 v24, v24, v25
    v_mfma_f32_16x16x32_bf16 v[44:47], v[240:243], v[60:63], v[48:51]
    v_cvt_pk_bf16_f32 v25, v26, v27
    v_cvt_pk_bf16_f32 v26, v28, v29
    v_cvt_pk_bf16_f32 v27, v30, v31
    ds_read_b128 v[96:99], v249 offset:9216
    s_waitcnt lgkmcnt(2)
    v_mfma_f32_16x16x32_bf16 v[68:71], v[204:207], v[24:27], v[68:71]
    v_exp_f32 v32, v32
    v_exp_f32 v33, v33
    v_exp_f32 v34, v34
    v_exp_f32 v35, v35
    v_mfma_f32_16x16x32_bf16 v[12:15], v[100:103], v[24:27], v[12:15]
    v_exp_f32 v36, v36
    v_exp_f32 v37, v37
    v_exp_f32 v38, v38
    v_exp_f32 v39, v39
    v_mfma_f32_16x16x32_bf16 v[16:19], v[112:115], v[60:63], v[48:51]
    v_cvt_pk_bf16_f32 v32, v32, v33
    v_cvt_pk_bf16_f32 v33, v34, v35
    v_cvt_pk_bf16_f32 v34, v36, v37
    v_cvt_pk_bf16_f32 v35, v38, v39
    ds_read_b128 v[100:103], v249 offset:10240
    s_waitcnt lgkmcnt(2)
    v_mfma_f32_16x16x32_bf16 v[68:71], v[176:179], v[32:35], v[68:71]
    v_exp_f32 v40, v40
    v_exp_f32 v41, v41
    v_exp_f32 v42, v42
    v_exp_f32 v43, v43
    v_exp_f32 v44, v44
    v_exp_f32 v45, v45
    v_mfma_f32_16x16x32_bf16 v[12:15], v[92:95], v[32:35], v[12:15]
    v_exp_f32 v46, v46
    v_exp_f32 v47, v47
    v_cvt_pk_bf16_f32 v40, v40, v41
    v_cvt_pk_bf16_f32 v41, v42, v43
    v_cvt_pk_bf16_f32 v42, v44, v45
    v_cvt_pk_bf16_f32 v43, v46, v47
    s_waitcnt lgkmcnt(1)
    s_nop 0
    v_mfma_f32_16x16x32_bf16 v[68:71], v[180:183], v[40:43], v[68:71]
    v_cndmask_b32 v16, v16, v86, s[4:5]
    v_cndmask_b32 v17, v17, v86, s[6:7]
    v_cndmask_b32 v18, v18, v86, s[8:9]
    v_cndmask_b32 v19, v19, v86, s[10:11]
    v_exp_f32 v16, v16
    v_exp_f32 v17, v17
    v_mfma_f32_16x16x32_bf16 v[12:15], v[96:99], v[40:43], v[12:15]
    v_exp_f32 v18, v18
    v_exp_f32 v19, v19
    v_cvt_pk_bf16_f32 v16, v16, v17
    v_cvt_pk_bf16_f32 v17, v18, v19
    v_mov_b32 v18, 0
    v_mov_b32 v19, 0
    s_waitcnt lgkmcnt(0)
    s_nop 0
    v_mfma_f32_16x16x32_bf16 v[68:71], v[184:187], v[16:19], v[68:71]
    v_mfma_f32_16x16x32_bf16 v[12:15], v[100:103], v[16:19], v[12:15]
    s_nop 6
    v_add_f32 v250, |v68|, |v69|
    v_add_f32 v251, |v70|, |v71|
    v_add_f32 v88, |v12|, |v13|
    v_add_f32 v89, |v14|, |v15|
    v_add_f32 v250, v250, v251
    v_add_f32 v88, v88, v89
    v_add_f32 v250, v250, v88
    v_cmp_nle_f32 vcc, v250, v253
    s_cbranch_vccnz L_slowq4
L_cont_neg4:
    v_mov_b32 v88, v12
    v_mov_b32 v89, v12
    s_nop 1
    v_permlane32_swap_b32 v88, v89
    v_cndmask_b32 v88, v88, v89, s[16:17]
    v_rcp_f32 v88, v88
    v_cndmask_b32 v12, v12, v14, s[18:19]
    v_cndmask_b32 v13, v13, v15, s[18:19]
    v_mul_f32 v68, v68, v88
    v_mul_f32 v69, v69, v88
    v_mul_f32 v70, v70, v88
    v_mul_f32 v71, v71, v88
    v_mul_f32 v12, v12, v88
    v_mul_f32 v13, v13, v88
    v_cvt_pk_bf16_f32 v90, v68, v69
    v_cvt_pk_bf16_f32 v91, v70, v71
    v_cvt_pk_bf16_f32 v89, v12, v13
    s_add_u32 s58, s72, 73728
    buffer_store_dwordx2 v[90:91], v252, s[36:39], s58 offen sc1
    s_add_u32 s58, s74, 73728
    s_mov_b64 exec, s[100:101]
    buffer_store_dword v89, v252, s[36:39], s58 offen sc1
    s_mov_b64 exec, -1
    v_cndmask_b32 v66, 0, v66, s[12:13]
    v_cndmask_b32 v67, 0, v67, s[14:15]
    ds_read_b64 v[60:61], v248 offset:3072
    ds_read_b64 v[62:63], v80 offset:35840
    s_cmp_eq_u32 s75, 0x70000000
    s_cselect_b32 s57, 0xf149f2ca, 0
    v_mov_b32 v52, s57
    v_mov_b32 v53, s57
    v_mov_b32 v54, s57
    v_mov_b32 v55, s57
    s_cmp_eq_u32 s69, 0x70000000
    s_cselect_b32 s57, 0xf149f2ca, 0
    v_mov_b32 v56, s57
    v_mov_b32 v57, s57
    v_mov_b32 v58, s57
    v_mov_b32 v59, s57
    v_mfma_f32_16x16x32_bf16 v[16:19], v[172:175], v[64:67], 0
    ds_read_b128 v[92:95], v249 offset:2048
    ds_read_b128 v[96:99], v249 offset:3072
    s_nop 5
    v_cndmask_b32 v16, v16, v86, s[4:5]
    v_cndmask_b32 v17, v17, v86, s[6:7]
    v_cndmask_b32 v18, v18, v86, s[8:9]
    v_cndmask_b32 v19, v19, v86, s[10:11]
    v_max_f32 v87, v16, v17
    v_max_f32 v88, v18, v19
    v_max_f32 v87, v87, v88
    v_mov_b32 v88, v87
    s_nop 1
    v_permlane32_swap_b32 v87, v88
    v_max_f32 v87, v87, v88
    v_mov_b32 v88, v87
    s_nop 1
    v_permlane16_swap_b32 v87, v88
    v_max_f32 v87, v87, v88
    v_sub_f32 v48, 0, v87
    v_sub_f32 v49, 0, v87
    v_sub_f32 v50, 0, v87
    v_sub_f32 v51, 0, v87
    v_add_f32 v52, v52, v48
    v_add_f32 v53, v53, v48
    v_add_f32 v54, v54, v48
    v_add_f32 v55, v55, v48
    v_add_f32 v56, v56, v48
    v_add_f32 v57, v57, v48
    v_add_f32 v58, v58, v48
    v_add_f32 v59, v59, v48
    v_mfma_f32_16x16x32_bf16 v[20:23], v[156:159], v[64:67], v[52:55]
    v_mfma_f32_16x16x32_bf16 v[24:27], v[148:151], v[64:67], v[52:55]
    v_mfma_f32_16x16x32_bf16 v[28:31], v[228:231], v[64:67], v[52:55]
    v_mfma_f32_16x16x32_bf16 v[32:35], v[120:123], v[64:67], v[56:59]
    s_nop 4
    v_cndmask_b32 v20, v86, v20, s[4:5]
    v_cndmask_b32 v21, v86, v21, s[6:7]
    v_cndmask_b32 v22, v86, v22, s[8:9]
    v_cndmask_b32 v23, v86, v23, s[10:11]
    v_exp_f32 v20, v20
    v_exp_f32 v21, v21
    v_mfma_f32_16x16x32_bf16 v[36:39], v[160:163], v[64:67], v[56:59]
    v_exp_f32 v22, v22
    v_exp_f32 v23, v23
    v_mov_b32 v16, 0
    v_mov_b32 v17, 0
    v_cvt_pk_bf16_f32 v18, v20, v21
    v_cvt_pk_bf16_f32 v19, v22, v23
    ds_read_b128 v[100:103], v249 offset:4096
    s_waitcnt lgkmcnt(2)
    v_mfma_f32_16x16x32_bf16 v[68:71], v[216:219], v[16:19], 0
    v_exp_f32 v24, v24
    v_exp_f32 v25, v25
    v_exp_f32 v26, v26
    v_mfma_f32_16x16x32_bf16 v[12:15], v[92:95], v[16:19], 0
    v_exp_f32 v27, v27
    v_exp_f32 v28, v28
    v_exp_f32 v29, v29
    v_mfma_f32_16x16x32_bf16 v[40:43], v[124:127], v[64:67], v[56:59]
    v_exp_f32 v30, v30
    v_exp_f32 v31, v31
    v_cvt_pk_bf16_f32 v24, v24, v25
    v_mfma_f32_16x16x32_bf16 v[44:47], v[232:235], v[64:67], v[56:59]
    v_cvt_pk_bf16_f32 v25, v26, v27
    v_cvt_pk_bf16_f32 v26, v28, v29
    v_cvt_pk_bf16_f32 v27, v30, v31
    ds_read_b128 v[92:95], v249 offset:5120
    s_waitcnt lgkmcnt(2)
    v_mfma_f32_16x16x32_bf16 v[68:71], v[220:223], v[24:27], v[68:71]
    v_exp_f32 v32, v32
    v_exp_f32 v33, v33
    v_exp_f32 v34, v34
    v_mfma_f32_16x16x32_bf16 v[12:15], v[96:99], v[24:27], v[12:15]
    v_exp_f32 v35, v35
    v_exp_f32 v36, v36
    v_exp_f32 v37, v37
    v_mfma_f32_16x16x32_bf16 v[16:19], v[128:131], v[64:67], v[56:59]
    v_exp_f32 v38, v38
    v_exp_f32 v39, v39
    v_cvt_pk_bf16_f32 v32, v32, v33
    v_mfma_f32_16x16x32_bf16 v[20:23], v[164:167], v[64:67], v[56:59]
    v_cvt_pk_bf16_f32 v33, v34, v35
    v_cvt_pk_bf16_f32 v34, v36, v37
    v_cvt_pk_bf16_f32 v35, v38, v39
    ds_read_b128 v[96:99], v249 offset:6144
    s_waitcnt lgkmcnt(2)
    v_mfma_f32_16x16x32_bf16 v[68:71], v[192:195], v[32:35], v[68:71]
    v_exp_f32 v40, v40
    v_exp_f32 v41, v41
    v_exp_f32 v42, v42
    v_mfma_f32_16x16x32_bf16 v[12:15], v[100:103], v[32:35], v[12:15]
    v_exp_f32 v43, v43
    v_exp_f32 v44, v44
    v_exp_f32 v45, v45
    v_mfma_f32_16x16x32_bf16 v[24:27], v[132:135], v[64:67], v[56:59]
    v_exp_f32 v46, v46
    v_exp_f32 v47, v47
    v_cvt_pk_bf16_f32 v40, v40, v41
    v_mfma_f32_16x16x32_bf16 v[28:31], v[236:239], v[64:67], v[56:59]
    v_cvt_pk_bf16_f32 v41, v42, v43
    v_cvt_pk_bf16_f32 v42, v44, v45
    v_cvt_pk_bf16_f32 v43, v46, v47
    ds_read_b128 v[100:103], v249 offset:7168
    s_waitcnt lgkmcnt(2)
    v_mfma_f32_16x16x32_bf16 v[68:71], v[196:199], v[40:43], v[68:71]
    v_exp_f32 v16, v16
    v_exp_f32 v17, v17
    v_exp_f32 v18, v18
    v_mfma_f32_16x16x32_bf16 v[12:15], v[92:95], v[40:43], v[12:15]
    v_exp_f32 v19, v19
    v_exp_f32 v20, v20
    v_exp_f32 v21, v21
    v_mfma_f32_16x16x32_bf16 v[32:35], v[104:107], v[64:67], v[48:51]
    v_exp_f32 v22, v22
    v_exp_f32 v23, v23
    v_cvt_pk_bf16_f32 v16, v16, v17
    v_mfma_f32_16x16x32_bf16 v[36:39], v[168:171], v[64:67], v[48:51]
    v_cvt_pk_bf16_f32 v17, v18, v19
    v_cvt_pk_bf16_f32 v18, v20, v21
    v_cvt_pk_bf16_f32 v19, v22, v23
    ds_read_b128 v[92:95], v249 offset:8192
    s_waitcnt lgkmcnt(2)
    v_mfma_f32_16x16x32_bf16 v[68:71], v[200:203], v[16:19], v[68:71]
    v_exp_f32 v24, v24
    v_exp_f32 v25, v25
    v_exp_f32 v26, v26
    v_mfma_f32_16x16x32_bf16 v[12:15], v[96:99], v[16:19], v[12:15]
    v_exp_f32 v27, v27
    v_exp_f32 v28, v28
    v_exp_f32 v29, v29
    v_mfma_f32_16x16x32_bf16 v[40:43], v[108:111], v[64:67], v[48:51]
    v_exp_f32 v30, v30
    v_exp_f32 v31, v31
    v_cvt_pk_bf16_f32 v24, v24, v25
    v_mfma_f32_16x16x32_bf16 v[44:47], v[240:243], v[64:67], v[48:51]
    v_cvt_pk_bf16_f32 v25, v26, v27
    v_cvt_pk_bf16_f32 v26, v28, v29
    v_cvt_pk_bf16_f32 v27, v30, v31
    ds_read_b128 v[96:99], v249 offset:9216
    s_waitcnt lgkmcnt(2)
    v_mfma_f32_16x16x32_bf16 v[68:71], v[204:207], v[24:27], v[68:71]
    v_exp_f32 v32, v32
    v_exp_f32 v33, v33
    v_exp_f32 v34, v34
    v_mfma_f32_16x16x32_bf16 v[12:15], v[100:103], v[24:27], v[12:15]
    v_exp_f32 v35, v35
    v_exp_f32 v36, v36
    v_exp_f32 v37, v37
    v_mfma_f32_16x16x32_bf16 v[16:19], v[112:115], v[64:67], v[48:51]
    v_exp_f32 v38, v38
    v_exp_f32 v39, v39
    v_cvt_pk_bf16_f32 v32, v32, v33
    v_mfma_f32_16x16x32_bf16 v[20:23], v[172:175], v[64:67], v[48:51]
    v_cvt_pk_bf16_f32 v33, v34, v35
    v_cvt_pk_bf16_f32 v34, v36, v37
    v_cvt_pk_bf16_f32 v35, v38, v39
    ds_read_b128 v[100:103], v249 offset:10240
    s_waitcnt lgkmcnt(2)
    v_mfma_f32_16x16x32_bf16 v[68:71], v[176:179], v[32:35], v[68:71]
    v_exp_f32 v40, v40
    v_exp_f32 v41, v41
    v_exp_f32 v42, v42
    v_exp_f32 v43, v43
    v_exp_f32 v44, v44
    v_exp_f32 v45, v45
    v_mfma_f32_16x16x32_bf16 v[12:15], v[92:95], v[32:35], v[12:15]
    v_exp_f32 v46, v46
    v_exp_f32 v47, v47
    v_cvt_pk_bf16_f32 v40, v40, v41
    v_cvt_pk_bf16_f32 v41, v42, v43
    v_cvt_pk_bf16_f32 v42, v44, v45
    v_cvt_pk_bf16_f32 v43, v46, v47
    s_waitcnt lgkmcnt(1)
    s_nop 0
    v_mfma_f32_16x16x32_bf16 v[68:71], v[180:183], v[40:43], v[68:71]
    v_exp_f32 v16, v16
    v_exp_f32 v17, v17
    v_exp_f32 v18, v18
    v_exp_f32 v19, v19
    v_cndmask_b32 v20, v20, v86, s[4:5]
    v_cndmask_b32 v21, v21, v86, s[6:7]
    v_cndmask_b32 v22, v22, v86, s[8:9]
    v_cndmask_b32 v23, v23, v86, s[10:11]
    v_mfma_f32_16x16x32_bf16 v[12:15], v[96:99], v[40:43], v[12:15]
    v_exp_f32 v20, v20
    v_exp_f32 v21, v21
    v_exp_f32 v22, v22
    v_exp_f32 v23, v23
    v_cvt_pk_bf16_f32 v16, v16, v17
    v_cvt_pk_bf16_f32 v17, v18, v19
    v_cvt_pk_bf16_f32 v18, v20, v21
    v_cvt_pk_bf16_f32 v19, v22, v23
    s_waitcnt lgkmcnt(0)
    s_nop 0
    v_mfma_f32_16x16x32_bf16 v[68:71], v[184:187], v[16:19], v[68:71]
    v_mfma_f32_16x16x32_bf16 v[12:15], v[100:103], v[16:19], v[12:15]
    s_nop 6
    v_add_f32 v250, |v68|, |v69|
    v_add_f32 v251, |v70|, |v71|
    v_add_f32 v88, |v12|, |v13|
    v_add_f32 v89, |v14|, |v15|
    v_add_f32 v250, v250, v251
    v_add_f32 v88, v88, v89
    v_add_f32 v250, v250, v88
    v_cmp_nle_f32 vcc, v250, v253
    s_cbranch_vccnz L_slowq5
L_cont_neg5:
    v_mov_b32 v88, v12
    v_mov_b32 v89, v12
    s_nop 1
    v_permlane32_swap_b32 v88, v89
    v_cndmask_b32 v88, v88, v89, s[16:17]
    v_rcp_f32 v88, v88
    v_cndmask_b32 v12, v12, v14, s[18:19]
    v_cndmask_b32 v13, v13, v15, s[18:19]
    v_mul_f32 v68, v68, v88
    v_mul_f32 v69, v69, v88
    v_mul_f32 v70, v70, v88
    v_mul_f32 v71, v71, v88
    v_mul_f32 v12, v12, v88
    v_mul_f32 v13, v13, v88
    v_cvt_pk_bf16_f32 v90, v68, v69
    v_cvt_pk_bf16_f32 v91, v70, v71
    v_cvt_pk_bf16_f32 v89, v12, v13
    s_add_u32 s58, s72, 73984
    buffer_store_dwordx2 v[90:91], v252, s[36:39], s58 offen sc1
    s_add_u32 s58, s74, 73984
    s_mov_b64 exec, s[100:101]
    buffer_store_dword v89, v252, s[36:39], s58 offen sc1
    s_mov_b64 exec, -1
    v_cndmask_b32 v62, 0, v62, s[12:13]
    v_cndmask_b32 v63, 0, v63, s[14:15]
    ds_read_b64 v[64:65], v248 offset:3584
    ds_read_b64 v[66:67], v80 offset:36352
    s_cmp_eq_u32 s75, 0x70000000
    s_cselect_b32 s57, 0xf149f2ca, 0
    v_mov_b32 v52, s57
    v_mov_b32 v53, s57
    v_mov_b32 v54, s57
    v_mov_b32 v55, s57
    s_cmp_eq_u32 s69, 0x70000000
    s_cselect_b32 s57, 0xf149f2ca, 0
    v_mov_b32 v56, s57
    v_mov_b32 v57, s57
    v_mov_b32 v58, s57
    v_mov_b32 v59, s57
    v_mfma_f32_16x16x32_bf16 v[16:19], v[116:119], v[60:63], 0
    ds_read_b128 v[92:95], v249 offset:3072
    ds_read_b128 v[96:99], v249 offset:4096
    s_nop 5
    v_cndmask_b32 v16, v16, v86, s[4:5]
    v_cndmask_b32 v17, v17, v86, s[6:7]
    v_cndmask_b32 v18, v18, v86, s[8:9]
    v_cndmask_b32 v19, v19, v86, s[10:11]
    v_max_f32 v87, v16, v17
    v_max_f32 v88, v18, v19
    v_max_f32 v87, v87, v88
    v_mov_b32 v88, v87
    s_nop 1
    v_permlane32_swap_b32 v87, v88
    v_max_f32 v87, v87, v88
    v_mov_b32 v88, v87
    s_nop 1
    v_permlane16_swap_b32 v87, v88
    v_max_f32 v87, v87, v88
    v_sub_f32 v48, 0, v87
    v_sub_f32 v49, 0, v87
    v_sub_f32 v50, 0, v87
    v_sub_f32 v51, 0, v87
    v_add_f32 v52, v52, v48
    v_add_f32 v53, v53, v48
    v_add_f32 v54, v54, v48
    v_add_f32 v55, v55, v48
    v_add_f32 v56, v56, v48
    v_add_f32 v57, v57, v48
    v_add_f32 v58, v58, v48
    v_add_f32 v59, v59, v48
    v_mfma_f32_16x16x32_bf16 v[16:19], v[148:151], v[60:63], v[52:55]
    v_mfma_f32_16x16x32_bf16 v[20:23], v[228:231], v[60:63], v[52:55]
    v_mfma_f32_16x16x32_bf16 v[24:27], v[120:123], v[60:63], v[56:59]
    v_mfma_f32_16x16x32_bf16 v[28:31], v[160:163], v[60:63], v[56:59]
    v_mfma_f32_16x16x32_bf16 v[32:35], v[124:127], v[60:63], v[56:59]
    s_nop 3
    v_cndmask_b32 v16, v86, v16, s[4:5]
    v_cndmask_b32 v17, v86, v17, s[6:7]
    v_cndmask_b32 v18, v86, v18, s[8:9]
    v_cndmask_b32 v19, v86, v19, s[10:11]
    v_exp_f32 v16, v16
    v_exp_f32 v17, v17
    v_exp_f32 v18, v18
    v_exp_f32 v19, v19
    v_mfma_f32_16x16x32_bf16 v[36:39], v[232:235], v[60:63], v[56:59]
    v_exp_f32 v20, v20
    v_exp_f32 v21, v21
    v_exp_f32 v22, v22
    v_exp_f32 v23, v23
    v_cvt_pk_bf16_f32 v16, v16, v17
    v_cvt_pk_bf16_f32 v17, v18, v19
    v_cvt_pk_bf16_f32 v18, v20, v21
    v_cvt_pk_bf16_f32 v19, v22, v23
    ds_read_b128 v[100:103], v249 offset:5120
    s_waitcnt lgkmcnt(2)
    v_mfma_f32_16x16x32_bf16 v[68:71], v[220:223], v[16:19], 0
    v_exp_f32 v24, v24
    v_exp_f32 v25, v25
    v_exp_f32 v26, v26
    v_mfma_f32_16x16x32_bf16 v[12:15], v[92:95], v[16:19], 0
    v_exp_f32 v27, v27
    v_exp_f32 v28, v28
    v_exp_f32 v29, v29
    v_mfma_f32_16x16x32_bf16 v[40:43], v[128:131], v[60:63], v[56:59]
    v_exp_f32 v30, v30
    v_exp_f32 v31, v31
    v_cvt_pk_bf16_f32 v24, v24, v25
    v_mfma_f32_16x16x32_bf16 v[44:47], v[164:167], v[60:63], v[56:59]
    v_cvt_pk_bf16_f32 v25, v26, v27
    v_cvt_pk_bf16_f32 v26, v28, v29
    v_cvt_pk_bf16_f32 v27, v30, v31
    ds_read_b128 v[92:95], v249 offset:6144
    s_waitcnt lgkmcnt(2)
    v_mfma_f32_16x16x32_bf16 v[68:71], v[192:195], v[24:27], v[68:71]
    v_exp_f32 v32, v32
    v_exp_f32 v33, v33
    v_exp_f32 v34, v34
    v_mfma_f32_16x16x32_bf16 v[12:15], v[96:99], v[24:27], v[12:15]
    v_exp_f32 v35, v35
    v_exp_f32 v36, v36
    v_exp_f32 v37, v37
    v_mfma_f32_16x16x32_bf16 v[16:19], v[132:135], v[60:63], v[56:59]
    v_exp_f32 v38, v38
    v_exp_f32 v39, v39
    v_cvt_pk_bf16_f32 v32, v32, v33
    v_mfma_f32_16x16x32_bf16 v[20:23], v[236:239], v[60:63], v[56:59]
    v_cvt_pk_bf16_f32 v33, v34, v35
    v_cvt_pk_bf16_f32 v34, v36, v37
    v_cvt_pk_bf16_f32 v35, v38, v39
    ds_read_b128 v[96:99], v249 offset:7168
    s_waitcnt lgkmcnt(2)
    v_mfma_f32_16x16x32_bf16 v[68:71], v[196:199], v[32:35], v[68:71]
    v_exp_f32 v40, v40
    v_exp_f32 v41, v41
    v_exp_f32 v42, v42
    v_mfma_f32_16x16x32_bf16 v[12:15], v[100:103], v[32:35], v[12:15]
    v_exp_f32 v43, v43
    v_exp_f32 v44, v44
    v_exp_f32 v45, v45
    v_mfma_f32_16x16x32_bf16 v[24:27], v[104:107], v[60:63], v[48:51]
    v_exp_f32 v46, v46
    v_exp_f32 v47, v47
    v_cvt_pk_bf16_f32 v40, v40, v41
    v_mfma_f32_16x16x32_bf16 v[28:31], v[168:171], v[60:63], v[48:51]
    v_cvt_pk_bf16_f32 v41, v42, v43
    v_cvt_pk_bf16_f32 v42, v44, v45
    v_cvt_pk_bf16_f32 v43, v46, v47
    ds_read_b128 v[100:103], v249 offset:8192
    s_waitcnt lgkmcnt(2)
    v_mfma_f32_16x16x32_bf16 v[68:71], v[200:203], v[40:43], v[68:71]
    v_exp_f32 v16, v16
    v_exp_f32 v17, v17
    v_exp_f32 v18, v18
    v_mfma_f32_16x16x32_bf16 v[12:15], v[92:95], v[40:43], v[12:15]
    v_exp_f32 v19, v19
    v_exp_f32 v20, v20
    v_exp_f32 v21, v21
    v_mfma_f32_16x16x32_bf16 v[32:35], v[108:111], v[60:63], v[48:51]
    v_exp_f32 v22, v22
    v_exp_f32 v23, v23
    v_cvt_pk_bf16_f32 v16, v16, v17
    v_mfma_f32_16x16x32_bf16 v[36:39], v[240:243], v[60:63], v[48:51]
    v_cvt_pk_bf16_f32 v17, v18, v19
    v_cvt_pk_bf16_f32 v18, v20, v21
    v_cvt_pk_bf16_f32 v19, v22, v23
    ds_read_b128 v[92:95], v249 offset:9216
    s_waitcnt lgkmcnt(2)
    v_mfma_f32_16x16x32_bf16 v[68:71], v[204:207], v[16:19], v[68:71]
    v_exp_f32 v24, v24
    v_exp_f32 v25, v25
    v_exp_f32 v26, v26
    v_mfma_f32_16x16x32_bf16 v[12:15], v[96:99], v[16:19], v[12:15]
    v_exp_f32 v27, v27
    v_exp_f32 v28, v28
    v_exp_f32 v29, v29
    v_mfma_f32_16x16x32_bf16 v[40:43], v[112:115], v[60:63], v[48:51]
    v_exp_f32 v30, v30
    v_exp_f32 v31, v31
    v_cvt_pk_bf16_f32 v24, v24, v25
    v_mfma_f32_16x16x32_bf16 v[44:47], v[172:175], v[60:63], v[48:51]
    v_cvt_pk_bf16_f32 v25, v26, v27
    v_cvt_pk_bf16_f32 v26, v28, v29
    v_cvt_pk_bf16_f32 v27, v30, v31
    ds_read_b128 v[96:99], v249 offset:10240
    s_waitcnt lgkmcnt(2)
    v_mfma_f32_16x16x32_bf16 v[68:71], v[176:179], v[24:27], v[68:71]
    v_exp_f32 v32, v32
    v_exp_f32 v33, v33
    v_exp_f32 v34, v34
    v_exp_f32 v35, v35
    v_mfma_f32_16x16x32_bf16 v[12:15], v[100:103], v[24:27], v[12:15]
    v_exp_f32 v36, v36
    v_exp_f32 v37, v37
    v_exp_f32 v38, v38
    v_exp_f32 v39, v39
    v_mfma_f32_16x16x32_bf16 v[16:19], v[116:119], v[60:63], v[48:51]
    v_cvt_pk_bf16_f32 v32, v32, v33
    v_cvt_pk_bf16_f32 v33, v34, v35
    v_cvt_pk_bf16_f32 v34, v36, v37
    v_cvt_pk_bf16_f32 v35, v38, v39
    ds_read_b128 v[100:103], v249 offset:11264
    s_waitcnt lgkmcnt(2)
    v_mfma_f32_16x16x32_bf16 v[68:71], v[180:183], v[32:35], v[68:71]
    v_exp_f32 v40, v40
    v_exp_f32 v41, v41
    v_exp_f32 v42, v42
    v_exp_f32 v43, v43
    v_exp_f32 v44, v44
    v_exp_f32 v45, v45
    v_mfma_f32_16x16x32_bf16 v[12:15], v[92:95], v[32:35], v[12:15]
    v_exp_f32 v46, v46
    v_exp_f32 v47, v47
    v_cvt_pk_bf16_f32 v40, v40, v41
    v_cvt_pk_bf16_f32 v41, v42, v43
    v_cvt_pk_bf16_f32 v42, v44, v45
    v_cvt_pk_bf16_f32 v43, v46, v47
    s_waitcnt lgkmcnt(1)
    s_nop 0
    v_mfma_f32_16x16x32_bf16 v[68:71], v[184:187], v[40:43], v[68:71]
    v_cndmask_b32 v16, v16, v86, s[4:5]
    v_cndmask_b32 v17, v17, v86, s[6:7]
    v_cndmask_b32 v18, v18, v86, s[8:9]
    v_cndmask_b32 v19, v19, v86, s[10:11]
    v_exp_f32 v16, v16
    v_exp_f32 v17, v17
    v_mfma_f32_16x16x32_bf16 v[12:15], v[96:99], v[40:43], v[12:15]
    v_exp_f32 v18, v18
    v_exp_f32 v19, v19
    v_cvt_pk_bf16_f32 v16, v16, v17
    v_cvt_pk_bf16_f32 v17, v18, v19
    v_mov_b32 v18, 0
    v_mov_b32 v19, 0
    s_waitcnt lgkmcnt(0)
    s_nop 0
    v_mfma_f32_16x16x32_bf16 v[68:71], v[188:191], v[16:19], v[68:71]
    v_mfma_f32_16x16x32_bf16 v[12:15], v[100:103], v[16:19], v[12:15]
    s_nop 6
    v_add_f32 v250, |v68|, |v69|
    v_add_f32 v251, |v70|, |v71|
    v_add_f32 v88, |v12|, |v13|
    v_add_f32 v89, |v14|, |v15|
    v_add_f32 v250, v250, v251
    v_add_f32 v88, v88, v89
    v_add_f32 v250, v250, v88
    v_cmp_nle_f32 vcc, v250, v253
    s_cbranch_vccnz L_slowq6
L_cont_neg6:
    v_mov_b32 v88, v12
    v_mov_b32 v89, v12
    s_nop 1
    v_permlane32_swap_b32 v88, v89
    v_cndmask_b32 v88, v88, v89, s[16:17]
    v_rcp_f32 v88, v88
    v_cndmask_b32 v12, v12, v14, s[18:19]
    v_cndmask_b32 v13, v13, v15, s[18:19]
    v_mul_f32 v68, v68, v88
    v_mul_f32 v69, v69, v88
    v_mul_f32 v70, v70, v88
    v_mul_f32 v71, v71, v88
    v_mul_f32 v12, v12, v88
    v_mul_f32 v13, v13, v88
    v_cvt_pk_bf16_f32 v90, v68, v69
    v_cvt_pk_bf16_f32 v91, v70, v71
    v_cvt_pk_bf16_f32 v89, v12, v13
    s_add_u32 s58, s72, 110592
    buffer_store_dwordx2 v[90:91], v252, s[36:39], s58 offen sc1
    s_add_u32 s58, s74, 110592
    s_mov_b64 exec, s[100:101]
    buffer_store_dword v89, v252, s[36:39], s58 offen sc1
    s_mov_b64 exec, -1
    v_cndmask_b32 v66, 0, v66, s[12:13]
    v_cndmask_b32 v67, 0, v67, s[14:15]
    s_cmp_eq_u32 s75, 0x70000000
    s_cselect_b32 s57, 0xf149f2ca, 0
    v_mov_b32 v52, s57
    v_mov_b32 v53, s57
    v_mov_b32 v54, s57
    v_mov_b32 v55, s57
    s_cmp_eq_u32 s69, 0x70000000
    s_cselect_b32 s57, 0xf149f2ca, 0
    v_mov_b32 v56, s57
    v_mov_b32 v57, s57
    v_mov_b32 v58, s57
    v_mov_b32 v59, s57
    v_mfma_f32_16x16x32_bf16 v[16:19], v[244:247], v[64:67], 0
    ds_read_b128 v[92:95], v249 offset:3072
    ds_read_b128 v[96:99], v249 offset:4096
    s_nop 5
    v_cndmask_b32 v16, v16, v86, s[4:5]
    v_cndmask_b32 v17, v17, v86, s[6:7]
    v_cndmask_b32 v18, v18, v86, s[8:9]
    v_cndmask_b32 v19, v19, v86, s[10:11]
    v_max_f32 v87, v16, v17
    v_max_f32 v88, v18, v19
    v_max_f32 v87, v87, v88
    v_mov_b32 v88, v87
    s_nop 1
    v_permlane32_swap_b32 v87, v88
    v_max_f32 v87, v87, v88
    v_mov_b32 v88, v87
    s_nop 1
    v_permlane16_swap_b32 v87, v88
    v_max_f32 v87, v87, v88
    v_sub_f32 v48, 0, v87
    v_sub_f32 v49, 0, v87
    v_sub_f32 v50, 0, v87
    v_sub_f32 v51, 0, v87
    v_add_f32 v52, v52, v48
    v_add_f32 v53, v53, v48
    v_add_f32 v54, v54, v48
    v_add_f32 v55, v55, v48
    v_add_f32 v56, v56, v48
    v_add_f32 v57, v57, v48
    v_add_f32 v58, v58, v48
    v_add_f32 v59, v59, v48
    v_mfma_f32_16x16x32_bf16 v[20:23], v[228:231], v[64:67], v[52:55]
    s_nop 0
    v_mfma_f32_16x16x32_bf16 v[24:27], v[120:123], v[64:67], v[56:59]
    v_mfma_f32_16x16x32_bf16 v[28:31], v[160:163], v[64:67], v[56:59]
    v_mfma_f32_16x16x32_bf16 v[32:35], v[124:127], v[64:67], v[56:59]
    s_nop 3
    v_cndmask_b32 v20, v86, v20, s[4:5]
    v_cndmask_b32 v21, v86, v21, s[6:7]
    v_cndmask_b32 v22, v86, v22, s[8:9]
    v_cndmask_b32 v23, v86, v23, s[10:11]
    v_exp_f32 v20, v20
    v_exp_f32 v21, v21
    v_mfma_f32_16x16x32_bf16 v[36:39], v[232:235], v[64:67], v[56:59]
    v_exp_f32 v22, v22
    v_exp_f32 v23, v23
    v_mov_b32 v16, 0
    v_mov_b32 v17, 0
    v_cvt_pk_bf16_f32 v18, v20, v21
    v_cvt_pk_bf16_f32 v19, v22, v23
    ds_read_b128 v[100:103], v249 offset:5120
    s_waitcnt lgkmcnt(2)
    v_mfma_f32_16x16x32_bf16 v[68:71], v[220:223], v[16:19], 0
    v_exp_f32 v24, v24
    v_exp_f32 v25, v25
    v_exp_f32 v26, v26
    v_mfma_f32_16x16x32_bf16 v[12:15], v[92:95], v[16:19], 0
    v_exp_f32 v27, v27
    v_exp_f32 v28, v28
    v_exp_f32 v29, v29
    v_mfma_f32_16x16x32_bf16 v[40:43], v[128:131], v[64:67], v[56:59]
    v_exp_f32 v30, v30
    v_exp_f32 v31, v31
    v_cvt_pk_bf16_f32 v24, v24, v25
    v_mfma_f32_16x16x32_bf16 v[44:47], v[164:167], v[64:67], v[56:59]
    v_cvt_pk_bf16_f32 v25, v26, v27
    v_cvt_pk_bf16_f32 v26, v28, v29
    v_cvt_pk_bf16_f32 v27, v30, v31
    ds_read_b128 v[92:95], v249 offset:6144
    s_waitcnt lgkmcnt(2)
    v_mfma_f32_16x16x32_bf16 v[68:71], v[192:195], v[24:27], v[68:71]
    v_exp_f32 v32, v32
    v_exp_f32 v33, v33
    v_exp_f32 v34, v34
    v_mfma_f32_16x16x32_bf16 v[12:15], v[96:99], v[24:27], v[12:15]
    v_exp_f32 v35, v35
    v_exp_f32 v36, v36
    v_exp_f32 v37, v37
    v_mfma_f32_16x16x32_bf16 v[16:19], v[132:135], v[64:67], v[56:59]
    v_exp_f32 v38, v38
    v_exp_f32 v39, v39
    v_cvt_pk_bf16_f32 v32, v32, v33
    v_mfma_f32_16x16x32_bf16 v[20:23], v[236:239], v[64:67], v[56:59]
    v_cvt_pk_bf16_f32 v33, v34, v35
    v_cvt_pk_bf16_f32 v34, v36, v37
    v_cvt_pk_bf16_f32 v35, v38, v39
    ds_read_b128 v[96:99], v249 offset:7168
    s_waitcnt lgkmcnt(2)
    v_mfma_f32_16x16x32_bf16 v[68:71], v[196:199], v[32:35], v[68:71]
    v_exp_f32 v40, v40
    v_exp_f32 v41, v41
    v_exp_f32 v42, v42
    v_mfma_f32_16x16x32_bf16 v[12:15], v[100:103], v[32:35], v[12:15]
    v_exp_f32 v43, v43
    v_exp_f32 v44, v44
    v_exp_f32 v45, v45
    v_mfma_f32_16x16x32_bf16 v[24:27], v[104:107], v[64:67], v[48:51]
    v_exp_f32 v46, v46
    v_exp_f32 v47, v47
    v_cvt_pk_bf16_f32 v40, v40, v41
    v_mfma_f32_16x16x32_bf16 v[28:31], v[168:171], v[64:67], v[48:51]
    v_cvt_pk_bf16_f32 v41, v42, v43
    v_cvt_pk_bf16_f32 v42, v44, v45
    v_cvt_pk_bf16_f32 v43, v46, v47
    ds_read_b128 v[100:103], v249 offset:8192
    s_waitcnt lgkmcnt(2)
    v_mfma_f32_16x16x32_bf16 v[68:71], v[200:203], v[40:43], v[68:71]
    v_exp_f32 v16, v16
    v_exp_f32 v17, v17
    v_exp_f32 v18, v18
    v_mfma_f32_16x16x32_bf16 v[12:15], v[92:95], v[40:43], v[12:15]
    v_exp_f32 v19, v19
    v_exp_f32 v20, v20
    v_exp_f32 v21, v21
    v_mfma_f32_16x16x32_bf16 v[32:35], v[108:111], v[64:67], v[48:51]
    v_exp_f32 v22, v22
    v_exp_f32 v23, v23
    v_cvt_pk_bf16_f32 v16, v16, v17
    v_mfma_f32_16x16x32_bf16 v[36:39], v[240:243], v[64:67], v[48:51]
    v_cvt_pk_bf16_f32 v17, v18, v19
    v_cvt_pk_bf16_f32 v18, v20, v21
    v_cvt_pk_bf16_f32 v19, v22, v23
    ds_read_b128 v[92:95], v249 offset:9216
    s_waitcnt lgkmcnt(2)
    v_mfma_f32_16x16x32_bf16 v[68:71], v[204:207], v[16:19], v[68:71]
    v_exp_f32 v24, v24
    v_exp_f32 v25, v25
    v_exp_f32 v26, v26
    v_mfma_f32_16x16x32_bf16 v[12:15], v[96:99], v[16:19], v[12:15]
    v_exp_f32 v27, v27
    v_exp_f32 v28, v28
    v_exp_f32 v29, v29
    v_mfma_f32_16x16x32_bf16 v[40:43], v[112:115], v[64:67], v[48:51]
    v_exp_f32 v30, v30
    v_exp_f32 v31, v31
    v_cvt_pk_bf16_f32 v24, v24, v25
    v_mfma_f32_16x16x32_bf16 v[44:47], v[172:175], v[64:67], v[48:51]
    v_cvt_pk_bf16_f32 v25, v26, v27
    v_cvt_pk_bf16_f32 v26, v28, v29
    v_cvt_pk_bf16_f32 v27, v30, v31
    ds_read_b128 v[96:99], v249 offset:10240
    s_waitcnt lgkmcnt(2)
    v_mfma_f32_16x16x32_bf16 v[68:71], v[176:179], v[24:27], v[68:71]
    v_exp_f32 v32, v32
    v_exp_f32 v33, v33
    v_exp_f32 v34, v34
    v_mfma_f32_16x16x32_bf16 v[12:15], v[100:103], v[24:27], v[12:15]
    v_exp_f32 v35, v35
    v_exp_f32 v36, v36
    v_exp_f32 v37, v37
    v_mfma_f32_16x16x32_bf16 v[16:19], v[116:119], v[64:67], v[48:51]
    v_exp_f32 v38, v38
    v_exp_f32 v39, v39
    v_cvt_pk_bf16_f32 v32, v32, v33
    v_mfma_f32_16x16x32_bf16 v[20:23], v[244:247], v[64:67], v[48:51]
    v_cvt_pk_bf16_f32 v33, v34, v35
    v_cvt_pk_bf16_f32 v34, v36, v37
    v_cvt_pk_bf16_f32 v35, v38, v39
    ds_read_b128 v[100:103], v249 offset:11264
    s_waitcnt lgkmcnt(2)
    v_mfma_f32_16x16x32_bf16 v[68:71], v[180:183], v[32:35], v[68:71]
    v_exp_f32 v40, v40
    v_exp_f32 v41, v41
    v_exp_f32 v42, v42
    v_exp_f32 v43, v43
    v_exp_f32 v44, v44
    v_exp_f32 v45, v45
    v_mfma_f32_16x16x32_bf16 v[12:15], v[92:95], v[32:35], v[12:15]
    v_exp_f32 v46, v46
    v_exp_f32 v47, v47
    v_cvt_pk_bf16_f32 v40, v40, v41
    v_cvt_pk_bf16_f32 v41, v42, v43
    v_cvt_pk_bf16_f32 v42, v44, v45
    v_cvt_pk_bf16_f32 v43, v46, v47
    s_waitcnt lgkmcnt(1)
    s_nop 0
    v_mfma_f32_16x16x32_bf16 v[68:71], v[184:187], v[40:43], v[68:71]
    v_exp_f32 v16, v16
    v_exp_f32 v17, v17
    v_exp_f32 v18, v18
    v_exp_f32 v19, v19
    v_cndmask_b32 v20, v20, v86, s[4:5]
    v_cndmask_b32 v21, v21, v86, s[6:7]
    v_cndmask_b32 v22, v22, v86, s[8:9]
    v_cndmask_b32 v23, v23, v86, s[10:11]
    v_mfma_f32_16x16x32_bf16 v[12:15], v[96:99], v[40:43], v[12:15]
    v_exp_f32 v20, v20
    v_exp_f32 v21, v21
    v_exp_f32 v22, v22
    v_exp_f32 v23, v23
    v_cvt_pk_bf16_f32 v16, v16, v17
    v_cvt_pk_bf16_f32 v17, v18, v19
    v_cvt_pk_bf16_f32 v18, v20, v21
    v_cvt_pk_bf16_f32 v19, v22, v23
    s_waitcnt lgkmcnt(0)
    s_nop 0
    v_mfma_f32_16x16x32_bf16 v[68:71], v[188:191], v[16:19], v[68:71]
    v_mfma_f32_16x16x32_bf16 v[12:15], v[100:103], v[16:19], v[12:15]
    s_nop 6
    v_add_f32 v250, |v68|, |v69|
    v_add_f32 v251, |v70|, |v71|
    v_add_f32 v88, |v12|, |v13|
    v_add_f32 v89, |v14|, |v15|
    v_add_f32 v250, v250, v251
    v_add_f32 v88, v88, v89
    v_add_f32 v250, v250, v88
    v_cmp_nle_f32 vcc, v250, v253
    s_cbranch_vccnz L_slowq7
L_cont_neg7:
    v_mov_b32 v88, v12
    v_mov_b32 v89, v12
    s_nop 1
    v_permlane32_swap_b32 v88, v89
    v_cndmask_b32 v88, v88, v89, s[16:17]
    v_rcp_f32 v88, v88
    v_cndmask_b32 v12, v12, v14, s[18:19]
    v_cndmask_b32 v13, v13, v15, s[18:19]
    v_mul_f32 v68, v68, v88
    v_mul_f32 v69, v69, v88
    v_mul_f32 v70, v70, v88
    v_mul_f32 v71, v71, v88
    v_mul_f32 v12, v12, v88
    v_mul_f32 v13, v13, v88
    v_cvt_pk_bf16_f32 v90, v68, v69
    v_cvt_pk_bf16_f32 v91, v70, v71
    v_cvt_pk_bf16_f32 v89, v12, v13
    s_add_u32 s58, s72, 110848
    buffer_store_dwordx2 v[90:91], v252, s[36:39], s58 offen sc1
    s_add_u32 s58, s74, 110848
    s_mov_b64 exec, s[100:101]
    buffer_store_dword v89, v252, s[36:39], s58 offen sc1
    s_mov_b64 exec, -1
    s_branch L_att_done
L_slowq0:
    s_nop 7
    s_nop 7
    s_waitcnt lgkmcnt(0)
    s_cmp_eq_u32 s75, 0x70000000
    s_cselect_b32 s57, 0xf149f2ca, 0
    v_mov_b32 v52, s57
    v_mov_b32 v53, s57
    v_mov_b32 v54, s57
    v_mov_b32 v55, s57
    s_cmp_eq_u32 s69, 0x70000000
    s_cselect_b32 s57, 0xf149f2ca, 0
    v_mov_b32 v56, s57
    v_mov_b32 v57, s57
    v_mov_b32 v58, s57
    v_mov_b32 v59, s57
    v_mfma_f32_16x16x32_bf16 v[16:19], v[136:139], v[60:63], v[52:55]
    v_mfma_f32_16x16x32_bf16 v[20:23], v[152:155], v[60:63], v[52:55]
    v_mfma_f32_16x16x32_bf16 v[24:27], v[140:143], v[60:63], v[52:55]
    v_mfma_f32_16x16x32_bf16 v[28:31], v[224:227], v[60:63], v[52:55]
    v_mfma_f32_16x16x32_bf16 v[32:35], v[144:147], v[60:63], v[52:55]
    s_nop 3
    v_cndmask_b32 v16, v86, v16, s[4:5]
    v_cndmask_b32 v17, v86, v17, s[6:7]
    v_cndmask_b32 v18, v86, v18, s[8:9]
    v_cndmask_b32 v19, v86, v19, s[10:11]
    v_max_f32 v87, v16, v17
    v_max_f32 v88, v18, v19
    v_mfma_f32_16x16x32_bf16 v[36:39], v[156:159], v[60:63], v[52:55]
    v_max3_f32 v87, v87, v20, v21
    v_max3_f32 v88, v88, v22, v23
    v_mfma_f32_16x16x32_bf16 v[40:43], v[148:151], v[60:63], v[52:55]
    v_max3_f32 v87, v87, v24, v25
    v_max3_f32 v88, v88, v26, v27
    v_mfma_f32_16x16x32_bf16 v[44:47], v[228:231], v[60:63], v[52:55]
    v_max3_f32 v87, v87, v28, v29
    v_max3_f32 v88, v88, v30, v31
    v_mfma_f32_16x16x32_bf16 v[16:19], v[120:123], v[60:63], v[56:59]
    v_max3_f32 v87, v87, v32, v33
    v_max3_f32 v88, v88, v34, v35
    v_mfma_f32_16x16x32_bf16 v[20:23], v[160:163], v[60:63], v[56:59]
    v_max3_f32 v87, v87, v36, v37
    v_max3_f32 v88, v88, v38, v39
    v_mfma_f32_16x16x32_bf16 v[24:27], v[124:127], v[60:63], v[56:59]
    v_max3_f32 v87, v87, v40, v41
    v_max3_f32 v88, v88, v42, v43
    v_mfma_f32_16x16x32_bf16 v[28:31], v[232:235], v[60:63], v[56:59]
    v_max3_f32 v87, v87, v44, v45
    v_max3_f32 v88, v88, v46, v47
    v_mfma_f32_16x16x32_bf16 v[32:35], v[128:131], v[60:63], v[56:59]
    v_max3_f32 v87, v87, v16, v17
    v_max3_f32 v88, v88, v18, v19
    v_mfma_f32_16x16x32_bf16 v[36:39], v[164:167], v[60:63], v[56:59]
    v_max3_f32 v87, v87, v20, v21
    v_max3_f32 v88, v88, v22, v23
    v_mfma_f32_16x16x32_bf16 v[40:43], v[132:135], v[60:63], v[56:59]
    v_max3_f32 v87, v87, v24, v25
    v_max3_f32 v88, v88, v26, v27
    v_mfma_f32_16x16x32_bf16 v[44:47], v[236:239], v[60:63], v[56:59]
    v_max3_f32 v87, v87, v28, v29
    v_max3_f32 v88, v88, v30, v31
    v_mfma_f32_16x16x32_bf16 v[16:19], v[104:107], v[60:63], 0
    v_max3_f32 v87, v87, v32, v33
    v_max3_f32 v88, v88, v34, v35
    v_max3_f32 v87, v87, v36, v37
    v_max3_f32 v88, v88, v38, v39
    v_max3_f32 v87, v87, v40, v41
    v_max3_f32 v88, v88, v42, v43
    v_max3_f32 v87, v87, v44, v45
    v_max3_f32 v88, v88, v46, v47
    v_cndmask_b32 v16, v16, v86, s[4:5]
    v_cndmask_b32 v17, v17, v86, s[6:7]
    v_cndmask_b32 v18, v18, v86, s[8:9]
    v_cndmask_b32 v19, v19, v86, s[10:11]
    v_max3_f32 v87, v87, v16, v17
    v_max3_f32 v88, v88, v18, v19
    ds_read_b128 v[92:95], v249 offset:0
    ds_read_b128 v[96:99], v249 offset:1024
    v_max_f32 v87, v87, v88
    v_mov_b32 v88, v87
    s_nop 1
    v_permlane32_swap_b32 v87, v88
    v_max_f32 v87, v87, v88
    v_mov_b32 v88, v87
    s_nop 1
    v_permlane16_swap_b32 v87, v88
    v_max_f32 v87, v87, v88
    v_sub_f32 v48, 0, v87
    v_sub_f32 v49, 0, v87
    v_sub_f32 v50, 0, v87
    v_sub_f32 v51, 0, v87
    v_add_f32 v52, v52, v48
    v_add_f32 v53, v53, v48
    v_add_f32 v54, v54, v48
    v_add_f32 v55, v55, v48
    v_add_f32 v56, v56, v48
    v_add_f32 v57, v57, v48
    v_add_f32 v58, v58, v48
    v_add_f32 v59, v59, v48
    v_mfma_f32_16x16x32_bf16 v[16:19], v[136:139], v[60:63], v[52:55]
    v_mfma_f32_16x16x32_bf16 v[20:23], v[152:155], v[60:63], v[52:55]
    v_mfma_f32_16x16x32_bf16 v[24:27], v[140:143], v[60:63], v[52:55]
    v_mfma_f32_16x16x32_bf16 v[28:31], v[224:227], v[60:63], v[52:55]
    v_mfma_f32_16x16x32_bf16 v[32:35], v[144:147], v[60:63], v[52:55]
    s_nop 3
    v_cndmask_b32 v16, v86, v16, s[4:5]
    v_cndmask_b32 v17, v86, v17, s[6:7]
    v_cndmask_b32 v18, v86, v18, s[8:9]
    v_cndmask_b32 v19, v86, v19, s[10:11]
    v_exp_f32 v16, v16
    v_exp_f32 v17, v17
    v_exp_f32 v18, v18
    v_exp_f32 v19, v19
    v_mfma_f32_16x16x32_bf16 v[36:39], v[156:159], v[60:63], v[52:55]
    v_exp_f32 v20, v20
    v_exp_f32 v21, v21
    v_exp_f32 v22, v22
    v_exp_f32 v23, v23
    v_cvt_pk_bf16_f32 v16, v16, v17
    v_cvt_pk_bf16_f32 v17, v18, v19
    v_cvt_pk_bf16_f32 v18, v20, v21
    v_cvt_pk_bf16_f32 v19, v22, v23
    ds_read_b128 v[100:103], v249 offset:2048
    s_waitcnt lgkmcnt(2)
    v_mfma_f32_16x16x32_bf16 v[68:71], v[208:211], v[16:19], 0
    v_exp_f32 v24, v24
    v_exp_f32 v25, v25
    v_exp_f32 v26, v26
    v_mfma_f32_16x16x32_bf16 v[12:15], v[92:95], v[16:19], 0
    v_exp_f32 v27, v27
    v_exp_f32 v28, v28
    v_exp_f32 v29, v29
    v_mfma_f32_16x16x32_bf16 v[40:43], v[148:151], v[60:63], v[52:55]
    v_exp_f32 v30, v30
    v_exp_f32 v31, v31
    v_cvt_pk_bf16_f32 v24, v24, v25
    v_mfma_f32_16x16x32_bf16 v[44:47], v[228:231], v[60:63], v[52:55]
    v_cvt_pk_bf16_f32 v25, v26, v27
    v_cvt_pk_bf16_f32 v26, v28, v29
    v_cvt_pk_bf16_f32 v27, v30, v31
    ds_read_b128 v[92:95], v249 offset:3072
    s_waitcnt lgkmcnt(2)
    v_mfma_f32_16x16x32_bf16 v[68:71], v[212:215], v[24:27], v[68:71]
    v_exp_f32 v32, v32
    v_exp_f32 v33, v33
    v_exp_f32 v34, v34
    v_mfma_f32_16x16x32_bf16 v[12:15], v[96:99], v[24:27], v[12:15]
    v_exp_f32 v35, v35
    v_exp_f32 v36, v36
    v_exp_f32 v37, v37
    v_mfma_f32_16x16x32_bf16 v[16:19], v[120:123], v[60:63], v[56:59]
    v_exp_f32 v38, v38
    v_exp_f32 v39, v39
    v_cvt_pk_bf16_f32 v32, v32, v33
    v_mfma_f32_16x16x32_bf16 v[20:23], v[160:163], v[60:63], v[56:59]
    v_cvt_pk_bf16_f32 v33, v34, v35
    v_cvt_pk_bf16_f32 v34, v36, v37
    v_cvt_pk_bf16_f32 v35, v38, v39
    ds_read_b128 v[96:99], v249 offset:4096
    s_waitcnt lgkmcnt(2)
    v_mfma_f32_16x16x32_bf16 v[68:71], v[216:219], v[32:35], v[68:71]
    v_exp_f32 v40, v40
    v_exp_f32 v41, v41
    v_exp_f32 v42, v42
    v_mfma_f32_16x16x32_bf16 v[12:15], v[100:103], v[32:35], v[12:15]
    v_exp_f32 v43, v43
    v_exp_f32 v44, v44
    v_exp_f32 v45, v45
    v_mfma_f32_16x16x32_bf16 v[24:27], v[124:127], v[60:63], v[56:59]
    v_exp_f32 v46, v46
    v_exp_f32 v47, v47
    v_cvt_pk_bf16_f32 v40, v40, v41
    v_mfma_f32_16x16x32_bf16 v[28:31], v[232:235], v[60:63], v[56:59]
    v_cvt_pk_bf16_f32 v41, v42, v43
    v_cvt_pk_bf16_f32 v42, v44, v45
    v_cvt_pk_bf16_f32 v43, v46, v47
    ds_read_b128 v[100:103], v249 offset:5120
    s_waitcnt lgkmcnt(2)
    v_mfma_f32_16x16x32_bf16 v[68:71], v[220:223], v[40:43], v[68:71]
    v_exp_f32 v16, v16
    v_exp_f32 v17, v17
    v_exp_f32 v18, v18
    v_mfma_f32_16x16x32_bf16 v[12:15], v[92:95], v[40:43], v[12:15]
    v_exp_f32 v19, v19
    v_exp_f32 v20, v20
    v_exp_f32 v21, v21
    v_mfma_f32_16x16x32_bf16 v[32:35], v[128:131], v[60:63], v[56:59]
    v_exp_f32 v22, v22
    v_exp_f32 v23, v23
    v_cvt_pk_bf16_f32 v16, v16, v17
    v_mfma_f32_16x16x32_bf16 v[36:39], v[164:167], v[60:63], v[56:59]
    v_cvt_pk_bf16_f32 v17, v18, v19
    v_cvt_pk_bf16_f32 v18, v20, v21
    v_cvt_pk_bf16_f32 v19, v22, v23
    ds_read_b128 v[92:95], v249 offset:6144
    s_waitcnt lgkmcnt(2)
    v_mfma_f32_16x16x32_bf16 v[68:71], v[192:195], v[16:19], v[68:71]
    v_exp_f32 v24, v24
    v_exp_f32 v25, v25
    v_exp_f32 v26, v26
    v_mfma_f32_16x16x32_bf16 v[12:15], v[96:99], v[16:19], v[12:15]
    v_exp_f32 v27, v27
    v_exp_f32 v28, v28
    v_exp_f32 v29, v29
    v_mfma_f32_16x16x32_bf16 v[40:43], v[132:135], v[60:63], v[56:59]
    v_exp_f32 v30, v30
    v_exp_f32 v31, v31
    v_cvt_pk_bf16_f32 v24, v24, v25
    v_mfma_f32_16x16x32_bf16 v[44:47], v[236:239], v[60:63], v[56:59]
    v_cvt_pk_bf16_f32 v25, v26, v27
    v_cvt_pk_bf16_f32 v26, v28, v29
    v_cvt_pk_bf16_f32 v27, v30, v31
    ds_read_b128 v[96:99], v249 offset:7168
    s_waitcnt lgkmcnt(2)
    v_mfma_f32_16x16x32_bf16 v[68:71], v[196:199], v[24:27], v[68:71]
    v_exp_f32 v32, v32
    v_exp_f32 v33, v33
    v_exp_f32 v34, v34
    v_exp_f32 v35, v35
    v_mfma_f32_16x16x32_bf16 v[12:15], v[100:103], v[24:27], v[12:15]
    v_exp_f32 v36, v36
    v_exp_f32 v37, v37
    v_exp_f32 v38, v38
    v_exp_f32 v39, v39
    v_mfma_f32_16x16x32_bf16 v[16:19], v[104:107], v[60:63], v[48:51]
    v_cvt_pk_bf16_f32 v32, v32, v33
    v_cvt_pk_bf16_f32 v33, v34, v35
    v_cvt_pk_bf16_f32 v34, v36, v37
    v_cvt_pk_bf16_f32 v35, v38, v39
    ds_read_b128 v[100:103], v249 offset:8192
    s_waitcnt lgkmcnt(2)
    v_mfma_f32_16x16x32_bf16 v[68:71], v[200:203], v[32:35], v[68:71]
    v_exp_f32 v40, v40
    v_exp_f32 v41, v41
    v_exp_f32 v42, v42
    v_exp_f32 v43, v43
    v_exp_f32 v44, v44
    v_exp_f32 v45, v45
    v_mfma_f32_16x16x32_bf16 v[12:15], v[92:95], v[32:35], v[12:15]
    v_exp_f32 v46, v46
    v_exp_f32 v47, v47
    v_cvt_pk_bf16_f32 v40, v40, v41
    v_cvt_pk_bf16_f32 v41, v42, v43
    v_cvt_pk_bf16_f32 v42, v44, v45
    v_cvt_pk_bf16_f32 v43, v46, v47
    s_waitcnt lgkmcnt(1)
    s_nop 0
    v_mfma_f32_16x16x32_bf16 v[68:71], v[204:207], v[40:43], v[68:71]
    v_cndmask_b32 v16, v16, v86, s[4:5]
    v_cndmask_b32 v17, v17, v86, s[6:7]
    v_cndmask_b32 v18, v18, v86, s[8:9]
    v_cndmask_b32 v19, v19, v86, s[10:11]
    v_exp_f32 v16, v16
    v_exp_f32 v17, v17
    v_mfma_f32_16x16x32_bf16 v[12:15], v[96:99], v[40:43], v[12:15]
    v_exp_f32 v18, v18
    v_exp_f32 v19, v19
    v_cvt_pk_bf16_f32 v16, v16, v17
    v_cvt_pk_bf16_f32 v17, v18, v19
    v_mov_b32 v18, 0
    v_mov_b32 v19, 0
    s_waitcnt lgkmcnt(0)
    s_nop 0
    v_mfma_f32_16x16x32_bf16 v[68:71], v[176:179], v[16:19], v[68:71]
    v_mfma_f32_16x16x32_bf16 v[12:15], v[100:103], v[16:19], v[12:15]
    s_nop 7
    s_nop 3
    s_cmp_eq_u32 s67, 0
    s_cbranch_scc1 L_cont0
    s_branch L_cont_neg0
L_slowq1:
    s_nop 7
    s_nop 7
    s_waitcnt lgkmcnt(0)
    s_cmp_eq_u32 s75, 0x70000000
    s_cselect_b32 s57, 0xf149f2ca, 0
    v_mov_b32 v52, s57
    v_mov_b32 v53, s57
    v_mov_b32 v54, s57
    v_mov_b32 v55, s57
    s_cmp_eq_u32 s69, 0x70000000
    s_cselect_b32 s57, 0xf149f2ca, 0
    v_mov_b32 v56, s57
    v_mov_b32 v57, s57
    v_mov_b32 v58, s57
    v_mov_b32 v59, s57
    v_mfma_f32_16x16x32_bf16 v[16:19], v[152:155], v[64:67], v[52:55]
    v_mfma_f32_16x16x32_bf16 v[20:23], v[140:143], v[64:67], v[52:55]
    v_mfma_f32_16x16x32_bf16 v[24:27], v[224:227], v[64:67], v[52:55]
    v_mfma_f32_16x16x32_bf16 v[28:31], v[144:147], v[64:67], v[52:55]
    v_mfma_f32_16x16x32_bf16 v[32:35], v[156:159], v[64:67], v[52:55]
    s_nop 3
    v_cndmask_b32 v16, v86, v16, s[4:5]
    v_cndmask_b32 v17, v86, v17, s[6:7]
    v_cndmask_b32 v18, v86, v18, s[8:9]
    v_cndmask_b32 v19, v86, v19, s[10:11]
    v_max_f32 v87, v16, v17
    v_max_f32 v88, v18, v19
    v_mfma_f32_16x16x32_bf16 v[36:39], v[148:151], v[64:67], v[52:55]
    v_max3_f32 v87, v87, v20, v21
    v_max3_f32 v88, v88, v22, v23
    v_mfma_f32_16x16x32_bf16 v[40:43], v[228:231], v[64:67], v[52:55]
    v_max3_f32 v87, v87, v24, v25
    v_max3_f32 v88, v88, v26, v27
    v_mfma_f32_16x16x32_bf16 v[44:47], v[120:123], v[64:67], v[56:59]
    v_max3_f32 v87, v87, v28, v29
    v_max3_f32 v88, v88, v30, v31
    v_mfma_f32_16x16x32_bf16 v[16:19], v[160:163], v[64:67], v[56:59]
    v_max3_f32 v87, v87, v32, v33
    v_max3_f32 v88, v88, v34, v35
    v_mfma_f32_16x16x32_bf16 v[20:23], v[124:127], v[64:67], v[56:59]
    v_max3_f32 v87, v87, v36, v37
    v_max3_f32 v88, v88, v38, v39
    v_mfma_f32_16x16x32_bf16 v[24:27], v[232:235], v[64:67], v[56:59]
    v_max3_f32 v87, v87, v40, v41
    v_max3_f32 v88, v88, v42, v43
    v_mfma_f32_16x16x32_bf16 v[28:31], v[128:131], v[64:67], v[56:59]
    v_max3_f32 v87, v87, v44, v45
    v_max3_f32 v88, v88, v46, v47
    v_mfma_f32_16x16x32_bf16 v[32:35], v[164:167], v[64:67], v[56:59]
    v_max3_f32 v87, v87, v16, v17
    v_max3_f32 v88, v88, v18, v19
    v_mfma_f32_16x16x32_bf16 v[36:39], v[132:135], v[64:67], v[56:59]
    v_max3_f32 v87, v87, v20, v21
    v_max3_f32 v88, v88, v22, v23
    v_mfma_f32_16x16x32_bf16 v[40:43], v[236:239], v[64:67], v[56:59]
    v_max3_f32 v87, v87, v24, v25
    v_max3_f32 v88, v88, v26, v27
    v_mfma_f32_16x16x32_bf16 v[44:47], v[104:107], v[64:67], 0
    v_max3_f32 v87, v87, v28, v29
    v_max3_f32 v88, v88, v30, v31
    v_mfma_f32_16x16x32_bf16 v[16:19], v[168:171], v[64:67], 0
    v_max3_f32 v87, v87, v32, v33
    v_max3_f32 v88, v88, v34, v35
    v_max3_f32 v87, v87, v36, v37
    v_max3_f32 v88, v88, v38, v39
    v_max3_f32 v87, v87, v40, v41
    v_max3_f32 v88, v88, v42, v43
    v_max3_f32 v87, v87, v44, v45
    v_max3_f32 v88, v88, v46, v47
    v_cndmask_b32 v16, v16, v86, s[4:5]
    v_cndmask_b32 v17, v17, v86, s[6:7]
    v_cndmask_b32 v18, v18, v86, s[8:9]
    v_cndmask_b32 v19, v19, v86, s[10:11]
    v_max3_f32 v87, v87, v16, v17
    v_max3_f32 v88, v88, v18, v19
    ds_read_b128 v[92:95], v249 offset:0
    ds_read_b128 v[96:99], v249 offset:1024
    v_max_f32 v87, v87, v88
    v_mov_b32 v88, v87
    s_nop 1
    v_permlane32_swap_b32 v87, v88
    v_max_f32 v87, v87, v88
    v_mov_b32 v88, v87
    s_nop 1
    v_permlane16_swap_b32 v87, v88
    v_max_f32 v87, v87, v88
    v_sub_f32 v48, 0, v87
    v_sub_f32 v49, 0, v87
    v_sub_f32 v50, 0, v87
    v_sub_f32 v51, 0, v87
    v_add_f32 v52, v52, v48
    v_add_f32 v53, v53, v48
    v_add_f32 v54, v54, v48
    v_add_f32 v55, v55, v48
    v_add_f32 v56, v56, v48
    v_add_f32 v57, v57, v48
    v_add_f32 v58, v58, v48
    v_add_f32 v59, v59, v48
    v_mfma_f32_16x16x32_bf16 v[20:23], v[152:155], v[64:67], v[52:55]
    v_mfma_f32_16x16x32_bf16 v[24:27], v[140:143], v[64:67], v[52:55]
    v_mfma_f32_16x16x32_bf16 v[28:31], v[224:227], v[64:67], v[52:55]
    v_mfma_f32_16x16x32_bf16 v[32:35], v[144:147], v[64:67], v[52:55]
    s_nop 4
    v_cndmask_b32 v20, v86, v20, s[4:5]
    v_cndmask_b32 v21, v86, v21, s[6:7]
    v_cndmask_b32 v22, v86, v22, s[8:9]
    v_cndmask_b32 v23, v86, v23, s[10:11]
    v_exp_f32 v20, v20
    v_exp_f32 v21, v21
    v_mfma_f32_16x16x32_bf16 v[36:39], v[156:159], v[64:67], v[52:55]
    v_exp_f32 v22, v22
    v_exp_f32 v23, v23
    v_mov_b32 v16, 0
    v_mov_b32 v17, 0
    v_cvt_pk_bf16_f32 v18, v20, v21
    v_cvt_pk_bf16_f32 v19, v22, v23
    ds_read_b128 v[100:103], v249 offset:2048
    s_waitcnt lgkmcnt(2)
    v_mfma_f32_16x16x32_bf16 v[68:71], v[208:211], v[16:19], 0
    v_exp_f32 v24, v24
    v_exp_f32 v25, v25
    v_exp_f32 v26, v26
    v_mfma_f32_16x16x32_bf16 v[12:15], v[92:95], v[16:19], 0
    v_exp_f32 v27, v27
    v_exp_f32 v28, v28
    v_exp_f32 v29, v29
    v_mfma_f32_16x16x32_bf16 v[40:43], v[148:151], v[64:67], v[52:55]
    v_exp_f32 v30, v30
    v_exp_f32 v31, v31
    v_cvt_pk_bf16_f32 v24, v24, v25
    v_mfma_f32_16x16x32_bf16 v[44:47], v[228:231], v[64:67], v[52:55]
    v_cvt_pk_bf16_f32 v25, v26, v27
    v_cvt_pk_bf16_f32 v26, v28, v29
    v_cvt_pk_bf16_f32 v27, v30, v31
    ds_read_b128 v[92:95], v249 offset:3072
    s_waitcnt lgkmcnt(2)
    v_mfma_f32_16x16x32_bf16 v[68:71], v[212:215], v[24:27], v[68:71]
    v_exp_f32 v32, v32
    v_exp_f32 v33, v33
    v_exp_f32 v34, v34
    v_mfma_f32_16x16x32_bf16 v[12:15], v[96:99], v[24:27], v[12:15]
    v_exp_f32 v35, v35
    v_exp_f32 v36, v36
    v_exp_f32 v37, v37
    v_mfma_f32_16x16x32_bf16 v[16:19], v[120:123], v[64:67], v[56:59]
    v_exp_f32 v38, v38
    v_exp_f32 v39, v39
    v_cvt_pk_bf16_f32 v32, v32, v33
    v_mfma_f32_16x16x32_bf16 v[20:23], v[160:163], v[64:67], v[56:59]
    v_cvt_pk_bf16_f32 v33, v34, v35
    v_cvt_pk_bf16_f32 v34, v36, v37
    v_cvt_pk_bf16_f32 v35, v38, v39
    ds_read_b128 v[96:99], v249 offset:4096
    s_waitcnt lgkmcnt(2)
    v_mfma_f32_16x16x32_bf16 v[68:71], v[216:219], v[32:35], v[68:71]
    v_exp_f32 v40, v40
    v_exp_f32 v41, v41
    v_exp_f32 v42, v42
    v_mfma_f32_16x16x32_bf16 v[12:15], v[100:103], v[32:35], v[12:15]
    v_exp_f32 v43, v43
    v_exp_f32 v44, v44
    v_exp_f32 v45, v45
    v_mfma_f32_16x16x32_bf16 v[24:27], v[124:127], v[64:67], v[56:59]
    v_exp_f32 v46, v46
    v_exp_f32 v47, v47
    v_cvt_pk_bf16_f32 v40, v40, v41
    v_mfma_f32_16x16x32_bf16 v[28:31], v[232:235], v[64:67], v[56:59]
    v_cvt_pk_bf16_f32 v41, v42, v43
    v_cvt_pk_bf16_f32 v42, v44, v45
    v_cvt_pk_bf16_f32 v43, v46, v47
    ds_read_b128 v[100:103], v249 offset:5120
    s_waitcnt lgkmcnt(2)
    v_mfma_f32_16x16x32_bf16 v[68:71], v[220:223], v[40:43], v[68:71]
    v_exp_f32 v16, v16
    v_exp_f32 v17, v17
    v_exp_f32 v18, v18
    v_mfma_f32_16x16x32_bf16 v[12:15], v[92:95], v[40:43], v[12:15]
    v_exp_f32 v19, v19
    v_exp_f32 v20, v20
    v_exp_f32 v21, v21
    v_mfma_f32_16x16x32_bf16 v[32:35], v[128:131], v[64:67], v[56:59]
    v_exp_f32 v22, v22
    v_exp_f32 v23, v23
    v_cvt_pk_bf16_f32 v16, v16, v17
    v_mfma_f32_16x16x32_bf16 v[36:39], v[164:167], v[64:67], v[56:59]
    v_cvt_pk_bf16_f32 v17, v18, v19
    v_cvt_pk_bf16_f32 v18, v20, v21
    v_cvt_pk_bf16_f32 v19, v22, v23
    ds_read_b128 v[92:95], v249 offset:6144
    s_waitcnt lgkmcnt(2)
    v_mfma_f32_16x16x32_bf16 v[68:71], v[192:195], v[16:19], v[68:71]
    v_exp_f32 v24, v24
    v_exp_f32 v25, v25
    v_exp_f32 v26, v26
    v_mfma_f32_16x16x32_bf16 v[12:15], v[96:99], v[16:19], v[12:15]
    v_exp_f32 v27, v27
    v_exp_f32 v28, v28
    v_exp_f32 v29, v29
    v_mfma_f32_16x16x32_bf16 v[40:43], v[132:135], v[64:67], v[56:59]
    v_exp_f32 v30, v30
    v_exp_f32 v31, v31
    v_cvt_pk_bf16_f32 v24, v24, v25
    v_mfma_f32_16x16x32_bf16 v[44:47], v[236:239], v[64:67], v[56:59]
    v_cvt_pk_bf16_f32 v25, v26, v27
    v_cvt_pk_bf16_f32 v26, v28, v29
    v_cvt_pk_bf16_f32 v27, v30, v31
    ds_read_b128 v[96:99], v249 offset:7168
    s_waitcnt lgkmcnt(2)
    v_mfma_f32_16x16x32_bf16 v[68:71], v[196:199], v[24:27], v[68:71]
    v_exp_f32 v32, v32
    v_exp_f32 v33, v33
    v_exp_f32 v34, v34
    v_mfma_f32_16x16x32_bf16 v[12:15], v[100:103], v[24:27], v[12:15]
    v_exp_f32 v35, v35
    v_exp_f32 v36, v36
    v_exp_f32 v37, v37
    v_mfma_f32_16x16x32_bf16 v[16:19], v[104:107], v[64:67], v[48:51]
    v_exp_f32 v38, v38
    v_exp_f32 v39, v39
    v_cvt_pk_bf16_f32 v32, v32, v33
    v_mfma_f32_16x16x32_bf16 v[20:23], v[168:171], v[64:67], v[48:51]
    v_cvt_pk_bf16_f32 v33, v34, v35
    v_cvt_pk_bf16_f32 v34, v36, v37
    v_cvt_pk_bf16_f32 v35, v38, v39
    ds_read_b128 v[100:103], v249 offset:8192
    s_waitcnt lgkmcnt(2)
    v_mfma_f32_16x16x32_bf16 v[68:71], v[200:203], v[32:35], v[68:71]
    v_exp_f32 v40, v40
    v_exp_f32 v41, v41
    v_exp_f32 v42, v42
    v_exp_f32 v43, v43
    v_exp_f32 v44, v44
    v_exp_f32 v45, v45
    v_mfma_f32_16x16x32_bf16 v[12:15], v[92:95], v[32:35], v[12:15]
    v_exp_f32 v46, v46
    v_exp_f32 v47, v47
    v_cvt_pk_bf16_f32 v40, v40, v41
    v_cvt_pk_bf16_f32 v41, v42, v43
    v_cvt_pk_bf16_f32 v42, v44, v45
    v_cvt_pk_bf16_f32 v43, v46, v47
    s_waitcnt lgkmcnt(1)
    s_nop 0
    v_mfma_f32_16x16x32_bf16 v[68:71], v[204:207], v[40:43], v[68:71]
    v_exp_f32 v16, v16
    v_exp_f32 v17, v17
    v_exp_f32 v18, v18
    v_exp_f32 v19, v19
    v_cndmask_b32 v20, v20, v86, s[4:5]
    v_cndmask_b32 v21, v21, v86, s[6:7]
    v_cndmask_b32 v22, v22, v86, s[8:9]
    v_cndmask_b32 v23, v23, v86, s[10:11]
    v_mfma_f32_16x16x32_bf16 v[12:15], v[96:99], v[40:43], v[12:15]
    v_exp_f32 v20, v20
    v_exp_f32 v21, v21
    v_exp_f32 v22, v22
    v_exp_f32 v23, v23
    v_cvt_pk_bf16_f32 v16, v16, v17
    v_cvt_pk_bf16_f32 v17, v18, v19
    v_cvt_pk_bf16_f32 v18, v20, v21
    v_cvt_pk_bf16_f32 v19, v22, v23
    s_waitcnt lgkmcnt(0)
    s_nop 0
    v_mfma_f32_16x16x32_bf16 v[68:71], v[176:179], v[16:19], v[68:71]
    v_mfma_f32_16x16x32_bf16 v[12:15], v[100:103], v[16:19], v[12:15]
    s_nop 7
    s_nop 3
    s_cmp_eq_u32 s67, 0
    s_cbranch_scc1 L_cont1
    s_branch L_cont_neg1
L_slowq2:
    s_nop 7
    s_nop 7
    s_waitcnt lgkmcnt(0)
    s_cmp_eq_u32 s75, 0x70000000
    s_cselect_b32 s57, 0xf149f2ca, 0
    v_mov_b32 v52, s57
    v_mov_b32 v53, s57
    v_mov_b32 v54, s57
    v_mov_b32 v55, s57
    s_cmp_eq_u32 s69, 0x70000000
    s_cselect_b32 s57, 0xf149f2ca, 0
    v_mov_b32 v56, s57
    v_mov_b32 v57, s57
    v_mov_b32 v58, s57
    v_mov_b32 v59, s57
    v_mfma_f32_16x16x32_bf16 v[16:19], v[140:143], v[60:63], v[52:55]
    v_mfma_f32_16x16x32_bf16 v[20:23], v[224:227], v[60:63], v[52:55]
    v_mfma_f32_16x16x32_bf16 v[24:27], v[144:147], v[60:63], v[52:55]
    v_mfma_f32_16x16x32_bf16 v[28:31], v[156:159], v[60:63], v[52:55]
    v_mfma_f32_16x16x32_bf16 v[32:35], v[148:151], v[60:63], v[52:55]
    s_nop 3
    v_cndmask_b32 v16, v86, v16, s[4:5]
    v_cndmask_b32 v17, v86, v17, s[6:7]
    v_cndmask_b32 v18, v86, v18, s[8:9]
    v_cndmask_b32 v19, v86, v19, s[10:11]
    v_max_f32 v87, v16, v17
    v_max_f32 v88, v18, v19
    v_mfma_f32_16x16x32_bf16 v[36:39], v[228:231], v[60:63], v[52:55]
    v_max3_f32 v87, v87, v20, v21
    v_max3_f32 v88, v88, v22, v23
    v_mfma_f32_16x16x32_bf16 v[40:43], v[120:123], v[60:63], v[56:59]
    v_max3_f32 v87, v87, v24, v25
    v_max3_f32 v88, v88, v26, v27
    v_mfma_f32_16x16x32_bf16 v[44:47], v[160:163], v[60:63], v[56:59]
    v_max3_f32 v87, v87, v28, v29
    v_max3_f32 v88, v88, v30, v31
    v_mfma_f32_16x16x32_bf16 v[16:19], v[124:127], v[60:63], v[56:59]
    v_max3_f32 v87, v87, v32, v33
    v_max3_f32 v88, v88, v34, v35
    v_mfma_f32_16x16x32_bf16 v[20:23], v[232:235], v[60:63], v[56:59]
    v_max3_f32 v87, v87, v36, v37
    v_max3_f32 v88, v88, v38, v39
    v_mfma_f32_16x16x32_bf16 v[24:27], v[128:131], v[60:63], v[56:59]
    v_max3_f32 v87, v87, v40, v41
    v_max3_f32 v88, v88, v42, v43
    v_mfma_f32_16x16x32_bf16 v[28:31], v[164:167], v[60:63], v[56:59]
    v_max3_f32 v87, v87, v44, v45
    v_max3_f32 v88, v88, v46, v47
    v_mfma_f32_16x16x32_bf16 v[32:35], v[132:135], v[60:63], v[56:59]
    v_max3_f32 v87, v87, v16, v17
    v_max3_f32 v88, v88, v18, v19
    v_mfma_f32_16x16x32_bf16 v[36:39], v[236:239], v[60:63], v[56:59]
    v_max3_f32 v87, v87, v20, v21
    v_max3_f32 v88, v88, v22, v23
    v_mfma_f32_16x16x32_bf16 v[40:43], v[104:107], v[60:63], 0
    v_max3_f32 v87, v87, v24, v25
    v_max3_f32 v88, v88, v26, v27
    v_mfma_f32_16x16x32_bf16 v[44:47], v[168:171], v[60:63], 0
    v_max3_f32 v87, v87, v28, v29
    v_max3_f32 v88, v88, v30, v31
    v_mfma_f32_16x16x32_bf16 v[16:19], v[108:111], v[60:63], 0
    v_max3_f32 v87, v87, v32, v33
    v_max3_f32 v88, v88, v34, v35
    v_max3_f32 v87, v87, v36, v37
    v_max3_f32 v88, v88, v38, v39
    v_max3_f32 v87, v87, v40, v41
    v_max3_f32 v88, v88, v42, v43
    v_max3_f32 v87, v87, v44, v45
    v_max3_f32 v88, v88, v46, v47
    v_cndmask_b32 v16, v16, v86, s[4:5]
    v_cndmask_b32 v17, v17, v86, s[6:7]
    v_cndmask_b32 v18, v18, v86, s[8:9]
    v_cndmask_b32 v19, v19, v86, s[10:11]
    v_max3_f32 v87, v87, v16, v17
    v_max3_f32 v88, v88, v18, v19
    ds_read_b128 v[92:95], v249 offset:1024
    ds_read_b128 v[96:99], v249 offset:2048
    v_max_f32 v87, v87, v88
    v_mov_b32 v88, v87
    s_nop 1
    v_permlane32_swap_b32 v87, v88
    v_max_f32 v87, v87, v88
    v_mov_b32 v88, v87
    s_nop 1
    v_permlane16_swap_b32 v87, v88
    v_max_f32 v87, v87, v88
    v_sub_f32 v48, 0, v87
    v_sub_f32 v49, 0, v87
    v_sub_f32 v50, 0, v87
    v_sub_f32 v51, 0, v87
    v_add_f32 v52, v52, v48
    v_add_f32 v53, v53, v48
    v_add_f32 v54, v54, v48
    v_add_f32 v55, v55, v48
    v_add_f32 v56, v56, v48
    v_add_f32 v57, v57, v48
    v_add_f32 v58, v58, v48
    v_add_f32 v59, v59, v48
    v_mfma_f32_16x16x32_bf16 v[16:19], v[140:143], v[60:63], v[52:55]
    v_mfma_f32_16x16x32_bf16 v[20:23], v[224:227], v[60:63], v[52:55]
    v_mfma_f32_16x16x32_bf16 v[24:27], v[144:147], v[60:63], v[52:55]
    v_mfma_f32_16x16x32_bf16 v[28:31], v[156:159], v[60:63], v[52:55]
    v_mfma_f32_16x16x32_bf16 v[32:35], v[148:151], v[60:63], v[52:55]
    s_nop 3
    v_cndmask_b32 v16, v86, v16, s[4:5]
    v_cndmask_b32 v17, v86, v17, s[6:7]
    v_cndmask_b32 v18, v86, v18, s[8:9]
    v_cndmask_b32 v19, v86, v19, s[10:11]
    v_exp_f32 v16, v16
    v_exp_f32 v17, v17
    v_exp_f32 v18, v18
    v_exp_f32 v19, v19
    v_mfma_f32_16x16x32_bf16 v[36:39], v[228:231], v[60:63], v[52:55]
    v_exp_f32 v20, v20
    v_exp_f32 v21, v21
    v_exp_f32 v22, v22
    v_exp_f32 v23, v23
    v_cvt_pk_bf16_f32 v16, v16, v17
    v_cvt_pk_bf16_f32 v17, v18, v19
    v_cvt_pk_bf16_f32 v18, v20, v21
    v_cvt_pk_bf16_f32 v19, v22, v23
    ds_read_b128 v[100:103], v249 offset:3072
    s_waitcnt lgkmcnt(2)
    v_mfma_f32_16x16x32_bf16 v[68:71], v[212:215], v[16:19], 0
    v_exp_f32 v24, v24
    v_exp_f32 v25, v25
    v_exp_f32 v26, v26
    v_mfma_f32_16x16x32_bf16 v[12:15], v[92:95], v[16:19], 0
    v_exp_f32 v27, v27
    v_exp_f32 v28, v28
    v_exp_f32 v29, v29
    v_mfma_f32_16x16x32_bf16 v[40:43], v[120:123], v[60:63], v[56:59]
    v_exp_f32 v30, v30
    v_exp_f32 v31, v31
    v_cvt_pk_bf16_f32 v24, v24, v25
    v_mfma_f32_16x16x32_bf16 v[44:47], v[160:163], v[60:63], v[56:59]
    v_cvt_pk_bf16_f32 v25, v26, v27
    v_cvt_pk_bf16_f32 v26, v28, v29
    v_cvt_pk_bf16_f32 v27, v30, v31
    ds_read_b128 v[92:95], v249 offset:4096
    s_waitcnt lgkmcnt(2)
    v_mfma_f32_16x16x32_bf16 v[68:71], v[216:219], v[24:27], v[68:71]
    v_exp_f32 v32, v32
    v_exp_f32 v33, v33
    v_exp_f32 v34, v34
    v_mfma_f32_16x16x32_bf16 v[12:15], v[96:99], v[24:27], v[12:15]
    v_exp_f32 v35, v35
    v_exp_f32 v36, v36
    v_exp_f32 v37, v37
    v_mfma_f32_16x16x32_bf16 v[16:19], v[124:127], v[60:63], v[56:59]
    v_exp_f32 v38, v38
    v_exp_f32 v39, v39
    v_cvt_pk_bf16_f32 v32, v32, v33
    v_mfma_f32_16x16x32_bf16 v[20:23], v[232:235], v[60:63], v[56:59]
    v_cvt_pk_bf16_f32 v33, v34, v35
    v_cvt_pk_bf16_f32 v34, v36, v37
    v_cvt_pk_bf16_f32 v35, v38, v39
    ds_read_b128 v[96:99], v249 offset:5120
    s_waitcnt lgkmcnt(2)
    v_mfma_f32_16x16x32_bf16 v[68:71], v[220:223], v[32:35], v[68:71]
    v_exp_f32 v40, v40
    v_exp_f32 v41, v41
    v_exp_f32 v42, v42
    v_mfma_f32_16x16x32_bf16 v[12:15], v[100:103], v[32:35], v[12:15]
    v_exp_f32 v43, v43
    v_exp_f32 v44, v44
    v_exp_f32 v45, v45
    v_mfma_f32_16x16x32_bf16 v[24:27], v[128:131], v[60:63], v[56:59]
    v_exp_f32 v46, v46
    v_exp_f32 v47, v47
    v_cvt_pk_bf16_f32 v40, v40, v41
    v_mfma_f32_16x16x32_bf16 v[28:31], v[164:167], v[60:63], v[56:59]
    v_cvt_pk_bf16_f32 v41, v42, v43
    v_cvt_pk_bf16_f32 v42, v44, v45
    v_cvt_pk_bf16_f32 v43, v46, v47
    ds_read_b128 v[100:103], v249 offset:6144
    s_waitcnt lgkmcnt(2)
    v_mfma_f32_16x16x32_bf16 v[68:71], v[192:195], v[40:43], v[68:71]
    v_exp_f32 v16, v16
    v_exp_f32 v17, v17
    v_exp_f32 v18, v18
    v_mfma_f32_16x16x32_bf16 v[12:15], v[92:95], v[40:43], v[12:15]
    v_exp_f32 v19, v19
    v_exp_f32 v20, v20
    v_exp_f32 v21, v21
    v_mfma_f32_16x16x32_bf16 v[32:35], v[132:135], v[60:63], v[56:59]
    v_exp_f32 v22, v22
    v_exp_f32 v23, v23
    v_cvt_pk_bf16_f32 v16, v16, v17
    v_mfma_f32_16x16x32_bf16 v[36:39], v[236:239], v[60:63], v[56:59]
    v_cvt_pk_bf16_f32 v17, v18, v19
    v_cvt_pk_bf16_f32 v18, v20, v21
    v_cvt_pk_bf16_f32 v19, v22, v23
    ds_read_b128 v[92:95], v249 offset:7168
    s_waitcnt lgkmcnt(2)
    v_mfma_f32_16x16x32_bf16 v[68:71], v[196:199], v[16:19], v[68:71]
    v_exp_f32 v24, v24
    v_exp_f32 v25, v25
    v_exp_f32 v26, v26
    v_mfma_f32_16x16x32_bf16 v[12:15], v[96:99], v[16:19], v[12:15]
    v_exp_f32 v27, v27
    v_exp_f32 v28, v28
    v_exp_f32 v29, v29
    v_mfma_f32_16x16x32_bf16 v[40:43], v[104:107], v[60:63], v[48:51]
    v_exp_f32 v30, v30
    v_exp_f32 v31, v31
    v_cvt_pk_bf16_f32 v24, v24, v25
    v_mfma_f32_16x16x32_bf16 v[44:47], v[168:171], v[60:63], v[48:51]
    v_cvt_pk_bf16_f32 v25, v26, v27
    v_cvt_pk_bf16_f32 v26, v28, v29
    v_cvt_pk_bf16_f32 v27, v30, v31
    ds_read_b128 v[96:99], v249 offset:8192
    s_waitcnt lgkmcnt(2)
    v_mfma_f32_16x16x32_bf16 v[68:71], v[200:203], v[24:27], v[68:71]
    v_exp_f32 v32, v32
    v_exp_f32 v33, v33
    v_exp_f32 v34, v34
    v_exp_f32 v35, v35
    v_mfma_f32_16x16x32_bf16 v[12:15], v[100:103], v[24:27], v[12:15]
    v_exp_f32 v36, v36
    v_exp_f32 v37, v37
    v_exp_f32 v38, v38
    v_exp_f32 v39, v39
    v_mfma_f32_16x16x32_bf16 v[16:19], v[108:111], v[60:63], v[48:51]
    v_cvt_pk_bf16_f32 v32, v32, v33
    v_cvt_pk_bf16_f32 v33, v34, v35
    v_cvt_pk_bf16_f32 v34, v36, v37
    v_cvt_pk_bf16_f32 v35, v38, v39
    ds_read_b128 v[100:103], v249 offset:9216
    s_waitcnt lgkmcnt(2)
    v_mfma_f32_16x16x32_bf16 v[68:71], v[204:207], v[32:35], v[68:71]
    v_exp_f32 v40, v40
    v_exp_f32 v41, v41
    v_exp_f32 v42, v42
    v_exp_f32 v43, v43
    v_exp_f32 v44, v44
    v_exp_f32 v45, v45
    v_mfma_f32_16x16x32_bf16 v[12:15], v[92:95], v[32:35], v[12:15]
    v_exp_f32 v46, v46
    v_exp_f32 v47, v47
    v_cvt_pk_bf16_f32 v40, v40, v41
    v_cvt_pk_bf16_f32 v41, v42, v43
    v_cvt_pk_bf16_f32 v42, v44, v45
    v_cvt_pk_bf16_f32 v43, v46, v47
    s_waitcnt lgkmcnt(1)
    s_nop 0
    v_mfma_f32_16x16x32_bf16 v[68:71], v[176:179], v[40:43], v[68:71]
    v_cndmask_b32 v16, v16, v86, s[4:5]
    v_cndmask_b32 v17, v17, v86, s[6:7]
    v_cndmask_b32 v18, v18, v86, s[8:9]
    v_cndmask_b32 v19, v19, v86, s[10:11]
    v_exp_f32 v16, v16
    v_exp_f32 v17, v17
    v_mfma_f32_16x16x32_bf16 v[12:15], v[96:99], v[40:43], v[12:15]
    v_exp_f32 v18, v18
    v_exp_f32 v19, v19
    v_cvt_pk_bf16_f32 v16, v16, v17
    v_cvt_pk_bf16_f32 v17, v18, v19
    v_mov_b32 v18, 0
    v_mov_b32 v19, 0
    s_waitcnt lgkmcnt(0)
    s_nop 0
    v_mfma_f32_16x16x32_bf16 v[68:71], v[180:183], v[16:19], v[68:71]
    v_mfma_f32_16x16x32_bf16 v[12:15], v[100:103], v[16:19], v[12:15]
    s_nop 7
    s_nop 3
    s_cmp_eq_u32 s67, 0
    s_cbranch_scc1 L_cont2
    s_branch L_cont_neg2
L_slowq3:
    s_nop 7
    s_nop 7
    s_waitcnt lgkmcnt(0)
    s_cmp_eq_u32 s75, 0x70000000
    s_cselect_b32 s57, 0xf149f2ca, 0
    v_mov_b32 v52, s57
    v_mov_b32 v53, s57
    v_mov_b32 v54, s57
    v_mov_b32 v55, s57
    s_cmp_eq_u32 s69, 0x70000000
    s_cselect_b32 s57, 0xf149f2ca, 0
    v_mov_b32 v56, s57
    v_mov_b32 v57, s57
    v_mov_b32 v58, s57
    v_mov_b32 v59, s57
    v_mfma_f32_16x16x32_bf16 v[16:19], v[224:227], v[64:67], v[52:55]
    v_mfma_f32_16x16x32_bf16 v[20:23], v[144:147], v[64:67], v[52:55]
    v_mfma_f32_16x16x32_bf16 v[24:27], v[156:159], v[64:67], v[52:55]
    v_mfma_f32_16x16x32_bf16 v[28:31], v[148:151], v[64:67], v[52:55]
    v_mfma_f32_16x16x32_bf16 v[32:35], v[228:231], v[64:67], v[52:55]
    s_nop 3
    v_cndmask_b32 v16, v86, v16, s[4:5]
    v_cndmask_b32 v17, v86, v17, s[6:7]
    v_cndmask_b32 v18, v86, v18, s[8:9]
    v_cndmask_b32 v19, v86, v19, s[10:11]
    v_max_f32 v87, v16, v17
    v_max_f32 v88, v18, v19
    v_mfma_f32_16x16x32_bf16 v[36:39], v[120:123], v[64:67], v[56:59]
    v_max3_f32 v87, v87, v20, v21
    v_max3_f32 v88, v88, v22, v23
    v_mfma_f32_16x16x32_bf16 v[40:43], v[160:163], v[64:67], v[56:59]
    v_max3_f32 v87, v87, v24, v25
    v_max3_f32 v88, v88, v26, v27
    v_mfma_f32_16x16x32_bf16 v[44:47], v[124:127], v[64:67], v[56:59]
    v_max3_f32 v87, v87, v28, v29
    v_max3_f32 v88, v88, v30, v31
    v_mfma_f32_16x16x32_bf16 v[16:19], v[232:235], v[64:67], v[56:59]
    v_max3_f32 v87, v87, v32, v33
    v_max3_f32 v88, v88, v34, v35
    v_mfma_f32_16x16x32_bf16 v[20:23], v[128:131], v[64:67], v[56:59]
    v_max3_f32 v87, v87, v36, v37
    v_max3_f32 v88, v88, v38, v39
    v_mfma_f32_16x16x32_bf16 v[24:27], v[164:167], v[64:67], v[56:59]
    v_max3_f32 v87, v87, v40, v41
    v_max3_f32 v88, v88, v42, v43
    v_mfma_f32_16x16x32_bf16 v[28:31], v[132:135], v[64:67], v[56:59]
    v_max3_f32 v87, v87, v44, v45
    v_max3_f32 v88, v88, v46, v47
    v_mfma_f32_16x16x32_bf16 v[32:35], v[236:239], v[64:67], v[56:59]
    v_max3_f32 v87, v87, v16, v17
    v_max3_f32 v88, v88, v18, v19
    v_mfma_f32_16x16x32_bf16 v[36:39], v[104:107], v[64:67], 0
    v_max3_f32 v87, v87, v20, v21
    v_max3_f32 v88, v88, v22, v23
    v_mfma_f32_16x16x32_bf16 v[40:43], v[168:171], v[64:67], 0
    v_max3_f32 v87, v87, v24, v25
    v_max3_f32 v88, v88, v26, v27
    v_mfma_f32_16x16x32_bf16 v[44:47], v[108:111], v[64:67], 0
    v_max3_f32 v87, v87, v28, v29
    v_max3_f32 v88, v88, v30, v31
    v_mfma_f32_16x16x32_bf16 v[16:19], v[240:243], v[64:67], 0
    v_max3_f32 v87, v87, v32, v33
    v_max3_f32 v88, v88, v34, v35
    v_max3_f32 v87, v87, v36, v37
    v_max3_f32 v88, v88, v38, v39
    v_max3_f32 v87, v87, v40, v41
    v_max3_f32 v88, v88, v42, v43
    v_max3_f32 v87, v87, v44, v45
    v_max3_f32 v88, v88, v46, v47
    v_cndmask_b32 v16, v16, v86, s[4:5]
    v_cndmask_b32 v17, v17, v86, s[6:7]
    v_cndmask_b32 v18, v18, v86, s[8:9]
    v_cndmask_b32 v19, v19, v86, s[10:11]
    v_max3_f32 v87, v87, v16, v17
    v_max3_f32 v88, v88, v18, v19
    ds_read_b128 v[92:95], v249 offset:1024
    ds_read_b128 v[96:99], v249 offset:2048
    v_max_f32 v87, v87, v88
    v_mov_b32 v88, v87
    s_nop 1
    v_permlane32_swap_b32 v87, v88
    v_max_f32 v87, v87, v88
    v_mov_b32 v88, v87
    s_nop 1
    v_permlane16_swap_b32 v87, v88
    v_max_f32 v87, v87, v88
    v_sub_f32 v48, 0, v87
    v_sub_f32 v49, 0, v87
    v_sub_f32 v50, 0, v87
    v_sub_f32 v51, 0, v87
    v_add_f32 v52, v52, v48
    v_add_f32 v53, v53, v48
    v_add_f32 v54, v54, v48
    v_add_f32 v55, v55, v48
    v_add_f32 v56, v56, v48
    v_add_f32 v57, v57, v48
    v_add_f32 v58, v58, v48
    v_add_f32 v59, v59, v48
    v_mfma_f32_16x16x32_bf16 v[20:23], v[224:227], v[64:67], v[52:55]
    v_mfma_f32_16x16x32_bf16 v[24:27], v[144:147], v[64:67], v[52:55]
    v_mfma_f32_16x16x32_bf16 v[28:31], v[156:159], v[64:67], v[52:55]
    v_mfma_f32_16x16x32_bf16 v[32:35], v[148:151], v[64:67], v[52:55]
    s_nop 4
    v_cndmask_b32 v20, v86, v20, s[4:5]
    v_cndmask_b32 v21, v86, v21, s[6:7]
    v_cndmask_b32 v22, v86, v22, s[8:9]
    v_cndmask_b32 v23, v86, v23, s[10:11]
    v_exp_f32 v20, v20
    v_exp_f32 v21, v21
    v_mfma_f32_16x16x32_bf16 v[36:39], v[228:231], v[64:67], v[52:55]
    v_exp_f32 v22, v22
    v_exp_f32 v23, v23
    v_mov_b32 v16, 0
    v_mov_b32 v17, 0
    v_cvt_pk_bf16_f32 v18, v20, v21
    v_cvt_pk_bf16_f32 v19, v22, v23
    ds_read_b128 v[100:103], v249 offset:3072
    s_waitcnt lgkmcnt(2)
    v_mfma_f32_16x16x32_bf16 v[68:71], v[212:215], v[16:19], 0
    v_exp_f32 v24, v24
    v_exp_f32 v25, v25
    v_exp_f32 v26, v26
    v_mfma_f32_16x16x32_bf16 v[12:15], v[92:95], v[16:19], 0
    v_exp_f32 v27, v27
    v_exp_f32 v28, v28
    v_exp_f32 v29, v29
    v_mfma_f32_16x16x32_bf16 v[40:43], v[120:123], v[64:67], v[56:59]
    v_exp_f32 v30, v30
    v_exp_f32 v31, v31
    v_cvt_pk_bf16_f32 v24, v24, v25
    v_mfma_f32_16x16x32_bf16 v[44:47], v[160:163], v[64:67], v[56:59]
    v_cvt_pk_bf16_f32 v25, v26, v27
    v_cvt_pk_bf16_f32 v26, v28, v29
    v_cvt_pk_bf16_f32 v27, v30, v31
    ds_read_b128 v[92:95], v249 offset:4096
    s_waitcnt lgkmcnt(2)
    v_mfma_f32_16x16x32_bf16 v[68:71], v[216:219], v[24:27], v[68:71]
    v_exp_f32 v32, v32
    v_exp_f32 v33, v33
    v_exp_f32 v34, v34
    v_mfma_f32_16x16x32_bf16 v[12:15], v[96:99], v[24:27], v[12:15]
    v_exp_f32 v35, v35
    v_exp_f32 v36, v36
    v_exp_f32 v37, v37
    v_mfma_f32_16x16x32_bf16 v[16:19], v[124:127], v[64:67], v[56:59]
    v_exp_f32 v38, v38
    v_exp_f32 v39, v39
    v_cvt_pk_bf16_f32 v32, v32, v33
    v_mfma_f32_16x16x32_bf16 v[20:23], v[232:235], v[64:67], v[56:59]
    v_cvt_pk_bf16_f32 v33, v34, v35
    v_cvt_pk_bf16_f32 v34, v36, v37
    v_cvt_pk_bf16_f32 v35, v38, v39
    ds_read_b128 v[96:99], v249 offset:5120
    s_waitcnt lgkmcnt(2)
    v_mfma_f32_16x16x32_bf16 v[68:71], v[220:223], v[32:35], v[68:71]
    v_exp_f32 v40, v40
    v_exp_f32 v41, v41
    v_exp_f32 v42, v42
    v_mfma_f32_16x16x32_bf16 v[12:15], v[100:103], v[32:35], v[12:15]
    v_exp_f32 v43, v43
    v_exp_f32 v44, v44
    v_exp_f32 v45, v45
    v_mfma_f32_16x16x32_bf16 v[24:27], v[128:131], v[64:67], v[56:59]
    v_exp_f32 v46, v46
    v_exp_f32 v47, v47
    v_cvt_pk_bf16_f32 v40, v40, v41
    v_mfma_f32_16x16x32_bf16 v[28:31], v[164:167], v[64:67], v[56:59]
    v_cvt_pk_bf16_f32 v41, v42, v43
    v_cvt_pk_bf16_f32 v42, v44, v45
    v_cvt_pk_bf16_f32 v43, v46, v47
    ds_read_b128 v[100:103], v249 offset:6144
    s_waitcnt lgkmcnt(2)
    v_mfma_f32_16x16x32_bf16 v[68:71], v[192:195], v[40:43], v[68:71]
    v_exp_f32 v16, v16
    v_exp_f32 v17, v17
    v_exp_f32 v18, v18
    v_mfma_f32_16x16x32_bf16 v[12:15], v[92:95], v[40:43], v[12:15]
    v_exp_f32 v19, v19
    v_exp_f32 v20, v20
    v_exp_f32 v21, v21
    v_mfma_f32_16x16x32_bf16 v[32:35], v[132:135], v[64:67], v[56:59]
    v_exp_f32 v22, v22
    v_exp_f32 v23, v23
    v_cvt_pk_bf16_f32 v16, v16, v17
    v_mfma_f32_16x16x32_bf16 v[36:39], v[236:239], v[64:67], v[56:59]
    v_cvt_pk_bf16_f32 v17, v18, v19
    v_cvt_pk_bf16_f32 v18, v20, v21
    v_cvt_pk_bf16_f32 v19, v22, v23
    ds_read_b128 v[92:95], v249 offset:7168
    s_waitcnt lgkmcnt(2)
    v_mfma_f32_16x16x32_bf16 v[68:71], v[196:199], v[16:19], v[68:71]
    v_exp_f32 v24, v24
    v_exp_f32 v25, v25
    v_exp_f32 v26, v26
    v_mfma_f32_16x16x32_bf16 v[12:15], v[96:99], v[16:19], v[12:15]
    v_exp_f32 v27, v27
    v_exp_f32 v28, v28
    v_exp_f32 v29, v29
    v_mfma_f32_16x16x32_bf16 v[40:43], v[104:107], v[64:67], v[48:51]
    v_exp_f32 v30, v30
    v_exp_f32 v31, v31
    v_cvt_pk_bf16_f32 v24, v24, v25
    v_mfma_f32_16x16x32_bf16 v[44:47], v[168:171], v[64:67], v[48:51]
    v_cvt_pk_bf16_f32 v25, v26, v27
    v_cvt_pk_bf16_f32 v26, v28, v29
    v_cvt_pk_bf16_f32 v27, v30, v31
    ds_read_b128 v[96:99], v249 offset:8192
    s_waitcnt lgkmcnt(2)
    v_mfma_f32_16x16x32_bf16 v[68:71], v[200:203], v[24:27], v[68:71]
    v_exp_f32 v32, v32
    v_exp_f32 v33, v33
    v_exp_f32 v34, v34
    v_mfma_f32_16x16x32_bf16 v[12:15], v[100:103], v[24:27], v[12:15]
    v_exp_f32 v35, v35
    v_exp_f32 v36, v36
    v_exp_f32 v37, v37
    v_mfma_f32_16x16x32_bf16 v[16:19], v[108:111], v[64:67], v[48:51]
    v_exp_f32 v38, v38
    v_exp_f32 v39, v39
    v_cvt_pk_bf16_f32 v32, v32, v33
    v_mfma_f32_16x16x32_bf16 v[20:23], v[240:243], v[64:67], v[48:51]
    v_cvt_pk_bf16_f32 v33, v34, v35
    v_cvt_pk_bf16_f32 v34, v36, v37
    v_cvt_pk_bf16_f32 v35, v38, v39
    ds_read_b128 v[100:103], v249 offset:9216
    s_waitcnt lgkmcnt(2)
    v_mfma_f32_16x16x32_bf16 v[68:71], v[204:207], v[32:35], v[68:71]
    v_exp_f32 v40, v40
    v_exp_f32 v41, v41
    v_exp_f32 v42, v42
    v_exp_f32 v43, v43
    v_exp_f32 v44, v44
    v_exp_f32 v45, v45
    v_mfma_f32_16x16x32_bf16 v[12:15], v[92:95], v[32:35], v[12:15]
    v_exp_f32 v46, v46
    v_exp_f32 v47, v47
    v_cvt_pk_bf16_f32 v40, v40, v41
    v_cvt_pk_bf16_f32 v41, v42, v43
    v_cvt_pk_bf16_f32 v42, v44, v45
    v_cvt_pk_bf16_f32 v43, v46, v47
    s_waitcnt lgkmcnt(1)
    s_nop 0
    v_mfma_f32_16x16x32_bf16 v[68:71], v[176:179], v[40:43], v[68:71]
    v_exp_f32 v16, v16
    v_exp_f32 v17, v17
    v_exp_f32 v18, v18
    v_exp_f32 v19, v19
    v_cndmask_b32 v20, v20, v86, s[4:5]
    v_cndmask_b32 v21, v21, v86, s[6:7]
    v_cndmask_b32 v22, v22, v86, s[8:9]
    v_cndmask_b32 v23, v23, v86, s[10:11]
    v_mfma_f32_16x16x32_bf16 v[12:15], v[96:99], v[40:43], v[12:15]
    v_exp_f32 v20, v20
    v_exp_f32 v21, v21
    v_exp_f32 v22, v22
    v_exp_f32 v23, v23
    v_cvt_pk_bf16_f32 v16, v16, v17
    v_cvt_pk_bf16_f32 v17, v18, v19
    v_cvt_pk_bf16_f32 v18, v20, v21
    v_cvt_pk_bf16_f32 v19, v22, v23
    s_waitcnt lgkmcnt(0)
    s_nop 0
    v_mfma_f32_16x16x32_bf16 v[68:71], v[180:183], v[16:19], v[68:71]
    v_mfma_f32_16x16x32_bf16 v[12:15], v[100:103], v[16:19], v[12:15]
    s_nop 7
    s_nop 3
    s_cmp_eq_u32 s67, 0
    s_cbranch_scc1 L_cont3
    s_branch L_cont_neg3
L_slowq4:
    s_nop 7
    s_nop 7
    s_waitcnt lgkmcnt(0)
    s_cmp_eq_u32 s75, 0x70000000
    s_cselect_b32 s57, 0xf149f2ca, 0
    v_mov_b32 v52, s57
    v_mov_b32 v53, s57
    v_mov_b32 v54, s57
    v_mov_b32 v55, s57
    s_cmp_eq_u32 s69, 0x70000000
    s_cselect_b32 s57, 0xf149f2ca, 0
    v_mov_b32 v56, s57
    v_mov_b32 v57, s57
    v_mov_b32 v58, s57
    v_mov_b32 v59, s57
    v_mfma_f32_16x16x32_bf16 v[16:19], v[144:147], v[60:63], v[52:55]
    v_mfma_f32_16x16x32_bf16 v[20:23], v[156:159], v[60:63], v[52:55]
    v_mfma_f32_16x16x32_bf16 v[24:27], v[148:151], v[60:63], v[52:55]
    v_mfma_f32_16x16x32_bf16 v[28:31], v[228:231], v[60:63], v[52:55]
    v_mfma_f32_16x16x32_bf16 v[32:35], v[120:123], v[60:63], v[56:59]
    s_nop 3
    v_cndmask_b32 v16, v86, v16, s[4:5]
    v_cndmask_b32 v17, v86, v17, s[6:7]
    v_cndmask_b32 v18, v86, v18, s[8:9]
    v_cndmask_b32 v19, v86, v19, s[10:11]
    v_max_f32 v87, v16, v17
    v_max_f32 v88, v18, v19
    v_mfma_f32_16x16x32_bf16 v[36:39], v[160:163], v[60:63], v[56:59]
    v_max3_f32 v87, v87, v20, v21
    v_max3_f32 v88, v88, v22, v23
    v_mfma_f32_16x16x32_bf16 v[40:43], v[124:127], v[60:63], v[56:59]
    v_max3_f32 v87, v87, v24, v25
    v_max3_f32 v88, v88, v26, v27
    v_mfma_f32_16x16x32_bf16 v[44:47], v[232:235], v[60:63], v[56:59]
    v_max3_f32 v87, v87, v28, v29
    v_max3_f32 v88, v88, v30, v31
    v_mfma_f32_16x16x32_bf16 v[16:19], v[128:131], v[60:63], v[56:59]
    v_max3_f32 v87, v87, v32, v33
    v_max3_f32 v88, v88, v34, v35
    v_mfma_f32_16x16x32_bf16 v[20:23], v[164:167], v[60:63], v[56:59]
    v_max3_f32 v87, v87, v36, v37
    v_max3_f32 v88, v88, v38, v39
    v_mfma_f32_16x16x32_bf16 v[24:27], v[132:135], v[60:63], v[56:59]
    v_max3_f32 v87, v87, v40, v41
    v_max3_f32 v88, v88, v42, v43
    v_mfma_f32_16x16x32_bf16 v[28:31], v[236:239], v[60:63], v[56:59]
    v_max3_f32 v87, v87, v44, v45
    v_max3_f32 v88, v88, v46, v47
    v_mfma_f32_16x16x32_bf16 v[32:35], v[104:107], v[60:63], 0
    v_max3_f32 v87, v87, v16, v17
    v_max3_f32 v88, v88, v18, v19
    v_mfma_f32_16x16x32_bf16 v[36:39], v[168:171], v[60:63], 0
    v_max3_f32 v87, v87, v20, v21
    v_max3_f32 v88, v88, v22, v23
    v_mfma_f32_16x16x32_bf16 v[40:43], v[108:111], v[60:63], 0
    v_max3_f32 v87, v87, v24, v25
    v_max3_f32 v88, v88, v26, v27
    v_mfma_f32_16x16x32_bf16 v[44:47], v[240:243], v[60:63], 0
    v_max3_f32 v87, v87, v28, v29
    v_max3_f32 v88, v88, v30, v31
    v_mfma_f32_16x16x32_bf16 v[16:19], v[112:115], v[60:63], 0
    v_max3_f32 v87, v87, v32, v33
    v_max3_f32 v88, v88, v34, v35
    v_max3_f32 v87, v87, v36, v37
    v_max3_f32 v88, v88, v38, v39
    v_max3_f32 v87, v87, v40, v41
    v_max3_f32 v88, v88, v42, v43
    v_max3_f32 v87, v87, v44, v45
    v_max3_f32 v88, v88, v46, v47
    v_cndmask_b32 v16, v16, v86, s[4:5]
    v_cndmask_b32 v17, v17, v86, s[6:7]
    v_cndmask_b32 v18, v18, v86, s[8:9]
    v_cndmask_b32 v19, v19, v86, s[10:11]
    v_max3_f32 v87, v87, v16, v17
    v_max3_f32 v88, v88, v18, v19
    ds_read_b128 v[92:95], v249 offset:2048
    ds_read_b128 v[96:99], v249 offset:3072
    v_max_f32 v87, v87, v88
    v_mov_b32 v88, v87
    s_nop 1
    v_permlane32_swap_b32 v87, v88
    v_max_f32 v87, v87, v88
    v_mov_b32 v88, v87
    s_nop 1
    v_permlane16_swap_b32 v87, v88
    v_max_f32 v87, v87, v88
    v_sub_f32 v48, 0, v87
    v_sub_f32 v49, 0, v87
    v_sub_f32 v50, 0, v87
    v_sub_f32 v51, 0, v87
    v_add_f32 v52, v52, v48
    v_add_f32 v53, v53, v48
    v_add_f32 v54, v54, v48
    v_add_f32 v55, v55, v48
    v_add_f32 v56, v56, v48
    v_add_f32 v57, v57, v48
    v_add_f32 v58, v58, v48
    v_add_f32 v59, v59, v48
    v_mfma_f32_16x16x32_bf16 v[16:19], v[144:147], v[60:63], v[52:55]
    v_mfma_f32_16x16x32_bf16 v[20:23], v[156:159], v[60:63], v[52:55]
    v_mfma_f32_16x16x32_bf16 v[24:27], v[148:151], v[60:63], v[52:55]
    v_mfma_f32_16x16x32_bf16 v[28:31], v[228:231], v[60:63], v[52:55]
    v_mfma_f32_16x16x32_bf16 v[32:35], v[120:123], v[60:63], v[56:59]
    s_nop 3
    v_cndmask_b32 v16, v86, v16, s[4:5]
    v_cndmask_b32 v17, v86, v17, s[6:7]
    v_cndmask_b32 v18, v86, v18, s[8:9]
    v_cndmask_b32 v19, v86, v19, s[10:11]
    v_exp_f32 v16, v16
    v_exp_f32 v17, v17
    v_exp_f32 v18, v18
    v_exp_f32 v19, v19
    v_mfma_f32_16x16x32_bf16 v[36:39], v[160:163], v[60:63], v[56:59]
    v_exp_f32 v20, v20
    v_exp_f32 v21, v21
    v_exp_f32 v22, v22
    v_exp_f32 v23, v23
    v_cvt_pk_bf16_f32 v16, v16, v17
    v_cvt_pk_bf16_f32 v17, v18, v19
    v_cvt_pk_bf16_f32 v18, v20, v21
    v_cvt_pk_bf16_f32 v19, v22, v23
    ds_read_b128 v[100:103], v249 offset:4096
    s_waitcnt lgkmcnt(2)
    v_mfma_f32_16x16x32_bf16 v[68:71], v[216:219], v[16:19], 0
    v_exp_f32 v24, v24
    v_exp_f32 v25, v25
    v_exp_f32 v26, v26
    v_mfma_f32_16x16x32_bf16 v[12:15], v[92:95], v[16:19], 0
    v_exp_f32 v27, v27
    v_exp_f32 v28, v28
    v_exp_f32 v29, v29
    v_mfma_f32_16x16x32_bf16 v[40:43], v[124:127], v[60:63], v[56:59]
    v_exp_f32 v30, v30
    v_exp_f32 v31, v31
    v_cvt_pk_bf16_f32 v24, v24, v25
    v_mfma_f32_16x16x32_bf16 v[44:47], v[232:235], v[60:63], v[56:59]
    v_cvt_pk_bf16_f32 v25, v26, v27
    v_cvt_pk_bf16_f32 v26, v28, v29
    v_cvt_pk_bf16_f32 v27, v30, v31
    ds_read_b128 v[92:95], v249 offset:5120
    s_waitcnt lgkmcnt(2)
    v_mfma_f32_16x16x32_bf16 v[68:71], v[220:223], v[24:27], v[68:71]
    v_exp_f32 v32, v32
    v_exp_f32 v33, v33
    v_exp_f32 v34, v34
    v_mfma_f32_16x16x32_bf16 v[12:15], v[96:99], v[24:27], v[12:15]
    v_exp_f32 v35, v35
    v_exp_f32 v36, v36
    v_exp_f32 v37, v37
    v_mfma_f32_16x16x32_bf16 v[16:19], v[128:131], v[60:63], v[56:59]
    v_exp_f32 v38, v38
    v_exp_f32 v39, v39
    v_cvt_pk_bf16_f32 v32, v32, v33
    v_mfma_f32_16x16x32_bf16 v[20:23], v[164:167], v[60:63], v[56:59]
    v_cvt_pk_bf16_f32 v33, v34, v35
    v_cvt_pk_bf16_f32 v34, v36, v37
    v_cvt_pk_bf16_f32 v35, v38, v39
    ds_read_b128 v[96:99], v249 offset:6144
    s_waitcnt lgkmcnt(2)
    v_mfma_f32_16x16x32_bf16 v[68:71], v[192:195], v[32:35], v[68:71]
    v_exp_f32 v40, v40
    v_exp_f32 v41, v41
    v_exp_f32 v42, v42
    v_mfma_f32_16x16x32_bf16 v[12:15], v[100:103], v[32:35], v[12:15]
    v_exp_f32 v43, v43
    v_exp_f32 v44, v44
    v_exp_f32 v45, v45
    v_mfma_f32_16x16x32_bf16 v[24:27], v[132:135], v[60:63], v[56:59]
    v_exp_f32 v46, v46
    v_exp_f32 v47, v47
    v_cvt_pk_bf16_f32 v40, v40, v41
    v_mfma_f32_16x16x32_bf16 v[28:31], v[236:239], v[60:63], v[56:59]
    v_cvt_pk_bf16_f32 v41, v42, v43
    v_cvt_pk_bf16_f32 v42, v44, v45
    v_cvt_pk_bf16_f32 v43, v46, v47
    ds_read_b128 v[100:103], v249 offset:7168
    s_waitcnt lgkmcnt(2)
    v_mfma_f32_16x16x32_bf16 v[68:71], v[196:199], v[40:43], v[68:71]
    v_exp_f32 v16, v16
    v_exp_f32 v17, v17
    v_exp_f32 v18, v18
    v_mfma_f32_16x16x32_bf16 v[12:15], v[92:95], v[40:43], v[12:15]
    v_exp_f32 v19, v19
    v_exp_f32 v20, v20
    v_exp_f32 v21, v21
    v_mfma_f32_16x16x32_bf16 v[32:35], v[104:107], v[60:63], v[48:51]
    v_exp_f32 v22, v22
    v_exp_f32 v23, v23
    v_cvt_pk_bf16_f32 v16, v16, v17
    v_mfma_f32_16x16x32_bf16 v[36:39], v[168:171], v[60:63], v[48:51]
    v_cvt_pk_bf16_f32 v17, v18, v19
    v_cvt_pk_bf16_f32 v18, v20, v21
    v_cvt_pk_bf16_f32 v19, v22, v23
    ds_read_b128 v[92:95], v249 offset:8192
    s_waitcnt lgkmcnt(2)
    v_mfma_f32_16x16x32_bf16 v[68:71], v[200:203], v[16:19], v[68:71]
    v_exp_f32 v24, v24
    v_exp_f32 v25, v25
    v_exp_f32 v26, v26
    v_mfma_f32_16x16x32_bf16 v[12:15], v[96:99], v[16:19], v[12:15]
    v_exp_f32 v27, v27
    v_exp_f32 v28, v28
    v_exp_f32 v29, v29
    v_mfma_f32_16x16x32_bf16 v[40:43], v[108:111], v[60:63], v[48:51]
    v_exp_f32 v30, v30
    v_exp_f32 v31, v31
    v_cvt_pk_bf16_f32 v24, v24, v25
    v_mfma_f32_16x16x32_bf16 v[44:47], v[240:243], v[60:63], v[48:51]
    v_cvt_pk_bf16_f32 v25, v26, v27
    v_cvt_pk_bf16_f32 v26, v28, v29
    v_cvt_pk_bf16_f32 v27, v30, v31
    ds_read_b128 v[96:99], v249 offset:9216
    s_waitcnt lgkmcnt(2)
    v_mfma_f32_16x16x32_bf16 v[68:71], v[204:207], v[24:27], v[68:71]
    v_exp_f32 v32, v32
    v_exp_f32 v33, v33
    v_exp_f32 v34, v34
    v_exp_f32 v35, v35
    v_mfma_f32_16x16x32_bf16 v[12:15], v[100:103], v[24:27], v[12:15]
    v_exp_f32 v36, v36
    v_exp_f32 v37, v37
    v_exp_f32 v38, v38
    v_exp_f32 v39, v39
    v_mfma_f32_16x16x32_bf16 v[16:19], v[112:115], v[60:63], v[48:51]
    v_cvt_pk_bf16_f32 v32, v32, v33
    v_cvt_pk_bf16_f32 v33, v34, v35
    v_cvt_pk_bf16_f32 v34, v36, v37
    v_cvt_pk_bf16_f32 v35, v38, v39
    ds_read_b128 v[100:103], v249 offset:10240
    s_waitcnt lgkmcnt(2)
    v_mfma_f32_16x16x32_bf16 v[68:71], v[176:179], v[32:35], v[68:71]
    v_exp_f32 v40, v40
    v_exp_f32 v41, v41
    v_exp_f32 v42, v42
    v_exp_f32 v43, v43
    v_exp_f32 v44, v44
    v_exp_f32 v45, v45
    v_mfma_f32_16x16x32_bf16 v[12:15], v[92:95], v[32:35], v[12:15]
    v_exp_f32 v46, v46
    v_exp_f32 v47, v47
    v_cvt_pk_bf16_f32 v40, v40, v41
    v_cvt_pk_bf16_f32 v41, v42, v43
    v_cvt_pk_bf16_f32 v42, v44, v45
    v_cvt_pk_bf16_f32 v43, v46, v47
    s_waitcnt lgkmcnt(1)
    s_nop 0
    v_mfma_f32_16x16x32_bf16 v[68:71], v[180:183], v[40:43], v[68:71]
    v_cndmask_b32 v16, v16, v86, s[4:5]
    v_cndmask_b32 v17, v17, v86, s[6:7]
    v_cndmask_b32 v18, v18, v86, s[8:9]
    v_cndmask_b32 v19, v19, v86, s[10:11]
    v_exp_f32 v16, v16
    v_exp_f32 v17, v17
    v_mfma_f32_16x16x32_bf16 v[12:15], v[96:99], v[40:43], v[12:15]
    v_exp_f32 v18, v18
    v_exp_f32 v19, v19
    v_cvt_pk_bf16_f32 v16, v16, v17
    v_cvt_pk_bf16_f32 v17, v18, v19
    v_mov_b32 v18, 0
    v_mov_b32 v19, 0
    s_waitcnt lgkmcnt(0)
    s_nop 0
    v_mfma_f32_16x16x32_bf16 v[68:71], v[184:187], v[16:19], v[68:71]
    v_mfma_f32_16x16x32_bf16 v[12:15], v[100:103], v[16:19], v[12:15]
    s_nop 7
    s_nop 3
    s_cmp_eq_u32 s67, 0
    s_cbranch_scc1 L_cont4
    s_branch L_cont_neg4
L_slowq5:
    s_nop 7
    s_nop 7
    s_waitcnt lgkmcnt(0)
    s_cmp_eq_u32 s75, 0x70000000
    s_cselect_b32 s57, 0xf149f2ca, 0
    v_mov_b32 v52, s57
    v_mov_b32 v53, s57
    v_mov_b32 v54, s57
    v_mov_b32 v55, s57
    s_cmp_eq_u32 s69, 0x70000000
    s_cselect_b32 s57, 0xf149f2ca, 0
    v_mov_b32 v56, s57
    v_mov_b32 v57, s57
    v_mov_b32 v58, s57
    v_mov_b32 v59, s57
    v_mfma_f32_16x16x32_bf16 v[16:19], v[156:159], v[64:67], v[52:55]
    v_mfma_f32_16x16x32_bf16 v[20:23], v[148:151], v[64:67], v[52:55]
    v_mfma_f32_16x16x32_bf16 v[24:27], v[228:231], v[64:67], v[52:55]
    v_mfma_f32_16x16x32_bf16 v[28:31], v[120:123], v[64:67], v[56:59]
    v_mfma_f32_16x16x32_bf16 v[32:35], v[160:163], v[64:67], v[56:59]
    s_nop 3
    v_cndmask_b32 v16, v86, v16, s[4:5]
    v_cndmask_b32 v17, v86, v17, s[6:7]
    v_cndmask_b32 v18, v86, v18, s[8:9]
    v_cndmask_b32 v19, v86, v19, s[10:11]
    v_max_f32 v87, v16, v17
    v_max_f32 v88, v18, v19
    v_mfma_f32_16x16x32_bf16 v[36:39], v[124:127], v[64:67], v[56:59]
    v_max3_f32 v87, v87, v20, v21
    v_max3_f32 v88, v88, v22, v23
    v_mfma_f32_16x16x32_bf16 v[40:43], v[232:235], v[64:67], v[56:59]
    v_max3_f32 v87, v87, v24, v25
    v_max3_f32 v88, v88, v26, v27
    v_mfma_f32_16x16x32_bf16 v[44:47], v[128:131], v[64:67], v[56:59]
    v_max3_f32 v87, v87, v28, v29
    v_max3_f32 v88, v88, v30, v31
    v_mfma_f32_16x16x32_bf16 v[16:19], v[164:167], v[64:67], v[56:59]
    v_max3_f32 v87, v87, v32, v33
    v_max3_f32 v88, v88, v34, v35
    v_mfma_f32_16x16x32_bf16 v[20:23], v[132:135], v[64:67], v[56:59]
    v_max3_f32 v87, v87, v36, v37
    v_max3_f32 v88, v88, v38, v39
    v_mfma_f32_16x16x32_bf16 v[24:27], v[236:239], v[64:67], v[56:59]
    v_max3_f32 v87, v87, v40, v41
    v_max3_f32 v88, v88, v42, v43
    v_mfma_f32_16x16x32_bf16 v[28:31], v[104:107], v[64:67], 0
    v_max3_f32 v87, v87, v44, v45
    v_max3_f32 v88, v88, v46, v47
    v_mfma_f32_16x16x32_bf16 v[32:35], v[168:171], v[64:67], 0
    v_max3_f32 v87, v87, v16, v17
    v_max3_f32 v88, v88, v18, v19
    v_mfma_f32_16x16x32_bf16 v[36:39], v[108:111], v[64:67], 0
    v_max3_f32 v87, v87, v20, v21
    v_max3_f32 v88, v88, v22, v23
    v_mfma_f32_16x16x32_bf16 v[40:43], v[240:243], v[64:67], 0
    v_max3_f32 v87, v87, v24, v25
    v_max3_f32 v88, v88, v26, v27
    v_mfma_f32_16x16x32_bf16 v[44:47], v[112:115], v[64:67], 0
    v_max3_f32 v87, v87, v28, v29
    v_max3_f32 v88, v88, v30, v31
    v_mfma_f32_16x16x32_bf16 v[16:19], v[172:175], v[64:67], 0
    v_max3_f32 v87, v87, v32, v33
    v_max3_f32 v88, v88, v34, v35
    v_max3_f32 v87, v87, v36, v37
    v_max3_f32 v88, v88, v38, v39
    v_max3_f32 v87, v87, v40, v41
    v_max3_f32 v88, v88, v42, v43
    v_max3_f32 v87, v87, v44, v45
    v_max3_f32 v88, v88, v46, v47
    v_cndmask_b32 v16, v16, v86, s[4:5]
    v_cndmask_b32 v17, v17, v86, s[6:7]
    v_cndmask_b32 v18, v18, v86, s[8:9]
    v_cndmask_b32 v19, v19, v86, s[10:11]
    v_max3_f32 v87, v87, v16, v17
    v_max3_f32 v88, v88, v18, v19
    ds_read_b128 v[92:95], v249 offset:2048
    ds_read_b128 v[96:99], v249 offset:3072
    v_max_f32 v87, v87, v88
    v_mov_b32 v88, v87
    s_nop 1
    v_permlane32_swap_b32 v87, v88
    v_max_f32 v87, v87, v88
    v_mov_b32 v88, v87
    s_nop 1
    v_permlane16_swap_b32 v87, v88
    v_max_f32 v87, v87, v88
    v_sub_f32 v48, 0, v87
    v_sub_f32 v49, 0, v87
    v_sub_f32 v50, 0, v87
    v_sub_f32 v51, 0, v87
    v_add_f32 v52, v52, v48
    v_add_f32 v53, v53, v48
    v_add_f32 v54, v54, v48
    v_add_f32 v55, v55, v48
    v_add_f32 v56, v56, v48
    v_add_f32 v57, v57, v48
    v_add_f32 v58, v58, v48
    v_add_f32 v59, v59, v48
    v_mfma_f32_16x16x32_bf16 v[20:23], v[156:159], v[64:67], v[52:55]
    v_mfma_f32_16x16x32_bf16 v[24:27], v[148:151], v[64:67], v[52:55]
    v_mfma_f32_16x16x32_bf16 v[28:31], v[228:231], v[64:67], v[52:55]
    v_mfma_f32_16x16x32_bf16 v[32:35], v[120:123], v[64:67], v[56:59]
    s_nop 4
    v_cndmask_b32 v20, v86, v20, s[4:5]
    v_cndmask_b32 v21, v86, v21, s[6:7]
    v_cndmask_b32 v22, v86, v22, s[8:9]
    v_cndmask_b32 v23, v86, v23, s[10:11]
    v_exp_f32 v20, v20
    v_exp_f32 v21, v21
    v_mfma_f32_16x16x32_bf16 v[36:39], v[160:163], v[64:67], v[56:59]
    v_exp_f32 v22, v22
    v_exp_f32 v23, v23
    v_mov_b32 v16, 0
    v_mov_b32 v17, 0
    v_cvt_pk_bf16_f32 v18, v20, v21
    v_cvt_pk_bf16_f32 v19, v22, v23
    ds_read_b128 v[100:103], v249 offset:4096
    s_waitcnt lgkmcnt(2)
    v_mfma_f32_16x16x32_bf16 v[68:71], v[216:219], v[16:19], 0
    v_exp_f32 v24, v24
    v_exp_f32 v25, v25
    v_exp_f32 v26, v26
    v_mfma_f32_16x16x32_bf16 v[12:15], v[92:95], v[16:19], 0
    v_exp_f32 v27, v27
    v_exp_f32 v28, v28
    v_exp_f32 v29, v29
    v_mfma_f32_16x16x32_bf16 v[40:43], v[124:127], v[64:67], v[56:59]
    v_exp_f32 v30, v30
    v_exp_f32 v31, v31
    v_cvt_pk_bf16_f32 v24, v24, v25
    v_mfma_f32_16x16x32_bf16 v[44:47], v[232:235], v[64:67], v[56:59]
    v_cvt_pk_bf16_f32 v25, v26, v27
    v_cvt_pk_bf16_f32 v26, v28, v29
    v_cvt_pk_bf16_f32 v27, v30, v31
    ds_read_b128 v[92:95], v249 offset:5120
    s_waitcnt lgkmcnt(2)
    v_mfma_f32_16x16x32_bf16 v[68:71], v[220:223], v[24:27], v[68:71]
    v_exp_f32 v32, v32
    v_exp_f32 v33, v33
    v_exp_f32 v34, v34
    v_mfma_f32_16x16x32_bf16 v[12:15], v[96:99], v[24:27], v[12:15]
    v_exp_f32 v35, v35
    v_exp_f32 v36, v36
    v_exp_f32 v37, v37
    v_mfma_f32_16x16x32_bf16 v[16:19], v[128:131], v[64:67], v[56:59]
    v_exp_f32 v38, v38
    v_exp_f32 v39, v39
    v_cvt_pk_bf16_f32 v32, v32, v33
    v_mfma_f32_16x16x32_bf16 v[20:23], v[164:167], v[64:67], v[56:59]
    v_cvt_pk_bf16_f32 v33, v34, v35
    v_cvt_pk_bf16_f32 v34, v36, v37
    v_cvt_pk_bf16_f32 v35, v38, v39
    ds_read_b128 v[96:99], v249 offset:6144
    s_waitcnt lgkmcnt(2)
    v_mfma_f32_16x16x32_bf16 v[68:71], v[192:195], v[32:35], v[68:71]
    v_exp_f32 v40, v40
    v_exp_f32 v41, v41
    v_exp_f32 v42, v42
    v_mfma_f32_16x16x32_bf16 v[12:15], v[100:103], v[32:35], v[12:15]
    v_exp_f32 v43, v43
    v_exp_f32 v44, v44
    v_exp_f32 v45, v45
    v_mfma_f32_16x16x32_bf16 v[24:27], v[132:135], v[64:67], v[56:59]
    v_exp_f32 v46, v46
    v_exp_f32 v47, v47
    v_cvt_pk_bf16_f32 v40, v40, v41
    v_mfma_f32_16x16x32_bf16 v[28:31], v[236:239], v[64:67], v[56:59]
    v_cvt_pk_bf16_f32 v41, v42, v43
    v_cvt_pk_bf16_f32 v42, v44, v45
    v_cvt_pk_bf16_f32 v43, v46, v47
    ds_read_b128 v[100:103], v249 offset:7168
    s_waitcnt lgkmcnt(2)
    v_mfma_f32_16x16x32_bf16 v[68:71], v[196:199], v[40:43], v[68:71]
    v_exp_f32 v16, v16
    v_exp_f32 v17, v17
    v_exp_f32 v18, v18
    v_mfma_f32_16x16x32_bf16 v[12:15], v[92:95], v[40:43], v[12:15]
    v_exp_f32 v19, v19
    v_exp_f32 v20, v20
    v_exp_f32 v21, v21
    v_mfma_f32_16x16x32_bf16 v[32:35], v[104:107], v[64:67], v[48:51]
    v_exp_f32 v22, v22
    v_exp_f32 v23, v23
    v_cvt_pk_bf16_f32 v16, v16, v17
    v_mfma_f32_16x16x32_bf16 v[36:39], v[168:171], v[64:67], v[48:51]
    v_cvt_pk_bf16_f32 v17, v18, v19
    v_cvt_pk_bf16_f32 v18, v20, v21
    v_cvt_pk_bf16_f32 v19, v22, v23
    ds_read_b128 v[92:95], v249 offset:8192
    s_waitcnt lgkmcnt(2)
    v_mfma_f32_16x16x32_bf16 v[68:71], v[200:203], v[16:19], v[68:71]
    v_exp_f32 v24, v24
    v_exp_f32 v25, v25
    v_exp_f32 v26, v26
    v_mfma_f32_16x16x32_bf16 v[12:15], v[96:99], v[16:19], v[12:15]
    v_exp_f32 v27, v27
    v_exp_f32 v28, v28
    v_exp_f32 v29, v29
    v_mfma_f32_16x16x32_bf16 v[40:43], v[108:111], v[64:67], v[48:51]
    v_exp_f32 v30, v30
    v_exp_f32 v31, v31
    v_cvt_pk_bf16_f32 v24, v24, v25
    v_mfma_f32_16x16x32_bf16 v[44:47], v[240:243], v[64:67], v[48:51]
    v_cvt_pk_bf16_f32 v25, v26, v27
    v_cvt_pk_bf16_f32 v26, v28, v29
    v_cvt_pk_bf16_f32 v27, v30, v31
    ds_read_b128 v[96:99], v249 offset:9216
    s_waitcnt lgkmcnt(2)
    v_mfma_f32_16x16x32_bf16 v[68:71], v[204:207], v[24:27], v[68:71]
    v_exp_f32 v32, v32
    v_exp_f32 v33, v33
    v_exp_f32 v34, v34
    v_mfma_f32_16x16x32_bf16 v[12:15], v[100:103], v[24:27], v[12:15]
    v_exp_f32 v35, v35
    v_exp_f32 v36, v36
    v_exp_f32 v37, v37
    v_mfma_f32_16x16x32_bf16 v[16:19], v[112:115], v[64:67], v[48:51]
    v_exp_f32 v38, v38
    v_exp_f32 v39, v39
    v_cvt_pk_bf16_f32 v32, v32, v33
    v_mfma_f32_16x16x32_bf16 v[20:23], v[172:175], v[64:67], v[48:51]
    v_cvt_pk_bf16_f32 v33, v34, v35
    v_cvt_pk_bf16_f32 v34, v36, v37
    v_cvt_pk_bf16_f32 v35, v38, v39
    ds_read_b128 v[100:103], v249 offset:10240
    s_waitcnt lgkmcnt(2)
    v_mfma_f32_16x16x32_bf16 v[68:71], v[176:179], v[32:35], v[68:71]
    v_exp_f32 v40, v40
    v_exp_f32 v41, v41
    v_exp_f32 v42, v42
    v_exp_f32 v43, v43
    v_exp_f32 v44, v44
    v_exp_f32 v45, v45
    v_mfma_f32_16x16x32_bf16 v[12:15], v[92:95], v[32:35], v[12:15]
    v_exp_f32 v46, v46
    v_exp_f32 v47, v47
    v_cvt_pk_bf16_f32 v40, v40, v41
    v_cvt_pk_bf16_f32 v41, v42, v43
    v_cvt_pk_bf16_f32 v42, v44, v45
    v_cvt_pk_bf16_f32 v43, v46, v47
    s_waitcnt lgkmcnt(1)
    s_nop 0
    v_mfma_f32_16x16x32_bf16 v[68:71], v[180:183], v[40:43], v[68:71]
    v_exp_f32 v16, v16
    v_exp_f32 v17, v17
    v_exp_f32 v18, v18
    v_exp_f32 v19, v19
    v_cndmask_b32 v20, v20, v86, s[4:5]
    v_cndmask_b32 v21, v21, v86, s[6:7]
    v_cndmask_b32 v22, v22, v86, s[8:9]
    v_cndmask_b32 v23, v23, v86, s[10:11]
    v_mfma_f32_16x16x32_bf16 v[12:15], v[96:99], v[40:43], v[12:15]
    v_exp_f32 v20, v20
    v_exp_f32 v21, v21
    v_exp_f32 v22, v22
    v_exp_f32 v23, v23
    v_cvt_pk_bf16_f32 v16, v16, v17
    v_cvt_pk_bf16_f32 v17, v18, v19
    v_cvt_pk_bf16_f32 v18, v20, v21
    v_cvt_pk_bf16_f32 v19, v22, v23
    s_waitcnt lgkmcnt(0)
    s_nop 0
    v_mfma_f32_16x16x32_bf16 v[68:71], v[184:187], v[16:19], v[68:71]
    v_mfma_f32_16x16x32_bf16 v[12:15], v[100:103], v[16:19], v[12:15]
    s_nop 7
    s_nop 3
    s_cmp_eq_u32 s67, 0
    s_cbranch_scc1 L_cont5
    s_branch L_cont_neg5
L_slowq6:
    s_nop 7
    s_nop 7
    s_waitcnt lgkmcnt(0)
    s_cmp_eq_u32 s75, 0x70000000
    s_cselect_b32 s57, 0xf149f2ca, 0
    v_mov_b32 v52, s57
    v_mov_b32 v53, s57
    v_mov_b32 v54, s57
    v_mov_b32 v55, s57
    s_cmp_eq_u32 s69, 0x70000000
    s_cselect_b32 s57, 0xf149f2ca, 0
    v_mov_b32 v56, s57
    v_mov_b32 v57, s57
    v_mov_b32 v58, s57
    v_mov_b32 v59, s57
    v_mfma_f32_16x16x32_bf16 v[16:19], v[148:151], v[60:63], v[52:55]
    v_mfma_f32_16x16x32_bf16 v[20:23], v[228:231], v[60:63], v[52:55]
    v_mfma_f32_16x16x32_bf16 v[24:27], v[120:123], v[60:63], v[56:59]
    v_mfma_f32_16x16x32_bf16 v[28:31], v[160:163], v[60:63], v[56:59]
    v_mfma_f32_16x16x32_bf16 v[32:35], v[124:127], v[60:63], v[56:59]
    s_nop 3
    v_cndmask_b32 v16, v86, v16, s[4:5]
    v_cndmask_b32 v17, v86, v17, s[6:7]
    v_cndmask_b32 v18, v86, v18, s[8:9]
    v_cndmask_b32 v19, v86, v19, s[10:11]
    v_max_f32 v87, v16, v17
    v_max_f32 v88, v18, v19
    v_mfma_f32_16x16x32_bf16 v[36:39], v[232:235], v[60:63], v[56:59]
    v_max3_f32 v87, v87, v20, v21
    v_max3_f32 v88, v88, v22, v23
    v_mfma_f32_16x16x32_bf16 v[40:43], v[128:131], v[60:63], v[56:59]
    v_max3_f32 v87, v87, v24, v25
    v_max3_f32 v88, v88, v26, v27
    v_mfma_f32_16x16x32_bf16 v[44:47], v[164:167], v[60:63], v[56:59]
    v_max3_f32 v87, v87, v28, v29
    v_max3_f32 v88, v88, v30, v31
    v_mfma_f32_16x16x32_bf16 v[16:19], v[132:135], v[60:63], v[56:59]
    v_max3_f32 v87, v87, v32, v33
    v_max3_f32 v88, v88, v34, v35
    v_mfma_f32_16x16x32_bf16 v[20:23], v[236:239], v[60:63], v[56:59]
    v_max3_f32 v87, v87, v36, v37
    v_max3_f32 v88, v88, v38, v39
    v_mfma_f32_16x16x32_bf16 v[24:27], v[104:107], v[60:63], 0
    v_max3_f32 v87, v87, v40, v41
    v_max3_f32 v88, v88, v42, v43
    v_mfma_f32_16x16x32_bf16 v[28:31], v[168:171], v[60:63], 0
    v_max3_f32 v87, v87, v44, v45
    v_max3_f32 v88, v88, v46, v47
    v_mfma_f32_16x16x32_bf16 v[32:35], v[108:111], v[60:63], 0
    v_max3_f32 v87, v87, v16, v17
    v_max3_f32 v88, v88, v18, v19
    v_mfma_f32_16x16x32_bf16 v[36:39], v[240:243], v[60:63], 0
    v_max3_f32 v87, v87, v20, v21
    v_max3_f32 v88, v88, v22, v23
    v_mfma_f32_16x16x32_bf16 v[40:43], v[112:115], v[60:63], 0
    v_max3_f32 v87, v87, v24, v25
    v_max3_f32 v88, v88, v26, v27
    v_mfma_f32_16x16x32_bf16 v[44:47], v[172:175], v[60:63], 0
    v_max3_f32 v87, v87, v28, v29
    v_max3_f32 v88, v88, v30, v31
    v_mfma_f32_16x16x32_bf16 v[16:19], v[116:119], v[60:63], 0
    v_max3_f32 v87, v87, v32, v33
    v_max3_f32 v88, v88, v34, v35
    v_max3_f32 v87, v87, v36, v37
    v_max3_f32 v88, v88, v38, v39
    v_max3_f32 v87, v87, v40, v41
    v_max3_f32 v88, v88, v42, v43
    v_max3_f32 v87, v87, v44, v45
    v_max3_f32 v88, v88, v46, v47
    v_cndmask_b32 v16, v16, v86, s[4:5]
    v_cndmask_b32 v17, v17, v86, s[6:7]
    v_cndmask_b32 v18, v18, v86, s[8:9]
    v_cndmask_b32 v19, v19, v86, s[10:11]
    v_max3_f32 v87, v87, v16, v17
    v_max3_f32 v88, v88, v18, v19
    ds_read_b128 v[92:95], v249 offset:3072
    ds_read_b128 v[96:99], v249 offset:4096
    v_max_f32 v87, v87, v88
    v_mov_b32 v88, v87
    s_nop 1
    v_permlane32_swap_b32 v87, v88
    v_max_f32 v87, v87, v88
    v_mov_b32 v88, v87
    s_nop 1
    v_permlane16_swap_b32 v87, v88
    v_max_f32 v87, v87, v88
    v_sub_f32 v48, 0, v87
    v_sub_f32 v49, 0, v87
    v_sub_f32 v50, 0, v87
    v_sub_f32 v51, 0, v87
    v_add_f32 v52, v52, v48
    v_add_f32 v53, v53, v48
    v_add_f32 v54, v54, v48
    v_add_f32 v55, v55, v48
    v_add_f32 v56, v56, v48
    v_add_f32 v57, v57, v48
    v_add_f32 v58, v58, v48
    v_add_f32 v59, v59, v48
    v_mfma_f32_16x16x32_bf16 v[16:19], v[148:151], v[60:63], v[52:55]
    v_mfma_f32_16x16x32_bf16 v[20:23], v[228:231], v[60:63], v[52:55]
    v_mfma_f32_16x16x32_bf16 v[24:27], v[120:123], v[60:63], v[56:59]
    v_mfma_f32_16x16x32_bf16 v[28:31], v[160:163], v[60:63], v[56:59]
    v_mfma_f32_16x16x32_bf16 v[32:35], v[124:127], v[60:63], v[56:59]
    s_nop 3
    v_cndmask_b32 v16, v86, v16, s[4:5]
    v_cndmask_b32 v17, v86, v17, s[6:7]
    v_cndmask_b32 v18, v86, v18, s[8:9]
    v_cndmask_b32 v19, v86, v19, s[10:11]
    v_exp_f32 v16, v16
    v_exp_f32 v17, v17
    v_exp_f32 v18, v18
    v_exp_f32 v19, v19
    v_mfma_f32_16x16x32_bf16 v[36:39], v[232:235], v[60:63], v[56:59]
    v_exp_f32 v20, v20
    v_exp_f32 v21, v21
    v_exp_f32 v22, v22
    v_exp_f32 v23, v23
    v_cvt_pk_bf16_f32 v16, v16, v17
    v_cvt_pk_bf16_f32 v17, v18, v19
    v_cvt_pk_bf16_f32 v18, v20, v21
    v_cvt_pk_bf16_f32 v19, v22, v23
    ds_read_b128 v[100:103], v249 offset:5120
    s_waitcnt lgkmcnt(2)
    v_mfma_f32_16x16x32_bf16 v[68:71], v[220:223], v[16:19], 0
    v_exp_f32 v24, v24
    v_exp_f32 v25, v25
    v_exp_f32 v26, v26
    v_mfma_f32_16x16x32_bf16 v[12:15], v[92:95], v[16:19], 0
    v_exp_f32 v27, v27
    v_exp_f32 v28, v28
    v_exp_f32 v29, v29
    v_mfma_f32_16x16x32_bf16 v[40:43], v[128:131], v[60:63], v[56:59]
    v_exp_f32 v30, v30
    v_exp_f32 v31, v31
    v_cvt_pk_bf16_f32 v24, v24, v25
    v_mfma_f32_16x16x32_bf16 v[44:47], v[164:167], v[60:63], v[56:59]
    v_cvt_pk_bf16_f32 v25, v26, v27
    v_cvt_pk_bf16_f32 v26, v28, v29
    v_cvt_pk_bf16_f32 v27, v30, v31
    ds_read_b128 v[92:95], v249 offset:6144
    s_waitcnt lgkmcnt(2)
    v_mfma_f32_16x16x32_bf16 v[68:71], v[192:195], v[24:27], v[68:71]
    v_exp_f32 v32, v32
    v_exp_f32 v33, v33
    v_exp_f32 v34, v34
    v_mfma_f32_16x16x32_bf16 v[12:15], v[96:99], v[24:27], v[12:15]
    v_exp_f32 v35, v35
    v_exp_f32 v36, v36
    v_exp_f32 v37, v37
    v_mfma_f32_16x16x32_bf16 v[16:19], v[132:135], v[60:63], v[56:59]
    v_exp_f32 v38, v38
    v_exp_f32 v39, v39
    v_cvt_pk_bf16_f32 v32, v32, v33
    v_mfma_f32_16x16x32_bf16 v[20:23], v[236:239], v[60:63], v[56:59]
    v_cvt_pk_bf16_f32 v33, v34, v35
    v_cvt_pk_bf16_f32 v34, v36, v37
    v_cvt_pk_bf16_f32 v35, v38, v39
    ds_read_b128 v[96:99], v249 offset:7168
    s_waitcnt lgkmcnt(2)
    v_mfma_f32_16x16x32_bf16 v[68:71], v[196:199], v[32:35], v[68:71]
    v_exp_f32 v40, v40
    v_exp_f32 v41, v41
    v_exp_f32 v42, v42
    v_mfma_f32_16x16x32_bf16 v[12:15], v[100:103], v[32:35], v[12:15]
    v_exp_f32 v43, v43
    v_exp_f32 v44, v44
    v_exp_f32 v45, v45
    v_mfma_f32_16x16x32_bf16 v[24:27], v[104:107], v[60:63], v[48:51]
    v_exp_f32 v46, v46
    v_exp_f32 v47, v47
    v_cvt_pk_bf16_f32 v40, v40, v41
    v_mfma_f32_16x16x32_bf16 v[28:31], v[168:171], v[60:63], v[48:51]
    v_cvt_pk_bf16_f32 v41, v42, v43
    v_cvt_pk_bf16_f32 v42, v44, v45
    v_cvt_pk_bf16_f32 v43, v46, v47
    ds_read_b128 v[100:103], v249 offset:8192
    s_waitcnt lgkmcnt(2)
    v_mfma_f32_16x16x32_bf16 v[68:71], v[200:203], v[40:43], v[68:71]
    v_exp_f32 v16, v16
    v_exp_f32 v17, v17
    v_exp_f32 v18, v18
    v_mfma_f32_16x16x32_bf16 v[12:15], v[92:95], v[40:43], v[12:15]
    v_exp_f32 v19, v19
    v_exp_f32 v20, v20
    v_exp_f32 v21, v21
    v_mfma_f32_16x16x32_bf16 v[32:35], v[108:111], v[60:63], v[48:51]
    v_exp_f32 v22, v22
    v_exp_f32 v23, v23
    v_cvt_pk_bf16_f32 v16, v16, v17
    v_mfma_f32_16x16x32_bf16 v[36:39], v[240:243], v[60:63], v[48:51]
    v_cvt_pk_bf16_f32 v17, v18, v19
    v_cvt_pk_bf16_f32 v18, v20, v21
    v_cvt_pk_bf16_f32 v19, v22, v23
    ds_read_b128 v[92:95], v249 offset:9216
    s_waitcnt lgkmcnt(2)
    v_mfma_f32_16x16x32_bf16 v[68:71], v[204:207], v[16:19], v[68:71]
    v_exp_f32 v24, v24
    v_exp_f32 v25, v25
    v_exp_f32 v26, v26
    v_mfma_f32_16x16x32_bf16 v[12:15], v[96:99], v[16:19], v[12:15]
    v_exp_f32 v27, v27
    v_exp_f32 v28, v28
    v_exp_f32 v29, v29
    v_mfma_f32_16x16x32_bf16 v[40:43], v[112:115], v[60:63], v[48:51]
    v_exp_f32 v30, v30
    v_exp_f32 v31, v31
    v_cvt_pk_bf16_f32 v24, v24, v25
    v_mfma_f32_16x16x32_bf16 v[44:47], v[172:175], v[60:63], v[48:51]
    v_cvt_pk_bf16_f32 v25, v26, v27
    v_cvt_pk_bf16_f32 v26, v28, v29
    v_cvt_pk_bf16_f32 v27, v30, v31
    ds_read_b128 v[96:99], v249 offset:10240
    s_waitcnt lgkmcnt(2)
    v_mfma_f32_16x16x32_bf16 v[68:71], v[176:179], v[24:27], v[68:71]
    v_exp_f32 v32, v32
    v_exp_f32 v33, v33
    v_exp_f32 v34, v34
    v_exp_f32 v35, v35
    v_mfma_f32_16x16x32_bf16 v[12:15], v[100:103], v[24:27], v[12:15]
    v_exp_f32 v36, v36
    v_exp_f32 v37, v37
    v_exp_f32 v38, v38
    v_exp_f32 v39, v39
    v_mfma_f32_16x16x32_bf16 v[16:19], v[116:119], v[60:63], v[48:51]
    v_cvt_pk_bf16_f32 v32, v32, v33
    v_cvt_pk_bf16_f32 v33, v34, v35
    v_cvt_pk_bf16_f32 v34, v36, v37
    v_cvt_pk_bf16_f32 v35, v38, v39
    ds_read_b128 v[100:103], v249 offset:11264
    s_waitcnt lgkmcnt(2)
    v_mfma_f32_16x16x32_bf16 v[68:71], v[180:183], v[32:35], v[68:71]
    v_exp_f32 v40, v40
    v_exp_f32 v41, v41
    v_exp_f32 v42, v42
    v_exp_f32 v43, v43
    v_exp_f32 v44, v44
    v_exp_f32 v45, v45
    v_mfma_f32_16x16x32_bf16 v[12:15], v[92:95], v[32:35], v[12:15]
    v_exp_f32 v46, v46
    v_exp_f32 v47, v47
    v_cvt_pk_bf16_f32 v40, v40, v41
    v_cvt_pk_bf16_f32 v41, v42, v43
    v_cvt_pk_bf16_f32 v42, v44, v45
    v_cvt_pk_bf16_f32 v43, v46, v47
    s_waitcnt lgkmcnt(1)
    s_nop 0
    v_mfma_f32_16x16x32_bf16 v[68:71], v[184:187], v[40:43], v[68:71]
    v_cndmask_b32 v16, v16, v86, s[4:5]
    v_cndmask_b32 v17, v17, v86, s[6:7]
    v_cndmask_b32 v18, v18, v86, s[8:9]
    v_cndmask_b32 v19, v19, v86, s[10:11]
    v_exp_f32 v16, v16
    v_exp_f32 v17, v17
    v_mfma_f32_16x16x32_bf16 v[12:15], v[96:99], v[40:43], v[12:15]
    v_exp_f32 v18, v18
    v_exp_f32 v19, v19
    v_cvt_pk_bf16_f32 v16, v16, v17
    v_cvt_pk_bf16_f32 v17, v18, v19
    v_mov_b32 v18, 0
    v_mov_b32 v19, 0
    s_waitcnt lgkmcnt(0)
    s_nop 0
    v_mfma_f32_16x16x32_bf16 v[68:71], v[188:191], v[16:19], v[68:71]
    v_mfma_f32_16x16x32_bf16 v[12:15], v[100:103], v[16:19], v[12:15]
    s_nop 7
    s_nop 3
    s_cmp_eq_u32 s67, 0
    s_cbranch_scc1 L_cont6
    s_branch L_cont_neg6
L_slowq7:
    s_nop 7
    s_nop 7
    s_waitcnt lgkmcnt(0)
    s_cmp_eq_u32 s75, 0x70000000
    s_cselect_b32 s57, 0xf149f2ca, 0
    v_mov_b32 v52, s57
    v_mov_b32 v53, s57
    v_mov_b32 v54, s57
    v_mov_b32 v55, s57
    s_cmp_eq_u32 s69, 0x70000000
    s_cselect_b32 s57, 0xf149f2ca, 0
    v_mov_b32 v56, s57
    v_mov_b32 v57, s57
    v_mov_b32 v58, s57
    v_mov_b32 v59, s57
    v_mfma_f32_16x16x32_bf16 v[16:19], v[228:231], v[64:67], v[52:55]
    s_nop 0
    v_mfma_f32_16x16x32_bf16 v[20:23], v[120:123], v[64:67], v[56:59]
    v_mfma_f32_16x16x32_bf16 v[24:27], v[160:163], v[64:67], v[56:59]
    v_mfma_f32_16x16x32_bf16 v[28:31], v[124:127], v[64:67], v[56:59]
    v_mfma_f32_16x16x32_bf16 v[32:35], v[232:235], v[64:67], v[56:59]
    s_nop 2
    v_cndmask_b32 v16, v86, v16, s[4:5]
    v_cndmask_b32 v17, v86, v17, s[6:7]
    v_cndmask_b32 v18, v86, v18, s[8:9]
    v_cndmask_b32 v19, v86, v19, s[10:11]
    v_max_f32 v87, v16, v17
    v_max_f32 v88, v18, v19
    v_mfma_f32_16x16x32_bf16 v[36:39], v[128:131], v[64:67], v[56:59]
    v_max3_f32 v87, v87, v20, v21
    v_max3_f32 v88, v88, v22, v23
    v_mfma_f32_16x16x32_bf16 v[40:43], v[164:167], v[64:67], v[56:59]
    v_max3_f32 v87, v87, v24, v25
    v_max3_f32 v88, v88, v26, v27
    v_mfma_f32_16x16x32_bf16 v[44:47], v[132:135], v[64:67], v[56:59]
    v_max3_f32 v87, v87, v28, v29
    v_max3_f32 v88, v88, v30, v31
    v_mfma_f32_16x16x32_bf16 v[16:19], v[236:239], v[64:67], v[56:59]
    v_max3_f32 v87, v87, v32, v33
    v_max3_f32 v88, v88, v34, v35
    v_mfma_f32_16x16x32_bf16 v[20:23], v[104:107], v[64:67], 0
    v_max3_f32 v87, v87, v36, v37
    v_max3_f32 v88, v88, v38, v39
    v_mfma_f32_16x16x32_bf16 v[24:27], v[168:171], v[64:67], 0
    v_max3_f32 v87, v87, v40, v41
    v_max3_f32 v88, v88, v42, v43
    v_mfma_f32_16x16x32_bf16 v[28:31], v[108:111], v[64:67], 0
    v_max3_f32 v87, v87, v44, v45
    v_max3_f32 v88, v88, v46, v47
    v_mfma_f32_16x16x32_bf16 v[32:35], v[240:243], v[64:67], 0
    v_max3_f32 v87, v87, v16, v17
    v_max3_f32 v88, v88, v18, v19
    v_mfma_f32_16x16x32_bf16 v[36:39], v[112:115], v[64:67], 0
    v_max3_f32 v87, v87, v20, v21
    v_max3_f32 v88, v88, v22, v23
    v_mfma_f32_16x16x32_bf16 v[40:43], v[172:175], v[64:67], 0
    v_max3_f32 v87, v87, v24, v25
    v_max3_f32 v88, v88, v26, v27
    v_mfma_f32_16x16x32_bf16 v[44:47], v[116:119], v[64:67], 0
    v_max3_f32 v87, v87, v28, v29
    v_max3_f32 v88, v88, v30, v31
    v_mfma_f32_16x16x32_bf16 v[16:19], v[244:247], v[64:67], 0
    v_max3_f32 v87, v87, v32, v33
    v_max3_f32 v88, v88, v34, v35
    v_max3_f32 v87, v87, v36, v37
    v_max3_f32 v88, v88, v38, v39
    v_max3_f32 v87, v87, v40, v41
    v_max3_f32 v88, v88, v42, v43
    v_max3_f32 v87, v87, v44, v45
    v_max3_f32 v88, v88, v46, v47
    v_cndmask_b32 v16, v16, v86, s[4:5]
    v_cndmask_b32 v17, v17, v86, s[6:7]
    v_cndmask_b32 v18, v18, v86, s[8:9]
    v_cndmask_b32 v19, v19, v86, s[10:11]
    v_max3_f32 v87, v87, v16, v17
    v_max3_f32 v88, v88, v18, v19
    ds_read_b128 v[92:95], v249 offset:3072
    ds_read_b128 v[96:99], v249 offset:4096
    v_max_f32 v87, v87, v88
    v_mov_b32 v88, v87
    s_nop 1
    v_permlane32_swap_b32 v87, v88
    v_max_f32 v87, v87, v88
    v_mov_b32 v88, v87
    s_nop 1
    v_permlane16_swap_b32 v87, v88
    v_max_f32 v87, v87, v88
    v_sub_f32 v48, 0, v87
    v_sub_f32 v49, 0, v87
    v_sub_f32 v50, 0, v87
    v_sub_f32 v51, 0, v87
    v_add_f32 v52, v52, v48
    v_add_f32 v53, v53, v48
    v_add_f32 v54, v54, v48
    v_add_f32 v55, v55, v48
    v_add_f32 v56, v56, v48
    v_add_f32 v57, v57, v48
    v_add_f32 v58, v58, v48
    v_add_f32 v59, v59, v48
    v_mfma_f32_16x16x32_bf16 v[20:23], v[228:231], v[64:67], v[52:55]
    s_nop 0
    v_mfma_f32_16x16x32_bf16 v[24:27], v[120:123], v[64:67], v[56:59]
    v_mfma_f32_16x16x32_bf16 v[28:31], v[160:163], v[64:67], v[56:59]
    v_mfma_f32_16x16x32_bf16 v[32:35], v[124:127], v[64:67], v[56:59]
    s_nop 3
    v_cndmask_b32 v20, v86, v20, s[4:5]
    v_cndmask_b32 v21, v86, v21, s[6:7]
    v_cndmask_b32 v22, v86, v22, s[8:9]
    v_cndmask_b32 v23, v86, v23, s[10:11]
    v_exp_f32 v20, v20
    v_exp_f32 v21, v21
    v_mfma_f32_16x16x32_bf16 v[36:39], v[232:235], v[64:67], v[56:59]
    v_exp_f32 v22, v22
    v_exp_f32 v23, v23
    v_mov_b32 v16, 0
    v_mov_b32 v17, 0
    v_cvt_pk_bf16_f32 v18, v20, v21
    v_cvt_pk_bf16_f32 v19, v22, v23
    ds_read_b128 v[100:103], v249 offset:5120
    s_waitcnt lgkmcnt(2)
    v_mfma_f32_16x16x32_bf16 v[68:71], v[220:223], v[16:19], 0
    v_exp_f32 v24, v24
    v_exp_f32 v25, v25
    v_exp_f32 v26, v26
    v_mfma_f32_16x16x32_bf16 v[12:15], v[92:95], v[16:19], 0
    v_exp_f32 v27, v27
    v_exp_f32 v28, v28
    v_exp_f32 v29, v29
    v_mfma_f32_16x16x32_bf16 v[40:43], v[128:131], v[64:67], v[56:59]
    v_exp_f32 v30, v30
    v_exp_f32 v31, v31
    v_cvt_pk_bf16_f32 v24, v24, v25
    v_mfma_f32_16x16x32_bf16 v[44:47], v[164:167], v[64:67], v[56:59]
    v_cvt_pk_bf16_f32 v25, v26, v27
    v_cvt_pk_bf16_f32 v26, v28, v29
    v_cvt_pk_bf16_f32 v27, v30, v31
    ds_read_b128 v[92:95], v249 offset:6144
    s_waitcnt lgkmcnt(2)
    v_mfma_f32_16x16x32_bf16 v[68:71], v[192:195], v[24:27], v[68:71]
    v_exp_f32 v32, v32
    v_exp_f32 v33, v33
    v_exp_f32 v34, v34
    v_mfma_f32_16x16x32_bf16 v[12:15], v[96:99], v[24:27], v[12:15]
    v_exp_f32 v35, v35
    v_exp_f32 v36, v36
    v_exp_f32 v37, v37
    v_mfma_f32_16x16x32_bf16 v[16:19], v[132:135], v[64:67], v[56:59]
    v_exp_f32 v38, v38
    v_exp_f32 v39, v39
    v_cvt_pk_bf16_f32 v32, v32, v33
    v_mfma_f32_16x16x32_bf16 v[20:23], v[236:239], v[64:67], v[56:59]
    v_cvt_pk_bf16_f32 v33, v34, v35
    v_cvt_pk_bf16_f32 v34, v36, v37
    v_cvt_pk_bf16_f32 v35, v38, v39
    ds_read_b128 v[96:99], v249 offset:7168
    s_waitcnt lgkmcnt(2)
    v_mfma_f32_16x16x32_bf16 v[68:71], v[196:199], v[32:35], v[68:71]
    v_exp_f32 v40, v40
    v_exp_f32 v41, v41
    v_exp_f32 v42, v42
    v_mfma_f32_16x16x32_bf16 v[12:15], v[100:103], v[32:35], v[12:15]
    v_exp_f32 v43, v43
    v_exp_f32 v44, v44
    v_exp_f32 v45, v45
    v_mfma_f32_16x16x32_bf16 v[24:27], v[104:107], v[64:67], v[48:51]
    v_exp_f32 v46, v46
    v_exp_f32 v47, v47
    v_cvt_pk_bf16_f32 v40, v40, v41
    v_mfma_f32_16x16x32_bf16 v[28:31], v[168:171], v[64:67], v[48:51]
    v_cvt_pk_bf16_f32 v41, v42, v43
    v_cvt_pk_bf16_f32 v42, v44, v45
    v_cvt_pk_bf16_f32 v43, v46, v47
    ds_read_b128 v[100:103], v249 offset:8192
    s_waitcnt lgkmcnt(2)
    v_mfma_f32_16x16x32_bf16 v[68:71], v[200:203], v[40:43], v[68:71]
    v_exp_f32 v16, v16
    v_exp_f32 v17, v17
    v_exp_f32 v18, v18
    v_mfma_f32_16x16x32_bf16 v[12:15], v[92:95], v[40:43], v[12:15]
    v_exp_f32 v19, v19
    v_exp_f32 v20, v20
    v_exp_f32 v21, v21
    v_mfma_f32_16x16x32_bf16 v[32:35], v[108:111], v[64:67], v[48:51]
    v_exp_f32 v22, v22
    v_exp_f32 v23, v23
    v_cvt_pk_bf16_f32 v16, v16, v17
    v_mfma_f32_16x16x32_bf16 v[36:39], v[240:243], v[64:67], v[48:51]
    v_cvt_pk_bf16_f32 v17, v18, v19
    v_cvt_pk_bf16_f32 v18, v20, v21
    v_cvt_pk_bf16_f32 v19, v22, v23
    ds_read_b128 v[92:95], v249 offset:9216
    s_waitcnt lgkmcnt(2)
    v_mfma_f32_16x16x32_bf16 v[68:71], v[204:207], v[16:19], v[68:71]
    v_exp_f32 v24, v24
    v_exp_f32 v25, v25
    v_exp_f32 v26, v26
    v_mfma_f32_16x16x32_bf16 v[12:15], v[96:99], v[16:19], v[12:15]
    v_exp_f32 v27, v27
    v_exp_f32 v28, v28
    v_exp_f32 v29, v29
    v_mfma_f32_16x16x32_bf16 v[40:43], v[112:115], v[64:67], v[48:51]
    v_exp_f32 v30, v30
    v_exp_f32 v31, v31
    v_cvt_pk_bf16_f32 v24, v24, v25
    v_mfma_f32_16x16x32_bf16 v[44:47], v[172:175], v[64:67], v[48:51]
    v_cvt_pk_bf16_f32 v25, v26, v27
    v_cvt_pk_bf16_f32 v26, v28, v29
    v_cvt_pk_bf16_f32 v27, v30, v31
    ds_read_b128 v[96:99], v249 offset:10240
    s_waitcnt lgkmcnt(2)
    v_mfma_f32_16x16x32_bf16 v[68:71], v[176:179], v[24:27], v[68:71]
    v_exp_f32 v32, v32
    v_exp_f32 v33, v33
    v_exp_f32 v34, v34
    v_mfma_f32_16x16x32_bf16 v[12:15], v[100:103], v[24:27], v[12:15]
    v_exp_f32 v35, v35
    v_exp_f32 v36, v36
    v_exp_f32 v37, v37
    v_mfma_f32_16x16x32_bf16 v[16:19], v[116:119], v[64:67], v[48:51]
    v_exp_f32 v38, v38
    v_exp_f32 v39, v39
    v_cvt_pk_bf16_f32 v32, v32, v33
    v_mfma_f32_16x16x32_bf16 v[20:23], v[244:247], v[64:67], v[48:51]
    v_cvt_pk_bf16_f32 v33, v34, v35
    v_cvt_pk_bf16_f32 v34, v36, v37
    v_cvt_pk_bf16_f32 v35, v38, v39
    ds_read_b128 v[100:103], v249 offset:11264
    s_waitcnt lgkmcnt(2)
    v_mfma_f32_16x16x32_bf16 v[68:71], v[180:183], v[32:35], v[68:71]
    v_exp_f32 v40, v40
    v_exp_f32 v41, v41
    v_exp_f32 v42, v42
    v_exp_f32 v43, v43
    v_exp_f32 v44, v44
    v_exp_f32 v45, v45
    v_mfma_f32_16x16x32_bf16 v[12:15], v[92:95], v[32:35], v[12:15]
    v_exp_f32 v46, v46
    v_exp_f32 v47, v47
    v_cvt_pk_bf16_f32 v40, v40, v41
    v_cvt_pk_bf16_f32 v41, v42, v43
    v_cvt_pk_bf16_f32 v42, v44, v45
    v_cvt_pk_bf16_f32 v43, v46, v47
    s_waitcnt lgkmcnt(1)
    s_nop 0
    v_mfma_f32_16x16x32_bf16 v[68:71], v[184:187], v[40:43], v[68:71]
    v_exp_f32 v16, v16
    v_exp_f32 v17, v17
    v_exp_f32 v18, v18
    v_exp_f32 v19, v19
    v_cndmask_b32 v20, v20, v86, s[4:5]
    v_cndmask_b32 v21, v21, v86, s[6:7]
    v_cndmask_b32 v22, v22, v86, s[8:9]
    v_cndmask_b32 v23, v23, v86, s[10:11]
    v_mfma_f32_16x16x32_bf16 v[12:15], v[96:99], v[40:43], v[12:15]
    v_exp_f32 v20, v20
    v_exp_f32 v21, v21
    v_exp_f32 v22, v22
    v_exp_f32 v23, v23
    v_cvt_pk_bf16_f32 v16, v16, v17
    v_cvt_pk_bf16_f32 v17, v18, v19
    v_cvt_pk_bf16_f32 v18, v20, v21
    v_cvt_pk_bf16_f32 v19, v22, v23
    s_waitcnt lgkmcnt(0)
    s_nop 0
    v_mfma_f32_16x16x32_bf16 v[68:71], v[188:191], v[16:19], v[68:71]
    v_mfma_f32_16x16x32_bf16 v[12:15], v[100:103], v[16:19], v[12:15]
    s_nop 7
    s_nop 3
    s_cmp_eq_u32 s67, 0
    s_cbranch_scc1 L_cont7
    s_branch L_cont_neg7
L_att_done:
    s_setprio 0
    s_load_dwordx2 s[4:5], s[0:1], 56
    s_load_dwordx2 s[6:7], s[0:1], 16
    s_load_dwordx2 s[8:9], s[0:1], 0
    s_waitcnt lgkmcnt(0)
    v_min_u32 v248, 11, v1
    v_lshlrev_b32 v248, 2, v248
    v_and_b32 v249, 3, v1
    v_lshlrev_b32 v249, 2, v249
    s_lshl_b32 s66, s56, 6
    s_lshr_b32 s57, s56, 1
    s_add_u32 s57, s57, 4
    s_lshl_b32 s70, s57, 6
    s_and_b32 s57, s56, 1
    s_lshl_b32 s57, s57, 1
    s_and_b32 s58, s52, 1
    s_add_u32 s57, s57, s58
    s_cmp_eq_u32 s54, 0
    s_cselect_b32 s72, s53, s57
    s_cmp_lt_u32 s52, 6
    s_cselect_b32 s73, 1, 0
    s_cmp_eq_u32 s54, 0
    s_cselect_b32 s71, s66, s70
    s_lshr_b32 s69, s71, 7
    s_bfe_u32 s57, s71, 0x10006
    s_lshl_b32 s74, s57, 3
    s_lshl_b32 s57, s72, 1
    s_add_u32 s74, s74, s57
    s_add_u32 s75, s74, 1
    s_lshl_b32 s62, s55, 11
    s_add_u32 s62, s62, 65011712
    s_lshl_b32 s58, s69, 6
    s_add_u32 s63, s62, s58
    s_add_u32 s63, s63, 128
    s_lshl_b32 s57, s55, 2
    s_add_u32 s57, s57, s72
    s_mul_i32 s57, s57, 36864
    s_add_u32 s64, s57, s71
    s_add_u32 s65, s64, 32
    s_mov_b32 s44, s4
    s_mov_b32 s45, s5
    s_mov_b32 s46, 2359296
    s_mov_b32 s47, 0x20000
    s_mov_b32 s48, s6
    s_mov_b32 s49, s7
    s_mov_b32 s50, 663552
    s_mov_b32 s51, 0x20000
    s_mov_b32 s24, s8
    s_mov_b32 s25, s9
    s_mov_b32 s26, 2359296
    s_mov_b32 s27, 0x20000
    s_mov_b32 s68, 0xbfb8aa3b
    s_lshl_b32 s61, s52, 10
    v_lshrrev_b32 v12, 5, v1
    v_lshlrev_b32 v12, 8, v12
    v_bfe_u32 v13, v1, 2, 2
    v_lshl_add_u32 v12, v13, 6, v12
    v_bfe_u32 v13, v1, 4, 1
    v_lshl_add_u32 v12, v13, 5, v12
    v_and_b32 v13, 3, v1
    v_lshl_add_u32 v12, v13, 3, v12
    s_lshl_b32 s57, s54, 9
    v_add_u32 v5, s57, v12
    v_add_u32 v6, 49152, v5
    v_add_u32 v7, 98304, v5
    v_and_b32 v13, 31, v1
    v_mul_u32_u24 v13, 1152, v13
    v_lshrrev_b32 v250, 5, v1
    v_lshl_add_u32 v13, v250, 3, v13
    s_sub_u32 s57, s70, s66
    v_mul_lo_u32 v4, v250, s57
    v_bfe_u32 v250, v1, 2, 3
    v_mul_u32_u24 v250, 1152, v250
    v_add_u32 v4, v4, v250
    v_and_b32 v250, 3, v1
    v_lshl_add_u32 v4, v250, 4, v4
    v_bfe_u32 v250, v1, 4, 1
    v_mul_u32_u24 v250, 36864, v250
    v_add_u32 v3, v4, v250
    s_lshr_b32 s57, s52, 1
    s_mul_i32 s58, s57, 18
    s_and_b32 s59, s57, 1
    s_lshl_b32 s59, s59, 1
    s_add_u32 s58, s58, s59
    s_and_b32 s59, s52, 1
    s_lshl_b32 s60, s59, 3
    s_add_u32 s58, s58, s60
    s_mul_i32 s58, s58, 1152
    s_add_u32 s67, s58, s66
    s_mul_i32 s57, s57, 144
    s_mul_i32 s59, s59, 72
    s_add_u32 s57, s57, s59
    s_add_u32 s57, s57, 16
    s_mul_i32 s57, s57, 1152
    s_add_u32 s98, s57, s66
    buffer_load_dword v251, v249, s[36:39], s62 offen sc1
    buffer_load_dword v250, v248, s[36:39], s63 offen sc1
    s_barrier
    s_add_u32 m0, s61, 0
    s_add_u32 s60, s67, 0
    buffer_load_dwordx4 v4, s[48:51], s60 offen lds
    s_add_u32 m0, s61, 8192
    s_add_u32 s60, s67, 82944
    buffer_load_dwordx4 v4, s[48:51], s60 offen lds
    s_add_u32 m0, s61, 16384
    s_add_u32 s60, s67, 165888
    buffer_load_dwordx4 v4, s[48:51], s60 offen lds
    s_add_u32 m0, s61, 24576
    s_add_u32 s60, s67, 248832
    buffer_load_dwordx4 v4, s[48:51], s60 offen lds
    s_add_u32 m0, s61, 32768
    s_add_u32 s60, s67, 331776
    buffer_load_dwordx4 v4, s[48:51], s60 offen lds
    s_add_u32 m0, s61, 40960
    s_add_u32 s60, s67, 414720
    buffer_load_dwordx4 v4, s[48:51], s60 offen lds
    s_add_u32 m0, s61, 49152
    s_add_u32 s60, s67, 497664
    buffer_load_dwordx4 v4, s[48:51], s60 offen lds
    s_add_u32 m0, s61, 57344
    s_add_u32 s60, s67, 580608
    buffer_load_dwordx4 v4, s[48:51], s60 offen lds
    s_add_u32 m0, s61, 65536
    s_nop 0
    buffer_load_dwordx4 v3, s[48:51], s98 offen lds
    s_waitcnt vmcnt(9)
    s_barrier
    s_cmp_eq_u32 s52, 0
    s_cbranch_scc0 L_fl_o
    s_lshl_b32 s57, s55, 11
    s_lshl_b32 s58, s56, 2
    s_add_u32 s57, s57, s58
    s_add_u32 s57, s57, 65011712
    v_mov_b32 v82, 2
    v_mov_b32 v83, 0
    s_mov_b64 exec, 1
    buffer_store_dword v82, v83, s[36:39], s57 offen sc1
    s_mov_b64 exec, -1
L_fl_o:
    s_cmp_lg_u32 s73, 0
    s_cbranch_scc1 L_a_work
    s_waitcnt vmcnt(0)
    s_barrier
    s_branch L_a_fin
L_a_work:
    s_mov_b32 s59, 0
    s_branch L_sp_aea_c
L_sp_aea:
    buffer_load_dword v250, v248, s[36:39], s63 offen sc1
    s_add_u32 s59, s59, 1
    s_cmp_gt_u32 s59, 0x40000
    s_cbranch_scc1 L_sp_aea_x
    s_waitcnt vmcnt(0)
L_sp_aea_c:
    v_cmp_gt_u32 vcc, 1, v250
    s_cbranch_vccz L_sp_aea_x
    s_sleep 1
    s_branch L_sp_aea
L_sp_aea_x:
    s_mul_i32 s57, s55, 9
    s_add_u32 s57, s57, s69
    s_lshl_b32 s57, s57, 4
    s_add_u32 s57, s57, s74
    s_lshl_b32 s57, s57, 10
    s_add_u32 s57, s57, 18874368
    buffer_load_dwordx4 v[104:107], v2, s[36:39], s57 offen sc1
    s_add_u32 s57, s57, 2359296
    buffer_load_dwordx4 v[108:111], v2, s[36:39], s57 offen sc1
    s_add_u32 s57, s57, 2359296
    buffer_load_dwordx4 v[112:115], v2, s[36:39], s57 offen sc1
    s_add_u32 s57, s57, 2359296
    buffer_load_dwordx4 v[116:119], v2, s[36:39], s57 offen sc1
    s_add_u32 s57, s57, 2359296
    buffer_load_dwordx4 v[120:123], v2, s[36:39], s57 offen sc1
    s_add_u32 s57, s57, 2359296
    buffer_load_dwordx4 v[124:127], v2, s[36:39], s57 offen sc1
    s_add_u32 s57, s57, 2359296
    buffer_load_dwordx4 v[128:131], v2, s[36:39], s57 offen sc1
    s_add_u32 s57, s57, 2359296
    buffer_load_dwordx4 v[132:135], v2, s[36:39], s57 offen sc1
    s_add_u32 s57, s57, 2359296
    buffer_load_dwordx4 v[136:139], v2, s[36:39], s57 offen sc1
    s_add_u32 s57, s57, 2359296
    buffer_load_dwordx4 v[140:143], v2, s[36:39], s57 offen sc1
    s_add_u32 s57, s57, 2359296
    buffer_load_dwordx4 v[144:147], v2, s[36:39], s57 offen sc1
    s_add_u32 s57, s57, 2359296
    buffer_load_dwordx4 v[148:151], v2, s[36:39], s57 offen sc1
    buffer_load_dwordx2 v[40:41], v13, s[24:27], s64 offen
    buffer_load_dwordx2 v[42:43], v13, s[24:27], s64 offen offset:16
    s_mul_i32 s57, s55, 9
    s_add_u32 s57, s57, s69
    s_lshl_b32 s57, s57, 4
    s_add_u32 s57, s57, s75
    s_lshl_b32 s57, s57, 10
    s_add_u32 s57, s57, 18874368
    buffer_load_dwordx4 v[152:155], v2, s[36:39], s57 offen sc1
    s_add_u32 s57, s57, 2359296
    buffer_load_dwordx4 v[156:159], v2, s[36:39], s57 offen sc1
    s_add_u32 s57, s57, 2359296
    buffer_load_dwordx4 v[160:163], v2, s[36:39], s57 offen sc1
    s_add_u32 s57, s57, 2359296
    buffer_load_dwordx4 v[164:167], v2, s[36:39], s57 offen sc1
    s_add_u32 s57, s57, 2359296
    buffer_load_dwordx4 v[168:171], v2, s[36:39], s57 offen sc1
    s_add_u32 s57, s57, 2359296
    buffer_load_dwordx4 v[172:175], v2, s[36:39], s57 offen sc1
    s_add_u32 s57, s57, 2359296
    buffer_load_dwordx4 v[176:179], v2, s[36:39], s57 offen sc1
    s_add_u32 s57, s57, 2359296
    buffer_load_dwordx4 v[180:183], v2, s[36:39], s57 offen sc1
    s_add_u32 s57, s57, 2359296
    buffer_load_dwordx4 v[184:187], v2, s[36:39], s57 offen sc1
    s_add_u32 s57, s57, 2359296
    buffer_load_dwordx4 v[188:191], v2, s[36:39], s57 offen sc1
    s_add_u32 s57, s57, 2359296
    buffer_load_dwordx4 v[192:195], v2, s[36:39], s57 offen sc1
    s_add_u32 s57, s57, 2359296
    buffer_load_dwordx4 v[196:199], v2, s[36:39], s57 offen sc1
    buffer_load_dwordx2 v[44:45], v13, s[24:27], s65 offen
    buffer_load_dwordx2 v[46:47], v13, s[24:27], s65 offen offset:16
    buffer_load_dword v251, v249, s[36:39], s62 offen sc1
    s_waitcnt vmcnt(0)
    s_barrier
    s_mov_b32 s59, 0
    s_branch L_sp_aoa_c
L_sp_aoa:
    buffer_load_dword v251, v249, s[36:39], s62 offen sc1
    s_add_u32 s59, s59, 1
    s_cmp_gt_u32 s59, 0x40000
    s_cbranch_scc1 L_sp_aoa_x
    s_waitcnt vmcnt(0)
L_sp_aoa_c:
    v_cmp_gt_u32 vcc, 2, v251
    s_cbranch_vccz L_sp_aoa_x
    s_sleep 1
    s_branch L_sp_aoa
L_sp_aoa_x:
    s_lshl_b32 s57, s55, 2
    s_add_u32 s57, s57, s72
    s_mul_i32 s57, s57, 36864
    s_add_u32 s57, s57, 59793408
    buffer_load_dwordx4 v[200:203], v2, s[36:39], s57 offen offset:0 sc1
    buffer_load_dwordx4 v[204:207], v2, s[36:39], s57 offen offset:1024 sc1
    buffer_load_dwordx4 v[208:211], v2, s[36:39], s57 offen offset:2048 sc1
    buffer_load_dwordx4 v[212:215], v2, s[36:39], s57 offen offset:3072 sc1
    s_add_u32 s57, s57, 4096
    buffer_load_dwordx4 v[216:219], v2, s[36:39], s57 offen offset:0 sc1
    buffer_load_dwordx4 v[220:223], v2, s[36:39], s57 offen offset:1024 sc1
    buffer_load_dwordx4 v[224:227], v2, s[36:39], s57 offen offset:2048 sc1
    buffer_load_dwordx4 v[228:231], v2, s[36:39], s57 offen offset:3072 sc1
    s_add_u32 s57, s57, 4096
    buffer_load_dwordx4 v[232:235], v2, s[36:39], s57 offen offset:0 sc1
    buffer_load_dwordx4 v[236:239], v2, s[36:39], s57 offen offset:1024 sc1
    buffer_load_dwordx4 v[240:243], v2, s[36:39], s57 offen offset:2048 sc1
    buffer_load_dwordx4 v[244:247], v2, s[36:39], s57 offen offset:3072 sc1
    v_lshlrev_b32 v48, 16, v104
    v_and_b32 v49, 0xffff0000, v104
    v_lshlrev_b32 v50, 16, v105
    v_and_b32 v51, 0xffff0000, v105
    v_lshlrev_b32 v52, 16, v106
    v_and_b32 v53, 0xffff0000, v106
    v_lshlrev_b32 v54, 16, v107
    v_and_b32 v55, 0xffff0000, v107
    v_lshlrev_b32 v64, 16, v108
    v_and_b32 v65, 0xffff0000, v108
    v_lshlrev_b32 v66, 16, v109
    v_and_b32 v67, 0xffff0000, v109
    v_lshlrev_b32 v68, 16, v110
    v_and_b32 v69, 0xffff0000, v110
    v_lshlrev_b32 v70, 16, v111
    v_and_b32 v71, 0xffff0000, v111
    v_add_f32 v48, v48, v64
    v_add_f32 v49, v49, v65
    v_add_f32 v50, v50, v66
    v_add_f32 v51, v51, v67
    v_add_f32 v52, v52, v68
    v_add_f32 v53, v53, v69
    v_add_f32 v54, v54, v70
    v_add_f32 v55, v55, v71
    v_lshlrev_b32 v64, 16, v112
    v_and_b32 v65, 0xffff0000, v112
    v_lshlrev_b32 v66, 16, v113
    v_and_b32 v67, 0xffff0000, v113
    v_lshlrev_b32 v68, 16, v114
    v_and_b32 v69, 0xffff0000, v114
    v_lshlrev_b32 v70, 16, v115
    v_and_b32 v71, 0xffff0000, v115
    v_add_f32 v48, v48, v64
    v_add_f32 v49, v49, v65
    v_add_f32 v50, v50, v66
    v_add_f32 v51, v51, v67
    v_add_f32 v52, v52, v68
    v_add_f32 v53, v53, v69
    v_add_f32 v54, v54, v70
    v_add_f32 v55, v55, v71
    v_lshlrev_b32 v64, 16, v116
    v_and_b32 v65, 0xffff0000, v116
    v_lshlrev_b32 v66, 16, v117
    v_and_b32 v67, 0xffff0000, v117
    v_lshlrev_b32 v68, 16, v118
    v_and_b32 v69, 0xffff0000, v118
    v_lshlrev_b32 v70, 16, v119
    v_and_b32 v71, 0xffff0000, v119
    v_add_f32 v48, v48, v64
    v_add_f32 v49, v49, v65
    v_add_f32 v50, v50, v66
    v_add_f32 v51, v51, v67
    v_add_f32 v52, v52, v68
    v_add_f32 v53, v53, v69
    v_add_f32 v54, v54, v70
    v_add_f32 v55, v55, v71
    v_lshlrev_b32 v64, 16, v120
    v_and_b32 v65, 0xffff0000, v120
    v_lshlrev_b32 v66, 16, v121
    v_and_b32 v67, 0xffff0000, v121
    v_lshlrev_b32 v68, 16, v122
    v_and_b32 v69, 0xffff0000, v122
    v_lshlrev_b32 v70, 16, v123
    v_and_b32 v71, 0xffff0000, v123
    v_add_f32 v48, v48, v64
    v_add_f32 v49, v49, v65
    v_add_f32 v50, v50, v66
    v_add_f32 v51, v51, v67
    v_add_f32 v52, v52, v68
    v_add_f32 v53, v53, v69
    v_add_f32 v54, v54, v70
    v_add_f32 v55, v55, v71
    v_lshlrev_b32 v64, 16, v124
    v_and_b32 v65, 0xffff0000, v124
    v_lshlrev_b32 v66, 16, v125
    v_and_b32 v67, 0xffff0000, v125
    v_lshlrev_b32 v68, 16, v126
    v_and_b32 v69, 0xffff0000, v126
    v_lshlrev_b32 v70, 16, v127
    v_and_b32 v71, 0xffff0000, v127
    v_add_f32 v48, v48, v64
    v_add_f32 v49, v49, v65
    v_add_f32 v50, v50, v66
    v_add_f32 v51, v51, v67
    v_add_f32 v52, v52, v68
    v_add_f32 v53, v53, v69
    v_add_f32 v54, v54, v70
    v_add_f32 v55, v55, v71
    v_lshlrev_b32 v64, 16, v128
    v_and_b32 v65, 0xffff0000, v128
    v_lshlrev_b32 v66, 16, v129
    v_and_b32 v67, 0xffff0000, v129
    v_lshlrev_b32 v68, 16, v130
    v_and_b32 v69, 0xffff0000, v130
    v_lshlrev_b32 v70, 16, v131
    v_and_b32 v71, 0xffff0000, v131
    v_add_f32 v48, v48, v64
    v_add_f32 v49, v49, v65
    v_add_f32 v50, v50, v66
    v_add_f32 v51, v51, v67
    v_add_f32 v52, v52, v68
    v_add_f32 v53, v53, v69
    v_add_f32 v54, v54, v70
    v_add_f32 v55, v55, v71
    v_lshlrev_b32 v64, 16, v132
    v_and_b32 v65, 0xffff0000, v132
    v_lshlrev_b32 v66, 16, v133
    v_and_b32 v67, 0xffff0000, v133
    v_lshlrev_b32 v68, 16, v134
    v_and_b32 v69, 0xffff0000, v134
    v_lshlrev_b32 v70, 16, v135
    v_and_b32 v71, 0xffff0000, v135
    v_add_f32 v48, v48, v64
    v_add_f32 v49, v49, v65
    v_add_f32 v50, v50, v66
    v_add_f32 v51, v51, v67
    v_add_f32 v52, v52, v68
    v_add_f32 v53, v53, v69
    v_add_f32 v54, v54, v70
    v_add_f32 v55, v55, v71
    v_lshlrev_b32 v64, 16, v136
    v_and_b32 v65, 0xffff0000, v136
    v_lshlrev_b32 v66, 16, v137
    v_and_b32 v67, 0xffff0000, v137
    v_lshlrev_b32 v68, 16, v138
    v_and_b32 v69, 0xffff0000, v138
    v_lshlrev_b32 v70, 16, v139
    v_and_b32 v71, 0xffff0000, v139
    v_add_f32 v48, v48, v64
    v_add_f32 v49, v49, v65
    v_add_f32 v50, v50, v66
    v_add_f32 v51, v51, v67
    v_add_f32 v52, v52, v68
    v_add_f32 v53, v53, v69
    v_add_f32 v54, v54, v70
    v_add_f32 v55, v55, v71
    v_lshlrev_b32 v64, 16, v140
    v_and_b32 v65, 0xffff0000, v140
    v_lshlrev_b32 v66, 16, v141
    v_and_b32 v67, 0xffff0000, v141
    v_lshlrev_b32 v68, 16, v142
    v_and_b32 v69, 0xffff0000, v142
    v_lshlrev_b32 v70, 16, v143
    v_and_b32 v71, 0xffff0000, v143
    v_add_f32 v48, v48, v64
    v_add_f32 v49, v49, v65
    v_add_f32 v50, v50, v66
    v_add_f32 v51, v51, v67
    v_add_f32 v52, v52, v68
    v_add_f32 v53, v53, v69
    v_add_f32 v54, v54, v70
    v_add_f32 v55, v55, v71
    v_lshlrev_b32 v64, 16, v144
    v_and_b32 v65, 0xffff0000, v144
    v_lshlrev_b32 v66, 16, v145
    v_and_b32 v67, 0xffff0000, v145
    v_lshlrev_b32 v68, 16, v146
    v_and_b32 v69, 0xffff0000, v146
    v_lshlrev_b32 v70, 16, v147
    v_and_b32 v71, 0xffff0000, v147
    v_add_f32 v48, v48, v64
    v_add_f32 v49, v49, v65
    v_add_f32 v50, v50, v66
    v_add_f32 v51, v51, v67
    v_add_f32 v52, v52, v68
    v_add_f32 v53, v53, v69
    v_add_f32 v54, v54, v70
    v_add_f32 v55, v55, v71
    v_lshlrev_b32 v64, 16, v148
    v_and_b32 v65, 0xffff0000, v148
    v_lshlrev_b32 v66, 16, v149
    v_and_b32 v67, 0xffff0000, v149
    v_lshlrev_b32 v68, 16, v150
    v_and_b32 v69, 0xffff0000, v150
    v_lshlrev_b32 v70, 16, v151
    v_and_b32 v71, 0xffff0000, v151
    v_add_f32 v48, v48, v64
    v_add_f32 v49, v49, v65
    v_add_f32 v50, v50, v66
    v_add_f32 v51, v51, v67
    v_add_f32 v52, v52, v68
    v_add_f32 v53, v53, v69
    v_add_f32 v54, v54, v70
    v_add_f32 v55, v55, v71
    v_cvt_pk_bf16_f32 v72, v48, v49
    v_cvt_pk_bf16_f32 v73, v50, v51
    v_cvt_pk_bf16_f32 v74, v52, v53
    v_cvt_pk_bf16_f32 v75, v54, v55
    v_lshlrev_b32 v48, 16, v72
    v_and_b32 v49, 0xffff0000, v72
    v_lshlrev_b32 v50, 16, v73
    v_and_b32 v51, 0xffff0000, v73
    v_lshlrev_b32 v52, 16, v74
    v_and_b32 v53, 0xffff0000, v74
    v_lshlrev_b32 v54, 16, v75
    v_and_b32 v55, 0xffff0000, v75
    v_mul_f32 v64, s68, v48
    v_mul_f32 v65, s68, v49
    v_mul_f32 v66, s68, v50
    v_mul_f32 v67, s68, v51
    v_mul_f32 v68, s68, v52
    v_mul_f32 v69, s68, v53
    v_mul_f32 v70, s68, v54
    v_mul_f32 v71, s68, v55
    v_exp_f32 v64, v64
    v_exp_f32 v65, v65
    v_exp_f32 v66, v66
    v_exp_f32 v67, v67
    v_exp_f32 v68, v68
    v_exp_f32 v69, v69
    v_exp_f32 v70, v70
    v_exp_f32 v71, v71
    v_add_f32 v64, 1.0, v64
    v_add_f32 v65, 1.0, v65
    v_add_f32 v66, 1.0, v66
    v_add_f32 v67, 1.0, v67
    v_add_f32 v68, 1.0, v68
    v_add_f32 v69, 1.0, v69
    v_add_f32 v70, 1.0, v70
    v_add_f32 v71, 1.0, v71
    v_rcp_f32 v64, v64
    v_rcp_f32 v65, v65
    v_rcp_f32 v66, v66
    v_rcp_f32 v67, v67
    v_rcp_f32 v68, v68
    v_rcp_f32 v69, v69
    v_rcp_f32 v70, v70
    v_rcp_f32 v71, v71
    v_mul_f32 v48, v48, v64
    v_mul_f32 v49, v49, v65
    v_mul_f32 v50, v50, v66
    v_mul_f32 v51, v51, v67
    v_mul_f32 v52, v52, v68
    v_mul_f32 v53, v53, v69
    v_mul_f32 v54, v54, v70
    v_mul_f32 v55, v55, v71
    v_cvt_pk_bf16_f32 v72, v48, v49
    v_cvt_pk_bf16_f32 v73, v50, v51
    v_cvt_pk_bf16_f32 v74, v52, v53
    v_cvt_pk_bf16_f32 v75, v54, v55
    v_lshlrev_b32 v48, 16, v72
    v_and_b32 v49, 0xffff0000, v72
    v_lshlrev_b32 v50, 16, v73
    v_and_b32 v51, 0xffff0000, v73
    v_lshlrev_b32 v52, 16, v74
    v_and_b32 v53, 0xffff0000, v74
    v_lshlrev_b32 v54, 16, v75
    v_and_b32 v55, 0xffff0000, v75
    s_lshl_b32 s57, s55, 2
    s_add_u32 s57, s57, s72
    s_mul_i32 s57, s57, 36864
    s_add_u32 s57, s57, 59768832
    buffer_load_dwordx4 v[104:107], v2, s[36:39], s57 offen offset:0 sc1
    buffer_load_dwordx4 v[108:111], v2, s[36:39], s57 offen offset:1024 sc1
    buffer_load_dwordx4 v[112:115], v2, s[36:39], s57 offen offset:2048 sc1
    buffer_load_dwordx4 v[116:119], v2, s[36:39], s57 offen offset:3072 sc1
    s_add_u32 s57, s57, 4096
    buffer_load_dwordx4 v[120:123], v2, s[36:39], s57 offen offset:0 sc1
    buffer_load_dwordx4 v[124:127], v2, s[36:39], s57 offen offset:1024 sc1
    buffer_load_dwordx4 v[128:131], v2, s[36:39], s57 offen offset:2048 sc1
    buffer_load_dwordx4 v[132:135], v2, s[36:39], s57 offen offset:3072 sc1
    s_add_u32 s57, s57, 4096
    buffer_load_dwordx4 v[136:139], v2, s[36:39], s57 offen offset:0 sc1
    buffer_load_dwordx4 v[140:143], v2, s[36:39], s57 offen offset:1024 sc1
    buffer_load_dwordx4 v[144:147], v2, s[36:39], s57 offen offset:2048 sc1
    buffer_load_dwordx4 v[148:151], v2, s[36:39], s57 offen offset:3072 sc1
    v_lshlrev_b32 v56, 16, v152
    v_and_b32 v57, 0xffff0000, v152
    v_lshlrev_b32 v58, 16, v153
    v_and_b32 v59, 0xffff0000, v153
    v_lshlrev_b32 v60, 16, v154
    v_and_b32 v61, 0xffff0000, v154
    v_lshlrev_b32 v62, 16, v155
    v_and_b32 v63, 0xffff0000, v155
    v_lshlrev_b32 v64, 16, v156
    v_and_b32 v65, 0xffff0000, v156
    v_lshlrev_b32 v66, 16, v157
    v_and_b32 v67, 0xffff0000, v157
    v_lshlrev_b32 v68, 16, v158
    v_and_b32 v69, 0xffff0000, v158
    v_lshlrev_b32 v70, 16, v159
    v_and_b32 v71, 0xffff0000, v159
    v_add_f32 v56, v56, v64
    v_add_f32 v57, v57, v65
    v_add_f32 v58, v58, v66
    v_add_f32 v59, v59, v67
    v_add_f32 v60, v60, v68
    v_add_f32 v61, v61, v69
    v_add_f32 v62, v62, v70
    v_add_f32 v63, v63, v71
    v_lshlrev_b32 v64, 16, v160
    v_and_b32 v65, 0xffff0000, v160
    v_lshlrev_b32 v66, 16, v161
    v_and_b32 v67, 0xffff0000, v161
    v_lshlrev_b32 v68, 16, v162
    v_and_b32 v69, 0xffff0000, v162
    v_lshlrev_b32 v70, 16, v163
    v_and_b32 v71, 0xffff0000, v163
    v_add_f32 v56, v56, v64
    v_add_f32 v57, v57, v65
    v_add_f32 v58, v58, v66
    v_add_f32 v59, v59, v67
    v_add_f32 v60, v60, v68
    v_add_f32 v61, v61, v69
    v_add_f32 v62, v62, v70
    v_add_f32 v63, v63, v71
    v_lshlrev_b32 v64, 16, v164
    v_and_b32 v65, 0xffff0000, v164
    v_lshlrev_b32 v66, 16, v165
    v_and_b32 v67, 0xffff0000, v165
    v_lshlrev_b32 v68, 16, v166
    v_and_b32 v69, 0xffff0000, v166
    v_lshlrev_b32 v70, 16, v167
    v_and_b32 v71, 0xffff0000, v167
    v_add_f32 v56, v56, v64
    v_add_f32 v57, v57, v65
    v_add_f32 v58, v58, v66
    v_add_f32 v59, v59, v67
    v_add_f32 v60, v60, v68
    v_add_f32 v61, v61, v69
    v_add_f32 v62, v62, v70
    v_add_f32 v63, v63, v71
    v_lshlrev_b32 v64, 16, v168
    v_and_b32 v65, 0xffff0000, v168
    v_lshlrev_b32 v66, 16, v169
    v_and_b32 v67, 0xffff0000, v169
    v_lshlrev_b32 v68, 16, v170
    v_and_b32 v69, 0xffff0000, v170
    v_lshlrev_b32 v70, 16, v171
    v_and_b32 v71, 0xffff0000, v171
    v_add_f32 v56, v56, v64
    v_add_f32 v57, v57, v65
    v_add_f32 v58, v58, v66
    v_add_f32 v59, v59, v67
    v_add_f32 v60, v60, v68
    v_add_f32 v61, v61, v69
    v_add_f32 v62, v62, v70
    v_add_f32 v63, v63, v71
    v_lshlrev_b32 v64, 16, v172
    v_and_b32 v65, 0xffff0000, v172
    v_lshlrev_b32 v66, 16, v173
    v_and_b32 v67, 0xffff0000, v173
    v_lshlrev_b32 v68, 16, v174
    v_and_b32 v69, 0xffff0000, v174
    v_lshlrev_b32 v70, 16, v175
    v_and_b32 v71, 0xffff0000, v175
    v_add_f32 v56, v56, v64
    v_add_f32 v57, v57, v65
    v_add_f32 v58, v58, v66
    v_add_f32 v59, v59, v67
    v_add_f32 v60, v60, v68
    v_add_f32 v61, v61, v69
    v_add_f32 v62, v62, v70
    v_add_f32 v63, v63, v71
    v_lshlrev_b32 v64, 16, v176
    v_and_b32 v65, 0xffff0000, v176
    v_lshlrev_b32 v66, 16, v177
    v_and_b32 v67, 0xffff0000, v177
    v_lshlrev_b32 v68, 16, v178
    v_and_b32 v69, 0xffff0000, v178
    v_lshlrev_b32 v70, 16, v179
    v_and_b32 v71, 0xffff0000, v179
    v_add_f32 v56, v56, v64
    v_add_f32 v57, v57, v65
    v_add_f32 v58, v58, v66
    v_add_f32 v59, v59, v67
    v_add_f32 v60, v60, v68
    v_add_f32 v61, v61, v69
    v_add_f32 v62, v62, v70
    v_add_f32 v63, v63, v71
    v_lshlrev_b32 v64, 16, v180
    v_and_b32 v65, 0xffff0000, v180
    v_lshlrev_b32 v66, 16, v181
    v_and_b32 v67, 0xffff0000, v181
    v_lshlrev_b32 v68, 16, v182
    v_and_b32 v69, 0xffff0000, v182
    v_lshlrev_b32 v70, 16, v183
    v_and_b32 v71, 0xffff0000, v183
    v_add_f32 v56, v56, v64
    v_add_f32 v57, v57, v65
    v_add_f32 v58, v58, v66
    v_add_f32 v59, v59, v67
    v_add_f32 v60, v60, v68
    v_add_f32 v61, v61, v69
    v_add_f32 v62, v62, v70
    v_add_f32 v63, v63, v71
    v_lshlrev_b32 v64, 16, v184
    v_and_b32 v65, 0xffff0000, v184
    v_lshlrev_b32 v66, 16, v185
    v_and_b32 v67, 0xffff0000, v185
    v_lshlrev_b32 v68, 16, v186
    v_and_b32 v69, 0xffff0000, v186
    v_lshlrev_b32 v70, 16, v187
    v_and_b32 v71, 0xffff0000, v187
    v_add_f32 v56, v56, v64
    v_add_f32 v57, v57, v65
    v_add_f32 v58, v58, v66
    v_add_f32 v59, v59, v67
    v_add_f32 v60, v60, v68
    v_add_f32 v61, v61, v69
    v_add_f32 v62, v62, v70
    v_add_f32 v63, v63, v71
    v_lshlrev_b32 v64, 16, v188
    v_and_b32 v65, 0xffff0000, v188
    v_lshlrev_b32 v66, 16, v189
    v_and_b32 v67, 0xffff0000, v189
    v_lshlrev_b32 v68, 16, v190
    v_and_b32 v69, 0xffff0000, v190
    v_lshlrev_b32 v70, 16, v191
    v_and_b32 v71, 0xffff0000, v191
    v_add_f32 v56, v56, v64
    v_add_f32 v57, v57, v65
    v_add_f32 v58, v58, v66
    v_add_f32 v59, v59, v67
    v_add_f32 v60, v60, v68
    v_add_f32 v61, v61, v69
    v_add_f32 v62, v62, v70
    v_add_f32 v63, v63, v71
    v_lshlrev_b32 v64, 16, v192
    v_and_b32 v65, 0xffff0000, v192
    v_lshlrev_b32 v66, 16, v193
    v_and_b32 v67, 0xffff0000, v193
    v_lshlrev_b32 v68, 16, v194
    v_and_b32 v69, 0xffff0000, v194
    v_lshlrev_b32 v70, 16, v195
    v_and_b32 v71, 0xffff0000, v195
    v_add_f32 v56, v56, v64
    v_add_f32 v57, v57, v65
    v_add_f32 v58, v58, v66
    v_add_f32 v59, v59, v67
    v_add_f32 v60, v60, v68
    v_add_f32 v61, v61, v69
    v_add_f32 v62, v62, v70
    v_add_f32 v63, v63, v71
    v_lshlrev_b32 v64, 16, v196
    v_and_b32 v65, 0xffff0000, v196
    v_lshlrev_b32 v66, 16, v197
    v_and_b32 v67, 0xffff0000, v197
    v_lshlrev_b32 v68, 16, v198
    v_and_b32 v69, 0xffff0000, v198
    v_lshlrev_b32 v70, 16, v199
    v_and_b32 v71, 0xffff0000, v199
    v_add_f32 v56, v56, v64
    v_add_f32 v57, v57, v65
    v_add_f32 v58, v58, v66
    v_add_f32 v59, v59, v67
    v_add_f32 v60, v60, v68
    v_add_f32 v61, v61, v69
    v_add_f32 v62, v62, v70
    v_add_f32 v63, v63, v71
    v_cvt_pk_bf16_f32 v72, v56, v57
    v_cvt_pk_bf16_f32 v73, v58, v59
    v_cvt_pk_bf16_f32 v74, v60, v61
    v_cvt_pk_bf16_f32 v75, v62, v63
    v_lshlrev_b32 v56, 16, v72
    v_and_b32 v57, 0xffff0000, v72
    v_lshlrev_b32 v58, 16, v73
    v_and_b32 v59, 0xffff0000, v73
    v_lshlrev_b32 v60, 16, v74
    v_and_b32 v61, 0xffff0000, v74
    v_lshlrev_b32 v62, 16, v75
    v_and_b32 v63, 0xffff0000, v75
    v_mul_f32 v64, s68, v56
    v_mul_f32 v65, s68, v57
    v_mul_f32 v66, s68, v58
    v_mul_f32 v67, s68, v59
    v_mul_f32 v68, s68, v60
    v_mul_f32 v69, s68, v61
    v_mul_f32 v70, s68, v62
    v_mul_f32 v71, s68, v63
    v_exp_f32 v64, v64
    v_exp_f32 v65, v65
    v_exp_f32 v66, v66
    v_exp_f32 v67, v67
    v_exp_f32 v68, v68
    v_exp_f32 v69, v69
    v_exp_f32 v70, v70
    v_exp_f32 v71, v71
    v_add_f32 v64, 1.0, v64
    v_add_f32 v65, 1.0, v65
    v_add_f32 v66, 1.0, v66
    v_add_f32 v67, 1.0, v67
    v_add_f32 v68, 1.0, v68
    v_add_f32 v69, 1.0, v69
    v_add_f32 v70, 1.0, v70
    v_add_f32 v71, 1.0, v71
    v_rcp_f32 v64, v64
    v_rcp_f32 v65, v65
    v_rcp_f32 v66, v66
    v_rcp_f32 v67, v67
    v_rcp_f32 v68, v68
    v_rcp_f32 v69, v69
    v_rcp_f32 v70, v70
    v_rcp_f32 v71, v71
    v_mul_f32 v56, v56, v64
    v_mul_f32 v57, v57, v65
    v_mul_f32 v58, v58, v66
    v_mul_f32 v59, v59, v67
    v_mul_f32 v60, v60, v68
    v_mul_f32 v61, v61, v69
    v_mul_f32 v62, v62, v70
    v_mul_f32 v63, v63, v71
    v_cvt_pk_bf16_f32 v72, v56, v57
    v_cvt_pk_bf16_f32 v73, v58, v59
    v_cvt_pk_bf16_f32 v74, v60, v61
    v_cvt_pk_bf16_f32 v75, v62, v63
    v_lshlrev_b32 v56, 16, v72
    v_and_b32 v57, 0xffff0000, v72
    v_lshlrev_b32 v58, 16, v73
    v_and_b32 v59, 0xffff0000, v73
    v_lshlrev_b32 v60, 16, v74
    v_and_b32 v61, 0xffff0000, v74
    v_lshlrev_b32 v62, 16, v75
    v_and_b32 v63, 0xffff0000, v75
    s_lshl_b32 s57, s55, 2
    s_add_u32 s57, s57, s72
    s_mul_i32 s57, s57, 36864
    s_add_u32 s57, s57, 59781120
    buffer_load_dwordx4 v[152:155], v2, s[36:39], s57 offen offset:0 sc1
    buffer_load_dwordx4 v[156:159], v2, s[36:39], s57 offen offset:1024 sc1
    buffer_load_dwordx4 v[160:163], v2, s[36:39], s57 offen offset:2048 sc1
    buffer_load_dwordx4 v[164:167], v2, s[36:39], s57 offen offset:3072 sc1
    s_add_u32 s57, s57, 4096
    buffer_load_dwordx4 v[168:171], v2, s[36:39], s57 offen offset:0 sc1
    buffer_load_dwordx4 v[172:175], v2, s[36:39], s57 offen offset:1024 sc1
    buffer_load_dwordx4 v[176:179], v2, s[36:39], s57 offen offset:2048 sc1
    buffer_load_dwordx4 v[180:183], v2, s[36:39], s57 offen offset:3072 sc1
    s_add_u32 s57, s57, 4096
    buffer_load_dwordx4 v[184:187], v2, s[36:39], s57 offen offset:0 sc1
    buffer_load_dwordx4 v[188:191], v2, s[36:39], s57 offen offset:1024 sc1
    buffer_load_dwordx4 v[192:195], v2, s[36:39], s57 offen offset:2048 sc1
    buffer_load_dwordx4 v[196:199], v2, s[36:39], s57 offen offset:3072 sc1
    ds_read_b64_tr_b16 v[16:17], v6 offset:0
    ds_read_b64_tr_b16 v[18:19], v6 offset:1024
    ds_read_b64_tr_b16 v[20:21], v6 offset:2048
    ds_read_b64_tr_b16 v[22:23], v6 offset:3072
    ds_read_b64_tr_b16 v[24:25], v6 offset:4096
    ds_read_b64_tr_b16 v[26:27], v6 offset:5120
    ds_read_b64_tr_b16 v[28:29], v6 offset:6144
    ds_read_b64_tr_b16 v[30:31], v6 offset:7168
    s_waitcnt vmcnt(35)
    s_waitcnt lgkmcnt(6)
    v_mfma_f32_32x32x16_bf16 v[88:103], v[16:19], v[200:203], 0
    ds_read_b64_tr_b16 v[32:33], v6 offset:8192
    ds_read_b64_tr_b16 v[34:35], v6 offset:9216
    s_waitcnt vmcnt(34)
    s_waitcnt lgkmcnt(6)
    v_mfma_f32_32x32x16_bf16 v[88:103], v[20:23], v[204:207], v[88:103]
    ds_read_b64_tr_b16 v[36:37], v6 offset:10240
    ds_read_b64_tr_b16 v[38:39], v6 offset:11264
    s_waitcnt vmcnt(33)
    s_waitcnt lgkmcnt(6)
    v_mfma_f32_32x32x16_bf16 v[88:103], v[24:27], v[208:211], v[88:103]
    ds_read_b64_tr_b16 v[16:17], v6 offset:12288
    ds_read_b64_tr_b16 v[18:19], v6 offset:13312
    s_waitcnt vmcnt(32)
    s_waitcnt lgkmcnt(6)
    v_mfma_f32_32x32x16_bf16 v[88:103], v[28:31], v[212:215], v[88:103]
    ds_read_b64_tr_b16 v[20:21], v6 offset:14336
    ds_read_b64_tr_b16 v[22:23], v6 offset:15360
    s_waitcnt vmcnt(31)
    s_waitcnt lgkmcnt(6)
    v_mfma_f32_32x32x16_bf16 v[88:103], v[32:35], v[216:219], v[88:103]
    ds_read_b64_tr_b16 v[24:25], v6 offset:16384
    ds_read_b64_tr_b16 v[26:27], v6 offset:17408
    s_waitcnt vmcnt(30)
    s_waitcnt lgkmcnt(6)
    v_mfma_f32_32x32x16_bf16 v[88:103], v[36:39], v[220:223], v[88:103]
    ds_read_b64_tr_b16 v[28:29], v6 offset:18432
    ds_read_b64_tr_b16 v[30:31], v6 offset:19456
    s_waitcnt vmcnt(29)
    s_waitcnt lgkmcnt(6)
    v_mfma_f32_32x32x16_bf16 v[88:103], v[16:19], v[224:227], v[88:103]
    ds_read_b64_tr_b16 v[32:33], v6 offset:20480
    ds_read_b64_tr_b16 v[34:35], v6 offset:21504
    s_waitcnt vmcnt(28)
    s_waitcnt lgkmcnt(6)
    v_mfma_f32_32x32x16_bf16 v[88:103], v[20:23], v[228:231], v[88:103]
    ds_read_b64_tr_b16 v[36:37], v6 offset:22528
    ds_read_b64_tr_b16 v[38:39], v6 offset:23552
    s_waitcnt vmcnt(27)
    s_waitcnt lgkmcnt(6)
    v_mfma_f32_32x32x16_bf16 v[88:103], v[24:27], v[232:235], v[88:103]
    ds_read_b64_tr_b16 v[16:17], v5 offset:0
    ds_read_b64_tr_b16 v[18:19], v5 offset:1024
    s_waitcnt vmcnt(26)
    s_waitcnt lgkmcnt(6)
    v_mfma_f32_32x32x16_bf16 v[88:103], v[28:31], v[236:239], v[88:103]
    ds_read_b64_tr_b16 v[20:21], v5 offset:2048
    ds_read_b64_tr_b16 v[22:23], v5 offset:3072
    s_waitcnt vmcnt(25)
    s_waitcnt lgkmcnt(6)
    v_mfma_f32_32x32x16_bf16 v[88:103], v[32:35], v[240:243], v[88:103]
    ds_read_b64_tr_b16 v[24:25], v5 offset:4096
    ds_read_b64_tr_b16 v[26:27], v5 offset:5120
    s_waitcnt vmcnt(24)
    s_waitcnt lgkmcnt(6)
    v_mfma_f32_32x32x16_bf16 v[88:103], v[36:39], v[244:247], v[88:103]
    ds_read_b64_tr_b16 v[28:29], v5 offset:6144
    ds_read_b64_tr_b16 v[30:31], v5 offset:7168
    s_waitcnt vmcnt(23)
    s_waitcnt lgkmcnt(6)
    v_mfma_f32_32x32x16_bf16 v[88:103], v[16:19], v[104:107], v[88:103]
    ds_read_b64_tr_b16 v[32:33], v5 offset:8192
    ds_read_b64_tr_b16 v[34:35], v5 offset:9216
    s_waitcnt vmcnt(22)
    s_waitcnt lgkmcnt(6)
    v_mfma_f32_32x32x16_bf16 v[88:103], v[20:23], v[108:111], v[88:103]
    ds_read_b64_tr_b16 v[36:37], v5 offset:10240
    ds_read_b64_tr_b16 v[38:39], v5 offset:11264
    s_waitcnt vmcnt(21)
    s_waitcnt lgkmcnt(6)
    v_mfma_f32_32x32x16_bf16 v[88:103], v[24:27], v[112:115], v[88:103]
    ds_read_b64_tr_b16 v[16:17], v5 offset:12288
    ds_read_b64_tr_b16 v[18:19], v5 offset:13312
    s_waitcnt vmcnt(20)
    s_waitcnt lgkmcnt(6)
    v_mfma_f32_32x32x16_bf16 v[88:103], v[28:31], v[116:119], v[88:103]
    ds_read_b64_tr_b16 v[20:21], v5 offset:14336
    ds_read_b64_tr_b16 v[22:23], v5 offset:15360
    s_waitcnt vmcnt(19)
    s_waitcnt lgkmcnt(6)
    v_mfma_f32_32x32x16_bf16 v[88:103], v[32:35], v[120:123], v[88:103]
    ds_read_b64_tr_b16 v[24:25], v5 offset:16384
    ds_read_b64_tr_b16 v[26:27], v5 offset:17408
    s_waitcnt vmcnt(18)
    s_waitcnt lgkmcnt(6)
    v_mfma_f32_32x32x16_bf16 v[88:103], v[36:39], v[124:127], v[88:103]
    ds_read_b64_tr_b16 v[28:29], v5 offset:18432
    ds_read_b64_tr_b16 v[30:31], v5 offset:19456
    s_waitcnt vmcnt(17)
    s_waitcnt lgkmcnt(6)
    v_mfma_f32_32x32x16_bf16 v[88:103], v[16:19], v[128:131], v[88:103]
    ds_read_b64_tr_b16 v[32:33], v5 offset:20480
    ds_read_b64_tr_b16 v[34:35], v5 offset:21504
    s_waitcnt vmcnt(16)
    s_waitcnt lgkmcnt(6)
    v_mfma_f32_32x32x16_bf16 v[88:103], v[20:23], v[132:135], v[88:103]
    ds_read_b64_tr_b16 v[36:37], v5 offset:22528
    ds_read_b64_tr_b16 v[38:39], v5 offset:23552
    s_waitcnt vmcnt(15)
    s_waitcnt lgkmcnt(6)
    v_mfma_f32_32x32x16_bf16 v[88:103], v[24:27], v[136:139], v[88:103]
    ds_read_b64_tr_b16 v[16:17], v5 offset:24576
    ds_read_b64_tr_b16 v[18:19], v5 offset:25600
    s_waitcnt vmcnt(14)
    s_waitcnt lgkmcnt(6)
    v_mfma_f32_32x32x16_bf16 v[88:103], v[28:31], v[140:143], v[88:103]
    ds_read_b64_tr_b16 v[20:21], v5 offset:26624
    ds_read_b64_tr_b16 v[22:23], v5 offset:27648
    s_waitcnt vmcnt(13)
    s_waitcnt lgkmcnt(6)
    v_mfma_f32_32x32x16_bf16 v[88:103], v[32:35], v[144:147], v[88:103]
    ds_read_b64_tr_b16 v[24:25], v5 offset:28672
    ds_read_b64_tr_b16 v[26:27], v5 offset:29696
    s_waitcnt vmcnt(12)
    s_waitcnt lgkmcnt(6)
    v_mfma_f32_32x32x16_bf16 v[88:103], v[36:39], v[148:151], v[88:103]
    ds_read_b64_tr_b16 v[28:29], v5 offset:30720
    ds_read_b64_tr_b16 v[30:31], v5 offset:31744
    s_waitcnt vmcnt(11)
    s_waitcnt lgkmcnt(6)
    v_mfma_f32_32x32x16_bf16 v[88:103], v[16:19], v[152:155], v[88:103]
    ds_read_b64_tr_b16 v[32:33], v5 offset:32768
    ds_read_b64_tr_b16 v[34:35], v5 offset:33792
    s_waitcnt vmcnt(10)
    s_waitcnt lgkmcnt(6)
    v_mfma_f32_32x32x16_bf16 v[88:103], v[20:23], v[156:159], v[88:103]
    ds_read_b64_tr_b16 v[36:37], v5 offset:34816
    ds_read_b64_tr_b16 v[38:39], v5 offset:35840
    s_waitcnt vmcnt(9)
    s_waitcnt lgkmcnt(6)
    v_mfma_f32_32x32x16_bf16 v[88:103], v[24:27], v[160:163], v[88:103]
    ds_read_b64_tr_b16 v[16:17], v5 offset:36864
    ds_read_b64_tr_b16 v[18:19], v5 offset:37888
    s_waitcnt vmcnt(8)
    s_waitcnt lgkmcnt(6)
    v_mfma_f32_32x32x16_bf16 v[88:103], v[28:31], v[164:167], v[88:103]
    ds_read_b64_tr_b16 v[20:21], v5 offset:38912
    ds_read_b64_tr_b16 v[22:23], v5 offset:39936
    s_waitcnt vmcnt(7)
    s_waitcnt lgkmcnt(6)
    v_mfma_f32_32x32x16_bf16 v[88:103], v[32:35], v[168:171], v[88:103]
    ds_read_b64_tr_b16 v[24:25], v5 offset:40960
    ds_read_b64_tr_b16 v[26:27], v5 offset:41984
    s_waitcnt vmcnt(6)
    s_waitcnt lgkmcnt(6)
    v_mfma_f32_32x32x16_bf16 v[88:103], v[36:39], v[172:175], v[88:103]
    ds_read_b64_tr_b16 v[28:29], v5 offset:43008
    ds_read_b64_tr_b16 v[30:31], v5 offset:44032
    s_waitcnt vmcnt(5)
    s_waitcnt lgkmcnt(6)
    v_mfma_f32_32x32x16_bf16 v[88:103], v[16:19], v[176:179], v[88:103]
    ds_read_b64_tr_b16 v[32:33], v5 offset:45056
    ds_read_b64_tr_b16 v[34:35], v5 offset:46080
    s_waitcnt vmcnt(4)
    s_waitcnt lgkmcnt(6)
    v_mfma_f32_32x32x16_bf16 v[88:103], v[20:23], v[180:183], v[88:103]
    ds_read_b64_tr_b16 v[36:37], v5 offset:47104
    ds_read_b64_tr_b16 v[38:39], v5 offset:48128
    s_waitcnt vmcnt(3)
    s_waitcnt lgkmcnt(6)
    v_mfma_f32_32x32x16_bf16 v[88:103], v[24:27], v[184:187], v[88:103]
    s_waitcnt vmcnt(2)
    s_waitcnt lgkmcnt(4)
    v_mfma_f32_32x32x16_bf16 v[88:103], v[28:31], v[188:191], v[88:103]
    s_waitcnt vmcnt(1)
    s_waitcnt lgkmcnt(2)
    v_mfma_f32_32x32x16_bf16 v[88:103], v[32:35], v[192:195], v[88:103]
    s_waitcnt vmcnt(0)
    s_waitcnt lgkmcnt(0)
    v_mfma_f32_32x32x16_bf16 v[88:103], v[36:39], v[196:199], v[88:103]
    s_nop 11
    v_cvt_pk_bf16_f32 v72, v88, v89
    v_cvt_pk_bf16_f32 v73, v90, v91
    v_cvt_pk_bf16_f32 v74, v92, v93
    v_cvt_pk_bf16_f32 v75, v94, v95
    v_lshlrev_b32 v88, 16, v72
    v_and_b32 v89, 0xffff0000, v72
    v_lshlrev_b32 v90, 16, v73
    v_and_b32 v91, 0xffff0000, v73
    v_lshlrev_b32 v92, 16, v74
    v_and_b32 v93, 0xffff0000, v74
    v_lshlrev_b32 v94, 16, v75
    v_and_b32 v95, 0xffff0000, v75
    v_mul_f32 v48, v48, v88
    v_mul_f32 v49, v49, v89
    v_mul_f32 v50, v50, v90
    v_mul_f32 v51, v51, v91
    v_mul_f32 v52, v52, v92
    v_mul_f32 v53, v53, v93
    v_mul_f32 v54, v54, v94
    v_mul_f32 v55, v55, v95
    v_cvt_pk_bf16_f32 v72, v48, v49
    v_cvt_pk_bf16_f32 v73, v50, v51
    v_cvt_pk_bf16_f32 v74, v52, v53
    v_cvt_pk_bf16_f32 v75, v54, v55
    v_lshlrev_b32 v48, 16, v72
    v_and_b32 v49, 0xffff0000, v72
    v_lshlrev_b32 v50, 16, v73
    v_and_b32 v51, 0xffff0000, v73
    v_lshlrev_b32 v52, 16, v74
    v_and_b32 v53, 0xffff0000, v74
    v_lshlrev_b32 v54, 16, v75
    v_and_b32 v55, 0xffff0000, v75
    v_lshlrev_b32 v64, 16, v40
    v_and_b32 v65, 0xffff0000, v40
    v_lshlrev_b32 v66, 16, v41
    v_and_b32 v67, 0xffff0000, v41
    v_lshlrev_b32 v68, 16, v42
    v_and_b32 v69, 0xffff0000, v42
    v_lshlrev_b32 v70, 16, v43
    v_and_b32 v71, 0xffff0000, v43
    v_add_f32 v48, v48, v64
    v_add_f32 v49, v49, v65
    v_add_f32 v50, v50, v66
    v_add_f32 v51, v51, v67
    v_add_f32 v52, v52, v68
    v_add_f32 v53, v53, v69
    v_add_f32 v54, v54, v70
    v_add_f32 v55, v55, v71
    v_cvt_pk_bf16_f32 v72, v48, v49
    v_cvt_pk_bf16_f32 v73, v50, v51
    v_cvt_pk_bf16_f32 v74, v52, v53
    v_cvt_pk_bf16_f32 v75, v54, v55
    buffer_store_dwordx2 v[72:73], v13, s[44:47], s64 offen
    buffer_store_dwordx2 v[74:75], v13, s[44:47], s64 offen offset:16
    v_cvt_pk_bf16_f32 v76, v96, v97
    v_cvt_pk_bf16_f32 v77, v98, v99
    v_cvt_pk_bf16_f32 v78, v100, v101
    v_cvt_pk_bf16_f32 v79, v102, v103
    v_lshlrev_b32 v96, 16, v76
    v_and_b32 v97, 0xffff0000, v76
    v_lshlrev_b32 v98, 16, v77
    v_and_b32 v99, 0xffff0000, v77
    v_lshlrev_b32 v100, 16, v78
    v_and_b32 v101, 0xffff0000, v78
    v_lshlrev_b32 v102, 16, v79
    v_and_b32 v103, 0xffff0000, v79
    v_mul_f32 v56, v56, v96
    v_mul_f32 v57, v57, v97
    v_mul_f32 v58, v58, v98
    v_mul_f32 v59, v59, v99
    v_mul_f32 v60, v60, v100
    v_mul_f32 v61, v61, v101
    v_mul_f32 v62, v62, v102
    v_mul_f32 v63, v63, v103
    v_cvt_pk_bf16_f32 v76, v56, v57
    v_cvt_pk_bf16_f32 v77, v58, v59
    v_cvt_pk_bf16_f32 v78, v60, v61
    v_cvt_pk_bf16_f32 v79, v62, v63
    v_lshlrev_b32 v56, 16, v76
    v_and_b32 v57, 0xffff0000, v76
    v_lshlrev_b32 v58, 16, v77
    v_and_b32 v59, 0xffff0000, v77
    v_lshlrev_b32 v60, 16, v78
    v_and_b32 v61, 0xffff0000, v78
    v_lshlrev_b32 v62, 16, v79
    v_and_b32 v63, 0xffff0000, v79
    v_lshlrev_b32 v64, 16, v44
    v_and_b32 v65, 0xffff0000, v44
    v_lshlrev_b32 v66, 16, v45
    v_and_b32 v67, 0xffff0000, v45
    v_lshlrev_b32 v68, 16, v46
    v_and_b32 v69, 0xffff0000, v46
    v_lshlrev_b32 v70, 16, v47
    v_and_b32 v71, 0xffff0000, v47
    v_add_f32 v56, v56, v64
    v_add_f32 v57, v57, v65
    v_add_f32 v58, v58, v66
    v_add_f32 v59, v59, v67
    v_add_f32 v60, v60, v68
    v_add_f32 v61, v61, v69
    v_add_f32 v62, v62, v70
    v_add_f32 v63, v63, v71
    v_cvt_pk_bf16_f32 v76, v56, v57
    v_cvt_pk_bf16_f32 v77, v58, v59
    v_cvt_pk_bf16_f32 v78, v60, v61
    v_cvt_pk_bf16_f32 v79, v62, v63
    buffer_store_dwordx2 v[76:77], v13, s[44:47], s65 offen
    buffer_store_dwordx2 v[78:79], v13, s[44:47], s65 offen offset:16
L_a_fin:
    s_endpgm
L_k1_end:
    s_endpgm
.section .rodata,"a"
.p2align 6
.amdhsa_kernel recurrent_scan__sliding_block__glu_gated_glu__prompt_kernel
  .amdhsa_next_free_vgpr 256
  .amdhsa_next_free_sgpr 102
  .amdhsa_accum_offset 256
  .amdhsa_group_segment_fixed_size 0
  .amdhsa_kernarg_size 80
  .amdhsa_user_sgpr_count 2
  .amdhsa_user_sgpr_kernarg_segment_ptr 1
  .amdhsa_system_sgpr_workgroup_id_x 1
.end_amdhsa_kernel
```
